```python
import torch

def _softmax(x, axis=-1):
    return torch.softmax(x, dim=axis)
def _gelu(x):
    return torch.nn.functional.gelu(x, approximate="tanh")
def _silu(x):
    return torch.nn.functional.silu(x)
def _sigmoid(x):
    return torch.sigmoid(x)
def _layernorm(x, axis=-1, eps=1e-5):
    m = x.mean(dim=axis, keepdim=True)
    v = x.var(dim=axis, keepdim=True, unbiased=False)
    return (x - m) / torch.sqrt(v + eps)
def _scatter_add(tgt, idx, src, axis=0):
    return tgt.clone().index_add_(axis, idx, src)
def _segment_sum(src, seg, n):
    out = torch.zeros((n,) + src.shape[1:], dtype=src.dtype)
    return out.index_add_(0, seg, src)
def _pad(x, pw):
    flat = tuple(v for pair in reversed(pw) for v in pair)
    return torch.nn.functional.pad(x, flat)

kernel_name = 'gated_mix__softmax_full_mha__glu_gated_bilinear__prompt'

def setup_inputs():

    _w = (lambda a: (lambda t: t.to(torch.bfloat16) if t.is_floating_point() else t)(torch.as_tensor(a)))
    def _A_setup():
        B, S, D = 1, 2048, 512
        return {
            "x": _w((lambda *s: torch.randn(*s, dtype=torch.bfloat16) * 0.05)(B, S, D)),
            "wqkv": _w((lambda *s: torch.randn(*s, dtype=torch.bfloat16) * 0.8)(D, 3 * D)),
            "wo": _w((lambda *s: torch.randn(*s, dtype=torch.bfloat16) * 0.05)(D, D)),
        }
    _A_in = _A_setup()

    def _B_setup():
        B, S, D, F = 1, 2048, 512, 1792
        return {
            "x": _w((lambda *s: torch.randn(*s, dtype=torch.bfloat16) * 0.05)(B, S, D)),
            "w_gate": _w((lambda *s: torch.randn(*s, dtype=torch.bfloat16) * 1.6)(D, F) * (D ** -0.5)),
            "w_up": _w((lambda *s: torch.randn(*s, dtype=torch.bfloat16) * 1.6)(D, F) * (D ** -0.5)),
            "w_down": _w((lambda *s: torch.randn(*s, dtype=torch.bfloat16) * 1.6)(F, D) * (F ** -0.5)),
        }
    _B_in = _B_setup()

    return {
        "A_x": _A_in["x"],
        "A_wqkv": _A_in["wqkv"],
        "A_wo": _A_in["wo"],
        "B_x": _B_in["x"],
        "B_w_gate": _B_in["w_gate"],
        "B_w_up": _B_in["w_up"],
        "B_w_down": _B_in["w_down"],
        "gate_w": _w((lambda *s: torch.randn(*s, dtype=torch.bfloat16) * 0.05)(512) * 16.0),
    }

def reference(A_x, A_wqkv, A_wo, B_x, B_w_gate, B_w_up, B_w_down, gate_w):
    def _A_ref(x, wqkv, wo):
        B, S, D = x.shape
        H = 32; Dh = D // H
        qkv = (lambda x, *d: x.permute(*d))((x @ wqkv).reshape(B, S, 3, H, Dh), 2, 0, 3, 1, 4)
        q, k, v = qkv[0], qkv[1], qkv[2]
        scale = Dh ** -0.5
        scores = torch.einsum("bhqd,bhkd->bhqk", q, k) * scale
        p = _softmax(scores, axis=-1)
        o = torch.einsum("bhqk,bhkd->bhqd", p, v)
        return (lambda x, *d: x.permute(*d))(o, 0, 2, 1, 3).reshape(B, S, D) @ wo

    def _B_ref(x, w_gate, w_up, w_down):
        g = torch.einsum("bsd,df->bsf", x, w_gate)
        u = torch.einsum("bsd,df->bsf", x, w_up)
        h = g * u
        return torch.einsum("bsf,fd->bsd", h, w_down)

    x = A_x
    g = _sigmoid((x * gate_w).sum(-1, keepdims=True))
    a = _A_ref(x, A_wqkv, A_wo)
    b = _B_ref(x, B_w_gate, B_w_up, B_w_down)
    return g * a + (1 - g) * b
```

```asm
; @launch grid=(256,1,1) block=(512,1,1) lds=163840
.amdgcn_target "amdgcn-amd-amdhsa--gfx950"
.text
.globl gated_mix__softmax_full_mha__glu_gated_bilinear__prompt_kernel
.p2align 8
.type gated_mix__softmax_full_mha__glu_gated_bilinear__prompt_kernel,@function
gated_mix__softmax_full_mha__glu_gated_bilinear__prompt_kernel:
    s_cmp_ge_u32 s2, 256
    s_cbranch_scc1 K_end_x
    s_load_dwordx16 s[4:19], s[0:1], 0
    s_load_dwordx4 s[20:23], s[0:1], 64
    s_load_dwordx2 s[24:25], s[0:1], 80
    s_getpc_b64 s[62:63]
PC0:
    s_lshr_b32 s61, s2, 3
    v_lshrrev_b32 v1, 6, v0
    v_and_b32 v2, 3, v0
    v_lshl_add_u32 v1, v1, 2, v2
    v_lshl_add_u32 v1, s61, 5, v1
    v_lshlrev_b32 v1, 7, v1
    v_min_u32 v1, K_end_x-PC0, v1
    v_mov_b32 v43, s63
    v_add_co_u32 v42, vcc, s62, v1
    v_addc_co_u32 v43, vcc, 0, v43, vcc
    s_mov_b64 exec, 15
    global_load_dword v40, v[42:43], off
    s_mov_b64 exec, -1
    v_lshrrev_b32 v1, 6, v0
    s_and_b32 s60, s2, 7
    v_readfirstlane_b32 s27, v1
    v_and_b32 v0, 63, v0
    s_and_b32 s48, s60, 3
    s_lshl_b32 s48, s48, 2
    s_bfe_u32 s62, s2, 0x20003
    s_add_u32 s48, s48, s62
    s_lshl_b32 s3, s60, 1
    s_and_b32 s63, s60, 4
    s_add_u32 s3, s3, s63
    v_lshrrev_b32 v30, 3, v0
    v_and_b32 v31, 7, v0
    v_lshrrev_b32 v32, 4, v0
    v_xor_b32 v32, v32, v31
    v_lshlrev_b32 v30, 10, v30
    v_lshl_add_u32 v11, v32, 4, v30
    v_xor_b32 v12, 64, v11
    s_lshl_b32 s54, s48, 17
    s_lshl_b32 s62, s27, 14
    s_add_u32 s54, s54, s62
    s_lshl_b32 s57, s27, 11
    s_mov_b32 s34, 0x200000
    s_mov_b32 s35, 0x00020000
    s_waitcnt lgkmcnt(0)
    s_mov_b32 s32, s4
    s_and_b32 s33, s5, 0xffff
    s_and_b32 s45, s15, 0xffff
    s_and_b32 s73, s19, 0xffff
    s_add_u32 s19, s3, 0
    s_and_b32 s19, s19, 7
    s_lshl_b32 s15, s19, 7
    s_add_u32 s15, s15, s54
    s_mul_i32 s19, s19, 196608
    s_add_u32 m0, s57, 0
    s_add_u32 s60, s15, 0
    buffer_load_dwordx4 v11, s[32:35], s60 offen lds
    s_add_u32 m0, s57, 1024
    s_add_u32 s60, s15, 8192
    buffer_load_dwordx4 v12, s[32:35], s60 offen lds
    v_lshlrev_b32 v1, 4, v0
    s_lshr_b32 s61, s2, 5
    s_bfe_u32 s62, s2, 0x10002
    s_lshl_b32 s49, s62, 3
    s_add_u32 s49, s49, s61
    s_mul_i32 s50, s62, 7
    s_min_u32 s63, s61, 6
    s_add_u32 s50, s50, s63
    s_cmp_lt_u32 s61, 7
    s_cselect_b32 s53, 1, 0
    s_and_b32 s51, s27, 3
    s_lshr_b32 s52, s27, 2
    s_mul_i32 s55, s51, 49152
    s_mul_i32 s62, s49, 192
    s_add_u32 s55, s55, s62
    s_mul_i32 s58, s51, 3072
    v_add_u32 v30, 0, v0
    v_mul_u32_u24 v31, 5462, v30
    v_lshrrev_b32 v31, 16, v31
    v_mul_u32_u24 v32, 12, v31
    v_sub_u32 v32, v30, v32
    v_mul_u32_u24 v31, 3072, v31
    v_lshl_add_u32 v13, v32, 4, v31
    v_add_u32 v30, 64, v0
    v_mul_u32_u24 v31, 5462, v30
    v_lshrrev_b32 v31, 16, v31
    v_mul_u32_u24 v32, 12, v31
    v_sub_u32 v32, v30, v32
    v_mul_u32_u24 v31, 3072, v31
    v_lshl_add_u32 v14, v32, 4, v31
    v_add_u32 v30, 128, v0
    v_mul_u32_u24 v31, 5462, v30
    v_lshrrev_b32 v31, 16, v31
    v_mul_u32_u24 v32, 12, v31
    v_sub_u32 v32, v30, v32
    v_mul_u32_u24 v31, 3072, v31
    v_lshl_add_u32 v15, v32, 4, v31
    s_mov_b32 s36, s6
    s_and_b32 s37, s7, 0xffff
    s_mov_b32 s38, 0x180000
    s_mov_b32 s39, 0x00020000
    s_cmp_eq_u32 s52, 0
    s_cbranch_scc1 PRO0
    s_add_u32 m0, s58, 17408
    s_add_u32 s60, s55, s19
    buffer_load_dwordx4 v14, s[36:39], s60 offen lds
    s_add_u32 m0, s58, 18432
    s_add_u32 s60, s55, s19
    buffer_load_dwordx4 v15, s[36:39], s60 offen lds
    s_branch PRO1
PRO0:
    s_add_u32 m0, s58, 16384
    s_add_u32 s60, s55, s19
    buffer_load_dwordx4 v13, s[36:39], s60 offen lds
PRO1:
    s_and_b32 s60, s2, 7
    s_lshl_b32 s69, s2, 3
    s_add_u32 s69, s69, s27
    s_lshl_b32 s70, s49, 4
    s_add_u32 s70, s70, s48
    s_lshl_b32 s70, s70, 7
    s_add_u32 s70, s70, 0xf10000
    s_mul_i32 s56, s27, 28672
    s_lshl_b32 s62, s50, 8
    s_add_u32 s56, s56, s62
    s_lshl_b32 s59, s27, 11
    s_lshl_b32 s64, s60, 2
    s_bfe_u32 s62, s2, 0x20003
    s_add_u32 s64, s64, s62
    s_lshr_b32 s65, s2, 5
    s_lshl_b32 s68, s64, 6
    s_lshl_b32 s62, s65, 3
    s_add_u32 s68, s68, s62
    s_lshl_b32 s62, s51, 1
    s_add_u32 s68, s68, s62
    s_add_u32 s68, s68, s52
    s_lshl_b32 s68, s68, 10
    s_lshl_b32 s66, s64, 17
    s_add_u32 s66, s66, 0x200000
    s_lshl_b32 s62, s52, 16
    s_add_u32 s66, s66, s62
    s_lshl_b32 s62, s51, 11
    s_add_u32 s66, s66, s62
    s_mul_i32 s67, s52, 16640
    s_mul_i32 s62, s51, 2080
    s_add_u32 s67, s67, s62
    s_add_u32 s67, s67, 32768
    v_lshrrev_b32 v30, 4, v0
    v_and_b32 v31, 15, v0
    v_lshlrev_b32 v32, 1, v30
    v_xor_b32 v31, v31, v32
    v_mul_u32_u24 v30, 3584, v30
    v_lshl_add_u32 v28, v31, 4, v30
    v_xor_b32 v31, 8, v31
    v_lshl_add_u32 v29, v31, 4, v30
    s_mov_b32 s44, s14
    s_mov_b32 s46, 0x1c0000
    s_mov_b32 s47, 0x00020000
    s_mov_b32 s72, s18
    s_mov_b32 s74, 1024
    s_mov_b32 s75, 0x00020000
    s_mov_b32 s28, s24
    s_and_b32 s29, s25, 0xffff
    s_mov_b32 s30, 0x17b0000
    s_mov_b32 s31, 0x00020000
    s_mov_b32 s40, s12
    s_and_b32 s41, s13, 0xffff
    s_mov_b32 s42, 0x1c0000
    s_mov_b32 s43, 0x00020000
    s_sub_u32 s60, 11, s52
    s_cmp_ge_u32 s49, s60
    s_cselect_b32 s60, 2, 0
    s_lshl_b32 s61, s52, 2
    s_add_u32 s60, s60, s61
    s_xor_b32 s61, s53, 1
    s_add_u32 s60, s60, s61
    s_cmp_eq_u32 s60, 0
    s_cbranch_scc1 CLS0
    s_cmp_eq_u32 s60, 6
    s_cbranch_scc1 CLS6
    s_cmp_eq_u32 s60, 2
    s_cbranch_scc1 CLS2
    s_cmp_eq_u32 s60, 5
    s_cbranch_scc1 CLS5
    s_cmp_eq_u32 s60, 1
    s_cbranch_scc1 CLS1
    s_cmp_eq_u32 s60, 7
    s_cbranch_scc1 CLS7
    s_cmp_eq_u32 s60, 3
    s_cbranch_scc1 CLS3
CLS4:
    s_add_u32 s71, s3, 0
    s_and_b32 s71, s71, 7
    s_mul_i32 s71, s71, 229376
    s_add_u32 s71, s71, s56
    s_add_u32 m0, s59, 32768
    s_add_u32 s60, s71, 0
    buffer_load_dwordx4 v28, s[40:43], s60 offen lds
    s_add_u32 m0, s59, 49152
    s_add_u32 s60, s71, 0
    buffer_load_dwordx4 v29, s[44:47], s60 offen lds
    s_add_u32 m0, s59, 33792
    s_add_u32 s60, s71, 14336
    buffer_load_dwordx4 v28, s[40:43], s60 offen lds
    s_add_u32 m0, s59, 50176
    s_add_u32 s60, s71, 14336
    buffer_load_dwordx4 v29, s[44:47], s60 offen lds
    v_mov_b32 v24, 0
    s_mov_b32 s60, 0xf04000
    buffer_load_dword v25, v24, s[28:31], s60 offen sc1
    s_lshl_b32 s60, s69, 10
    buffer_load_dwordx4 v[16:19], v1, s[72:75], 0 offen
    buffer_load_dwordx4 v[20:23], v1, s[32:35], s60 offen
    s_and_b32 s60, s2, 7
    s_lshr_b32 s61, s2, 3
    s_lshl_b32 s4, s60, 2
    s_and_b32 s60, s61, 3
    s_add_u32 s4, s4, s60
    s_lshr_b32 s5, s61, 2
    s_mov_b32 s0, 0xffff
    s_mov_b32 s1, 0xffff
    s_and_b32 s13, s27, 1
    s_lshr_b32 s14, s27, 1
    s_mul_i32 s60, s4, 224
    s_mul_i32 s61, s27, 14
    s_add_u32 s60, s60, s61
    s_lshl_b32 s6, s60, 10
    s_add_u32 s6, s6, 0x800000
    s_lshl_b32 s7, s61, 14
    s_lshl_b32 s60, s5, 7
    s_add_u32 s7, s7, s60
    s_lshl_b32 s10, s27, 16
    s_add_u32 s10, s10, s60
    s_lshl_b32 s11, s51, 13
    s_lshl_b32 s60, s52, 17
    s_add_u32 s11, s11, s60
    s_lshl_b32 s60, s48, 2
    s_add_u32 s60, s60, s51
    s_lshl_b32 s60, s60, 5
    s_lshl_b32 s61, s50, 1
    s_add_u32 s60, s60, s61
    s_add_u32 s60, s60, s52
    s_lshl_b32 s60, s60, 7
    s_add_u32 s12, s60, 0xf70000
    s_lshl_b32 s60, s65, 3
    s_lshl_b32 s61, s51, 1
    s_add_u32 s60, s60, s61
    s_add_u32 s60, s60, s52
    s_lshl_b32 s60, s60, 5
    s_add_u32 s60, s60, s64
    s_lshl_b32 s18, s60, 10
    s_add_u32 s18, s18, 0x600000
    v_and_b32 v30, 31, v0
    v_lshrrev_b32 v31, 5, v0
    v_bfe_u32 v32, v0, 1, 3
    v_xor_b32 v32, v32, v31
    s_lshl_b32 s60, s51, 12
    v_lshlrev_b32 v33, 7, v30
    v_add_u32 v33, s60, v33
    v_xor_b32 v34, 0, v32
    v_lshl_add_u32 v2, v34, 4, v33
    v_xor_b32 v34, 2, v32
    v_lshl_add_u32 v3, v34, 4, v33
    v_xor_b32 v34, 4, v32
    v_lshl_add_u32 v4, v34, 4, v33
    v_xor_b32 v34, 6, v32
    v_lshl_add_u32 v5, v34, 4, v33
    v_bfe_u32 v32, v0, 2, 2
    v_lshl_add_u32 v33, v31, 3, v32
    v_mul_u32_u24 v34, 192, v33
    v_bfe_u32 v35, v0, 4, 1
    v_lshl_add_u32 v34, v35, 5, v34
    v_and_b32 v36, 3, v0
    v_lshl_add_u32 v34, v36, 3, v34
    v_add_u32 v6, 16512, v34
    v_lshlrev_b32 v33, 8, v33
    v_lshl_add_u32 v33, v35, 14, v33
    v_lshl_add_u32 v33, v36, 3, v33
    v_bfe_u32 v32, v0, 2, 3
    v_xor_b32 v34, 4, v32
    v_lshl_add_u32 v7, v34, 5, v33
    v_xor_b32 v34, 5, v32
    v_lshl_add_u32 v8, v34, 5, v33
    v_xor_b32 v34, 6, v32
    v_lshl_add_u32 v9, v34, 5, v33
    v_xor_b32 v34, 7, v32
    v_lshl_add_u32 v10, v34, 5, v33
    s_waitcnt vmcnt(7)
    s_barrier
    ds_read_b128 v[160:163], v2 offset:0
    ds_read_b64_tr_b16 v[32:33], v6 offset:0
    ds_read_b64_tr_b16 v[34:35], v6 offset:768
    ds_read_b128 v[164:167], v3 offset:0
    ds_read_b64_tr_b16 v[40:41], v6 offset:3072
    ds_read_b64_tr_b16 v[42:43], v6 offset:3840
    ds_read_b128 v[168:171], v4 offset:0
    ds_read_b64_tr_b16 v[48:49], v6 offset:6144
    ds_read_b64_tr_b16 v[50:51], v6 offset:6912
    ds_read_b128 v[172:175], v5 offset:0
    ds_read_b64_tr_b16 v[56:57], v6 offset:9216
    ds_read_b64_tr_b16 v[58:59], v6 offset:9984
    s_add_u32 s19, s3, 1
    s_and_b32 s19, s19, 7
    s_lshl_b32 s15, s19, 7
    s_add_u32 s15, s15, s54
    s_mul_i32 s19, s19, 196608
    s_add_u32 m0, s57, 65536
    s_add_u32 s60, s15, 0
    buffer_load_dwordx4 v11, s[32:35], s60 offen lds
    s_add_u32 m0, s57, 66560
    s_add_u32 s60, s15, 8192
    buffer_load_dwordx4 v12, s[32:35], s60 offen lds
    s_add_u32 m0, s58, 82944
    s_add_u32 s60, s55, s19
    buffer_load_dwordx4 v14, s[36:39], s60 offen lds
    s_waitcnt lgkmcnt(9)
    v_mfma_f32_32x32x16_bf16 v[128:143], v[32:35], v[160:163], 0
    s_waitcnt lgkmcnt(6)
    v_mfma_f32_32x32x16_bf16 v[128:143], v[40:43], v[164:167], v[128:143]
    s_add_u32 m0, s58, 83968
    s_add_u32 s60, s55, s19
    buffer_load_dwordx4 v15, s[36:39], s60 offen lds
    s_waitcnt vmcnt(7) lgkmcnt(0)
    s_barrier
    v_mfma_f32_32x32x16_bf16 v[128:143], v[48:51], v[168:171], v[128:143]
    ds_read_b64_tr_b16 v[32:33], v7 offset:32768
    ds_read_b64_tr_b16 v[34:35], v7 offset:33792
    ds_read_b64_tr_b16 v[36:37], v8 offset:32768
    ds_read_b64_tr_b16 v[38:39], v8 offset:33792
    v_mfma_f32_32x32x16_bf16 v[128:143], v[56:59], v[172:175], v[128:143]
    ds_read_b64_tr_b16 v[40:41], v9 offset:32768
    ds_read_b64_tr_b16 v[42:43], v9 offset:33792
    ds_read_b64_tr_b16 v[44:45], v10 offset:32768
    ds_read_b64_tr_b16 v[46:47], v10 offset:33792
    s_add_u32 s19, s3, 2
    s_and_b32 s19, s19, 7
    s_lshl_b32 s15, s19, 7
    s_add_u32 s15, s15, s54
    s_mul_i32 s19, s19, 196608
    s_add_u32 m0, s57, 98304
    s_add_u32 s60, s15, 0
    buffer_load_dwordx4 v11, s[32:35], s60 offen lds
    s_add_u32 m0, s57, 99328
    s_add_u32 s60, s15, 8192
    buffer_load_dwordx4 v12, s[32:35], s60 offen lds
    s_waitcnt lgkmcnt(0)
    v_mfma_f32_32x32x16_bf16 v[64:79], v[32:35], v[160:163], 0
    ds_read_b64_tr_b16 v[48:49], v7 offset:36864
    ds_read_b64_tr_b16 v[50:51], v7 offset:37888
    ds_read_b64_tr_b16 v[52:53], v8 offset:36864
    ds_read_b64_tr_b16 v[54:55], v8 offset:37888
    v_mfma_f32_32x32x16_bf16 v[80:95], v[36:39], v[160:163], 0
    ds_read_b64_tr_b16 v[56:57], v9 offset:36864
    ds_read_b64_tr_b16 v[58:59], v9 offset:37888
    ds_read_b64_tr_b16 v[60:61], v10 offset:36864
    ds_read_b64_tr_b16 v[62:63], v10 offset:37888
    v_mfma_f32_32x32x16_bf16 v[96:111], v[40:43], v[160:163], 0
    s_add_u32 m0, s58, 115712
    s_add_u32 s60, s55, s19
    buffer_load_dwordx4 v14, s[36:39], s60 offen lds
    v_mfma_f32_32x32x16_bf16 v[112:127], v[44:47], v[160:163], 0
    s_add_u32 m0, s58, 116736
    s_add_u32 s60, s55, s19
    buffer_load_dwordx4 v15, s[36:39], s60 offen lds
    s_waitcnt lgkmcnt(0)
    v_mfma_f32_32x32x16_bf16 v[64:79], v[48:51], v[164:167], v[64:79]
    ds_read_b64_tr_b16 v[32:33], v7 offset:40960
    ds_read_b64_tr_b16 v[34:35], v7 offset:41984
    ds_read_b64_tr_b16 v[36:37], v8 offset:40960
    ds_read_b64_tr_b16 v[38:39], v8 offset:41984
    v_mfma_f32_32x32x16_bf16 v[80:95], v[52:55], v[164:167], v[80:95]
    ds_read_b64_tr_b16 v[40:41], v9 offset:40960
    ds_read_b64_tr_b16 v[42:43], v9 offset:41984
    ds_read_b64_tr_b16 v[44:45], v10 offset:40960
    ds_read_b64_tr_b16 v[46:47], v10 offset:41984
    v_mfma_f32_32x32x16_bf16 v[96:111], v[56:59], v[164:167], v[96:111]
    s_add_u32 s19, s3, 3
    s_and_b32 s19, s19, 7
    s_lshl_b32 s15, s19, 7
    s_add_u32 s15, s15, s54
    s_mul_i32 s19, s19, 196608
    s_add_u32 m0, s57, 131072
    s_add_u32 s60, s15, 0
    buffer_load_dwordx4 v11, s[32:35], s60 offen lds
    v_mfma_f32_32x32x16_bf16 v[112:127], v[60:63], v[164:167], v[112:127]
    s_add_u32 m0, s57, 132096
    s_add_u32 s60, s15, 8192
    buffer_load_dwordx4 v12, s[32:35], s60 offen lds
    s_waitcnt lgkmcnt(0)
    v_mfma_f32_32x32x16_bf16 v[64:79], v[32:35], v[168:171], v[64:79]
    ds_read_b64_tr_b16 v[48:49], v7 offset:45056
    ds_read_b64_tr_b16 v[50:51], v7 offset:46080
    ds_read_b64_tr_b16 v[52:53], v8 offset:45056
    ds_read_b64_tr_b16 v[54:55], v8 offset:46080
    v_mfma_f32_32x32x16_bf16 v[80:95], v[36:39], v[168:171], v[80:95]
    ds_read_b64_tr_b16 v[56:57], v9 offset:45056
    ds_read_b64_tr_b16 v[58:59], v9 offset:46080
    ds_read_b64_tr_b16 v[60:61], v10 offset:45056
    ds_read_b64_tr_b16 v[62:63], v10 offset:46080
    v_mfma_f32_32x32x16_bf16 v[96:111], v[40:43], v[168:171], v[96:111]
    s_add_u32 m0, s58, 148480
    s_add_u32 s60, s55, s19
    buffer_load_dwordx4 v14, s[36:39], s60 offen lds
    v_mfma_f32_32x32x16_bf16 v[112:127], v[44:47], v[168:171], v[112:127]
    s_add_u32 m0, s58, 149504
    s_add_u32 s60, s55, s19
    buffer_load_dwordx4 v15, s[36:39], s60 offen lds
    s_waitcnt vmcnt(12)
    s_mov_b32 s63, 0xffff0000
    v_lshlrev_b32 v30, 16, v16
    v_and_b32 v16, s63, v16
    v_lshlrev_b32 v31, 16, v20
    v_and_b32 v20, s63, v20
    v_mul_f32 v30, v30, v31
    v_mul_f32 v31, v16, v20
    v_cvt_pk_bf16_f32 v30, v30, v31
    v_and_b32 v31, s63, v30
    v_lshlrev_b32 v30, 16, v30
    v_add_f32 v26, v30, v31
    v_lshlrev_b32 v30, 16, v17
    v_and_b32 v17, s63, v17
    v_lshlrev_b32 v31, 16, v21
    v_and_b32 v21, s63, v21
    v_mul_f32 v30, v30, v31
    v_mul_f32 v31, v17, v21
    v_cvt_pk_bf16_f32 v30, v30, v31
    v_and_b32 v31, s63, v30
    v_lshlrev_b32 v30, 16, v30
    v_add_f32 v26, v26, v30
    v_add_f32 v26, v26, v31
    v_lshlrev_b32 v30, 16, v18
    v_and_b32 v18, s63, v18
    v_lshlrev_b32 v31, 16, v22
    v_and_b32 v22, s63, v22
    v_mul_f32 v30, v30, v31
    v_mul_f32 v31, v18, v22
    v_cvt_pk_bf16_f32 v30, v30, v31
    v_and_b32 v31, s63, v30
    v_lshlrev_b32 v30, 16, v30
    v_add_f32 v26, v26, v30
    v_add_f32 v26, v26, v31
    v_lshlrev_b32 v30, 16, v19
    v_and_b32 v19, s63, v19
    v_lshlrev_b32 v31, 16, v23
    v_and_b32 v23, s63, v23
    v_mul_f32 v30, v30, v31
    v_mul_f32 v31, v19, v23
    v_cvt_pk_bf16_f32 v30, v30, v31
    v_and_b32 v31, s63, v30
    v_lshlrev_b32 v30, 16, v30
    v_add_f32 v26, v26, v30
    v_add_f32 v26, v26, v31
    s_nop 1
    v_add_f32_dpp v26, v26, v26 row_ror:8 row_mask:0xf bank_mask:0xf
    s_nop 1
    v_add_f32_dpp v26, v26, v26 row_ror:4 row_mask:0xf bank_mask:0xf
    s_nop 1
    v_add_f32_dpp v26, v26, v26 row_ror:2 row_mask:0xf bank_mask:0xf
    s_nop 1
    v_add_f32_dpp v26, v26, v26 row_ror:1 row_mask:0xf bank_mask:0xf
    s_nop 1
    v_readlane_b32 s60, v26, 0
    v_readlane_b32 s61, v26, 16
    v_readlane_b32 s62, v26, 32
    v_readlane_b32 s63, v26, 48
    s_nop 1
    v_mov_b32 v26, s60
    v_add_f32 v26, s61, v26
    v_add_f32 v26, s62, v26
    v_add_f32 v26, s63, v26
    v_cvt_pk_bf16_f32 v26, v26, v26
    v_lshlrev_b32 v26, 16, v26
    v_mul_f32 v26, 0xbfb8aa3b, v26
    v_exp_f32 v26, v26
    s_nop 0
    v_add_f32 v26, 1.0, v26
    v_rcp_f32 v26, v26
    s_nop 0
    v_cvt_pk_bf16_f32 v26, v26, v26
    v_lshlrev_b32 v26, 16, v26
    s_mov_b32 s72, s22
    s_and_b32 s73, s23, 0xffff
    s_mov_b32 s74, 0x100
    s_mov_b32 s75, 0x00020000
    buffer_load_dword v16, v24, s[72:75], 0 offen sc1
    s_waitcnt vmcnt(9) lgkmcnt(0)
    s_barrier
    v_add_u32 v2, 0x10000, v2
    v_add_u32 v3, 0x10000, v3
    v_add_u32 v4, 0x10000, v4
    v_add_u32 v5, 0x10000, v5
    v_add_u32 v6, 0x10000, v6
    ds_read_b128 v[176:179], v2 offset:0
    ds_read_b64_tr_b16 v[32:33], v6 offset:0
    ds_read_b64_tr_b16 v[34:35], v6 offset:768
    v_mfma_f32_32x32x16_bf16 v[64:79], v[48:51], v[172:175], v[64:79]
    v_mfma_f32_32x32x16_bf16 v[80:95], v[52:55], v[172:175], v[80:95]
    ds_read_b128 v[180:183], v3 offset:0
    ds_read_b64_tr_b16 v[40:41], v6 offset:3072
    ds_read_b64_tr_b16 v[42:43], v6 offset:3840
    v_mfma_f32_32x32x16_bf16 v[96:111], v[56:59], v[172:175], v[96:111]
    v_mfma_f32_32x32x16_bf16 v[112:127], v[60:63], v[172:175], v[112:127]
    ds_read_b128 v[184:187], v4 offset:0
    ds_read_b64_tr_b16 v[48:49], v6 offset:6144
    ds_read_b64_tr_b16 v[50:51], v6 offset:6912
    ds_read_b128 v[188:191], v5 offset:0
    ds_read_b64_tr_b16 v[56:57], v6 offset:9216
    ds_read_b64_tr_b16 v[58:59], v6 offset:9984
    s_add_u32 s71, s3, 1
    s_and_b32 s71, s71, 7
    s_mul_i32 s71, s71, 229376
    s_add_u32 s71, s71, s56
    s_add_u32 m0, s59, 0
    s_add_u32 s60, s71, 0
    buffer_load_dwordx4 v28, s[40:43], s60 offen lds
    s_add_u32 m0, s59, 16384
    s_add_u32 s60, s71, 0
    buffer_load_dwordx4 v29, s[44:47], s60 offen lds
    s_add_u32 m0, s59, 1024
    s_add_u32 s60, s71, 14336
    buffer_load_dwordx4 v28, s[40:43], s60 offen lds
    s_waitcnt lgkmcnt(9)
    v_mfma_f32_32x32x16_bf16 v[128:143], v[32:35], v[176:179], v[128:143]
    s_waitcnt lgkmcnt(6)
    v_mfma_f32_32x32x16_bf16 v[128:143], v[40:43], v[180:183], v[128:143]
    s_waitcnt vmcnt(8) lgkmcnt(0)
    s_barrier
    ds_read_b128 v[192:195], v2 offset:32768
    ds_read_b64_tr_b16 v[32:33], v6 offset:32768
    ds_read_b64_tr_b16 v[34:35], v6 offset:33536
    v_mfma_f32_32x32x16_bf16 v[128:143], v[48:51], v[184:187], v[128:143]
    ds_read_b128 v[196:199], v3 offset:32768
    ds_read_b64_tr_b16 v[40:41], v6 offset:35840
    ds_read_b64_tr_b16 v[42:43], v6 offset:36608
    v_mfma_f32_32x32x16_bf16 v[128:143], v[56:59], v[188:191], v[128:143]
    ds_read_b128 v[200:203], v4 offset:32768
    ds_read_b64_tr_b16 v[48:49], v6 offset:38912
    ds_read_b64_tr_b16 v[50:51], v6 offset:39680
    ds_read_b128 v[204:207], v5 offset:32768
    ds_read_b64_tr_b16 v[56:57], v6 offset:41984
    ds_read_b64_tr_b16 v[58:59], v6 offset:42752
    s_add_u32 m0, s59, 17408
    s_add_u32 s60, s71, 14336
    buffer_load_dwordx4 v29, s[44:47], s60 offen lds
    s_add_u32 s19, s3, 4
    s_and_b32 s19, s19, 7
    s_lshl_b32 s15, s19, 7
    s_add_u32 s15, s15, s54
    s_mul_i32 s19, s19, 196608
    s_add_u32 m0, s57, 32768
    s_add_u32 s60, s15, 0
    buffer_load_dwordx4 v11, s[32:35], s60 offen lds
    s_add_u32 m0, s57, 33792
    s_add_u32 s60, s15, 8192
    buffer_load_dwordx4 v12, s[32:35], s60 offen lds
    s_waitcnt lgkmcnt(9)
    v_mfma_f32_32x32x16_bf16 v[128:143], v[32:35], v[192:195], v[128:143]
    s_waitcnt lgkmcnt(6)
    v_mfma_f32_32x32x16_bf16 v[128:143], v[40:43], v[196:199], v[128:143]
    s_waitcnt vmcnt(7) lgkmcnt(0)
    s_barrier
    v_add_u32 v2, 0x10000, v2
    v_add_u32 v3, 0x10000, v3
    v_add_u32 v4, 0x10000, v4
    v_add_u32 v5, 0x10000, v5
    v_add_u32 v6, 0x10000, v6
    ds_read_b128 v[208:211], v2 offset:0
    ds_read_b64_tr_b16 v[32:33], v6 offset:0
    ds_read_b64_tr_b16 v[34:35], v6 offset:768
    v_mfma_f32_32x32x16_bf16 v[128:143], v[48:51], v[200:203], v[128:143]
    ds_read_b128 v[212:215], v3 offset:0
    ds_read_b64_tr_b16 v[40:41], v6 offset:3072
    ds_read_b64_tr_b16 v[42:43], v6 offset:3840
    v_mfma_f32_32x32x16_bf16 v[128:143], v[56:59], v[204:207], v[128:143]
    ds_read_b128 v[216:219], v4 offset:0
    ds_read_b64_tr_b16 v[48:49], v6 offset:6144
    ds_read_b64_tr_b16 v[50:51], v6 offset:6912
    ds_read_b128 v[220:223], v5 offset:0
    ds_read_b64_tr_b16 v[56:57], v6 offset:9216
    ds_read_b64_tr_b16 v[58:59], v6 offset:9984
    s_add_u32 m0, s58, 50176
    s_add_u32 s60, s55, s19
    buffer_load_dwordx4 v14, s[36:39], s60 offen lds
    s_add_u32 m0, s58, 51200
    s_add_u32 s60, s55, s19
    buffer_load_dwordx4 v15, s[36:39], s60 offen lds
    s_add_u32 s19, s3, 5
    s_and_b32 s19, s19, 7
    s_lshl_b32 s15, s19, 7
    s_add_u32 s15, s15, s54
    s_mul_i32 s19, s19, 196608
    s_add_u32 m0, s57, 65536
    s_add_u32 s60, s15, 0
    buffer_load_dwordx4 v11, s[32:35], s60 offen lds
    s_waitcnt lgkmcnt(9)
    v_mfma_f32_32x32x16_bf16 v[128:143], v[32:35], v[208:211], v[128:143]
    s_waitcnt lgkmcnt(6)
    v_mfma_f32_32x32x16_bf16 v[128:143], v[40:43], v[212:215], v[128:143]
    s_waitcnt vmcnt(5) lgkmcnt(0)
    s_barrier
    v_mfma_f32_32x32x16_bf16 v[128:143], v[48:51], v[216:219], v[128:143]
    ds_read_b64_tr_b16 v[32:33], v7 offset:0
    ds_read_b64_tr_b16 v[34:35], v7 offset:1024
    ds_read_b64_tr_b16 v[36:37], v8 offset:0
    ds_read_b64_tr_b16 v[38:39], v8 offset:1024
    v_mfma_f32_32x32x16_bf16 v[128:143], v[56:59], v[220:223], v[128:143]
    ds_read_b64_tr_b16 v[40:41], v9 offset:0
    ds_read_b64_tr_b16 v[42:43], v9 offset:1024
    ds_read_b64_tr_b16 v[44:45], v10 offset:0
    ds_read_b64_tr_b16 v[46:47], v10 offset:1024
    s_add_u32 m0, s57, 66560
    s_add_u32 s60, s15, 8192
    buffer_load_dwordx4 v12, s[32:35], s60 offen lds
    s_add_u32 m0, s58, 82944
    s_add_u32 s60, s55, s19
    buffer_load_dwordx4 v14, s[36:39], s60 offen lds
    s_waitcnt lgkmcnt(0)
    v_mfma_f32_32x32x16_bf16 v[64:79], v[32:35], v[176:179], v[64:79]
    ds_read_b64_tr_b16 v[48:49], v7 offset:4096
    ds_read_b64_tr_b16 v[50:51], v7 offset:5120
    ds_read_b64_tr_b16 v[52:53], v8 offset:4096
    ds_read_b64_tr_b16 v[54:55], v8 offset:5120
    v_mfma_f32_32x32x16_bf16 v[80:95], v[36:39], v[176:179], v[80:95]
    ds_read_b64_tr_b16 v[56:57], v9 offset:4096
    ds_read_b64_tr_b16 v[58:59], v9 offset:5120
    ds_read_b64_tr_b16 v[60:61], v10 offset:4096
    ds_read_b64_tr_b16 v[62:63], v10 offset:5120
    v_mfma_f32_32x32x16_bf16 v[96:111], v[40:43], v[176:179], v[96:111]
    s_add_u32 m0, s58, 83968
    s_add_u32 s60, s55, s19
    buffer_load_dwordx4 v15, s[36:39], s60 offen lds
    v_mfma_f32_32x32x16_bf16 v[112:127], v[44:47], v[176:179], v[112:127]
    s_add_u32 s19, s3, 6
    s_and_b32 s19, s19, 7
    s_lshl_b32 s15, s19, 7
    s_add_u32 s15, s15, s54
    s_mul_i32 s19, s19, 196608
    s_add_u32 m0, s57, 98304
    s_add_u32 s60, s15, 0
    buffer_load_dwordx4 v11, s[32:35], s60 offen lds
    s_waitcnt lgkmcnt(0)
    v_mfma_f32_32x32x16_bf16 v[64:79], v[48:51], v[180:183], v[64:79]
    ds_read_b64_tr_b16 v[32:33], v7 offset:8192
    ds_read_b64_tr_b16 v[34:35], v7 offset:9216
    ds_read_b64_tr_b16 v[36:37], v8 offset:8192
    ds_read_b64_tr_b16 v[38:39], v8 offset:9216
    v_mfma_f32_32x32x16_bf16 v[80:95], v[52:55], v[180:183], v[80:95]
    ds_read_b64_tr_b16 v[40:41], v9 offset:8192
    ds_read_b64_tr_b16 v[42:43], v9 offset:9216
    ds_read_b64_tr_b16 v[44:45], v10 offset:8192
    ds_read_b64_tr_b16 v[46:47], v10 offset:9216
    v_mfma_f32_32x32x16_bf16 v[96:111], v[56:59], v[180:183], v[96:111]
    s_add_u32 m0, s57, 99328
    s_add_u32 s60, s15, 8192
    buffer_load_dwordx4 v12, s[32:35], s60 offen lds
    v_mfma_f32_32x32x16_bf16 v[112:127], v[60:63], v[180:183], v[112:127]
    s_add_u32 m0, s58, 115712
    s_add_u32 s60, s55, s19
    buffer_load_dwordx4 v14, s[36:39], s60 offen lds
    s_waitcnt lgkmcnt(0)
    v_mfma_f32_32x32x16_bf16 v[64:79], v[32:35], v[184:187], v[64:79]
    ds_read_b64_tr_b16 v[48:49], v7 offset:12288
    ds_read_b64_tr_b16 v[50:51], v7 offset:13312
    ds_read_b64_tr_b16 v[52:53], v8 offset:12288
    ds_read_b64_tr_b16 v[54:55], v8 offset:13312
    v_mfma_f32_32x32x16_bf16 v[80:95], v[36:39], v[184:187], v[80:95]
    ds_read_b64_tr_b16 v[56:57], v9 offset:12288
    ds_read_b64_tr_b16 v[58:59], v9 offset:13312
    ds_read_b64_tr_b16 v[60:61], v10 offset:12288
    ds_read_b64_tr_b16 v[62:63], v10 offset:13312
    v_mfma_f32_32x32x16_bf16 v[96:111], v[40:43], v[184:187], v[96:111]
    s_add_u32 m0, s58, 116736
    s_add_u32 s60, s55, s19
    buffer_load_dwordx4 v15, s[36:39], s60 offen lds
    v_mfma_f32_32x32x16_bf16 v[112:127], v[44:47], v[184:187], v[112:127]
    s_add_u32 s19, s3, 7
    s_and_b32 s19, s19, 7
    s_lshl_b32 s15, s19, 7
    s_add_u32 s15, s15, s54
    s_mul_i32 s19, s19, 196608
    s_add_u32 m0, s57, 131072
    s_add_u32 s60, s15, 0
    buffer_load_dwordx4 v11, s[32:35], s60 offen lds
    s_waitcnt vmcnt(9) lgkmcnt(0)
    s_barrier
    v_add_u32 v2, 0xfffe8000, v2
    v_add_u32 v3, 0xfffe8000, v3
    v_add_u32 v4, 0xfffe8000, v4
    v_add_u32 v5, 0xfffe8000, v5
    v_add_u32 v6, 0xfffe8000, v6
    ds_read_b128 v[224:227], v2 offset:0
    ds_read_b64_tr_b16 v[32:33], v6 offset:0
    ds_read_b64_tr_b16 v[34:35], v6 offset:768
    v_mfma_f32_32x32x16_bf16 v[64:79], v[48:51], v[188:191], v[64:79]
    v_mfma_f32_32x32x16_bf16 v[80:95], v[52:55], v[188:191], v[80:95]
    ds_read_b128 v[228:231], v3 offset:0
    ds_read_b64_tr_b16 v[40:41], v6 offset:3072
    ds_read_b64_tr_b16 v[42:43], v6 offset:3840
    v_mfma_f32_32x32x16_bf16 v[96:111], v[56:59], v[188:191], v[96:111]
    v_mfma_f32_32x32x16_bf16 v[112:127], v[60:63], v[188:191], v[112:127]
    ds_read_b128 v[232:235], v4 offset:0
    ds_read_b64_tr_b16 v[48:49], v6 offset:6144
    ds_read_b64_tr_b16 v[50:51], v6 offset:6912
    ds_read_b128 v[236:239], v5 offset:0
    ds_read_b64_tr_b16 v[56:57], v6 offset:9216
    ds_read_b64_tr_b16 v[58:59], v6 offset:9984
    s_add_u32 m0, s57, 132096
    s_add_u32 s60, s15, 8192
    buffer_load_dwordx4 v12, s[32:35], s60 offen lds
    s_add_u32 m0, s58, 148480
    s_add_u32 s60, s55, s19
    buffer_load_dwordx4 v14, s[36:39], s60 offen lds
    s_add_u32 m0, s58, 149504
    s_add_u32 s60, s55, s19
    buffer_load_dwordx4 v15, s[36:39], s60 offen lds
    s_waitcnt lgkmcnt(9)
    v_mfma_f32_32x32x16_bf16 v[128:143], v[32:35], v[224:227], v[128:143]
    s_waitcnt lgkmcnt(6)
    v_mfma_f32_32x32x16_bf16 v[128:143], v[40:43], v[228:231], v[128:143]
    v_readfirstlane_b32 s26, v25
    v_readfirstlane_b32 s60, v16
    s_nop 3
    s_mul_i32 s26, s26, 1664525
    s_add_u32 s26, s26, 1013904223
    s_or_b32 s26, s26, 1
    s_cmp_lg_u32 s60, 0
    s_cselect_b32 s26, s60, s26
    v_readfirstlane_b32 s22, v26
    s_waitcnt vmcnt(8) lgkmcnt(0)
    s_barrier
    ds_read_b128 v[240:243], v2 offset:32768
    ds_read_b64_tr_b16 v[32:33], v6 offset:32768
    ds_read_b64_tr_b16 v[34:35], v6 offset:33536
    v_mfma_f32_32x32x16_bf16 v[128:143], v[48:51], v[232:235], v[128:143]
    ds_read_b128 v[244:247], v3 offset:32768
    ds_read_b64_tr_b16 v[40:41], v6 offset:35840
    ds_read_b64_tr_b16 v[42:43], v6 offset:36608
    v_mfma_f32_32x32x16_bf16 v[128:143], v[56:59], v[236:239], v[128:143]
    ds_read_b128 v[248:251], v4 offset:32768
    ds_read_b64_tr_b16 v[48:49], v6 offset:38912
    ds_read_b64_tr_b16 v[50:51], v6 offset:39680
    ds_read_b128 v[252:255], v5 offset:32768
    ds_read_b64_tr_b16 v[56:57], v6 offset:41984
    ds_read_b64_tr_b16 v[58:59], v6 offset:42752
    s_add_u32 s71, s3, 2
    s_and_b32 s71, s71, 7
    s_mul_i32 s71, s71, 229376
    s_add_u32 s71, s71, s56
    s_add_u32 m0, s59, 0
    s_add_u32 s60, s71, 0
    buffer_load_dwordx4 v28, s[40:43], s60 offen lds
    s_add_u32 m0, s59, 16384
    s_add_u32 s60, s71, 0
    buffer_load_dwordx4 v29, s[44:47], s60 offen lds
    s_add_u32 m0, s59, 1024
    s_add_u32 s60, s71, 14336
    buffer_load_dwordx4 v28, s[40:43], s60 offen lds
    s_waitcnt lgkmcnt(9)
    v_mfma_f32_32x32x16_bf16 v[128:143], v[32:35], v[240:243], v[128:143]
    s_waitcnt lgkmcnt(6)
    v_mfma_f32_32x32x16_bf16 v[128:143], v[40:43], v[244:247], v[128:143]
    s_waitcnt vmcnt(7) lgkmcnt(0)
    s_barrier
    v_add_u32 v2, 0x10000, v2
    v_add_u32 v3, 0x10000, v3
    v_add_u32 v4, 0x10000, v4
    v_add_u32 v5, 0x10000, v5
    v_add_u32 v6, 0x10000, v6
    ds_read_b128 v[160:163], v2 offset:0
    ds_read_b64_tr_b16 v[32:33], v6 offset:0
    ds_read_b64_tr_b16 v[34:35], v6 offset:768
    v_mfma_f32_32x32x16_bf16 v[128:143], v[48:51], v[248:251], v[128:143]
    ds_read_b128 v[164:167], v3 offset:0
    ds_read_b64_tr_b16 v[40:41], v6 offset:3072
    ds_read_b64_tr_b16 v[42:43], v6 offset:3840
    v_mfma_f32_32x32x16_bf16 v[128:143], v[56:59], v[252:255], v[128:143]
    ds_read_b128 v[168:171], v4 offset:0
    ds_read_b64_tr_b16 v[48:49], v6 offset:6144
    ds_read_b64_tr_b16 v[50:51], v6 offset:6912
    ds_read_b128 v[172:175], v5 offset:0
    ds_read_b64_tr_b16 v[56:57], v6 offset:9216
    ds_read_b64_tr_b16 v[58:59], v6 offset:9984
    s_add_u32 m0, s59, 17408
    s_add_u32 s60, s71, 14336
    buffer_load_dwordx4 v29, s[44:47], s60 offen lds
    s_add_u32 s71, s3, 3
    s_and_b32 s71, s71, 7
    s_mul_i32 s71, s71, 229376
    s_add_u32 s71, s71, s56
    s_add_u32 m0, s59, 32768
    s_add_u32 s60, s71, 0
    buffer_load_dwordx4 v28, s[40:43], s60 offen lds
    s_add_u32 m0, s59, 49152
    s_add_u32 s60, s71, 0
    buffer_load_dwordx4 v29, s[44:47], s60 offen lds
    s_waitcnt lgkmcnt(9)
    v_mfma_f32_32x32x16_bf16 v[128:143], v[32:35], v[160:163], v[128:143]
    s_waitcnt lgkmcnt(6)
    v_mfma_f32_32x32x16_bf16 v[128:143], v[40:43], v[164:167], v[128:143]
    s_waitcnt vmcnt(6) lgkmcnt(0)
    s_barrier
    ds_read_b128 v[176:179], v2 offset:32768
    ds_read_b64_tr_b16 v[32:33], v6 offset:32768
    ds_read_b64_tr_b16 v[34:35], v6 offset:33536
    v_mfma_f32_32x32x16_bf16 v[128:143], v[48:51], v[168:171], v[128:143]
    ds_read_b128 v[180:183], v3 offset:32768
    ds_read_b64_tr_b16 v[40:41], v6 offset:35840
    ds_read_b64_tr_b16 v[42:43], v6 offset:36608
    v_mfma_f32_32x32x16_bf16 v[128:143], v[56:59], v[172:175], v[128:143]
    ds_read_b128 v[184:187], v4 offset:32768
    ds_read_b64_tr_b16 v[48:49], v6 offset:38912
    ds_read_b64_tr_b16 v[50:51], v6 offset:39680
    ds_read_b128 v[188:191], v5 offset:32768
    ds_read_b64_tr_b16 v[56:57], v6 offset:41984
    ds_read_b64_tr_b16 v[58:59], v6 offset:42752
    s_add_u32 m0, s59, 33792
    s_add_u32 s60, s71, 14336
    buffer_load_dwordx4 v28, s[40:43], s60 offen lds
    s_add_u32 m0, s59, 50176
    s_add_u32 s60, s71, 14336
    buffer_load_dwordx4 v29, s[44:47], s60 offen lds
    s_add_u32 s71, s3, 4
    s_and_b32 s71, s71, 7
    s_mul_i32 s71, s71, 229376
    s_add_u32 s71, s71, s56
    s_add_u32 m0, s59, 65536
    s_add_u32 s60, s71, 0
    buffer_load_dwordx4 v28, s[40:43], s60 offen lds
    s_waitcnt lgkmcnt(9)
    v_mfma_f32_32x32x16_bf16 v[128:143], v[32:35], v[176:179], v[128:143]
    s_waitcnt lgkmcnt(6)
    v_mfma_f32_32x32x16_bf16 v[128:143], v[40:43], v[180:183], v[128:143]
    s_waitcnt vmcnt(5) lgkmcnt(0)
    s_barrier
    v_mfma_f32_32x32x16_bf16 v[128:143], v[48:51], v[184:187], v[128:143]
    ds_read_b64_tr_b16 v[32:33], v7 offset:0
    ds_read_b64_tr_b16 v[34:35], v7 offset:1024
    ds_read_b64_tr_b16 v[36:37], v8 offset:0
    ds_read_b64_tr_b16 v[38:39], v8 offset:1024
    v_mfma_f32_32x32x16_bf16 v[128:143], v[56:59], v[188:191], v[128:143]
    ds_read_b64_tr_b16 v[40:41], v9 offset:0
    ds_read_b64_tr_b16 v[42:43], v9 offset:1024
    ds_read_b64_tr_b16 v[44:45], v10 offset:0
    ds_read_b64_tr_b16 v[46:47], v10 offset:1024
    s_add_u32 m0, s59, 81920
    s_add_u32 s60, s71, 0
    buffer_load_dwordx4 v29, s[44:47], s60 offen lds
    s_waitcnt lgkmcnt(0)
    v_mfma_f32_32x32x16_bf16 v[64:79], v[32:35], v[192:195], v[64:79]
    ds_read_b64_tr_b16 v[48:49], v7 offset:4096
    ds_read_b64_tr_b16 v[50:51], v7 offset:5120
    ds_read_b64_tr_b16 v[52:53], v8 offset:4096
    ds_read_b64_tr_b16 v[54:55], v8 offset:5120
    v_mfma_f32_32x32x16_bf16 v[80:95], v[36:39], v[192:195], v[80:95]
    ds_read_b64_tr_b16 v[56:57], v9 offset:4096
    ds_read_b64_tr_b16 v[58:59], v9 offset:5120
    ds_read_b64_tr_b16 v[60:61], v10 offset:4096
    ds_read_b64_tr_b16 v[62:63], v10 offset:5120
    v_mfma_f32_32x32x16_bf16 v[96:111], v[40:43], v[192:195], v[96:111]
    v_mfma_f32_32x32x16_bf16 v[112:127], v[44:47], v[192:195], v[112:127]
    s_add_u32 m0, s59, 66560
    s_add_u32 s60, s71, 14336
    buffer_load_dwordx4 v28, s[40:43], s60 offen lds
    s_mul_i32 s60, s49, 3
    s_add_u32 s60, s60, 2
    s_and_b32 s61, s60, 15
    s_lshl_b32 s61, s61, 7
    s_lshl_b32 s62, s48, 2
    s_add_u32 s62, s62, s51
    s_add_u32 s61, s61, s62
    s_lshl_b32 s62, s61, 10
    s_lshl_b32 s61, s61, 11
    s_add_u32 s61, s61, 0x200000
    s_cmp_lt_u32 s60, 16
    s_cselect_b32 s72, s62, s61
    s_cselect_b32 s62, 1, 2
    s_cselect_b32 s63, 0x3eb8aa3b, 1.0
    s_lshl_b32 s62, s62, 16
    s_add_u32 s73, s62, s72
    v_mul_f32 v128, s63, v128
    v_mul_f32 v129, s63, v129
    v_mul_f32 v130, s63, v130
    v_mul_f32 v131, s63, v131
    v_mul_f32 v132, s63, v132
    v_mul_f32 v133, s63, v133
    v_mul_f32 v134, s63, v134
    v_mul_f32 v135, s63, v135
    v_mul_f32 v136, s63, v136
    v_mul_f32 v137, s63, v137
    v_mul_f32 v138, s63, v138
    v_mul_f32 v139, s63, v139
    v_mul_f32 v140, s63, v140
    v_mul_f32 v141, s63, v141
    v_mul_f32 v142, s63, v142
    v_mul_f32 v143, s63, v143
    v_cvt_pk_bf16_f32 v128, v128, v129
    v_cvt_pk_bf16_f32 v129, v130, v131
    v_cvt_pk_bf16_f32 v130, v132, v133
    v_cvt_pk_bf16_f32 v131, v134, v135
    v_cvt_pk_bf16_f32 v132, v136, v137
    v_cvt_pk_bf16_f32 v133, v138, v139
    v_cvt_pk_bf16_f32 v134, v140, v141
    v_cvt_pk_bf16_f32 v135, v142, v143
    s_waitcnt lgkmcnt(0)
    v_mfma_f32_32x32x16_bf16 v[64:79], v[48:51], v[196:199], v[64:79]
    ds_read_b64_tr_b16 v[32:33], v7 offset:8192
    ds_read_b64_tr_b16 v[34:35], v7 offset:9216
    ds_read_b64_tr_b16 v[36:37], v8 offset:8192
    ds_read_b64_tr_b16 v[38:39], v8 offset:9216
    v_mfma_f32_32x32x16_bf16 v[80:95], v[52:55], v[196:199], v[80:95]
    ds_read_b64_tr_b16 v[40:41], v9 offset:8192
    ds_read_b64_tr_b16 v[42:43], v9 offset:9216
    ds_read_b64_tr_b16 v[44:45], v10 offset:8192
    ds_read_b64_tr_b16 v[46:47], v10 offset:9216
    v_mfma_f32_32x32x16_bf16 v[96:111], v[56:59], v[196:199], v[96:111]
    buffer_store_dwordx4 v[128:131], v1, s[28:31], s72 offen sc1
    v_mfma_f32_32x32x16_bf16 v[112:127], v[60:63], v[196:199], v[112:127]
    s_add_u32 m0, s59, 82944
    s_add_u32 s60, s71, 14336
    buffer_load_dwordx4 v29, s[44:47], s60 offen lds
    s_waitcnt lgkmcnt(0)
    v_mfma_f32_32x32x16_bf16 v[64:79], v[32:35], v[200:203], v[64:79]
    ds_read_b64_tr_b16 v[48:49], v7 offset:12288
    ds_read_b64_tr_b16 v[50:51], v7 offset:13312
    ds_read_b64_tr_b16 v[52:53], v8 offset:12288
    ds_read_b64_tr_b16 v[54:55], v8 offset:13312
    v_mfma_f32_32x32x16_bf16 v[80:95], v[36:39], v[200:203], v[80:95]
    ds_read_b64_tr_b16 v[56:57], v9 offset:12288
    ds_read_b64_tr_b16 v[58:59], v9 offset:13312
    ds_read_b64_tr_b16 v[60:61], v10 offset:12288
    ds_read_b64_tr_b16 v[62:63], v10 offset:13312
    v_mfma_f32_32x32x16_bf16 v[96:111], v[40:43], v[200:203], v[96:111]
    v_mfma_f32_32x32x16_bf16 v[112:127], v[44:47], v[200:203], v[112:127]
    s_add_u32 s71, s3, 5
    s_and_b32 s71, s71, 7
    s_mul_i32 s71, s71, 229376
    s_add_u32 s71, s71, s56
    s_add_u32 m0, s59, 98304
    s_add_u32 s60, s71, 0
    buffer_load_dwordx4 v28, s[40:43], s60 offen lds
    s_waitcnt vmcnt(6) lgkmcnt(0)
    s_barrier
    v_mfma_f32_32x32x16_bf16 v[64:79], v[48:51], v[204:207], v[64:79]
    ds_read_b64_tr_b16 v[32:33], v7 offset:32768
    ds_read_b64_tr_b16 v[34:35], v7 offset:33792
    ds_read_b64_tr_b16 v[36:37], v8 offset:32768
    ds_read_b64_tr_b16 v[38:39], v8 offset:33792
    v_mfma_f32_32x32x16_bf16 v[80:95], v[52:55], v[204:207], v[80:95]
    ds_read_b64_tr_b16 v[40:41], v9 offset:32768
    ds_read_b64_tr_b16 v[42:43], v9 offset:33792
    ds_read_b64_tr_b16 v[44:45], v10 offset:32768
    ds_read_b64_tr_b16 v[46:47], v10 offset:33792
    v_mfma_f32_32x32x16_bf16 v[96:111], v[56:59], v[204:207], v[96:111]
    buffer_store_dwordx4 v[132:135], v1, s[28:31], s73 offen sc1
    v_mfma_f32_32x32x16_bf16 v[112:127], v[60:63], v[204:207], v[112:127]
    s_add_u32 m0, s59, 114688
    s_add_u32 s60, s71, 0
    buffer_load_dwordx4 v29, s[44:47], s60 offen lds
    s_waitcnt lgkmcnt(0)
    v_mfma_f32_32x32x16_bf16 v[64:79], v[32:35], v[208:211], v[64:79]
    ds_read_b64_tr_b16 v[48:49], v7 offset:36864
    ds_read_b64_tr_b16 v[50:51], v7 offset:37888
    ds_read_b64_tr_b16 v[52:53], v8 offset:36864
    ds_read_b64_tr_b16 v[54:55], v8 offset:37888
    v_mfma_f32_32x32x16_bf16 v[80:95], v[36:39], v[208:211], v[80:95]
    ds_read_b64_tr_b16 v[56:57], v9 offset:36864
    ds_read_b64_tr_b16 v[58:59], v9 offset:37888
    ds_read_b64_tr_b16 v[60:61], v10 offset:36864
    ds_read_b64_tr_b16 v[62:63], v10 offset:37888
    v_mfma_f32_32x32x16_bf16 v[96:111], v[40:43], v[208:211], v[96:111]
    v_mfma_f32_32x32x16_bf16 v[112:127], v[44:47], v[208:211], v[112:127]
    s_add_u32 m0, s59, 99328
    s_add_u32 s60, s71, 14336
    buffer_load_dwordx4 v28, s[40:43], s60 offen lds
    s_waitcnt lgkmcnt(0)
    v_mfma_f32_32x32x16_bf16 v[64:79], v[48:51], v[212:215], v[64:79]
    ds_read_b64_tr_b16 v[32:33], v7 offset:40960
    ds_read_b64_tr_b16 v[34:35], v7 offset:41984
    ds_read_b64_tr_b16 v[36:37], v8 offset:40960
    ds_read_b64_tr_b16 v[38:39], v8 offset:41984
    v_mfma_f32_32x32x16_bf16 v[80:95], v[52:55], v[212:215], v[80:95]
    ds_read_b64_tr_b16 v[40:41], v9 offset:40960
    ds_read_b64_tr_b16 v[42:43], v9 offset:41984
    ds_read_b64_tr_b16 v[44:45], v10 offset:40960
    ds_read_b64_tr_b16 v[46:47], v10 offset:41984
    v_mfma_f32_32x32x16_bf16 v[96:111], v[56:59], v[212:215], v[96:111]
    v_mfma_f32_32x32x16_bf16 v[112:127], v[60:63], v[212:215], v[112:127]
    s_add_u32 m0, s59, 115712
    s_add_u32 s60, s71, 14336
    buffer_load_dwordx4 v29, s[44:47], s60 offen lds
    s_waitcnt lgkmcnt(0)
    v_mfma_f32_32x32x16_bf16 v[64:79], v[32:35], v[216:219], v[64:79]
    ds_read_b64_tr_b16 v[48:49], v7 offset:45056
    ds_read_b64_tr_b16 v[50:51], v7 offset:46080
    ds_read_b64_tr_b16 v[52:53], v8 offset:45056
    ds_read_b64_tr_b16 v[54:55], v8 offset:46080
    v_mfma_f32_32x32x16_bf16 v[80:95], v[36:39], v[216:219], v[80:95]
    ds_read_b64_tr_b16 v[56:57], v9 offset:45056
    ds_read_b64_tr_b16 v[58:59], v9 offset:46080
    ds_read_b64_tr_b16 v[60:61], v10 offset:45056
    ds_read_b64_tr_b16 v[62:63], v10 offset:46080
    v_mfma_f32_32x32x16_bf16 v[96:111], v[40:43], v[216:219], v[96:111]
    v_mfma_f32_32x32x16_bf16 v[112:127], v[44:47], v[216:219], v[112:127]
    s_add_u32 s71, s3, 6
    s_and_b32 s71, s71, 7
    s_mul_i32 s71, s71, 229376
    s_add_u32 s71, s71, s56
    s_add_u32 m0, s59, 131072
    s_add_u32 s60, s71, 0
    buffer_load_dwordx4 v28, s[40:43], s60 offen lds
    s_waitcnt vmcnt(6) lgkmcnt(0)
    s_barrier
    v_add_u32 v7, 0x10000, v7
    v_add_u32 v8, 0x10000, v8
    v_add_u32 v9, 0x10000, v9
    v_add_u32 v10, 0x10000, v10
    v_mfma_f32_32x32x16_bf16 v[64:79], v[48:51], v[220:223], v[64:79]
    ds_read_b64_tr_b16 v[32:33], v7 offset:0
    ds_read_b64_tr_b16 v[34:35], v7 offset:1024
    ds_read_b64_tr_b16 v[36:37], v8 offset:0
    ds_read_b64_tr_b16 v[38:39], v8 offset:1024
    v_mfma_f32_32x32x16_bf16 v[80:95], v[52:55], v[220:223], v[80:95]
    ds_read_b64_tr_b16 v[40:41], v9 offset:0
    ds_read_b64_tr_b16 v[42:43], v9 offset:1024
    ds_read_b64_tr_b16 v[44:45], v10 offset:0
    ds_read_b64_tr_b16 v[46:47], v10 offset:1024
    v_mfma_f32_32x32x16_bf16 v[96:111], v[56:59], v[220:223], v[96:111]
    v_mfma_f32_32x32x16_bf16 v[112:127], v[60:63], v[220:223], v[112:127]
    s_add_u32 m0, s59, 147456
    s_add_u32 s60, s71, 0
    buffer_load_dwordx4 v29, s[44:47], s60 offen lds
    s_waitcnt lgkmcnt(0)
    v_mfma_f32_32x32x16_bf16 v[64:79], v[32:35], v[224:227], v[64:79]
    ds_read_b64_tr_b16 v[48:49], v7 offset:4096
    ds_read_b64_tr_b16 v[50:51], v7 offset:5120
    ds_read_b64_tr_b16 v[52:53], v8 offset:4096
    ds_read_b64_tr_b16 v[54:55], v8 offset:5120
    v_mfma_f32_32x32x16_bf16 v[80:95], v[36:39], v[224:227], v[80:95]
    ds_read_b64_tr_b16 v[56:57], v9 offset:4096
    ds_read_b64_tr_b16 v[58:59], v9 offset:5120
    ds_read_b64_tr_b16 v[60:61], v10 offset:4096
    ds_read_b64_tr_b16 v[62:63], v10 offset:5120
    v_mfma_f32_32x32x16_bf16 v[96:111], v[40:43], v[224:227], v[96:111]
    v_mfma_f32_32x32x16_bf16 v[112:127], v[44:47], v[224:227], v[112:127]
    s_add_u32 m0, s59, 132096
    s_add_u32 s60, s71, 14336
    buffer_load_dwordx4 v28, s[40:43], s60 offen lds
    s_waitcnt lgkmcnt(0)
    v_mfma_f32_32x32x16_bf16 v[64:79], v[48:51], v[228:231], v[64:79]
    ds_read_b64_tr_b16 v[32:33], v7 offset:8192
    ds_read_b64_tr_b16 v[34:35], v7 offset:9216
    ds_read_b64_tr_b16 v[36:37], v8 offset:8192
    ds_read_b64_tr_b16 v[38:39], v8 offset:9216
    v_mfma_f32_32x32x16_bf16 v[80:95], v[52:55], v[228:231], v[80:95]
    ds_read_b64_tr_b16 v[40:41], v9 offset:8192
    ds_read_b64_tr_b16 v[42:43], v9 offset:9216
    ds_read_b64_tr_b16 v[44:45], v10 offset:8192
    ds_read_b64_tr_b16 v[46:47], v10 offset:9216
    v_mfma_f32_32x32x16_bf16 v[96:111], v[56:59], v[228:231], v[96:111]
    v_mfma_f32_32x32x16_bf16 v[112:127], v[60:63], v[228:231], v[112:127]
    s_add_u32 m0, s59, 148480
    s_add_u32 s60, s71, 14336
    buffer_load_dwordx4 v29, s[44:47], s60 offen lds
    s_waitcnt lgkmcnt(0)
    v_mfma_f32_32x32x16_bf16 v[64:79], v[32:35], v[232:235], v[64:79]
    ds_read_b64_tr_b16 v[48:49], v7 offset:12288
    ds_read_b64_tr_b16 v[50:51], v7 offset:13312
    ds_read_b64_tr_b16 v[52:53], v8 offset:12288
    ds_read_b64_tr_b16 v[54:55], v8 offset:13312
    v_mfma_f32_32x32x16_bf16 v[80:95], v[36:39], v[232:235], v[80:95]
    ds_read_b64_tr_b16 v[56:57], v9 offset:12288
    ds_read_b64_tr_b16 v[58:59], v9 offset:13312
    ds_read_b64_tr_b16 v[60:61], v10 offset:12288
    ds_read_b64_tr_b16 v[62:63], v10 offset:13312
    v_mfma_f32_32x32x16_bf16 v[96:111], v[40:43], v[232:235], v[96:111]
    v_mfma_f32_32x32x16_bf16 v[112:127], v[44:47], v[232:235], v[112:127]
    s_add_u32 s71, s3, 7
    s_and_b32 s71, s71, 7
    s_mul_i32 s71, s71, 229376
    s_add_u32 s71, s71, s56
    s_add_u32 m0, s59, 0
    s_add_u32 s60, s71, 0
    buffer_load_dwordx4 v28, s[40:43], s60 offen lds
    s_waitcnt vmcnt(5) lgkmcnt(0)
    s_barrier
    v_mfma_f32_32x32x16_bf16 v[64:79], v[48:51], v[236:239], v[64:79]
    ds_read_b64_tr_b16 v[32:33], v7 offset:32768
    ds_read_b64_tr_b16 v[34:35], v7 offset:33792
    ds_read_b64_tr_b16 v[36:37], v8 offset:32768
    ds_read_b64_tr_b16 v[38:39], v8 offset:33792
    v_mfma_f32_32x32x16_bf16 v[80:95], v[52:55], v[236:239], v[80:95]
    ds_read_b64_tr_b16 v[40:41], v9 offset:32768
    ds_read_b64_tr_b16 v[42:43], v9 offset:33792
    ds_read_b64_tr_b16 v[44:45], v10 offset:32768
    ds_read_b64_tr_b16 v[46:47], v10 offset:33792
    v_mfma_f32_32x32x16_bf16 v[96:111], v[56:59], v[236:239], v[96:111]
    v_mfma_f32_32x32x16_bf16 v[112:127], v[60:63], v[236:239], v[112:127]
    s_add_u32 m0, s59, 16384
    s_add_u32 s60, s71, 0
    buffer_load_dwordx4 v29, s[44:47], s60 offen lds
    s_waitcnt lgkmcnt(0)
    v_mfma_f32_32x32x16_bf16 v[64:79], v[32:35], v[240:243], v[64:79]
    ds_read_b64_tr_b16 v[48:49], v7 offset:36864
    ds_read_b64_tr_b16 v[50:51], v7 offset:37888
    ds_read_b64_tr_b16 v[52:53], v8 offset:36864
    ds_read_b64_tr_b16 v[54:55], v8 offset:37888
    s_mov_b32 s32, s16
    s_and_b32 s33, s17, 0xffff
    v_mfma_f32_32x32x16_bf16 v[80:95], v[36:39], v[240:243], v[80:95]
    ds_read_b64_tr_b16 v[56:57], v9 offset:36864
    ds_read_b64_tr_b16 v[58:59], v9 offset:37888
    ds_read_b64_tr_b16 v[60:61], v10 offset:36864
    ds_read_b64_tr_b16 v[62:63], v10 offset:37888
    s_mov_b32 s34, 0x1c0000
    s_mov_b32 s35, 0x00020000
    v_mfma_f32_32x32x16_bf16 v[96:111], v[40:43], v[240:243], v[96:111]
    s_mov_b32 s36, s8
    s_and_b32 s37, s9, 0xffff
    s_mov_b32 s38, 0x80000
    s_mov_b32 s39, 0x00020000
    v_mfma_f32_32x32x16_bf16 v[112:127], v[44:47], v[240:243], v[112:127]
    s_mul_i32 s54, s52, 16640
    s_add_u32 s54, s54, 32768
    v_add_u32 v2, s54, v1
    v_lshrrev_b32 v236, 5, v0
    s_add_u32 m0, s59, 1024
    s_add_u32 s60, s71, 14336
    buffer_load_dwordx4 v28, s[40:43], s60 offen lds
    s_waitcnt lgkmcnt(0)
    v_mfma_f32_32x32x16_bf16 v[64:79], v[48:51], v[244:247], v[64:79]
    ds_read_b64_tr_b16 v[32:33], v7 offset:40960
    ds_read_b64_tr_b16 v[34:35], v7 offset:41984
    ds_read_b64_tr_b16 v[36:37], v8 offset:40960
    ds_read_b64_tr_b16 v[38:39], v8 offset:41984
    v_lshlrev_b32 v232, 8, v236
    v_and_b32 v233, 15, v0
    v_mfma_f32_32x32x16_bf16 v[80:95], v[52:55], v[244:247], v[80:95]
    ds_read_b64_tr_b16 v[40:41], v9 offset:40960
    ds_read_b64_tr_b16 v[42:43], v9 offset:41984
    ds_read_b64_tr_b16 v[44:45], v10 offset:40960
    ds_read_b64_tr_b16 v[46:47], v10 offset:41984
    v_lshl_add_u32 v232, v233, 4, v232
    v_and_b32 v233, 11, v0
    v_mfma_f32_32x32x16_bf16 v[96:111], v[56:59], v[244:247], v[96:111]
    v_cmp_eq_u32 vcc, 0, v233
    v_mov_b32 v234, 16
    s_nop 0
    v_cndmask_b32 v234, v234, 0, vcc
    v_mfma_f32_32x32x16_bf16 v[112:127], v[60:63], v[244:247], v[112:127]
    v_add_u32 v235, 1024, v234
    v_add_u32 v234, 512, v234
    v_cndmask_b32 v3, v235, v232, s[0:1]
    v_cndmask_b32 v4, v234, v232, s[0:1]
    s_add_u32 m0, s59, 17408
    s_add_u32 s60, s71, 14336
    buffer_load_dwordx4 v29, s[44:47], s60 offen lds
    s_waitcnt lgkmcnt(0)
    v_mfma_f32_32x32x16_bf16 v[64:79], v[32:35], v[248:251], v[64:79]
    ds_read_b64_tr_b16 v[48:49], v7 offset:45056
    ds_read_b64_tr_b16 v[50:51], v7 offset:46080
    ds_read_b64_tr_b16 v[52:53], v8 offset:45056
    ds_read_b64_tr_b16 v[54:55], v8 offset:46080
    v_add_u32 v3, s54, v3
    v_add_u32 v4, s54, v4
    v_mfma_f32_32x32x16_bf16 v[80:95], v[36:39], v[248:251], v[80:95]
    ds_read_b64_tr_b16 v[56:57], v9 offset:45056
    ds_read_b64_tr_b16 v[58:59], v9 offset:46080
    ds_read_b64_tr_b16 v[60:61], v10 offset:45056
    ds_read_b64_tr_b16 v[62:63], v10 offset:46080
    v_lshrrev_b32 v232, 3, v0
    v_lshlrev_b32 v232, 10, v232
    v_mfma_f32_32x32x16_bf16 v[96:111], v[40:43], v[248:251], v[96:111]
    v_bfe_u32 v233, v0, 4, 1
    v_lshlrev_b32 v234, 2, v233
    v_and_b32 v235, 7, v0
    v_xor_b32 v234, v234, v235
    v_mfma_f32_32x32x16_bf16 v[112:127], v[44:47], v[248:251], v[112:127]
    v_lshl_add_u32 v11, v234, 4, v232
    v_add_u32 v12, 7168, v11
    s_mul_i32 s54, s13, 114688
    v_add_u32 v13, s54, v1
    s_waitcnt vmcnt(4) lgkmcnt(0)
    s_barrier
    v_add_u32 v7, 0x10000, v7
    v_add_u32 v8, 0x10000, v8
    v_add_u32 v9, 0x10000, v9
    v_add_u32 v10, 0x10000, v10
    v_mfma_f32_32x32x16_bf16 v[64:79], v[48:51], v[252:255], v[64:79]
    ds_read_b64_tr_b16 v[32:33], v7 offset:0
    ds_read_b64_tr_b16 v[34:35], v7 offset:1024
    ds_read_b64_tr_b16 v[36:37], v8 offset:0
    ds_read_b64_tr_b16 v[38:39], v8 offset:1024
    v_bfe_u32 v234, v0, 2, 2
    v_lshl_add_u32 v232, v236, 2, v234
    v_mfma_f32_32x32x16_bf16 v[80:95], v[52:55], v[252:255], v[80:95]
    ds_read_b64_tr_b16 v[40:41], v9 offset:0
    ds_read_b64_tr_b16 v[42:43], v9 offset:1024
    ds_read_b64_tr_b16 v[44:45], v10 offset:0
    ds_read_b64_tr_b16 v[46:47], v10 offset:1024
    v_lshlrev_b32 v232, 7, v232
    v_lshrrev_b32 v234, 1, v234
    v_mfma_f32_32x32x16_bf16 v[96:111], v[56:59], v[252:255], v[96:111]
    v_lshl_add_u32 v232, v234, 6, v232
    v_lshl_add_u32 v232, v233, 5, v232
    v_and_b32 v234, 3, v0
    v_lshl_add_u32 v232, v234, 3, v232
    v_mfma_f32_32x32x16_bf16 v[112:127], v[60:63], v[252:255], v[112:127]
    s_lshl_b32 s54, s14, 5
    v_xor_b32 v232, s54, v232
    v_add_u32 v5, s11, v232
    v_xor_b32 v6, 64, v5
    s_mul_i32 s54, s27, 14
    s_add_u32 s55, s54, 13
    s_lshr_b32 s54, s54, 2
    s_lshr_b32 s55, s55, 2
    v_and_b32 v14, 7, v0
    v_add_u32 v14, s54, v14
    v_min_u32 v14, s55, v14
    v_bfe_u32 v232, v0, 3, 1
    s_lshl_b32 s54, s4, 1
    v_add_u32 v232, s54, v232
    v_lshl_add_u32 v14, v232, 5, v14
    v_lshlrev_b32 v14, 7, v14
    s_waitcnt lgkmcnt(0)
    v_mfma_f32_32x32x16_bf16 v[64:79], v[32:35], v[160:163], v[64:79]
    ds_read_b64_tr_b16 v[48:49], v7 offset:4096
    ds_read_b64_tr_b16 v[50:51], v7 offset:5120
    ds_read_b64_tr_b16 v[52:53], v8 offset:4096
    ds_read_b64_tr_b16 v[54:55], v8 offset:5120
    v_and_b32 v232, 31, v0
    v_mul_u32_u24 v232, 2080, v232
    v_mfma_f32_32x32x16_bf16 v[80:95], v[36:39], v[160:163], v[80:95]
    ds_read_b64_tr_b16 v[56:57], v9 offset:4096
    ds_read_b64_tr_b16 v[58:59], v9 offset:5120
    ds_read_b64_tr_b16 v[60:61], v10 offset:4096
    ds_read_b64_tr_b16 v[62:63], v10 offset:5120
    v_lshrrev_b32 v233, 5, v0
    v_lshl_add_u32 v232, v233, 4, v232
    v_mfma_f32_32x32x16_bf16 v[96:111], v[40:43], v[160:163], v[96:111]
    v_cmp_eq_u32 vcc, 0, v233
    v_mov_b32 v236, 0x3f803f80
    s_nop 0
    v_cndmask_b32 v236, 0, v236, vcc
    v_mfma_f32_32x32x16_bf16 v[112:127], v[44:47], v[160:163], v[112:127]
    v_mov_b32 v237, v236
    v_mov_b32 v238, v236
    v_mov_b32 v239, v236
    ds_write_b128 v232, v[236:239] offset:34816
    s_waitcnt lgkmcnt(0)
    v_mfma_f32_32x32x16_bf16 v[64:79], v[48:51], v[164:167], v[64:79]
    ds_read_b64_tr_b16 v[32:33], v7 offset:8192
    ds_read_b64_tr_b16 v[34:35], v7 offset:9216
    ds_read_b64_tr_b16 v[36:37], v8 offset:8192
    ds_read_b64_tr_b16 v[38:39], v8 offset:9216
    s_mov_b32 s40, s20
    s_and_b32 s41, s21, 0xffff
    v_mfma_f32_32x32x16_bf16 v[80:95], v[52:55], v[164:167], v[80:95]
    ds_read_b64_tr_b16 v[40:41], v9 offset:8192
    ds_read_b64_tr_b16 v[42:43], v9 offset:9216
    ds_read_b64_tr_b16 v[44:45], v10 offset:8192
    ds_read_b64_tr_b16 v[46:47], v10 offset:9216
    s_mov_b32 s42, 0x200000
    s_mov_b32 s43, 0x00020000
    v_mfma_f32_32x32x16_bf16 v[96:111], v[56:59], v[164:167], v[96:111]
    s_lshl_b32 s72, s4, 1
    s_add_u32 s72, s72, s13
    s_lshl_b32 s73, s72, 5
    s_lshl_b32 s74, s14, 3
    v_mfma_f32_32x32x16_bf16 v[112:127], v[60:63], v[164:167], v[112:127]
    s_add_u32 s73, s73, s74
    s_lshl_b32 s54, s73, 10
    s_add_u32 s54, s54, 0x600000
    s_add_u32 s55, s54, 4096
    s_lshl_b32 s56, s72, 15
    s_lshl_b32 s74, s5, 7
    s_add_u32 s56, s56, s74
    s_lshl_b32 s74, s14, 5
    s_add_u32 s56, s56, s74
    s_lshl_b32 s59, s72, 8
    s_add_u32 s59, s59, 0xf00000
    s_lshl_b32 s58, s65, 3
    s_lshl_b32 s73, s51, 1
    s_add_u32 s58, s58, s73
    s_add_u32 s58, s58, s52
    s_lshl_b32 s58, s58, 8
    s_add_u32 s58, s58, 0xf00000
    s_lshl_b32 s72, s14, 1
    s_lshr_b32 s73, s4, 2
    s_lshl_b32 s73, s73, 5
    s_add_u32 s72, s72, s73
    s_lshl_b32 s73, s69, 3
    s_add_u32 s73, s73, 0xf00000
    s_waitcnt lgkmcnt(0)
    v_mfma_f32_32x32x16_bf16 v[64:79], v[32:35], v[168:171], v[64:79]
    ds_read_b64_tr_b16 v[48:49], v7 offset:12288
    ds_read_b64_tr_b16 v[50:51], v7 offset:13312
    ds_read_b64_tr_b16 v[52:53], v8 offset:12288
    ds_read_b64_tr_b16 v[54:55], v8 offset:13312
    v_mfma_f32_32x32x16_bf16 v[80:95], v[36:39], v[168:171], v[80:95]
    ds_read_b64_tr_b16 v[56:57], v9 offset:12288
    ds_read_b64_tr_b16 v[58:59], v9 offset:13312
    ds_read_b64_tr_b16 v[60:61], v10 offset:12288
    ds_read_b64_tr_b16 v[62:63], v10 offset:13312
    v_mfma_f32_32x32x16_bf16 v[96:111], v[40:43], v[168:171], v[96:111]
    v_mfma_f32_32x32x16_bf16 v[112:127], v[44:47], v[168:171], v[112:127]
    s_lshr_b32 s60, s64, 1
    v_lshrrev_b32 v30, 4, v0
    v_add_u32 v30, 1, v30
    v_cmp_gt_u32 vcc, 3, v30
    s_nop 1
    v_cndmask_b32 v30, 0, v30, vcc
    v_lshlrev_b32 v30, 4, v30
    v_add_u32 v30, s60, v30
    v_mul_u32_u24 v30, 43691, v30
    v_lshrrev_b32 v30, 17, v30
    v_and_b32 v31, 15, v0
    s_lshl_b32 s61, s65, 1
    v_add_u32 v24, s61, v31
    v_cndmask_b32 v31, v24, v31, vcc
    v_lshl_add_u32 v30, v30, 4, v31
    v_lshlrev_b32 v30, 7, v30
    s_mov_b32 s60, 0xf10000
    s_mov_b32 exec_lo, 0xffffffff
    s_mov_b32 exec_hi, 0x3
    buffer_load_dword v31, v30, s[28:31], s60 offen sc1
    s_mov_b64 exec, -1
    s_waitcnt vmcnt(1) lgkmcnt(0)
    s_barrier
    v_add_u32 v7, 0xfffe0000, v7
    v_add_u32 v8, 0xfffe0000, v8
    v_add_u32 v9, 0xfffe0000, v9
    v_add_u32 v10, 0xfffe0000, v10
    v_mfma_f32_32x32x16_bf16 v[64:79], v[48:51], v[172:175], v[64:79]
    ds_read_b64_tr_b16 v[32:33], v7 offset:0
    ds_read_b64_tr_b16 v[34:35], v7 offset:1024
    ds_read_b64_tr_b16 v[36:37], v8 offset:0
    ds_read_b64_tr_b16 v[38:39], v8 offset:1024
    v_mfma_f32_32x32x16_bf16 v[80:95], v[52:55], v[172:175], v[80:95]
    ds_read_b64_tr_b16 v[40:41], v9 offset:0
    ds_read_b64_tr_b16 v[42:43], v9 offset:1024
    ds_read_b64_tr_b16 v[44:45], v10 offset:0
    ds_read_b64_tr_b16 v[46:47], v10 offset:1024
    v_mfma_f32_32x32x16_bf16 v[96:111], v[56:59], v[172:175], v[96:111]
    v_mfma_f32_32x32x16_bf16 v[112:127], v[60:63], v[172:175], v[112:127]
    s_waitcnt lgkmcnt(0)
    v_mfma_f32_32x32x16_bf16 v[64:79], v[32:35], v[176:179], v[64:79]
    ds_read_b64_tr_b16 v[48:49], v7 offset:4096
    ds_read_b64_tr_b16 v[50:51], v7 offset:5120
    ds_read_b64_tr_b16 v[52:53], v8 offset:4096
    ds_read_b64_tr_b16 v[54:55], v8 offset:5120
    v_mfma_f32_32x32x16_bf16 v[80:95], v[36:39], v[176:179], v[80:95]
    ds_read_b64_tr_b16 v[56:57], v9 offset:4096
    ds_read_b64_tr_b16 v[58:59], v9 offset:5120
    ds_read_b64_tr_b16 v[60:61], v10 offset:4096
    ds_read_b64_tr_b16 v[62:63], v10 offset:5120
    v_mfma_f32_32x32x16_bf16 v[96:111], v[40:43], v[176:179], v[96:111]
    v_mfma_f32_32x32x16_bf16 v[112:127], v[44:47], v[176:179], v[112:127]
    s_waitcnt lgkmcnt(0)
    v_mfma_f32_32x32x16_bf16 v[64:79], v[48:51], v[180:183], v[64:79]
    ds_read_b64_tr_b16 v[32:33], v7 offset:8192
    ds_read_b64_tr_b16 v[34:35], v7 offset:9216
    ds_read_b64_tr_b16 v[36:37], v8 offset:8192
    ds_read_b64_tr_b16 v[38:39], v8 offset:9216
    v_mfma_f32_32x32x16_bf16 v[80:95], v[52:55], v[180:183], v[80:95]
    ds_read_b64_tr_b16 v[40:41], v9 offset:8192
    ds_read_b64_tr_b16 v[42:43], v9 offset:9216
    ds_read_b64_tr_b16 v[44:45], v10 offset:8192
    ds_read_b64_tr_b16 v[46:47], v10 offset:9216
    v_mfma_f32_32x32x16_bf16 v[96:111], v[56:59], v[180:183], v[96:111]
    v_mfma_f32_32x32x16_bf16 v[112:127], v[60:63], v[180:183], v[112:127]
    s_waitcnt vmcnt(0)
    v_cmp_ne_u32 vcc, s26, v31
    s_and_b32 vcc_lo, vcc_lo, 0xffffffff
    s_and_b32 vcc_hi, vcc_hi, 0x3
    s_or_b32 s60, vcc_lo, vcc_hi
    s_cbranch_scc0 FOK_1
    s_mov_b32 s60, 0xf10000
    s_mov_b32 s61, 0x80000
    s_mov_b32 exec_lo, 0xffffffff
    s_mov_b32 exec_hi, 0x3
POLL_2:
    buffer_load_dword v31, v30, s[28:31], s60 offen sc1
    s_waitcnt vmcnt(0)
    v_cmp_ne_u32 vcc, s26, v31
    s_cbranch_vccz POLLD_3
    s_mov_b64 exec, vcc
    s_sub_u32 s61, s61, 1
    s_cbranch_scc0 POLL_2
POLLD_3:
    s_mov_b64 exec, -1
FOK_1:
    s_xor_b32 s60, s68, 1024
    buffer_load_dwordx4 v[16:19], v1, s[28:31], s60 offen sc1
    buffer_load_dwordx4 v[20:23], v1, s[28:31], s68 offen sc1
    s_lshl_b32 s60, s64, 17
    s_add_u32 s60, s60, 0x200000
    buffer_load_dwordx4 v[224:227], v1, s[28:31], s60 offen sc1
    s_add_u32 m0, s67, 0
    s_nop 0
    buffer_load_dwordx4 v1, s[28:31], s66 offen sc1 lds
    buffer_load_dwordx4 v1, s[28:31], s66 offen offset:1024 sc1 lds
    s_add_u32 m0, s67, 8320
    s_add_u32 s66, s66, 8192
    buffer_load_dwordx4 v1, s[28:31], s66 offen sc1 lds
    buffer_load_dwordx4 v1, s[28:31], s66 offen offset:1024 sc1 lds
    s_add_u32 s66, s66, 8192
    s_waitcnt lgkmcnt(0)
    v_mfma_f32_32x32x16_bf16 v[64:79], v[32:35], v[184:187], v[64:79]
    ds_read_b64_tr_b16 v[48:49], v7 offset:12288
    ds_read_b64_tr_b16 v[50:51], v7 offset:13312
    ds_read_b64_tr_b16 v[52:53], v8 offset:12288
    ds_read_b64_tr_b16 v[54:55], v8 offset:13312
    v_mfma_f32_32x32x16_bf16 v[80:95], v[36:39], v[184:187], v[80:95]
    ds_read_b64_tr_b16 v[56:57], v9 offset:12288
    ds_read_b64_tr_b16 v[58:59], v9 offset:13312
    ds_read_b64_tr_b16 v[60:61], v10 offset:12288
    ds_read_b64_tr_b16 v[62:63], v10 offset:13312
    v_mfma_f32_32x32x16_bf16 v[96:111], v[40:43], v[184:187], v[96:111]
    v_mfma_f32_32x32x16_bf16 v[112:127], v[44:47], v[184:187], v[112:127]
    s_waitcnt lgkmcnt(0)
    v_mfma_f32_32x32x16_bf16 v[64:79], v[48:51], v[188:191], v[64:79]
    v_mfma_f32_32x32x16_bf16 v[80:95], v[52:55], v[188:191], v[80:95]
    v_mfma_f32_32x32x16_bf16 v[96:111], v[56:59], v[188:191], v[96:111]
    v_mfma_f32_32x32x16_bf16 v[112:127], v[60:63], v[188:191], v[112:127]
    s_setprio 3
    s_lshl_b32 s60, s48, 2
    s_add_u32 s60, s60, s51
    s_mul_i32 s60, s60, 112
    s_lshl_b32 s61, s50, 3
    s_add_u32 s60, s60, s61
    s_lshl_b32 s60, s60, 10
    s_add_u32 s57, s60, 0x801000
    s_nop 4
    s_xor_b32 s60, s13, 1
    s_mul_i32 s60, s60, 114688
    v_add_u32 v7, s60, v1
    s_mul_i32 s60, s27, 2560
    s_add_u32 s60, s60, 99328
    v_add_u32 v8, s60, v1
    s_xor_b32 s60, s27, 4
    s_mul_i32 s60, s60, 2560
    s_add_u32 s60, s60, 99328
    v_add_u32 v9, s60, v1
    v_bfe_u32 v10, v0, 2, 1
    v_and_b32 v232, 3, v0
    v_lshl_add_u32 v10, v232, 3, v10
    v_add_u32 v10, s72, v10
    v_lshlrev_b32 v10, 7, v10
    v_pk_mul_f32 v[64:65], v[64:65], v[72:73]
    v_pk_mul_f32 v[66:67], v[66:67], v[74:75]
    v_pk_mul_f32 v[68:69], v[68:69], v[76:77]
    v_pk_mul_f32 v[70:71], v[70:71], v[78:79]
    v_cvt_pk_bf16_f32 v72, v64, v65
    v_cvt_pk_bf16_f32 v73, v66, v67
    v_cvt_pk_bf16_f32 v74, v68, v69
    v_cvt_pk_bf16_f32 v75, v70, v71
    v_pk_mul_f32 v[80:81], v[80:81], v[88:89]
    v_pk_mul_f32 v[82:83], v[82:83], v[90:91]
    v_pk_mul_f32 v[84:85], v[84:85], v[92:93]
    v_pk_mul_f32 v[86:87], v[86:87], v[94:95]
    v_cvt_pk_bf16_f32 v88, v80, v81
    v_cvt_pk_bf16_f32 v89, v82, v83
    v_cvt_pk_bf16_f32 v90, v84, v85
    v_cvt_pk_bf16_f32 v91, v86, v87
    s_waitcnt vmcnt(4)
    v_mfma_f32_32x32x16_bf16 v[128:143], v[224:227], v[16:19], 0
    v_mfma_f32_32x32x16_bf16 v[144:159], v[224:227], v[20:23], 0
    v_pk_mul_f32 v[96:97], v[96:97], v[104:105]
    v_pk_mul_f32 v[98:99], v[98:99], v[106:107]
    v_pk_mul_f32 v[100:101], v[100:101], v[108:109]
    v_pk_mul_f32 v[102:103], v[102:103], v[110:111]
    v_cvt_pk_bf16_f32 v104, v96, v97
    v_cvt_pk_bf16_f32 v105, v98, v99
    v_cvt_pk_bf16_f32 v106, v100, v101
    v_cvt_pk_bf16_f32 v107, v102, v103
    v_pk_mul_f32 v[112:113], v[112:113], v[120:121]
    v_pk_mul_f32 v[114:115], v[114:115], v[122:123]
    v_pk_mul_f32 v[116:117], v[116:117], v[124:125]
    v_pk_mul_f32 v[118:119], v[118:119], v[126:127]
    v_cvt_pk_bf16_f32 v120, v112, v113
    v_cvt_pk_bf16_f32 v121, v114, v115
    v_cvt_pk_bf16_f32 v122, v116, v117
    v_cvt_pk_bf16_f32 v123, v118, v119
    s_nop 3
    v_max3_f32 v232, v128, v129, v130
    v_max3_f32 v232, v232, v131, v132
    v_max3_f32 v232, v232, v133, v134
    v_max3_f32 v232, v232, v135, v136
    v_max3_f32 v232, v232, v137, v138
    v_max3_f32 v232, v232, v139, v140
    v_max3_f32 v232, v232, v141, v142
    v_max_f32 v232, v232, v143
    v_mov_b32 v234, v232
    s_nop 1
    v_permlane32_swap_b32 v232, v234
    s_nop 1
    v_max_f32 v232, v232, v234
    v_max3_f32 v233, v144, v145, v146
    v_max3_f32 v233, v233, v147, v148
    v_max3_f32 v233, v233, v149, v150
    v_max3_f32 v233, v233, v151, v152
    v_max3_f32 v233, v233, v153, v154
    v_max3_f32 v233, v233, v155, v156
    v_max3_f32 v233, v233, v157, v158
    v_max_f32 v233, v233, v159
    v_mov_b32 v234, v233
    s_nop 1
    v_permlane32_swap_b32 v233, v234
    s_nop 1
    v_max_f32 v233, v233, v234
    v_min_f32 v232, v232, v233
    v_sub_f32 v240, 0, v232
    v_sub_f32 v241, 0, v232
    v_sub_f32 v242, 0, v232
    v_sub_f32 v243, 0, v232
    v_sub_f32 v244, 0, v232
    v_sub_f32 v245, 0, v232
    v_sub_f32 v246, 0, v232
    v_sub_f32 v247, 0, v232
    v_sub_f32 v248, 0, v232
    v_sub_f32 v249, 0, v232
    v_sub_f32 v250, 0, v232
    v_sub_f32 v251, 0, v232
    v_sub_f32 v252, 0, v232
    v_sub_f32 v253, 0, v232
    v_sub_f32 v254, 0, v232
    v_sub_f32 v255, 0, v232
    s_add_u32 m0, s67, 33280
    s_nop 0
    buffer_load_dwordx4 v1, s[28:31], s66 offen sc1 lds
    buffer_load_dwordx4 v1, s[28:31], s66 offen offset:1024 sc1 lds
    s_add_u32 m0, s67, 41600
    s_add_u32 s66, s66, 8192
    buffer_load_dwordx4 v1, s[28:31], s66 offen sc1 lds
    buffer_load_dwordx4 v1, s[28:31], s66 offen offset:1024 sc1 lds
    s_add_u32 s66, s66, 8192
    s_waitcnt vmcnt(4)
    s_barrier
    ds_read_b128 v[24:27], v2 offset:0
    ds_read_b128 v[208:211], v3 offset:1024
    ds_read_b128 v[212:215], v4 offset:1536
    s_waitcnt lgkmcnt(2)
    v_mfma_f32_32x32x16_bf16 v[128:143], v[24:27], v[16:19], v[240:255]
    buffer_store_dwordx4 v[72:75], v1, s[28:31], s57 offen offset:0 sc1
    buffer_store_dwordx4 v[88:91], v1, s[28:31], s57 offen offset:1024 sc1
    buffer_store_dwordx4 v[104:107], v1, s[28:31], s57 offen offset:2048 sc1
    buffer_store_dwordx4 v[120:123], v1, s[28:31], s57 offen offset:3072 sc1
    s_branch ATTN
CLS0:
    s_add_u32 s71, s3, 0
    s_and_b32 s71, s71, 7
    s_mul_i32 s71, s71, 229376
    s_add_u32 s71, s71, s56
    s_add_u32 m0, s59, 32768
    s_add_u32 s60, s71, 0
    buffer_load_dwordx4 v28, s[40:43], s60 offen lds
    s_add_u32 m0, s59, 49152
    s_add_u32 s60, s71, 0
    buffer_load_dwordx4 v29, s[44:47], s60 offen lds
    s_add_u32 m0, s59, 33792
    s_add_u32 s60, s71, 14336
    buffer_load_dwordx4 v28, s[40:43], s60 offen lds
    s_add_u32 m0, s59, 50176
    s_add_u32 s60, s71, 14336
    buffer_load_dwordx4 v29, s[44:47], s60 offen lds
    v_mov_b32 v24, 0
    s_mov_b32 s60, 0xf04000
    buffer_load_dword v25, v24, s[28:31], s60 offen sc1
    s_lshl_b32 s60, s69, 10
    buffer_load_dwordx4 v[16:19], v1, s[72:75], 0 offen
    buffer_load_dwordx4 v[20:23], v1, s[32:35], s60 offen
    s_and_b32 s60, s2, 7
    s_lshr_b32 s61, s2, 3
    s_lshl_b32 s4, s60, 2
    s_and_b32 s60, s61, 3
    s_add_u32 s4, s4, s60
    s_lshr_b32 s5, s61, 2
    s_mov_b32 s0, 0xffff
    s_mov_b32 s1, 0xffff
    s_and_b32 s13, s27, 1
    s_lshr_b32 s14, s27, 1
    s_mul_i32 s60, s4, 224
    s_mul_i32 s61, s27, 14
    s_add_u32 s60, s60, s61
    s_lshl_b32 s6, s60, 10
    s_add_u32 s6, s6, 0x800000
    s_lshl_b32 s7, s61, 14
    s_lshl_b32 s60, s5, 7
    s_add_u32 s7, s7, s60
    s_lshl_b32 s10, s27, 16
    s_add_u32 s10, s10, s60
    s_lshl_b32 s11, s51, 13
    s_lshl_b32 s60, s52, 17
    s_add_u32 s11, s11, s60
    s_lshl_b32 s60, s48, 2
    s_add_u32 s60, s60, s51
    s_lshl_b32 s60, s60, 5
    s_lshl_b32 s61, s50, 1
    s_add_u32 s60, s60, s61
    s_add_u32 s60, s60, s52
    s_lshl_b32 s60, s60, 7
    s_add_u32 s12, s60, 0xf70000
    s_lshl_b32 s60, s65, 3
    s_lshl_b32 s61, s51, 1
    s_add_u32 s60, s60, s61
    s_add_u32 s60, s60, s52
    s_lshl_b32 s60, s60, 5
    s_add_u32 s60, s60, s64
    s_lshl_b32 s18, s60, 10
    s_add_u32 s18, s18, 0x600000
    v_and_b32 v30, 31, v0
    v_lshrrev_b32 v31, 5, v0
    v_bfe_u32 v32, v0, 1, 3
    v_xor_b32 v32, v32, v31
    s_lshl_b32 s60, s51, 12
    v_lshlrev_b32 v33, 7, v30
    v_add_u32 v33, s60, v33
    v_xor_b32 v34, 0, v32
    v_lshl_add_u32 v2, v34, 4, v33
    v_xor_b32 v34, 2, v32
    v_lshl_add_u32 v3, v34, 4, v33
    v_xor_b32 v34, 4, v32
    v_lshl_add_u32 v4, v34, 4, v33
    v_xor_b32 v34, 6, v32
    v_lshl_add_u32 v5, v34, 4, v33
    v_bfe_u32 v32, v0, 2, 2
    v_lshl_add_u32 v33, v31, 3, v32
    v_mul_u32_u24 v34, 192, v33
    v_bfe_u32 v35, v0, 4, 1
    v_lshl_add_u32 v34, v35, 5, v34
    v_and_b32 v36, 3, v0
    v_lshl_add_u32 v34, v36, 3, v34
    v_add_u32 v6, 16384, v34
    v_lshlrev_b32 v33, 8, v33
    v_lshl_add_u32 v33, v35, 14, v33
    v_lshl_add_u32 v33, v36, 3, v33
    v_bfe_u32 v32, v0, 2, 3
    v_xor_b32 v34, 0, v32
    v_lshl_add_u32 v7, v34, 5, v33
    v_xor_b32 v34, 1, v32
    v_lshl_add_u32 v8, v34, 5, v33
    v_xor_b32 v34, 2, v32
    v_lshl_add_u32 v9, v34, 5, v33
    v_xor_b32 v34, 3, v32
    v_lshl_add_u32 v10, v34, 5, v33
    s_waitcnt vmcnt(7)
    s_barrier
    ds_read_b128 v[160:163], v2 offset:0
    ds_read_b64_tr_b16 v[32:33], v6 offset:0
    ds_read_b64_tr_b16 v[34:35], v6 offset:768
    ds_read_b64_tr_b16 v[36:37], v6 offset:64
    ds_read_b64_tr_b16 v[38:39], v6 offset:832
    ds_read_b128 v[164:167], v3 offset:0
    ds_read_b64_tr_b16 v[40:41], v6 offset:3072
    ds_read_b64_tr_b16 v[42:43], v6 offset:3840
    ds_read_b64_tr_b16 v[44:45], v6 offset:3136
    ds_read_b64_tr_b16 v[46:47], v6 offset:3904
    ds_read_b128 v[168:171], v4 offset:0
    ds_read_b64_tr_b16 v[48:49], v6 offset:6144
    ds_read_b64_tr_b16 v[50:51], v6 offset:6912
    ds_read_b64_tr_b16 v[52:53], v6 offset:6208
    ds_read_b64_tr_b16 v[54:55], v6 offset:6976
    s_waitcnt lgkmcnt(10)
    ds_read_b128 v[172:175], v5 offset:0
    ds_read_b64_tr_b16 v[56:57], v6 offset:9216
    ds_read_b64_tr_b16 v[58:59], v6 offset:9984
    ds_read_b64_tr_b16 v[60:61], v6 offset:9280
    ds_read_b64_tr_b16 v[62:63], v6 offset:10048
    s_add_u32 s19, s3, 1
    s_and_b32 s19, s19, 7
    s_lshl_b32 s15, s19, 7
    s_add_u32 s15, s15, s54
    s_mul_i32 s19, s19, 196608
    s_add_u32 m0, s57, 65536
    s_add_u32 s60, s15, 0
    buffer_load_dwordx4 v11, s[32:35], s60 offen lds
    s_add_u32 m0, s57, 66560
    s_add_u32 s60, s15, 8192
    buffer_load_dwordx4 v12, s[32:35], s60 offen lds
    s_add_u32 m0, s58, 81920
    s_add_u32 s60, s55, s19
    buffer_load_dwordx4 v13, s[36:39], s60 offen lds
    s_waitcnt lgkmcnt(15)
    v_mfma_f32_32x32x16_bf16 v[128:143], v[32:35], v[160:163], 0
    v_mfma_f32_32x32x16_bf16 v[144:159], v[36:39], v[160:163], 0
    s_waitcnt lgkmcnt(10)
    v_mfma_f32_32x32x16_bf16 v[128:143], v[40:43], v[164:167], v[128:143]
    v_mfma_f32_32x32x16_bf16 v[144:159], v[44:47], v[164:167], v[144:159]
    s_waitcnt vmcnt(6) lgkmcnt(0)
    s_barrier
    v_mfma_f32_32x32x16_bf16 v[128:143], v[48:51], v[168:171], v[128:143]
    ds_read_b64_tr_b16 v[32:33], v7 offset:32768
    ds_read_b64_tr_b16 v[34:35], v7 offset:33792
    ds_read_b64_tr_b16 v[36:37], v8 offset:32768
    ds_read_b64_tr_b16 v[38:39], v8 offset:33792
    v_mfma_f32_32x32x16_bf16 v[144:159], v[52:55], v[168:171], v[144:159]
    ds_read_b64_tr_b16 v[40:41], v9 offset:32768
    ds_read_b64_tr_b16 v[42:43], v9 offset:33792
    ds_read_b64_tr_b16 v[44:45], v10 offset:32768
    ds_read_b64_tr_b16 v[46:47], v10 offset:33792
    v_mfma_f32_32x32x16_bf16 v[128:143], v[56:59], v[172:175], v[128:143]
    s_add_u32 s19, s3, 2
    s_and_b32 s19, s19, 7
    s_lshl_b32 s15, s19, 7
    s_add_u32 s15, s15, s54
    s_mul_i32 s19, s19, 196608
    s_add_u32 m0, s57, 98304
    s_add_u32 s60, s15, 0
    buffer_load_dwordx4 v11, s[32:35], s60 offen lds
    v_mfma_f32_32x32x16_bf16 v[144:159], v[60:63], v[172:175], v[144:159]
    s_add_u32 m0, s57, 99328
    s_add_u32 s60, s15, 8192
    buffer_load_dwordx4 v12, s[32:35], s60 offen lds
    s_waitcnt lgkmcnt(0)
    v_mfma_f32_32x32x16_bf16 v[64:79], v[32:35], v[160:163], 0
    ds_read_b64_tr_b16 v[48:49], v7 offset:36864
    ds_read_b64_tr_b16 v[50:51], v7 offset:37888
    ds_read_b64_tr_b16 v[52:53], v8 offset:36864
    ds_read_b64_tr_b16 v[54:55], v8 offset:37888
    v_mfma_f32_32x32x16_bf16 v[80:95], v[36:39], v[160:163], 0
    ds_read_b64_tr_b16 v[56:57], v9 offset:36864
    ds_read_b64_tr_b16 v[58:59], v9 offset:37888
    ds_read_b64_tr_b16 v[60:61], v10 offset:36864
    ds_read_b64_tr_b16 v[62:63], v10 offset:37888
    v_mfma_f32_32x32x16_bf16 v[96:111], v[40:43], v[160:163], 0
    s_add_u32 m0, s58, 114688
    s_add_u32 s60, s55, s19
    buffer_load_dwordx4 v13, s[36:39], s60 offen lds
    v_mfma_f32_32x32x16_bf16 v[112:127], v[44:47], v[160:163], 0
    s_add_u32 s19, s3, 3
    s_and_b32 s19, s19, 7
    s_lshl_b32 s15, s19, 7
    s_add_u32 s15, s15, s54
    s_mul_i32 s19, s19, 196608
    s_add_u32 m0, s57, 131072
    s_add_u32 s60, s15, 0
    buffer_load_dwordx4 v11, s[32:35], s60 offen lds
    s_waitcnt vmcnt(7)
    s_mov_b32 s63, 0xffff0000
    v_lshlrev_b32 v30, 16, v16
    v_and_b32 v16, s63, v16
    v_lshlrev_b32 v31, 16, v20
    v_and_b32 v20, s63, v20
    v_mul_f32 v30, v30, v31
    v_mul_f32 v31, v16, v20
    v_cvt_pk_bf16_f32 v30, v30, v31
    v_and_b32 v31, s63, v30
    v_lshlrev_b32 v30, 16, v30
    v_add_f32 v26, v30, v31
    v_lshlrev_b32 v30, 16, v17
    v_and_b32 v17, s63, v17
    v_lshlrev_b32 v31, 16, v21
    v_and_b32 v21, s63, v21
    v_mul_f32 v30, v30, v31
    v_mul_f32 v31, v17, v21
    v_cvt_pk_bf16_f32 v30, v30, v31
    v_and_b32 v31, s63, v30
    v_lshlrev_b32 v30, 16, v30
    v_add_f32 v26, v26, v30
    v_add_f32 v26, v26, v31
    v_lshlrev_b32 v30, 16, v18
    v_and_b32 v18, s63, v18
    v_lshlrev_b32 v31, 16, v22
    v_and_b32 v22, s63, v22
    v_mul_f32 v30, v30, v31
    v_mul_f32 v31, v18, v22
    v_cvt_pk_bf16_f32 v30, v30, v31
    v_and_b32 v31, s63, v30
    v_lshlrev_b32 v30, 16, v30
    v_add_f32 v26, v26, v30
    v_add_f32 v26, v26, v31
    v_lshlrev_b32 v30, 16, v19
    v_and_b32 v19, s63, v19
    v_lshlrev_b32 v31, 16, v23
    v_and_b32 v23, s63, v23
    v_mul_f32 v30, v30, v31
    v_mul_f32 v31, v19, v23
    v_cvt_pk_bf16_f32 v30, v30, v31
    v_and_b32 v31, s63, v30
    v_lshlrev_b32 v30, 16, v30
    v_add_f32 v26, v26, v30
    v_add_f32 v26, v26, v31
    s_nop 1
    v_add_f32_dpp v26, v26, v26 row_ror:8 row_mask:0xf bank_mask:0xf
    s_nop 1
    v_add_f32_dpp v26, v26, v26 row_ror:4 row_mask:0xf bank_mask:0xf
    s_nop 1
    v_add_f32_dpp v26, v26, v26 row_ror:2 row_mask:0xf bank_mask:0xf
    s_nop 1
    v_add_f32_dpp v26, v26, v26 row_ror:1 row_mask:0xf bank_mask:0xf
    s_nop 1
    v_readlane_b32 s60, v26, 0
    v_readlane_b32 s61, v26, 16
    v_readlane_b32 s62, v26, 32
    v_readlane_b32 s63, v26, 48
    s_nop 1
    v_mov_b32 v26, s60
    v_add_f32 v26, s61, v26
    v_add_f32 v26, s62, v26
    v_add_f32 v26, s63, v26
    v_cvt_pk_bf16_f32 v26, v26, v26
    v_lshlrev_b32 v26, 16, v26
    v_mul_f32 v26, 0xbfb8aa3b, v26
    v_exp_f32 v26, v26
    s_nop 0
    v_add_f32 v26, 1.0, v26
    v_rcp_f32 v26, v26
    s_nop 0
    v_cvt_pk_bf16_f32 v26, v26, v26
    v_lshlrev_b32 v26, 16, v26
    s_mov_b32 s72, s22
    s_and_b32 s73, s23, 0xffff
    s_mov_b32 s74, 0x100
    s_mov_b32 s75, 0x00020000
    buffer_load_dword v16, v24, s[72:75], 0 offen sc1
    s_waitcnt lgkmcnt(0)
    v_mfma_f32_32x32x16_bf16 v[64:79], v[48:51], v[164:167], v[64:79]
    ds_read_b64_tr_b16 v[32:33], v7 offset:40960
    ds_read_b64_tr_b16 v[34:35], v7 offset:41984
    ds_read_b64_tr_b16 v[36:37], v8 offset:40960
    ds_read_b64_tr_b16 v[38:39], v8 offset:41984
    v_mfma_f32_32x32x16_bf16 v[80:95], v[52:55], v[164:167], v[80:95]
    ds_read_b64_tr_b16 v[40:41], v9 offset:40960
    ds_read_b64_tr_b16 v[42:43], v9 offset:41984
    ds_read_b64_tr_b16 v[44:45], v10 offset:40960
    ds_read_b64_tr_b16 v[46:47], v10 offset:41984
    v_mfma_f32_32x32x16_bf16 v[96:111], v[56:59], v[164:167], v[96:111]
    s_add_u32 m0, s57, 132096
    s_add_u32 s60, s15, 8192
    buffer_load_dwordx4 v12, s[32:35], s60 offen lds
    v_mfma_f32_32x32x16_bf16 v[112:127], v[60:63], v[164:167], v[112:127]
    s_add_u32 m0, s58, 147456
    s_add_u32 s60, s55, s19
    buffer_load_dwordx4 v13, s[36:39], s60 offen lds
    s_waitcnt lgkmcnt(0)
    v_mfma_f32_32x32x16_bf16 v[64:79], v[32:35], v[168:171], v[64:79]
    ds_read_b64_tr_b16 v[48:49], v7 offset:45056
    ds_read_b64_tr_b16 v[50:51], v7 offset:46080
    ds_read_b64_tr_b16 v[52:53], v8 offset:45056
    ds_read_b64_tr_b16 v[54:55], v8 offset:46080
    v_mfma_f32_32x32x16_bf16 v[80:95], v[36:39], v[168:171], v[80:95]
    ds_read_b64_tr_b16 v[56:57], v9 offset:45056
    ds_read_b64_tr_b16 v[58:59], v9 offset:46080
    ds_read_b64_tr_b16 v[60:61], v10 offset:45056
    ds_read_b64_tr_b16 v[62:63], v10 offset:46080
    v_mfma_f32_32x32x16_bf16 v[96:111], v[40:43], v[168:171], v[96:111]
    s_add_u32 s71, s3, 1
    s_and_b32 s71, s71, 7
    s_mul_i32 s71, s71, 229376
    s_add_u32 s71, s71, s56
    s_add_u32 m0, s59, 0
    s_add_u32 s60, s71, 0
    buffer_load_dwordx4 v28, s[40:43], s60 offen lds
    v_mfma_f32_32x32x16_bf16 v[112:127], v[44:47], v[168:171], v[112:127]
    s_add_u32 m0, s59, 16384
    s_add_u32 s60, s71, 0
    buffer_load_dwordx4 v29, s[44:47], s60 offen lds
    s_waitcnt vmcnt(9) lgkmcnt(0)
    s_barrier
    v_add_u32 v2, 0x10000, v2
    v_add_u32 v3, 0x10000, v3
    v_add_u32 v4, 0x10000, v4
    v_add_u32 v5, 0x10000, v5
    v_add_u32 v6, 0x10000, v6
    ds_read_b128 v[176:179], v2 offset:0
    ds_read_b64_tr_b16 v[32:33], v6 offset:0
    ds_read_b64_tr_b16 v[34:35], v6 offset:768
    ds_read_b64_tr_b16 v[36:37], v6 offset:64
    ds_read_b64_tr_b16 v[38:39], v6 offset:832
    v_mfma_f32_32x32x16_bf16 v[64:79], v[48:51], v[172:175], v[64:79]
    v_mfma_f32_32x32x16_bf16 v[80:95], v[52:55], v[172:175], v[80:95]
    ds_read_b128 v[180:183], v3 offset:0
    ds_read_b64_tr_b16 v[40:41], v6 offset:3072
    ds_read_b64_tr_b16 v[42:43], v6 offset:3840
    ds_read_b64_tr_b16 v[44:45], v6 offset:3136
    ds_read_b64_tr_b16 v[46:47], v6 offset:3904
    v_mfma_f32_32x32x16_bf16 v[96:111], v[56:59], v[172:175], v[96:111]
    v_mfma_f32_32x32x16_bf16 v[112:127], v[60:63], v[172:175], v[112:127]
    ds_read_b128 v[184:187], v4 offset:0
    ds_read_b64_tr_b16 v[48:49], v6 offset:6144
    ds_read_b64_tr_b16 v[50:51], v6 offset:6912
    ds_read_b64_tr_b16 v[52:53], v6 offset:6208
    ds_read_b64_tr_b16 v[54:55], v6 offset:6976
    s_waitcnt lgkmcnt(10)
    ds_read_b128 v[188:191], v5 offset:0
    ds_read_b64_tr_b16 v[56:57], v6 offset:9216
    ds_read_b64_tr_b16 v[58:59], v6 offset:9984
    ds_read_b64_tr_b16 v[60:61], v6 offset:9280
    ds_read_b64_tr_b16 v[62:63], v6 offset:10048
    s_add_u32 m0, s59, 1024
    s_add_u32 s60, s71, 14336
    buffer_load_dwordx4 v28, s[40:43], s60 offen lds
    s_add_u32 m0, s59, 17408
    s_add_u32 s60, s71, 14336
    buffer_load_dwordx4 v29, s[44:47], s60 offen lds
    s_add_u32 s19, s3, 4
    s_and_b32 s19, s19, 7
    s_lshl_b32 s15, s19, 7
    s_add_u32 s15, s15, s54
    s_mul_i32 s19, s19, 196608
    s_add_u32 m0, s57, 32768
    s_add_u32 s60, s15, 0
    buffer_load_dwordx4 v11, s[32:35], s60 offen lds
    s_waitcnt lgkmcnt(15)
    v_mfma_f32_32x32x16_bf16 v[128:143], v[32:35], v[176:179], v[128:143]
    v_mfma_f32_32x32x16_bf16 v[144:159], v[36:39], v[176:179], v[144:159]
    s_waitcnt lgkmcnt(10)
    v_mfma_f32_32x32x16_bf16 v[128:143], v[40:43], v[180:183], v[128:143]
    v_mfma_f32_32x32x16_bf16 v[144:159], v[44:47], v[180:183], v[144:159]
    s_waitcnt vmcnt(9) lgkmcnt(0)
    s_barrier
    ds_read_b128 v[192:195], v2 offset:32768
    ds_read_b64_tr_b16 v[32:33], v6 offset:32768
    ds_read_b64_tr_b16 v[34:35], v6 offset:33536
    ds_read_b64_tr_b16 v[36:37], v6 offset:32832
    ds_read_b64_tr_b16 v[38:39], v6 offset:33600
    v_mfma_f32_32x32x16_bf16 v[128:143], v[48:51], v[184:187], v[128:143]
    v_mfma_f32_32x32x16_bf16 v[144:159], v[52:55], v[184:187], v[144:159]
    ds_read_b128 v[196:199], v3 offset:32768
    ds_read_b64_tr_b16 v[40:41], v6 offset:35840
    ds_read_b64_tr_b16 v[42:43], v6 offset:36608
    ds_read_b64_tr_b16 v[44:45], v6 offset:35904
    ds_read_b64_tr_b16 v[46:47], v6 offset:36672
    v_mfma_f32_32x32x16_bf16 v[128:143], v[56:59], v[188:191], v[128:143]
    v_mfma_f32_32x32x16_bf16 v[144:159], v[60:63], v[188:191], v[144:159]
    ds_read_b128 v[200:203], v4 offset:32768
    ds_read_b64_tr_b16 v[48:49], v6 offset:38912
    ds_read_b64_tr_b16 v[50:51], v6 offset:39680
    ds_read_b64_tr_b16 v[52:53], v6 offset:38976
    ds_read_b64_tr_b16 v[54:55], v6 offset:39744
    s_waitcnt lgkmcnt(10)
    ds_read_b128 v[204:207], v5 offset:32768
    ds_read_b64_tr_b16 v[56:57], v6 offset:41984
    ds_read_b64_tr_b16 v[58:59], v6 offset:42752
    ds_read_b64_tr_b16 v[60:61], v6 offset:42048
    ds_read_b64_tr_b16 v[62:63], v6 offset:42816
    s_add_u32 m0, s57, 33792
    s_add_u32 s60, s15, 8192
    buffer_load_dwordx4 v12, s[32:35], s60 offen lds
    s_add_u32 m0, s58, 49152
    s_add_u32 s60, s55, s19
    buffer_load_dwordx4 v13, s[36:39], s60 offen lds
    s_add_u32 s19, s3, 5
    s_and_b32 s19, s19, 7
    s_lshl_b32 s15, s19, 7
    s_add_u32 s15, s15, s54
    s_mul_i32 s19, s19, 196608
    s_add_u32 m0, s57, 65536
    s_add_u32 s60, s15, 0
    buffer_load_dwordx4 v11, s[32:35], s60 offen lds
    s_waitcnt lgkmcnt(15)
    v_mfma_f32_32x32x16_bf16 v[128:143], v[32:35], v[192:195], v[128:143]
    v_mfma_f32_32x32x16_bf16 v[144:159], v[36:39], v[192:195], v[144:159]
    s_waitcnt lgkmcnt(10)
    v_mfma_f32_32x32x16_bf16 v[128:143], v[40:43], v[196:199], v[128:143]
    v_mfma_f32_32x32x16_bf16 v[144:159], v[44:47], v[196:199], v[144:159]
    s_waitcnt vmcnt(8) lgkmcnt(0)
    s_barrier
    v_add_u32 v2, 0x10000, v2
    v_add_u32 v3, 0x10000, v3
    v_add_u32 v4, 0x10000, v4
    v_add_u32 v5, 0x10000, v5
    v_add_u32 v6, 0x10000, v6
    ds_read_b128 v[208:211], v2 offset:0
    ds_read_b64_tr_b16 v[32:33], v6 offset:0
    ds_read_b64_tr_b16 v[34:35], v6 offset:768
    ds_read_b64_tr_b16 v[36:37], v6 offset:64
    ds_read_b64_tr_b16 v[38:39], v6 offset:832
    v_mfma_f32_32x32x16_bf16 v[128:143], v[48:51], v[200:203], v[128:143]
    v_mfma_f32_32x32x16_bf16 v[144:159], v[52:55], v[200:203], v[144:159]
    ds_read_b128 v[212:215], v3 offset:0
    ds_read_b64_tr_b16 v[40:41], v6 offset:3072
    ds_read_b64_tr_b16 v[42:43], v6 offset:3840
    ds_read_b64_tr_b16 v[44:45], v6 offset:3136
    ds_read_b64_tr_b16 v[46:47], v6 offset:3904
    v_mfma_f32_32x32x16_bf16 v[128:143], v[56:59], v[204:207], v[128:143]
    v_mfma_f32_32x32x16_bf16 v[144:159], v[60:63], v[204:207], v[144:159]
    ds_read_b128 v[216:219], v4 offset:0
    ds_read_b64_tr_b16 v[48:49], v6 offset:6144
    ds_read_b64_tr_b16 v[50:51], v6 offset:6912
    ds_read_b64_tr_b16 v[52:53], v6 offset:6208
    ds_read_b64_tr_b16 v[54:55], v6 offset:6976
    s_waitcnt lgkmcnt(10)
    ds_read_b128 v[220:223], v5 offset:0
    ds_read_b64_tr_b16 v[56:57], v6 offset:9216
    ds_read_b64_tr_b16 v[58:59], v6 offset:9984
    ds_read_b64_tr_b16 v[60:61], v6 offset:9280
    ds_read_b64_tr_b16 v[62:63], v6 offset:10048
    s_add_u32 m0, s57, 66560
    s_add_u32 s60, s15, 8192
    buffer_load_dwordx4 v12, s[32:35], s60 offen lds
    s_add_u32 m0, s58, 81920
    s_add_u32 s60, s55, s19
    buffer_load_dwordx4 v13, s[36:39], s60 offen lds
    s_add_u32 s19, s3, 6
    s_and_b32 s19, s19, 7
    s_lshl_b32 s15, s19, 7
    s_add_u32 s15, s15, s54
    s_mul_i32 s19, s19, 196608
    s_add_u32 m0, s57, 98304
    s_add_u32 s60, s15, 0
    buffer_load_dwordx4 v11, s[32:35], s60 offen lds
    s_waitcnt lgkmcnt(15)
    v_mfma_f32_32x32x16_bf16 v[128:143], v[32:35], v[208:211], v[128:143]
    v_mfma_f32_32x32x16_bf16 v[144:159], v[36:39], v[208:211], v[144:159]
    s_waitcnt lgkmcnt(10)
    v_mfma_f32_32x32x16_bf16 v[128:143], v[40:43], v[212:215], v[128:143]
    v_mfma_f32_32x32x16_bf16 v[144:159], v[44:47], v[212:215], v[144:159]
    s_waitcnt vmcnt(7) lgkmcnt(0)
    s_barrier
    v_mfma_f32_32x32x16_bf16 v[128:143], v[48:51], v[216:219], v[128:143]
    ds_read_b64_tr_b16 v[32:33], v7 offset:0
    ds_read_b64_tr_b16 v[34:35], v7 offset:1024
    ds_read_b64_tr_b16 v[36:37], v8 offset:0
    ds_read_b64_tr_b16 v[38:39], v8 offset:1024
    v_mfma_f32_32x32x16_bf16 v[144:159], v[52:55], v[216:219], v[144:159]
    ds_read_b64_tr_b16 v[40:41], v9 offset:0
    ds_read_b64_tr_b16 v[42:43], v9 offset:1024
    ds_read_b64_tr_b16 v[44:45], v10 offset:0
    ds_read_b64_tr_b16 v[46:47], v10 offset:1024
    v_mfma_f32_32x32x16_bf16 v[128:143], v[56:59], v[220:223], v[128:143]
    s_add_u32 m0, s57, 99328
    s_add_u32 s60, s15, 8192
    buffer_load_dwordx4 v12, s[32:35], s60 offen lds
    v_mfma_f32_32x32x16_bf16 v[144:159], v[60:63], v[220:223], v[144:159]
    s_add_u32 m0, s58, 114688
    s_add_u32 s60, s55, s19
    buffer_load_dwordx4 v13, s[36:39], s60 offen lds
    s_waitcnt lgkmcnt(0)
    v_mfma_f32_32x32x16_bf16 v[64:79], v[32:35], v[176:179], v[64:79]
    ds_read_b64_tr_b16 v[48:49], v7 offset:4096
    ds_read_b64_tr_b16 v[50:51], v7 offset:5120
    ds_read_b64_tr_b16 v[52:53], v8 offset:4096
    ds_read_b64_tr_b16 v[54:55], v8 offset:5120
    v_mfma_f32_32x32x16_bf16 v[80:95], v[36:39], v[176:179], v[80:95]
    ds_read_b64_tr_b16 v[56:57], v9 offset:4096
    ds_read_b64_tr_b16 v[58:59], v9 offset:5120
    ds_read_b64_tr_b16 v[60:61], v10 offset:4096
    ds_read_b64_tr_b16 v[62:63], v10 offset:5120
    v_mfma_f32_32x32x16_bf16 v[96:111], v[40:43], v[176:179], v[96:111]
    s_add_u32 s19, s3, 7
    s_and_b32 s19, s19, 7
    s_lshl_b32 s15, s19, 7
    s_add_u32 s15, s15, s54
    s_mul_i32 s19, s19, 196608
    s_add_u32 m0, s57, 131072
    s_add_u32 s60, s15, 0
    buffer_load_dwordx4 v11, s[32:35], s60 offen lds
    v_mfma_f32_32x32x16_bf16 v[112:127], v[44:47], v[176:179], v[112:127]
    s_add_u32 m0, s57, 132096
    s_add_u32 s60, s15, 8192
    buffer_load_dwordx4 v12, s[32:35], s60 offen lds
    s_waitcnt lgkmcnt(0)
    v_mfma_f32_32x32x16_bf16 v[64:79], v[48:51], v[180:183], v[64:79]
    ds_read_b64_tr_b16 v[32:33], v7 offset:8192
    ds_read_b64_tr_b16 v[34:35], v7 offset:9216
    ds_read_b64_tr_b16 v[36:37], v8 offset:8192
    ds_read_b64_tr_b16 v[38:39], v8 offset:9216
    v_mfma_f32_32x32x16_bf16 v[80:95], v[52:55], v[180:183], v[80:95]
    ds_read_b64_tr_b16 v[40:41], v9 offset:8192
    ds_read_b64_tr_b16 v[42:43], v9 offset:9216
    ds_read_b64_tr_b16 v[44:45], v10 offset:8192
    ds_read_b64_tr_b16 v[46:47], v10 offset:9216
    v_mfma_f32_32x32x16_bf16 v[96:111], v[56:59], v[180:183], v[96:111]
    s_add_u32 m0, s58, 147456
    s_add_u32 s60, s55, s19
    buffer_load_dwordx4 v13, s[36:39], s60 offen lds
    v_mfma_f32_32x32x16_bf16 v[112:127], v[60:63], v[180:183], v[112:127]
    s_waitcnt lgkmcnt(0)
    v_mfma_f32_32x32x16_bf16 v[64:79], v[32:35], v[184:187], v[64:79]
    ds_read_b64_tr_b16 v[48:49], v7 offset:12288
    ds_read_b64_tr_b16 v[50:51], v7 offset:13312
    ds_read_b64_tr_b16 v[52:53], v8 offset:12288
    ds_read_b64_tr_b16 v[54:55], v8 offset:13312
    v_mfma_f32_32x32x16_bf16 v[80:95], v[36:39], v[184:187], v[80:95]
    ds_read_b64_tr_b16 v[56:57], v9 offset:12288
    ds_read_b64_tr_b16 v[58:59], v9 offset:13312
    ds_read_b64_tr_b16 v[60:61], v10 offset:12288
    ds_read_b64_tr_b16 v[62:63], v10 offset:13312
    v_mfma_f32_32x32x16_bf16 v[96:111], v[40:43], v[184:187], v[96:111]
    v_mfma_f32_32x32x16_bf16 v[112:127], v[44:47], v[184:187], v[112:127]
    s_waitcnt vmcnt(9) lgkmcnt(0)
    s_barrier
    v_add_u32 v2, 0xfffe8000, v2
    v_add_u32 v3, 0xfffe8000, v3
    v_add_u32 v4, 0xfffe8000, v4
    v_add_u32 v5, 0xfffe8000, v5
    v_add_u32 v6, 0xfffe8000, v6
    ds_read_b128 v[224:227], v2 offset:0
    ds_read_b64_tr_b16 v[32:33], v6 offset:0
    ds_read_b64_tr_b16 v[34:35], v6 offset:768
    ds_read_b64_tr_b16 v[36:37], v6 offset:64
    ds_read_b64_tr_b16 v[38:39], v6 offset:832
    v_mfma_f32_32x32x16_bf16 v[64:79], v[48:51], v[188:191], v[64:79]
    v_mfma_f32_32x32x16_bf16 v[80:95], v[52:55], v[188:191], v[80:95]
    ds_read_b128 v[228:231], v3 offset:0
    ds_read_b64_tr_b16 v[40:41], v6 offset:3072
    ds_read_b64_tr_b16 v[42:43], v6 offset:3840
    ds_read_b64_tr_b16 v[44:45], v6 offset:3136
    ds_read_b64_tr_b16 v[46:47], v6 offset:3904
    v_mfma_f32_32x32x16_bf16 v[96:111], v[56:59], v[188:191], v[96:111]
    v_mfma_f32_32x32x16_bf16 v[112:127], v[60:63], v[188:191], v[112:127]
    ds_read_b128 v[232:235], v4 offset:0
    ds_read_b64_tr_b16 v[48:49], v6 offset:6144
    ds_read_b64_tr_b16 v[50:51], v6 offset:6912
    ds_read_b64_tr_b16 v[52:53], v6 offset:6208
    ds_read_b64_tr_b16 v[54:55], v6 offset:6976
    s_waitcnt lgkmcnt(10)
    ds_read_b128 v[236:239], v5 offset:0
    ds_read_b64_tr_b16 v[56:57], v6 offset:9216
    ds_read_b64_tr_b16 v[58:59], v6 offset:9984
    ds_read_b64_tr_b16 v[60:61], v6 offset:9280
    ds_read_b64_tr_b16 v[62:63], v6 offset:10048
    s_add_u32 s71, s3, 2
    s_and_b32 s71, s71, 7
    s_mul_i32 s71, s71, 229376
    s_add_u32 s71, s71, s56
    s_add_u32 m0, s59, 0
    s_add_u32 s60, s71, 0
    buffer_load_dwordx4 v28, s[40:43], s60 offen lds
    s_add_u32 m0, s59, 16384
    s_add_u32 s60, s71, 0
    buffer_load_dwordx4 v29, s[44:47], s60 offen lds
    s_add_u32 m0, s59, 1024
    s_add_u32 s60, s71, 14336
    buffer_load_dwordx4 v28, s[40:43], s60 offen lds
    s_waitcnt lgkmcnt(15)
    v_mfma_f32_32x32x16_bf16 v[128:143], v[32:35], v[224:227], v[128:143]
    v_mfma_f32_32x32x16_bf16 v[144:159], v[36:39], v[224:227], v[144:159]
    s_waitcnt lgkmcnt(10)
    v_mfma_f32_32x32x16_bf16 v[128:143], v[40:43], v[228:231], v[128:143]
    v_mfma_f32_32x32x16_bf16 v[144:159], v[44:47], v[228:231], v[144:159]
    v_readfirstlane_b32 s26, v25
    v_readfirstlane_b32 s60, v16
    s_nop 3
    s_mul_i32 s26, s26, 1664525
    s_add_u32 s26, s26, 1013904223
    s_or_b32 s26, s26, 1
    s_cmp_lg_u32 s60, 0
    s_cselect_b32 s26, s60, s26
    v_readfirstlane_b32 s22, v26
    s_waitcnt vmcnt(9) lgkmcnt(0)
    s_barrier
    ds_read_b128 v[240:243], v2 offset:32768
    ds_read_b64_tr_b16 v[32:33], v6 offset:32768
    ds_read_b64_tr_b16 v[34:35], v6 offset:33536
    ds_read_b64_tr_b16 v[36:37], v6 offset:32832
    ds_read_b64_tr_b16 v[38:39], v6 offset:33600
    v_mfma_f32_32x32x16_bf16 v[128:143], v[48:51], v[232:235], v[128:143]
    v_mfma_f32_32x32x16_bf16 v[144:159], v[52:55], v[232:235], v[144:159]
    ds_read_b128 v[244:247], v3 offset:32768
    ds_read_b64_tr_b16 v[40:41], v6 offset:35840
    ds_read_b64_tr_b16 v[42:43], v6 offset:36608
    ds_read_b64_tr_b16 v[44:45], v6 offset:35904
    ds_read_b64_tr_b16 v[46:47], v6 offset:36672
    v_mfma_f32_32x32x16_bf16 v[128:143], v[56:59], v[236:239], v[128:143]
    v_mfma_f32_32x32x16_bf16 v[144:159], v[60:63], v[236:239], v[144:159]
    ds_read_b128 v[248:251], v4 offset:32768
    ds_read_b64_tr_b16 v[48:49], v6 offset:38912
    ds_read_b64_tr_b16 v[50:51], v6 offset:39680
    ds_read_b64_tr_b16 v[52:53], v6 offset:38976
    ds_read_b64_tr_b16 v[54:55], v6 offset:39744
    s_waitcnt lgkmcnt(10)
    ds_read_b128 v[252:255], v5 offset:32768
    ds_read_b64_tr_b16 v[56:57], v6 offset:41984
    ds_read_b64_tr_b16 v[58:59], v6 offset:42752
    ds_read_b64_tr_b16 v[60:61], v6 offset:42048
    ds_read_b64_tr_b16 v[62:63], v6 offset:42816
    s_add_u32 m0, s59, 17408
    s_add_u32 s60, s71, 14336
    buffer_load_dwordx4 v29, s[44:47], s60 offen lds
    s_add_u32 s71, s3, 3
    s_and_b32 s71, s71, 7
    s_mul_i32 s71, s71, 229376
    s_add_u32 s71, s71, s56
    s_add_u32 m0, s59, 32768
    s_add_u32 s60, s71, 0
    buffer_load_dwordx4 v28, s[40:43], s60 offen lds
    s_add_u32 m0, s59, 49152
    s_add_u32 s60, s71, 0
    buffer_load_dwordx4 v29, s[44:47], s60 offen lds
    s_waitcnt lgkmcnt(15)
    v_mfma_f32_32x32x16_bf16 v[128:143], v[32:35], v[240:243], v[128:143]
    v_mfma_f32_32x32x16_bf16 v[144:159], v[36:39], v[240:243], v[144:159]
    s_waitcnt lgkmcnt(10)
    v_mfma_f32_32x32x16_bf16 v[128:143], v[40:43], v[244:247], v[128:143]
    v_mfma_f32_32x32x16_bf16 v[144:159], v[44:47], v[244:247], v[144:159]
    s_waitcnt vmcnt(9) lgkmcnt(0)
    s_barrier
    v_add_u32 v2, 0x10000, v2
    v_add_u32 v3, 0x10000, v3
    v_add_u32 v4, 0x10000, v4
    v_add_u32 v5, 0x10000, v5
    v_add_u32 v6, 0x10000, v6
    ds_read_b128 v[160:163], v2 offset:0
    ds_read_b64_tr_b16 v[32:33], v6 offset:0
    ds_read_b64_tr_b16 v[34:35], v6 offset:768
    ds_read_b64_tr_b16 v[36:37], v6 offset:64
    ds_read_b64_tr_b16 v[38:39], v6 offset:832
    v_mfma_f32_32x32x16_bf16 v[128:143], v[48:51], v[248:251], v[128:143]
    v_mfma_f32_32x32x16_bf16 v[144:159], v[52:55], v[248:251], v[144:159]
    ds_read_b128 v[164:167], v3 offset:0
    ds_read_b64_tr_b16 v[40:41], v6 offset:3072
    ds_read_b64_tr_b16 v[42:43], v6 offset:3840
    ds_read_b64_tr_b16 v[44:45], v6 offset:3136
    ds_read_b64_tr_b16 v[46:47], v6 offset:3904
    v_mfma_f32_32x32x16_bf16 v[128:143], v[56:59], v[252:255], v[128:143]
    v_mfma_f32_32x32x16_bf16 v[144:159], v[60:63], v[252:255], v[144:159]
    ds_read_b128 v[168:171], v4 offset:0
    ds_read_b64_tr_b16 v[48:49], v6 offset:6144
    ds_read_b64_tr_b16 v[50:51], v6 offset:6912
    ds_read_b64_tr_b16 v[52:53], v6 offset:6208
    ds_read_b64_tr_b16 v[54:55], v6 offset:6976
    s_waitcnt lgkmcnt(10)
    ds_read_b128 v[172:175], v5 offset:0
    ds_read_b64_tr_b16 v[56:57], v6 offset:9216
    ds_read_b64_tr_b16 v[58:59], v6 offset:9984
    ds_read_b64_tr_b16 v[60:61], v6 offset:9280
    ds_read_b64_tr_b16 v[62:63], v6 offset:10048
    s_add_u32 m0, s59, 33792
    s_add_u32 s60, s71, 14336
    buffer_load_dwordx4 v28, s[40:43], s60 offen lds
    s_add_u32 m0, s59, 50176
    s_add_u32 s60, s71, 14336
    buffer_load_dwordx4 v29, s[44:47], s60 offen lds
    s_add_u32 s71, s3, 4
    s_and_b32 s71, s71, 7
    s_mul_i32 s71, s71, 229376
    s_add_u32 s71, s71, s56
    s_add_u32 m0, s59, 65536
    s_add_u32 s60, s71, 0
    buffer_load_dwordx4 v28, s[40:43], s60 offen lds
    s_waitcnt lgkmcnt(15)
    v_mfma_f32_32x32x16_bf16 v[128:143], v[32:35], v[160:163], v[128:143]
    v_mfma_f32_32x32x16_bf16 v[144:159], v[36:39], v[160:163], v[144:159]
    s_waitcnt lgkmcnt(10)
    v_mfma_f32_32x32x16_bf16 v[128:143], v[40:43], v[164:167], v[128:143]
    v_mfma_f32_32x32x16_bf16 v[144:159], v[44:47], v[164:167], v[144:159]
    s_waitcnt vmcnt(9) lgkmcnt(0)
    s_barrier
    ds_read_b128 v[176:179], v2 offset:32768
    ds_read_b64_tr_b16 v[32:33], v6 offset:32768
    ds_read_b64_tr_b16 v[34:35], v6 offset:33536
    ds_read_b64_tr_b16 v[36:37], v6 offset:32832
    ds_read_b64_tr_b16 v[38:39], v6 offset:33600
    v_mfma_f32_32x32x16_bf16 v[128:143], v[48:51], v[168:171], v[128:143]
    v_mfma_f32_32x32x16_bf16 v[144:159], v[52:55], v[168:171], v[144:159]
    ds_read_b128 v[180:183], v3 offset:32768
    ds_read_b64_tr_b16 v[40:41], v6 offset:35840
    ds_read_b64_tr_b16 v[42:43], v6 offset:36608
    ds_read_b64_tr_b16 v[44:45], v6 offset:35904
    ds_read_b64_tr_b16 v[46:47], v6 offset:36672
    v_mfma_f32_32x32x16_bf16 v[128:143], v[56:59], v[172:175], v[128:143]
    v_mfma_f32_32x32x16_bf16 v[144:159], v[60:63], v[172:175], v[144:159]
    ds_read_b128 v[184:187], v4 offset:32768
    ds_read_b64_tr_b16 v[48:49], v6 offset:38912
    ds_read_b64_tr_b16 v[50:51], v6 offset:39680
    ds_read_b64_tr_b16 v[52:53], v6 offset:38976
    ds_read_b64_tr_b16 v[54:55], v6 offset:39744
    s_waitcnt lgkmcnt(10)
    ds_read_b128 v[188:191], v5 offset:32768
    ds_read_b64_tr_b16 v[56:57], v6 offset:41984
    ds_read_b64_tr_b16 v[58:59], v6 offset:42752
    ds_read_b64_tr_b16 v[60:61], v6 offset:42048
    ds_read_b64_tr_b16 v[62:63], v6 offset:42816
    s_add_u32 m0, s59, 81920
    s_add_u32 s60, s71, 0
    buffer_load_dwordx4 v29, s[44:47], s60 offen lds
    s_add_u32 m0, s59, 66560
    s_add_u32 s60, s71, 14336
    buffer_load_dwordx4 v28, s[40:43], s60 offen lds
    s_add_u32 m0, s59, 82944
    s_add_u32 s60, s71, 14336
    buffer_load_dwordx4 v29, s[44:47], s60 offen lds
    s_waitcnt lgkmcnt(15)
    v_mfma_f32_32x32x16_bf16 v[128:143], v[32:35], v[176:179], v[128:143]
    v_mfma_f32_32x32x16_bf16 v[144:159], v[36:39], v[176:179], v[144:159]
    s_waitcnt lgkmcnt(10)
    v_mfma_f32_32x32x16_bf16 v[128:143], v[40:43], v[180:183], v[128:143]
    v_mfma_f32_32x32x16_bf16 v[144:159], v[44:47], v[180:183], v[144:159]
    s_waitcnt vmcnt(8) lgkmcnt(0)
    s_barrier
    v_mfma_f32_32x32x16_bf16 v[128:143], v[48:51], v[184:187], v[128:143]
    ds_read_b64_tr_b16 v[32:33], v7 offset:0
    ds_read_b64_tr_b16 v[34:35], v7 offset:1024
    ds_read_b64_tr_b16 v[36:37], v8 offset:0
    ds_read_b64_tr_b16 v[38:39], v8 offset:1024
    v_mfma_f32_32x32x16_bf16 v[144:159], v[52:55], v[184:187], v[144:159]
    ds_read_b64_tr_b16 v[40:41], v9 offset:0
    ds_read_b64_tr_b16 v[42:43], v9 offset:1024
    ds_read_b64_tr_b16 v[44:45], v10 offset:0
    ds_read_b64_tr_b16 v[46:47], v10 offset:1024
    v_mfma_f32_32x32x16_bf16 v[128:143], v[56:59], v[188:191], v[128:143]
    v_mfma_f32_32x32x16_bf16 v[144:159], v[60:63], v[188:191], v[144:159]
    s_add_u32 s71, s3, 5
    s_and_b32 s71, s71, 7
    s_mul_i32 s71, s71, 229376
    s_add_u32 s71, s71, s56
    s_add_u32 m0, s59, 98304
    s_add_u32 s60, s71, 0
    buffer_load_dwordx4 v28, s[40:43], s60 offen lds
    s_waitcnt lgkmcnt(0)
    v_mfma_f32_32x32x16_bf16 v[64:79], v[32:35], v[192:195], v[64:79]
    ds_read_b64_tr_b16 v[48:49], v7 offset:4096
    ds_read_b64_tr_b16 v[50:51], v7 offset:5120
    ds_read_b64_tr_b16 v[52:53], v8 offset:4096
    ds_read_b64_tr_b16 v[54:55], v8 offset:5120
    v_mfma_f32_32x32x16_bf16 v[80:95], v[36:39], v[192:195], v[80:95]
    ds_read_b64_tr_b16 v[56:57], v9 offset:4096
    ds_read_b64_tr_b16 v[58:59], v9 offset:5120
    ds_read_b64_tr_b16 v[60:61], v10 offset:4096
    ds_read_b64_tr_b16 v[62:63], v10 offset:5120
    v_mfma_f32_32x32x16_bf16 v[96:111], v[40:43], v[192:195], v[96:111]
    v_mfma_f32_32x32x16_bf16 v[112:127], v[44:47], v[192:195], v[112:127]
    s_add_u32 m0, s59, 114688
    s_add_u32 s60, s71, 0
    buffer_load_dwordx4 v29, s[44:47], s60 offen lds
    s_mul_i32 s60, s49, 3
    s_add_u32 s60, s60, 0
    s_and_b32 s61, s60, 15
    s_lshl_b32 s61, s61, 7
    s_lshl_b32 s62, s48, 2
    s_add_u32 s62, s62, s51
    s_add_u32 s61, s61, s62
    s_lshl_b32 s62, s61, 10
    s_lshl_b32 s61, s61, 11
    s_add_u32 s61, s61, 0x200000
    s_cmp_lt_u32 s60, 16
    s_cselect_b32 s72, s62, s61
    s_cselect_b32 s62, 1, 2
    s_cselect_b32 s63, 0x3eb8aa3b, 1.0
    s_lshl_b32 s62, s62, 16
    s_add_u32 s73, s62, s72
    v_mul_f32 v128, s63, v128
    v_mul_f32 v129, s63, v129
    v_mul_f32 v130, s63, v130
    v_mul_f32 v131, s63, v131
    v_mul_f32 v132, s63, v132
    v_mul_f32 v133, s63, v133
    v_mul_f32 v134, s63, v134
    v_mul_f32 v135, s63, v135
    v_mul_f32 v136, s63, v136
    v_mul_f32 v137, s63, v137
    v_mul_f32 v138, s63, v138
    v_mul_f32 v139, s63, v139
    v_mul_f32 v140, s63, v140
    v_mul_f32 v141, s63, v141
    v_mul_f32 v142, s63, v142
    v_mul_f32 v143, s63, v143
    v_cvt_pk_bf16_f32 v128, v128, v129
    v_cvt_pk_bf16_f32 v129, v130, v131
    v_cvt_pk_bf16_f32 v130, v132, v133
    v_cvt_pk_bf16_f32 v131, v134, v135
    v_cvt_pk_bf16_f32 v132, v136, v137
    v_cvt_pk_bf16_f32 v133, v138, v139
    v_cvt_pk_bf16_f32 v134, v140, v141
    v_cvt_pk_bf16_f32 v135, v142, v143
    s_mul_i32 s60, s49, 3
    s_add_u32 s60, s60, 1
    s_and_b32 s61, s60, 15
    s_lshl_b32 s61, s61, 7
    s_lshl_b32 s62, s48, 2
    s_add_u32 s62, s62, s51
    s_add_u32 s61, s61, s62
    s_lshl_b32 s62, s61, 10
    s_lshl_b32 s61, s61, 11
    s_add_u32 s61, s61, 0x200000
    s_cmp_lt_u32 s60, 16
    s_cselect_b32 s74, s62, s61
    s_cselect_b32 s62, 1, 2
    s_cselect_b32 s63, 0x3eb8aa3b, 1.0
    s_lshl_b32 s62, s62, 16
    s_add_u32 s75, s62, s74
    v_mul_f32 v144, s63, v144
    v_mul_f32 v145, s63, v145
    v_mul_f32 v146, s63, v146
    v_mul_f32 v147, s63, v147
    v_mul_f32 v148, s63, v148
    v_mul_f32 v149, s63, v149
    v_mul_f32 v150, s63, v150
    v_mul_f32 v151, s63, v151
    v_mul_f32 v152, s63, v152
    v_mul_f32 v153, s63, v153
    v_mul_f32 v154, s63, v154
    v_mul_f32 v155, s63, v155
    v_mul_f32 v156, s63, v156
    v_mul_f32 v157, s63, v157
    v_mul_f32 v158, s63, v158
    v_mul_f32 v159, s63, v159
    v_cvt_pk_bf16_f32 v144, v144, v145
    v_cvt_pk_bf16_f32 v145, v146, v147
    v_cvt_pk_bf16_f32 v146, v148, v149
    v_cvt_pk_bf16_f32 v147, v150, v151
    v_cvt_pk_bf16_f32 v148, v152, v153
    v_cvt_pk_bf16_f32 v149, v154, v155
    v_cvt_pk_bf16_f32 v150, v156, v157
    v_cvt_pk_bf16_f32 v151, v158, v159
    s_waitcnt lgkmcnt(0)
    v_mfma_f32_32x32x16_bf16 v[64:79], v[48:51], v[196:199], v[64:79]
    ds_read_b64_tr_b16 v[32:33], v7 offset:8192
    ds_read_b64_tr_b16 v[34:35], v7 offset:9216
    ds_read_b64_tr_b16 v[36:37], v8 offset:8192
    ds_read_b64_tr_b16 v[38:39], v8 offset:9216
    v_mfma_f32_32x32x16_bf16 v[80:95], v[52:55], v[196:199], v[80:95]
    ds_read_b64_tr_b16 v[40:41], v9 offset:8192
    ds_read_b64_tr_b16 v[42:43], v9 offset:9216
    ds_read_b64_tr_b16 v[44:45], v10 offset:8192
    ds_read_b64_tr_b16 v[46:47], v10 offset:9216
    v_mfma_f32_32x32x16_bf16 v[96:111], v[56:59], v[196:199], v[96:111]
    buffer_store_dwordx4 v[128:131], v1, s[28:31], s72 offen sc1
    v_mfma_f32_32x32x16_bf16 v[112:127], v[60:63], v[196:199], v[112:127]
    s_add_u32 m0, s59, 99328
    s_add_u32 s60, s71, 14336
    buffer_load_dwordx4 v28, s[40:43], s60 offen lds
    s_waitcnt lgkmcnt(0)
    v_mfma_f32_32x32x16_bf16 v[64:79], v[32:35], v[200:203], v[64:79]
    ds_read_b64_tr_b16 v[48:49], v7 offset:12288
    ds_read_b64_tr_b16 v[50:51], v7 offset:13312
    ds_read_b64_tr_b16 v[52:53], v8 offset:12288
    ds_read_b64_tr_b16 v[54:55], v8 offset:13312
    v_mfma_f32_32x32x16_bf16 v[80:95], v[36:39], v[200:203], v[80:95]
    ds_read_b64_tr_b16 v[56:57], v9 offset:12288
    ds_read_b64_tr_b16 v[58:59], v9 offset:13312
    ds_read_b64_tr_b16 v[60:61], v10 offset:12288
    ds_read_b64_tr_b16 v[62:63], v10 offset:13312
    v_mfma_f32_32x32x16_bf16 v[96:111], v[40:43], v[200:203], v[96:111]
    buffer_store_dwordx4 v[132:135], v1, s[28:31], s73 offen sc1
    v_mfma_f32_32x32x16_bf16 v[112:127], v[44:47], v[200:203], v[112:127]
    s_add_u32 m0, s59, 115712
    s_add_u32 s60, s71, 14336
    buffer_load_dwordx4 v29, s[44:47], s60 offen lds
    s_waitcnt vmcnt(10) lgkmcnt(0)
    s_barrier
    v_mfma_f32_32x32x16_bf16 v[64:79], v[48:51], v[204:207], v[64:79]
    ds_read_b64_tr_b16 v[32:33], v7 offset:32768
    ds_read_b64_tr_b16 v[34:35], v7 offset:33792
    ds_read_b64_tr_b16 v[36:37], v8 offset:32768
    ds_read_b64_tr_b16 v[38:39], v8 offset:33792
    v_mfma_f32_32x32x16_bf16 v[80:95], v[52:55], v[204:207], v[80:95]
    ds_read_b64_tr_b16 v[40:41], v9 offset:32768
    ds_read_b64_tr_b16 v[42:43], v9 offset:33792
    ds_read_b64_tr_b16 v[44:45], v10 offset:32768
    ds_read_b64_tr_b16 v[46:47], v10 offset:33792
    v_mfma_f32_32x32x16_bf16 v[96:111], v[56:59], v[204:207], v[96:111]
    buffer_store_dwordx4 v[144:147], v1, s[28:31], s74 offen sc1
    v_mfma_f32_32x32x16_bf16 v[112:127], v[60:63], v[204:207], v[112:127]
    s_add_u32 s71, s3, 6
    s_and_b32 s71, s71, 7
    s_mul_i32 s71, s71, 229376
    s_add_u32 s71, s71, s56
    s_add_u32 m0, s59, 131072
    s_add_u32 s60, s71, 0
    buffer_load_dwordx4 v28, s[40:43], s60 offen lds
    s_waitcnt lgkmcnt(0)
    v_mfma_f32_32x32x16_bf16 v[64:79], v[32:35], v[208:211], v[64:79]
    ds_read_b64_tr_b16 v[48:49], v7 offset:36864
    ds_read_b64_tr_b16 v[50:51], v7 offset:37888
    ds_read_b64_tr_b16 v[52:53], v8 offset:36864
    ds_read_b64_tr_b16 v[54:55], v8 offset:37888
    v_mfma_f32_32x32x16_bf16 v[80:95], v[36:39], v[208:211], v[80:95]
    ds_read_b64_tr_b16 v[56:57], v9 offset:36864
    ds_read_b64_tr_b16 v[58:59], v9 offset:37888
    ds_read_b64_tr_b16 v[60:61], v10 offset:36864
    ds_read_b64_tr_b16 v[62:63], v10 offset:37888
    v_mfma_f32_32x32x16_bf16 v[96:111], v[40:43], v[208:211], v[96:111]
    buffer_store_dwordx4 v[148:151], v1, s[28:31], s75 offen sc1
    v_mfma_f32_32x32x16_bf16 v[112:127], v[44:47], v[208:211], v[112:127]
    s_add_u32 m0, s59, 147456
    s_add_u32 s60, s71, 0
    buffer_load_dwordx4 v29, s[44:47], s60 offen lds
    s_waitcnt lgkmcnt(0)
    v_mfma_f32_32x32x16_bf16 v[64:79], v[48:51], v[212:215], v[64:79]
    ds_read_b64_tr_b16 v[32:33], v7 offset:40960
    ds_read_b64_tr_b16 v[34:35], v7 offset:41984
    ds_read_b64_tr_b16 v[36:37], v8 offset:40960
    ds_read_b64_tr_b16 v[38:39], v8 offset:41984
    v_mfma_f32_32x32x16_bf16 v[80:95], v[52:55], v[212:215], v[80:95]
    ds_read_b64_tr_b16 v[40:41], v9 offset:40960
    ds_read_b64_tr_b16 v[42:43], v9 offset:41984
    ds_read_b64_tr_b16 v[44:45], v10 offset:40960
    ds_read_b64_tr_b16 v[46:47], v10 offset:41984
    v_mfma_f32_32x32x16_bf16 v[96:111], v[56:59], v[212:215], v[96:111]
    v_mfma_f32_32x32x16_bf16 v[112:127], v[60:63], v[212:215], v[112:127]
    s_add_u32 m0, s59, 132096
    s_add_u32 s60, s71, 14336
    buffer_load_dwordx4 v28, s[40:43], s60 offen lds
    s_waitcnt lgkmcnt(0)
    v_mfma_f32_32x32x16_bf16 v[64:79], v[32:35], v[216:219], v[64:79]
    ds_read_b64_tr_b16 v[48:49], v7 offset:45056
    ds_read_b64_tr_b16 v[50:51], v7 offset:46080
    ds_read_b64_tr_b16 v[52:53], v8 offset:45056
    ds_read_b64_tr_b16 v[54:55], v8 offset:46080
    v_mfma_f32_32x32x16_bf16 v[80:95], v[36:39], v[216:219], v[80:95]
    ds_read_b64_tr_b16 v[56:57], v9 offset:45056
    ds_read_b64_tr_b16 v[58:59], v9 offset:46080
    ds_read_b64_tr_b16 v[60:61], v10 offset:45056
    ds_read_b64_tr_b16 v[62:63], v10 offset:46080
    v_mfma_f32_32x32x16_bf16 v[96:111], v[40:43], v[216:219], v[96:111]
    v_mfma_f32_32x32x16_bf16 v[112:127], v[44:47], v[216:219], v[112:127]
    s_add_u32 m0, s59, 148480
    s_add_u32 s60, s71, 14336
    buffer_load_dwordx4 v29, s[44:47], s60 offen lds
    s_waitcnt vmcnt(12) lgkmcnt(0)
    s_barrier
    v_add_u32 v7, 0x10000, v7
    v_add_u32 v8, 0x10000, v8
    v_add_u32 v9, 0x10000, v9
    v_add_u32 v10, 0x10000, v10
    v_mfma_f32_32x32x16_bf16 v[64:79], v[48:51], v[220:223], v[64:79]
    ds_read_b64_tr_b16 v[32:33], v7 offset:0
    ds_read_b64_tr_b16 v[34:35], v7 offset:1024
    ds_read_b64_tr_b16 v[36:37], v8 offset:0
    ds_read_b64_tr_b16 v[38:39], v8 offset:1024
    v_mfma_f32_32x32x16_bf16 v[80:95], v[52:55], v[220:223], v[80:95]
    ds_read_b64_tr_b16 v[40:41], v9 offset:0
    ds_read_b64_tr_b16 v[42:43], v9 offset:1024
    ds_read_b64_tr_b16 v[44:45], v10 offset:0
    ds_read_b64_tr_b16 v[46:47], v10 offset:1024
    v_mfma_f32_32x32x16_bf16 v[96:111], v[56:59], v[220:223], v[96:111]
    v_mfma_f32_32x32x16_bf16 v[112:127], v[60:63], v[220:223], v[112:127]
    s_add_u32 s71, s3, 7
    s_and_b32 s71, s71, 7
    s_mul_i32 s71, s71, 229376
    s_add_u32 s71, s71, s56
    s_add_u32 m0, s59, 0
    s_add_u32 s60, s71, 0
    buffer_load_dwordx4 v28, s[40:43], s60 offen lds
    s_waitcnt lgkmcnt(0)
    v_mfma_f32_32x32x16_bf16 v[64:79], v[32:35], v[224:227], v[64:79]
    ds_read_b64_tr_b16 v[48:49], v7 offset:4096
    ds_read_b64_tr_b16 v[50:51], v7 offset:5120
    ds_read_b64_tr_b16 v[52:53], v8 offset:4096
    ds_read_b64_tr_b16 v[54:55], v8 offset:5120
    v_mfma_f32_32x32x16_bf16 v[80:95], v[36:39], v[224:227], v[80:95]
    ds_read_b64_tr_b16 v[56:57], v9 offset:4096
    ds_read_b64_tr_b16 v[58:59], v9 offset:5120
    ds_read_b64_tr_b16 v[60:61], v10 offset:4096
    ds_read_b64_tr_b16 v[62:63], v10 offset:5120
    v_mfma_f32_32x32x16_bf16 v[96:111], v[40:43], v[224:227], v[96:111]
    v_mfma_f32_32x32x16_bf16 v[112:127], v[44:47], v[224:227], v[112:127]
    s_add_u32 m0, s59, 16384
    s_add_u32 s60, s71, 0
    buffer_load_dwordx4 v29, s[44:47], s60 offen lds
    s_waitcnt lgkmcnt(0)
    v_mfma_f32_32x32x16_bf16 v[64:79], v[48:51], v[228:231], v[64:79]
    ds_read_b64_tr_b16 v[32:33], v7 offset:8192
    ds_read_b64_tr_b16 v[34:35], v7 offset:9216
    ds_read_b64_tr_b16 v[36:37], v8 offset:8192
    ds_read_b64_tr_b16 v[38:39], v8 offset:9216
    v_mfma_f32_32x32x16_bf16 v[80:95], v[52:55], v[228:231], v[80:95]
    ds_read_b64_tr_b16 v[40:41], v9 offset:8192
    ds_read_b64_tr_b16 v[42:43], v9 offset:9216
    ds_read_b64_tr_b16 v[44:45], v10 offset:8192
    ds_read_b64_tr_b16 v[46:47], v10 offset:9216
    v_mfma_f32_32x32x16_bf16 v[96:111], v[56:59], v[228:231], v[96:111]
    v_mfma_f32_32x32x16_bf16 v[112:127], v[60:63], v[228:231], v[112:127]
    s_add_u32 m0, s59, 1024
    s_add_u32 s60, s71, 14336
    buffer_load_dwordx4 v28, s[40:43], s60 offen lds
    s_waitcnt lgkmcnt(0)
    v_mfma_f32_32x32x16_bf16 v[64:79], v[32:35], v[232:235], v[64:79]
    ds_read_b64_tr_b16 v[48:49], v7 offset:12288
    ds_read_b64_tr_b16 v[50:51], v7 offset:13312
    ds_read_b64_tr_b16 v[52:53], v8 offset:12288
    ds_read_b64_tr_b16 v[54:55], v8 offset:13312
    v_mfma_f32_32x32x16_bf16 v[80:95], v[36:39], v[232:235], v[80:95]
    ds_read_b64_tr_b16 v[56:57], v9 offset:12288
    ds_read_b64_tr_b16 v[58:59], v9 offset:13312
    ds_read_b64_tr_b16 v[60:61], v10 offset:12288
    ds_read_b64_tr_b16 v[62:63], v10 offset:13312
    v_mfma_f32_32x32x16_bf16 v[96:111], v[40:43], v[232:235], v[96:111]
    v_mfma_f32_32x32x16_bf16 v[112:127], v[44:47], v[232:235], v[112:127]
    s_add_u32 m0, s59, 17408
    s_add_u32 s60, s71, 14336
    buffer_load_dwordx4 v29, s[44:47], s60 offen lds
    s_waitcnt vmcnt(7) lgkmcnt(0)
    s_barrier
    v_mfma_f32_32x32x16_bf16 v[64:79], v[48:51], v[236:239], v[64:79]
    ds_read_b64_tr_b16 v[32:33], v7 offset:32768
    ds_read_b64_tr_b16 v[34:35], v7 offset:33792
    ds_read_b64_tr_b16 v[36:37], v8 offset:32768
    ds_read_b64_tr_b16 v[38:39], v8 offset:33792
    v_mfma_f32_32x32x16_bf16 v[80:95], v[52:55], v[236:239], v[80:95]
    ds_read_b64_tr_b16 v[40:41], v9 offset:32768
    ds_read_b64_tr_b16 v[42:43], v9 offset:33792
    ds_read_b64_tr_b16 v[44:45], v10 offset:32768
    ds_read_b64_tr_b16 v[46:47], v10 offset:33792
    v_mfma_f32_32x32x16_bf16 v[96:111], v[56:59], v[236:239], v[96:111]
    v_mfma_f32_32x32x16_bf16 v[112:127], v[60:63], v[236:239], v[112:127]
    s_cmp_lg_u32 s27, 0
    s_cbranch_scc1 QF_4
    v_mov_b32 v30, 0
    v_mov_b32 v31, s26
    s_mov_b64 exec, 1
    buffer_store_dword v31, v30, s[28:31], s70 offen sc1
    s_mov_b64 exec, -1
QF_4:
    s_waitcnt lgkmcnt(0)
    v_mfma_f32_32x32x16_bf16 v[64:79], v[32:35], v[240:243], v[64:79]
    ds_read_b64_tr_b16 v[48:49], v7 offset:36864
    ds_read_b64_tr_b16 v[50:51], v7 offset:37888
    ds_read_b64_tr_b16 v[52:53], v8 offset:36864
    ds_read_b64_tr_b16 v[54:55], v8 offset:37888
    s_mov_b32 s32, s16
    s_and_b32 s33, s17, 0xffff
    v_mfma_f32_32x32x16_bf16 v[80:95], v[36:39], v[240:243], v[80:95]
    ds_read_b64_tr_b16 v[56:57], v9 offset:36864
    ds_read_b64_tr_b16 v[58:59], v9 offset:37888
    ds_read_b64_tr_b16 v[60:61], v10 offset:36864
    ds_read_b64_tr_b16 v[62:63], v10 offset:37888
    s_mov_b32 s34, 0x1c0000
    s_mov_b32 s35, 0x00020000
    v_mfma_f32_32x32x16_bf16 v[96:111], v[40:43], v[240:243], v[96:111]
    s_mov_b32 s36, s8
    s_and_b32 s37, s9, 0xffff
    s_mov_b32 s38, 0x80000
    s_mov_b32 s39, 0x00020000
    v_mfma_f32_32x32x16_bf16 v[112:127], v[44:47], v[240:243], v[112:127]
    s_mul_i32 s54, s52, 16640
    s_add_u32 s54, s54, 32768
    v_add_u32 v2, s54, v1
    v_lshrrev_b32 v236, 5, v0
    s_waitcnt lgkmcnt(0)
    v_mfma_f32_32x32x16_bf16 v[64:79], v[48:51], v[244:247], v[64:79]
    ds_read_b64_tr_b16 v[32:33], v7 offset:40960
    ds_read_b64_tr_b16 v[34:35], v7 offset:41984
    ds_read_b64_tr_b16 v[36:37], v8 offset:40960
    ds_read_b64_tr_b16 v[38:39], v8 offset:41984
    v_lshlrev_b32 v232, 8, v236
    v_and_b32 v233, 15, v0
    v_mfma_f32_32x32x16_bf16 v[80:95], v[52:55], v[244:247], v[80:95]
    ds_read_b64_tr_b16 v[40:41], v9 offset:40960
    ds_read_b64_tr_b16 v[42:43], v9 offset:41984
    ds_read_b64_tr_b16 v[44:45], v10 offset:40960
    ds_read_b64_tr_b16 v[46:47], v10 offset:41984
    v_lshl_add_u32 v232, v233, 4, v232
    v_and_b32 v233, 11, v0
    v_mfma_f32_32x32x16_bf16 v[96:111], v[56:59], v[244:247], v[96:111]
    v_cmp_eq_u32 vcc, 0, v233
    v_mov_b32 v234, 16
    s_nop 0
    v_cndmask_b32 v234, v234, 0, vcc
    v_mfma_f32_32x32x16_bf16 v[112:127], v[60:63], v[244:247], v[112:127]
    v_add_u32 v235, 1024, v234
    v_add_u32 v234, 512, v234
    v_cndmask_b32 v3, v235, v232, s[0:1]
    v_cndmask_b32 v4, v234, v232, s[0:1]
    s_waitcnt lgkmcnt(0)
    v_mfma_f32_32x32x16_bf16 v[64:79], v[32:35], v[248:251], v[64:79]
    ds_read_b64_tr_b16 v[48:49], v7 offset:45056
    ds_read_b64_tr_b16 v[50:51], v7 offset:46080
    ds_read_b64_tr_b16 v[52:53], v8 offset:45056
    ds_read_b64_tr_b16 v[54:55], v8 offset:46080
    v_add_u32 v3, s54, v3
    v_add_u32 v4, s54, v4
    v_mfma_f32_32x32x16_bf16 v[80:95], v[36:39], v[248:251], v[80:95]
    ds_read_b64_tr_b16 v[56:57], v9 offset:45056
    ds_read_b64_tr_b16 v[58:59], v9 offset:46080
    ds_read_b64_tr_b16 v[60:61], v10 offset:45056
    ds_read_b64_tr_b16 v[62:63], v10 offset:46080
    v_lshrrev_b32 v232, 3, v0
    v_lshlrev_b32 v232, 10, v232
    v_mfma_f32_32x32x16_bf16 v[96:111], v[40:43], v[248:251], v[96:111]
    v_bfe_u32 v233, v0, 4, 1
    v_lshlrev_b32 v234, 2, v233
    v_and_b32 v235, 7, v0
    v_xor_b32 v234, v234, v235
    v_mfma_f32_32x32x16_bf16 v[112:127], v[44:47], v[248:251], v[112:127]
    v_lshl_add_u32 v11, v234, 4, v232
    v_add_u32 v12, 7168, v11
    s_mul_i32 s54, s13, 114688
    v_add_u32 v13, s54, v1
    s_waitcnt vmcnt(4) lgkmcnt(0)
    s_barrier
    v_add_u32 v7, 0x10000, v7
    v_add_u32 v8, 0x10000, v8
    v_add_u32 v9, 0x10000, v9
    v_add_u32 v10, 0x10000, v10
    v_mfma_f32_32x32x16_bf16 v[64:79], v[48:51], v[252:255], v[64:79]
    ds_read_b64_tr_b16 v[32:33], v7 offset:0
    ds_read_b64_tr_b16 v[34:35], v7 offset:1024
    ds_read_b64_tr_b16 v[36:37], v8 offset:0
    ds_read_b64_tr_b16 v[38:39], v8 offset:1024
    v_bfe_u32 v234, v0, 2, 2
    v_lshl_add_u32 v232, v236, 2, v234
    v_mfma_f32_32x32x16_bf16 v[80:95], v[52:55], v[252:255], v[80:95]
    ds_read_b64_tr_b16 v[40:41], v9 offset:0
    ds_read_b64_tr_b16 v[42:43], v9 offset:1024
    ds_read_b64_tr_b16 v[44:45], v10 offset:0
    ds_read_b64_tr_b16 v[46:47], v10 offset:1024
    v_lshlrev_b32 v232, 7, v232
    v_lshrrev_b32 v234, 1, v234
    v_mfma_f32_32x32x16_bf16 v[96:111], v[56:59], v[252:255], v[96:111]
    v_lshl_add_u32 v232, v234, 6, v232
    v_lshl_add_u32 v232, v233, 5, v232
    v_and_b32 v234, 3, v0
    v_lshl_add_u32 v232, v234, 3, v232
    v_mfma_f32_32x32x16_bf16 v[112:127], v[60:63], v[252:255], v[112:127]
    s_lshl_b32 s54, s14, 5
    v_xor_b32 v232, s54, v232
    v_add_u32 v5, s11, v232
    v_xor_b32 v6, 64, v5
    s_mul_i32 s54, s27, 14
    s_add_u32 s55, s54, 13
    s_lshr_b32 s54, s54, 2
    s_lshr_b32 s55, s55, 2
    v_and_b32 v14, 7, v0
    v_add_u32 v14, s54, v14
    v_min_u32 v14, s55, v14
    v_bfe_u32 v232, v0, 3, 1
    s_lshl_b32 s54, s4, 1
    v_add_u32 v232, s54, v232
    v_lshl_add_u32 v14, v232, 5, v14
    v_lshlrev_b32 v14, 7, v14
    s_waitcnt lgkmcnt(0)
    v_mfma_f32_32x32x16_bf16 v[64:79], v[32:35], v[160:163], v[64:79]
    ds_read_b64_tr_b16 v[48:49], v7 offset:4096
    ds_read_b64_tr_b16 v[50:51], v7 offset:5120
    ds_read_b64_tr_b16 v[52:53], v8 offset:4096
    ds_read_b64_tr_b16 v[54:55], v8 offset:5120
    v_and_b32 v232, 31, v0
    v_mul_u32_u24 v232, 2080, v232
    v_mfma_f32_32x32x16_bf16 v[80:95], v[36:39], v[160:163], v[80:95]
    ds_read_b64_tr_b16 v[56:57], v9 offset:4096
    ds_read_b64_tr_b16 v[58:59], v9 offset:5120
    ds_read_b64_tr_b16 v[60:61], v10 offset:4096
    ds_read_b64_tr_b16 v[62:63], v10 offset:5120
    v_lshrrev_b32 v233, 5, v0
    v_lshl_add_u32 v232, v233, 4, v232
    v_mfma_f32_32x32x16_bf16 v[96:111], v[40:43], v[160:163], v[96:111]
    v_cmp_eq_u32 vcc, 0, v233
    v_mov_b32 v236, 0x3f803f80
    s_nop 0
    v_cndmask_b32 v236, 0, v236, vcc
    v_mfma_f32_32x32x16_bf16 v[112:127], v[44:47], v[160:163], v[112:127]
    v_mov_b32 v237, v236
    v_mov_b32 v238, v236
    v_mov_b32 v239, v236
    ds_write_b128 v232, v[236:239] offset:34816
    s_waitcnt lgkmcnt(0)
    v_mfma_f32_32x32x16_bf16 v[64:79], v[48:51], v[164:167], v[64:79]
    ds_read_b64_tr_b16 v[32:33], v7 offset:8192
    ds_read_b64_tr_b16 v[34:35], v7 offset:9216
    ds_read_b64_tr_b16 v[36:37], v8 offset:8192
    ds_read_b64_tr_b16 v[38:39], v8 offset:9216
    s_mov_b32 s40, s20
    s_and_b32 s41, s21, 0xffff
    v_mfma_f32_32x32x16_bf16 v[80:95], v[52:55], v[164:167], v[80:95]
    ds_read_b64_tr_b16 v[40:41], v9 offset:8192
    ds_read_b64_tr_b16 v[42:43], v9 offset:9216
    ds_read_b64_tr_b16 v[44:45], v10 offset:8192
    ds_read_b64_tr_b16 v[46:47], v10 offset:9216
    s_mov_b32 s42, 0x200000
    s_mov_b32 s43, 0x00020000
    v_mfma_f32_32x32x16_bf16 v[96:111], v[56:59], v[164:167], v[96:111]
    s_lshl_b32 s72, s4, 1
    s_add_u32 s72, s72, s13
    s_lshl_b32 s73, s72, 5
    s_lshl_b32 s74, s14, 3
    v_mfma_f32_32x32x16_bf16 v[112:127], v[60:63], v[164:167], v[112:127]
    s_add_u32 s73, s73, s74
    s_lshl_b32 s54, s73, 10
    s_add_u32 s54, s54, 0x600000
    s_add_u32 s55, s54, 4096
    s_lshl_b32 s56, s72, 15
    s_lshl_b32 s74, s5, 7
    s_add_u32 s56, s56, s74
    s_lshl_b32 s74, s14, 5
    s_add_u32 s56, s56, s74
    s_lshl_b32 s59, s72, 8
    s_add_u32 s59, s59, 0xf00000
    s_lshl_b32 s58, s65, 3
    s_lshl_b32 s73, s51, 1
    s_add_u32 s58, s58, s73
    s_add_u32 s58, s58, s52
    s_lshl_b32 s58, s58, 8
    s_add_u32 s58, s58, 0xf00000
    s_lshl_b32 s72, s14, 1
    s_lshr_b32 s73, s4, 2
    s_lshl_b32 s73, s73, 5
    s_add_u32 s72, s72, s73
    s_lshl_b32 s73, s69, 3
    s_add_u32 s73, s73, 0xf00000
    s_waitcnt lgkmcnt(0)
    v_mfma_f32_32x32x16_bf16 v[64:79], v[32:35], v[168:171], v[64:79]
    ds_read_b64_tr_b16 v[48:49], v7 offset:12288
    ds_read_b64_tr_b16 v[50:51], v7 offset:13312
    ds_read_b64_tr_b16 v[52:53], v8 offset:12288
    ds_read_b64_tr_b16 v[54:55], v8 offset:13312
    v_mfma_f32_32x32x16_bf16 v[80:95], v[36:39], v[168:171], v[80:95]
    ds_read_b64_tr_b16 v[56:57], v9 offset:12288
    ds_read_b64_tr_b16 v[58:59], v9 offset:13312
    ds_read_b64_tr_b16 v[60:61], v10 offset:12288
    ds_read_b64_tr_b16 v[62:63], v10 offset:13312
    v_mfma_f32_32x32x16_bf16 v[96:111], v[40:43], v[168:171], v[96:111]
    v_mfma_f32_32x32x16_bf16 v[112:127], v[44:47], v[168:171], v[112:127]
    s_lshr_b32 s60, s64, 1
    v_lshrrev_b32 v30, 4, v0
    v_add_u32 v30, 1, v30
    v_cmp_gt_u32 vcc, 3, v30
    s_nop 1
    v_cndmask_b32 v30, 0, v30, vcc
    v_lshlrev_b32 v30, 4, v30
    v_add_u32 v30, s60, v30
    v_mul_u32_u24 v30, 43691, v30
    v_lshrrev_b32 v30, 17, v30
    v_and_b32 v31, 15, v0
    s_lshl_b32 s61, s65, 1
    v_add_u32 v24, s61, v31
    v_cndmask_b32 v31, v24, v31, vcc
    v_lshl_add_u32 v30, v30, 4, v31
    v_lshlrev_b32 v30, 7, v30
    s_mov_b32 s60, 0xf10000
    s_mov_b32 exec_lo, 0xffffffff
    s_mov_b32 exec_hi, 0x3
    buffer_load_dword v31, v30, s[28:31], s60 offen sc1
    s_mov_b64 exec, -1
    s_waitcnt vmcnt(1) lgkmcnt(0)
    s_barrier
    v_add_u32 v7, 0xfffe0000, v7
    v_add_u32 v8, 0xfffe0000, v8
    v_add_u32 v9, 0xfffe0000, v9
    v_add_u32 v10, 0xfffe0000, v10
    v_mfma_f32_32x32x16_bf16 v[64:79], v[48:51], v[172:175], v[64:79]
    ds_read_b64_tr_b16 v[32:33], v7 offset:0
    ds_read_b64_tr_b16 v[34:35], v7 offset:1024
    ds_read_b64_tr_b16 v[36:37], v8 offset:0
    ds_read_b64_tr_b16 v[38:39], v8 offset:1024
    v_mfma_f32_32x32x16_bf16 v[80:95], v[52:55], v[172:175], v[80:95]
    ds_read_b64_tr_b16 v[40:41], v9 offset:0
    ds_read_b64_tr_b16 v[42:43], v9 offset:1024
    ds_read_b64_tr_b16 v[44:45], v10 offset:0
    ds_read_b64_tr_b16 v[46:47], v10 offset:1024
    v_mfma_f32_32x32x16_bf16 v[96:111], v[56:59], v[172:175], v[96:111]
    v_mfma_f32_32x32x16_bf16 v[112:127], v[60:63], v[172:175], v[112:127]
    s_waitcnt lgkmcnt(0)
    v_mfma_f32_32x32x16_bf16 v[64:79], v[32:35], v[176:179], v[64:79]
    ds_read_b64_tr_b16 v[48:49], v7 offset:4096
    ds_read_b64_tr_b16 v[50:51], v7 offset:5120
    ds_read_b64_tr_b16 v[52:53], v8 offset:4096
    ds_read_b64_tr_b16 v[54:55], v8 offset:5120
    v_mfma_f32_32x32x16_bf16 v[80:95], v[36:39], v[176:179], v[80:95]
    ds_read_b64_tr_b16 v[56:57], v9 offset:4096
    ds_read_b64_tr_b16 v[58:59], v9 offset:5120
    ds_read_b64_tr_b16 v[60:61], v10 offset:4096
    ds_read_b64_tr_b16 v[62:63], v10 offset:5120
    v_mfma_f32_32x32x16_bf16 v[96:111], v[40:43], v[176:179], v[96:111]
    v_mfma_f32_32x32x16_bf16 v[112:127], v[44:47], v[176:179], v[112:127]
    s_waitcnt lgkmcnt(0)
    v_mfma_f32_32x32x16_bf16 v[64:79], v[48:51], v[180:183], v[64:79]
    ds_read_b64_tr_b16 v[32:33], v7 offset:8192
    ds_read_b64_tr_b16 v[34:35], v7 offset:9216
    ds_read_b64_tr_b16 v[36:37], v8 offset:8192
    ds_read_b64_tr_b16 v[38:39], v8 offset:9216
    v_mfma_f32_32x32x16_bf16 v[80:95], v[52:55], v[180:183], v[80:95]
    ds_read_b64_tr_b16 v[40:41], v9 offset:8192
    ds_read_b64_tr_b16 v[42:43], v9 offset:9216
    ds_read_b64_tr_b16 v[44:45], v10 offset:8192
    ds_read_b64_tr_b16 v[46:47], v10 offset:9216
    v_mfma_f32_32x32x16_bf16 v[96:111], v[56:59], v[180:183], v[96:111]
    v_mfma_f32_32x32x16_bf16 v[112:127], v[60:63], v[180:183], v[112:127]
    s_waitcnt vmcnt(0)
    v_cmp_ne_u32 vcc, s26, v31
    s_and_b32 vcc_lo, vcc_lo, 0xffffffff
    s_and_b32 vcc_hi, vcc_hi, 0x3
    s_or_b32 s60, vcc_lo, vcc_hi
    s_cbranch_scc0 FOK_5
    s_mov_b32 s60, 0xf10000
    s_mov_b32 s61, 0x80000
    s_mov_b32 exec_lo, 0xffffffff
    s_mov_b32 exec_hi, 0x3
POLL_6:
    buffer_load_dword v31, v30, s[28:31], s60 offen sc1
    s_waitcnt vmcnt(0)
    v_cmp_ne_u32 vcc, s26, v31
    s_cbranch_vccz POLLD_7
    s_mov_b64 exec, vcc
    s_sub_u32 s61, s61, 1
    s_cbranch_scc0 POLL_6
POLLD_7:
    s_mov_b64 exec, -1
FOK_5:
    s_xor_b32 s60, s68, 1024
    buffer_load_dwordx4 v[16:19], v1, s[28:31], s60 offen sc1
    buffer_load_dwordx4 v[20:23], v1, s[28:31], s68 offen sc1
    s_lshl_b32 s60, s64, 17
    s_add_u32 s60, s60, 0x200000
    buffer_load_dwordx4 v[224:227], v1, s[28:31], s60 offen sc1
    s_add_u32 m0, s67, 0
    s_nop 0
    buffer_load_dwordx4 v1, s[28:31], s66 offen sc1 lds
    buffer_load_dwordx4 v1, s[28:31], s66 offen offset:1024 sc1 lds
    s_add_u32 m0, s67, 8320
    s_add_u32 s66, s66, 8192
    buffer_load_dwordx4 v1, s[28:31], s66 offen sc1 lds
    buffer_load_dwordx4 v1, s[28:31], s66 offen offset:1024 sc1 lds
    s_add_u32 s66, s66, 8192
    s_waitcnt lgkmcnt(0)
    v_mfma_f32_32x32x16_bf16 v[64:79], v[32:35], v[184:187], v[64:79]
    ds_read_b64_tr_b16 v[48:49], v7 offset:12288
    ds_read_b64_tr_b16 v[50:51], v7 offset:13312
    ds_read_b64_tr_b16 v[52:53], v8 offset:12288
    ds_read_b64_tr_b16 v[54:55], v8 offset:13312
    v_mfma_f32_32x32x16_bf16 v[80:95], v[36:39], v[184:187], v[80:95]
    ds_read_b64_tr_b16 v[56:57], v9 offset:12288
    ds_read_b64_tr_b16 v[58:59], v9 offset:13312
    ds_read_b64_tr_b16 v[60:61], v10 offset:12288
    ds_read_b64_tr_b16 v[62:63], v10 offset:13312
    v_mfma_f32_32x32x16_bf16 v[96:111], v[40:43], v[184:187], v[96:111]
    v_mfma_f32_32x32x16_bf16 v[112:127], v[44:47], v[184:187], v[112:127]
    s_waitcnt lgkmcnt(0)
    v_mfma_f32_32x32x16_bf16 v[64:79], v[48:51], v[188:191], v[64:79]
    v_mfma_f32_32x32x16_bf16 v[80:95], v[52:55], v[188:191], v[80:95]
    v_mfma_f32_32x32x16_bf16 v[96:111], v[56:59], v[188:191], v[96:111]
    v_mfma_f32_32x32x16_bf16 v[112:127], v[60:63], v[188:191], v[112:127]
    s_setprio 3
    s_lshl_b32 s60, s48, 2
    s_add_u32 s60, s60, s51
    s_mul_i32 s60, s60, 112
    s_lshl_b32 s61, s50, 3
    s_add_u32 s60, s60, s61
    s_lshl_b32 s60, s60, 10
    s_add_u32 s57, s60, 0x800000
    s_nop 4
    s_xor_b32 s60, s13, 1
    s_mul_i32 s60, s60, 114688
    v_add_u32 v7, s60, v1
    s_mul_i32 s60, s27, 2560
    s_add_u32 s60, s60, 99328
    v_add_u32 v8, s60, v1
    s_xor_b32 s60, s27, 4
    s_mul_i32 s60, s60, 2560
    s_add_u32 s60, s60, 99328
    v_add_u32 v9, s60, v1
    v_bfe_u32 v10, v0, 2, 1
    v_and_b32 v232, 3, v0
    v_lshl_add_u32 v10, v232, 3, v10
    v_add_u32 v10, s72, v10
    v_lshlrev_b32 v10, 7, v10
    v_pk_mul_f32 v[64:65], v[64:65], v[72:73]
    v_pk_mul_f32 v[66:67], v[66:67], v[74:75]
    v_pk_mul_f32 v[68:69], v[68:69], v[76:77]
    v_pk_mul_f32 v[70:71], v[70:71], v[78:79]
    v_cvt_pk_bf16_f32 v72, v64, v65
    v_cvt_pk_bf16_f32 v73, v66, v67
    v_cvt_pk_bf16_f32 v74, v68, v69
    v_cvt_pk_bf16_f32 v75, v70, v71
    v_pk_mul_f32 v[80:81], v[80:81], v[88:89]
    v_pk_mul_f32 v[82:83], v[82:83], v[90:91]
    v_pk_mul_f32 v[84:85], v[84:85], v[92:93]
    v_pk_mul_f32 v[86:87], v[86:87], v[94:95]
    v_cvt_pk_bf16_f32 v88, v80, v81
    v_cvt_pk_bf16_f32 v89, v82, v83
    v_cvt_pk_bf16_f32 v90, v84, v85
    v_cvt_pk_bf16_f32 v91, v86, v87
    s_waitcnt vmcnt(4)
    v_mfma_f32_32x32x16_bf16 v[128:143], v[224:227], v[16:19], 0
    v_mfma_f32_32x32x16_bf16 v[144:159], v[224:227], v[20:23], 0
    v_pk_mul_f32 v[96:97], v[96:97], v[104:105]
    v_pk_mul_f32 v[98:99], v[98:99], v[106:107]
    v_pk_mul_f32 v[100:101], v[100:101], v[108:109]
    v_pk_mul_f32 v[102:103], v[102:103], v[110:111]
    v_cvt_pk_bf16_f32 v104, v96, v97
    v_cvt_pk_bf16_f32 v105, v98, v99
    v_cvt_pk_bf16_f32 v106, v100, v101
    v_cvt_pk_bf16_f32 v107, v102, v103
    v_pk_mul_f32 v[112:113], v[112:113], v[120:121]
    v_pk_mul_f32 v[114:115], v[114:115], v[122:123]
    v_pk_mul_f32 v[116:117], v[116:117], v[124:125]
    v_pk_mul_f32 v[118:119], v[118:119], v[126:127]
    v_cvt_pk_bf16_f32 v120, v112, v113
    v_cvt_pk_bf16_f32 v121, v114, v115
    v_cvt_pk_bf16_f32 v122, v116, v117
    v_cvt_pk_bf16_f32 v123, v118, v119
    s_nop 3
    v_max3_f32 v232, v128, v129, v130
    v_max3_f32 v232, v232, v131, v132
    v_max3_f32 v232, v232, v133, v134
    v_max3_f32 v232, v232, v135, v136
    v_max3_f32 v232, v232, v137, v138
    v_max3_f32 v232, v232, v139, v140
    v_max3_f32 v232, v232, v141, v142
    v_max_f32 v232, v232, v143
    v_mov_b32 v234, v232
    s_nop 1
    v_permlane32_swap_b32 v232, v234
    s_nop 1
    v_max_f32 v232, v232, v234
    v_max3_f32 v233, v144, v145, v146
    v_max3_f32 v233, v233, v147, v148
    v_max3_f32 v233, v233, v149, v150
    v_max3_f32 v233, v233, v151, v152
    v_max3_f32 v233, v233, v153, v154
    v_max3_f32 v233, v233, v155, v156
    v_max3_f32 v233, v233, v157, v158
    v_max_f32 v233, v233, v159
    v_mov_b32 v234, v233
    s_nop 1
    v_permlane32_swap_b32 v233, v234
    s_nop 1
    v_max_f32 v233, v233, v234
    v_min_f32 v232, v232, v233
    v_sub_f32 v240, 0, v232
    v_sub_f32 v241, 0, v232
    v_sub_f32 v242, 0, v232
    v_sub_f32 v243, 0, v232
    v_sub_f32 v244, 0, v232
    v_sub_f32 v245, 0, v232
    v_sub_f32 v246, 0, v232
    v_sub_f32 v247, 0, v232
    v_sub_f32 v248, 0, v232
    v_sub_f32 v249, 0, v232
    v_sub_f32 v250, 0, v232
    v_sub_f32 v251, 0, v232
    v_sub_f32 v252, 0, v232
    v_sub_f32 v253, 0, v232
    v_sub_f32 v254, 0, v232
    v_sub_f32 v255, 0, v232
    s_add_u32 m0, s67, 33280
    s_nop 0
    buffer_load_dwordx4 v1, s[28:31], s66 offen sc1 lds
    buffer_load_dwordx4 v1, s[28:31], s66 offen offset:1024 sc1 lds
    s_add_u32 m0, s67, 41600
    s_add_u32 s66, s66, 8192
    buffer_load_dwordx4 v1, s[28:31], s66 offen sc1 lds
    buffer_load_dwordx4 v1, s[28:31], s66 offen offset:1024 sc1 lds
    s_add_u32 s66, s66, 8192
    buffer_store_dwordx4 v[72:75], v1, s[28:31], s57 offen offset:0 sc1
    buffer_store_dwordx4 v[88:91], v1, s[28:31], s57 offen offset:1024 sc1
    buffer_store_dwordx4 v[104:107], v1, s[28:31], s57 offen offset:2048 sc1
    buffer_store_dwordx4 v[120:123], v1, s[28:31], s57 offen offset:3072 sc1
    s_waitcnt vmcnt(8)
    s_barrier
    ds_read_b128 v[24:27], v2 offset:0
    ds_read_b128 v[208:211], v3 offset:1024
    ds_read_b128 v[212:215], v4 offset:1536
    s_waitcnt lgkmcnt(2)
    v_mfma_f32_32x32x16_bf16 v[128:143], v[24:27], v[16:19], v[240:255]
    s_branch ATTN
CLS6:
    s_add_u32 s71, s3, 0
    s_and_b32 s71, s71, 7
    s_mul_i32 s71, s71, 229376
    s_add_u32 s71, s71, s56
    s_add_u32 m0, s59, 32768
    s_add_u32 s60, s71, 0
    buffer_load_dwordx4 v28, s[40:43], s60 offen lds
    s_add_u32 m0, s59, 49152
    s_add_u32 s60, s71, 0
    buffer_load_dwordx4 v29, s[44:47], s60 offen lds
    s_add_u32 m0, s59, 33792
    s_add_u32 s60, s71, 14336
    buffer_load_dwordx4 v28, s[40:43], s60 offen lds
    s_add_u32 m0, s59, 50176
    s_add_u32 s60, s71, 14336
    buffer_load_dwordx4 v29, s[44:47], s60 offen lds
    v_mov_b32 v24, 0
    s_mov_b32 s60, 0xf04000
    buffer_load_dword v25, v24, s[28:31], s60 offen sc1
    s_lshl_b32 s60, s69, 10
    buffer_load_dwordx4 v[16:19], v1, s[72:75], 0 offen
    buffer_load_dwordx4 v[20:23], v1, s[32:35], s60 offen
    s_and_b32 s60, s2, 7
    s_lshr_b32 s61, s2, 3
    s_lshl_b32 s4, s60, 2
    s_and_b32 s60, s61, 3
    s_add_u32 s4, s4, s60
    s_lshr_b32 s5, s61, 2
    s_mov_b32 s0, 0xffff
    s_mov_b32 s1, 0xffff
    s_and_b32 s13, s27, 1
    s_lshr_b32 s14, s27, 1
    s_mul_i32 s60, s4, 224
    s_mul_i32 s61, s27, 14
    s_add_u32 s60, s60, s61
    s_lshl_b32 s6, s60, 10
    s_add_u32 s6, s6, 0x800000
    s_lshl_b32 s7, s61, 14
    s_lshl_b32 s60, s5, 7
    s_add_u32 s7, s7, s60
    s_lshl_b32 s10, s27, 16
    s_add_u32 s10, s10, s60
    s_lshl_b32 s11, s51, 13
    s_lshl_b32 s60, s52, 17
    s_add_u32 s11, s11, s60
    s_lshl_b32 s60, s48, 2
    s_add_u32 s60, s60, s51
    s_lshl_b32 s60, s60, 5
    s_lshl_b32 s61, s50, 1
    s_add_u32 s60, s60, s61
    s_add_u32 s60, s60, s52
    s_lshl_b32 s60, s60, 7
    s_add_u32 s12, s60, 0xf70000
    s_lshl_b32 s60, s65, 3
    s_lshl_b32 s61, s51, 1
    s_add_u32 s60, s60, s61
    s_add_u32 s60, s60, s52
    s_lshl_b32 s60, s60, 5
    s_add_u32 s60, s60, s64
    s_lshl_b32 s18, s60, 10
    s_add_u32 s18, s18, 0x600000
    v_and_b32 v30, 31, v0
    v_lshrrev_b32 v31, 5, v0
    v_bfe_u32 v32, v0, 1, 3
    v_xor_b32 v32, v32, v31
    s_lshl_b32 s60, s51, 12
    v_lshlrev_b32 v33, 7, v30
    v_add_u32 v33, s60, v33
    v_xor_b32 v34, 0, v32
    v_lshl_add_u32 v2, v34, 4, v33
    v_xor_b32 v34, 2, v32
    v_lshl_add_u32 v3, v34, 4, v33
    v_xor_b32 v34, 4, v32
    v_lshl_add_u32 v4, v34, 4, v33
    v_xor_b32 v34, 6, v32
    v_lshl_add_u32 v5, v34, 4, v33
    v_bfe_u32 v32, v0, 2, 2
    v_lshl_add_u32 v33, v31, 3, v32
    v_mul_u32_u24 v34, 192, v33
    v_bfe_u32 v35, v0, 4, 1
    v_lshl_add_u32 v34, v35, 5, v34
    v_and_b32 v36, 3, v0
    v_lshl_add_u32 v34, v36, 3, v34
    v_add_u32 v6, 16512, v34
    v_lshlrev_b32 v33, 8, v33
    v_lshl_add_u32 v33, v35, 14, v33
    v_lshl_add_u32 v33, v36, 3, v33
    v_bfe_u32 v32, v0, 2, 3
    v_xor_b32 v34, 4, v32
    v_lshl_add_u32 v7, v34, 5, v33
    v_xor_b32 v34, 5, v32
    v_lshl_add_u32 v8, v34, 5, v33
    v_xor_b32 v34, 6, v32
    v_lshl_add_u32 v9, v34, 5, v33
    v_xor_b32 v34, 7, v32
    v_lshl_add_u32 v10, v34, 5, v33
    s_waitcnt vmcnt(7)
    s_barrier
    ds_read_b128 v[160:163], v2 offset:0
    ds_read_b64_tr_b16 v[32:33], v6 offset:0
    ds_read_b64_tr_b16 v[34:35], v6 offset:768
    ds_read_b128 v[164:167], v3 offset:0
    ds_read_b64_tr_b16 v[40:41], v6 offset:3072
    ds_read_b64_tr_b16 v[42:43], v6 offset:3840
    ds_read_b128 v[168:171], v4 offset:0
    ds_read_b64_tr_b16 v[48:49], v6 offset:6144
    ds_read_b64_tr_b16 v[50:51], v6 offset:6912
    ds_read_b128 v[172:175], v5 offset:0
    ds_read_b64_tr_b16 v[56:57], v6 offset:9216
    ds_read_b64_tr_b16 v[58:59], v6 offset:9984
    s_add_u32 s19, s3, 1
    s_and_b32 s19, s19, 7
    s_lshl_b32 s15, s19, 7
    s_add_u32 s15, s15, s54
    s_mul_i32 s19, s19, 196608
    s_add_u32 m0, s57, 65536
    s_add_u32 s60, s15, 0
    buffer_load_dwordx4 v11, s[32:35], s60 offen lds
    s_add_u32 m0, s57, 66560
    s_add_u32 s60, s15, 8192
    buffer_load_dwordx4 v12, s[32:35], s60 offen lds
    s_add_u32 m0, s58, 82944
    s_add_u32 s60, s55, s19
    buffer_load_dwordx4 v14, s[36:39], s60 offen lds
    s_waitcnt lgkmcnt(9)
    v_mfma_f32_32x32x16_bf16 v[128:143], v[160:163], v[32:35], 0
    s_waitcnt lgkmcnt(6)
    v_mfma_f32_32x32x16_bf16 v[128:143], v[164:167], v[40:43], v[128:143]
    s_add_u32 m0, s58, 83968
    s_add_u32 s60, s55, s19
    buffer_load_dwordx4 v15, s[36:39], s60 offen lds
    s_waitcnt vmcnt(7) lgkmcnt(0)
    s_barrier
    v_mfma_f32_32x32x16_bf16 v[128:143], v[168:171], v[48:51], v[128:143]
    ds_read_b64_tr_b16 v[32:33], v7 offset:32768
    ds_read_b64_tr_b16 v[34:35], v7 offset:33792
    ds_read_b64_tr_b16 v[36:37], v8 offset:32768
    ds_read_b64_tr_b16 v[38:39], v8 offset:33792
    v_mfma_f32_32x32x16_bf16 v[128:143], v[172:175], v[56:59], v[128:143]
    ds_read_b64_tr_b16 v[40:41], v9 offset:32768
    ds_read_b64_tr_b16 v[42:43], v9 offset:33792
    ds_read_b64_tr_b16 v[44:45], v10 offset:32768
    ds_read_b64_tr_b16 v[46:47], v10 offset:33792
    s_add_u32 s19, s3, 2
    s_and_b32 s19, s19, 7
    s_lshl_b32 s15, s19, 7
    s_add_u32 s15, s15, s54
    s_mul_i32 s19, s19, 196608
    s_add_u32 m0, s57, 98304
    s_add_u32 s60, s15, 0
    buffer_load_dwordx4 v11, s[32:35], s60 offen lds
    s_add_u32 m0, s57, 99328
    s_add_u32 s60, s15, 8192
    buffer_load_dwordx4 v12, s[32:35], s60 offen lds
    s_waitcnt lgkmcnt(0)
    v_mfma_f32_32x32x16_bf16 v[64:79], v[32:35], v[160:163], 0
    ds_read_b64_tr_b16 v[48:49], v7 offset:36864
    ds_read_b64_tr_b16 v[50:51], v7 offset:37888
    ds_read_b64_tr_b16 v[52:53], v8 offset:36864
    ds_read_b64_tr_b16 v[54:55], v8 offset:37888
    v_mfma_f32_32x32x16_bf16 v[80:95], v[36:39], v[160:163], 0
    ds_read_b64_tr_b16 v[56:57], v9 offset:36864
    ds_read_b64_tr_b16 v[58:59], v9 offset:37888
    ds_read_b64_tr_b16 v[60:61], v10 offset:36864
    ds_read_b64_tr_b16 v[62:63], v10 offset:37888
    v_mfma_f32_32x32x16_bf16 v[96:111], v[40:43], v[160:163], 0
    s_add_u32 m0, s58, 115712
    s_add_u32 s60, s55, s19
    buffer_load_dwordx4 v14, s[36:39], s60 offen lds
    v_mfma_f32_32x32x16_bf16 v[112:127], v[44:47], v[160:163], 0
    s_add_u32 m0, s58, 116736
    s_add_u32 s60, s55, s19
    buffer_load_dwordx4 v15, s[36:39], s60 offen lds
    s_waitcnt lgkmcnt(0)
    v_mfma_f32_32x32x16_bf16 v[64:79], v[48:51], v[164:167], v[64:79]
    ds_read_b64_tr_b16 v[32:33], v7 offset:40960
    ds_read_b64_tr_b16 v[34:35], v7 offset:41984
    ds_read_b64_tr_b16 v[36:37], v8 offset:40960
    ds_read_b64_tr_b16 v[38:39], v8 offset:41984
    v_mfma_f32_32x32x16_bf16 v[80:95], v[52:55], v[164:167], v[80:95]
    ds_read_b64_tr_b16 v[40:41], v9 offset:40960
    ds_read_b64_tr_b16 v[42:43], v9 offset:41984
    ds_read_b64_tr_b16 v[44:45], v10 offset:40960
    ds_read_b64_tr_b16 v[46:47], v10 offset:41984
    v_mfma_f32_32x32x16_bf16 v[96:111], v[56:59], v[164:167], v[96:111]
    s_add_u32 s19, s3, 3
    s_and_b32 s19, s19, 7
    s_lshl_b32 s15, s19, 7
    s_add_u32 s15, s15, s54
    s_mul_i32 s19, s19, 196608
    s_add_u32 m0, s57, 131072
    s_add_u32 s60, s15, 0
    buffer_load_dwordx4 v11, s[32:35], s60 offen lds
    v_mfma_f32_32x32x16_bf16 v[112:127], v[60:63], v[164:167], v[112:127]
    s_add_u32 m0, s57, 132096
    s_add_u32 s60, s15, 8192
    buffer_load_dwordx4 v12, s[32:35], s60 offen lds
    s_waitcnt lgkmcnt(0)
    v_mfma_f32_32x32x16_bf16 v[64:79], v[32:35], v[168:171], v[64:79]
    ds_read_b64_tr_b16 v[48:49], v7 offset:45056
    ds_read_b64_tr_b16 v[50:51], v7 offset:46080
    ds_read_b64_tr_b16 v[52:53], v8 offset:45056
    ds_read_b64_tr_b16 v[54:55], v8 offset:46080
    v_mfma_f32_32x32x16_bf16 v[80:95], v[36:39], v[168:171], v[80:95]
    ds_read_b64_tr_b16 v[56:57], v9 offset:45056
    ds_read_b64_tr_b16 v[58:59], v9 offset:46080
    ds_read_b64_tr_b16 v[60:61], v10 offset:45056
    ds_read_b64_tr_b16 v[62:63], v10 offset:46080
    v_mfma_f32_32x32x16_bf16 v[96:111], v[40:43], v[168:171], v[96:111]
    s_add_u32 m0, s58, 148480
    s_add_u32 s60, s55, s19
    buffer_load_dwordx4 v14, s[36:39], s60 offen lds
    v_mfma_f32_32x32x16_bf16 v[112:127], v[44:47], v[168:171], v[112:127]
    s_add_u32 m0, s58, 149504
    s_add_u32 s60, s55, s19
    buffer_load_dwordx4 v15, s[36:39], s60 offen lds
    s_waitcnt vmcnt(12)
    s_mov_b32 s63, 0xffff0000
    v_lshlrev_b32 v30, 16, v16
    v_and_b32 v16, s63, v16
    v_lshlrev_b32 v31, 16, v20
    v_and_b32 v20, s63, v20
    v_mul_f32 v30, v30, v31
    v_mul_f32 v31, v16, v20
    v_cvt_pk_bf16_f32 v30, v30, v31
    v_and_b32 v31, s63, v30
    v_lshlrev_b32 v30, 16, v30
    v_add_f32 v26, v30, v31
    v_lshlrev_b32 v30, 16, v17
    v_and_b32 v17, s63, v17
    v_lshlrev_b32 v31, 16, v21
    v_and_b32 v21, s63, v21
    v_mul_f32 v30, v30, v31
    v_mul_f32 v31, v17, v21
    v_cvt_pk_bf16_f32 v30, v30, v31
    v_and_b32 v31, s63, v30
    v_lshlrev_b32 v30, 16, v30
    v_add_f32 v26, v26, v30
    v_add_f32 v26, v26, v31
    v_lshlrev_b32 v30, 16, v18
    v_and_b32 v18, s63, v18
    v_lshlrev_b32 v31, 16, v22
    v_and_b32 v22, s63, v22
    v_mul_f32 v30, v30, v31
    v_mul_f32 v31, v18, v22
    v_cvt_pk_bf16_f32 v30, v30, v31
    v_and_b32 v31, s63, v30
    v_lshlrev_b32 v30, 16, v30
    v_add_f32 v26, v26, v30
    v_add_f32 v26, v26, v31
    v_lshlrev_b32 v30, 16, v19
    v_and_b32 v19, s63, v19
    v_lshlrev_b32 v31, 16, v23
    v_and_b32 v23, s63, v23
    v_mul_f32 v30, v30, v31
    v_mul_f32 v31, v19, v23
    v_cvt_pk_bf16_f32 v30, v30, v31
    v_and_b32 v31, s63, v30
    v_lshlrev_b32 v30, 16, v30
    v_add_f32 v26, v26, v30
    v_add_f32 v26, v26, v31
    s_nop 1
    v_add_f32_dpp v26, v26, v26 row_ror:8 row_mask:0xf bank_mask:0xf
    s_nop 1
    v_add_f32_dpp v26, v26, v26 row_ror:4 row_mask:0xf bank_mask:0xf
    s_nop 1
    v_add_f32_dpp v26, v26, v26 row_ror:2 row_mask:0xf bank_mask:0xf
    s_nop 1
    v_add_f32_dpp v26, v26, v26 row_ror:1 row_mask:0xf bank_mask:0xf
    s_nop 1
    v_readlane_b32 s60, v26, 0
    v_readlane_b32 s61, v26, 16
    v_readlane_b32 s62, v26, 32
    v_readlane_b32 s63, v26, 48
    s_nop 1
    v_mov_b32 v26, s60
    v_add_f32 v26, s61, v26
    v_add_f32 v26, s62, v26
    v_add_f32 v26, s63, v26
    v_cvt_pk_bf16_f32 v26, v26, v26
    v_lshlrev_b32 v26, 16, v26
    v_mul_f32 v26, 0xbfb8aa3b, v26
    v_exp_f32 v26, v26
    s_nop 0
    v_add_f32 v26, 1.0, v26
    v_rcp_f32 v26, v26
    s_nop 0
    v_cvt_pk_bf16_f32 v26, v26, v26
    v_lshlrev_b32 v26, 16, v26
    s_mov_b32 s72, s22
    s_and_b32 s73, s23, 0xffff
    s_mov_b32 s74, 0x100
    s_mov_b32 s75, 0x00020000
    buffer_load_dword v16, v24, s[72:75], 0 offen sc1
    s_waitcnt vmcnt(9) lgkmcnt(0)
    s_barrier
    v_add_u32 v2, 0x10000, v2
    v_add_u32 v3, 0x10000, v3
    v_add_u32 v4, 0x10000, v4
    v_add_u32 v5, 0x10000, v5
    v_add_u32 v6, 0x10000, v6
    ds_read_b128 v[176:179], v2 offset:0
    ds_read_b64_tr_b16 v[32:33], v6 offset:0
    ds_read_b64_tr_b16 v[34:35], v6 offset:768
    v_mfma_f32_32x32x16_bf16 v[64:79], v[48:51], v[172:175], v[64:79]
    v_mfma_f32_32x32x16_bf16 v[80:95], v[52:55], v[172:175], v[80:95]
    ds_read_b128 v[180:183], v3 offset:0
    ds_read_b64_tr_b16 v[40:41], v6 offset:3072
    ds_read_b64_tr_b16 v[42:43], v6 offset:3840
    v_mfma_f32_32x32x16_bf16 v[96:111], v[56:59], v[172:175], v[96:111]
    v_mfma_f32_32x32x16_bf16 v[112:127], v[60:63], v[172:175], v[112:127]
    ds_read_b128 v[184:187], v4 offset:0
    ds_read_b64_tr_b16 v[48:49], v6 offset:6144
    ds_read_b64_tr_b16 v[50:51], v6 offset:6912
    ds_read_b128 v[188:191], v5 offset:0
    ds_read_b64_tr_b16 v[56:57], v6 offset:9216
    ds_read_b64_tr_b16 v[58:59], v6 offset:9984
    s_add_u32 s71, s3, 1
    s_and_b32 s71, s71, 7
    s_mul_i32 s71, s71, 229376
    s_add_u32 s71, s71, s56
    s_add_u32 m0, s59, 0
    s_add_u32 s60, s71, 0
    buffer_load_dwordx4 v28, s[40:43], s60 offen lds
    s_add_u32 m0, s59, 16384
    s_add_u32 s60, s71, 0
    buffer_load_dwordx4 v29, s[44:47], s60 offen lds
    s_add_u32 m0, s59, 1024
    s_add_u32 s60, s71, 14336
    buffer_load_dwordx4 v28, s[40:43], s60 offen lds
    s_waitcnt lgkmcnt(9)
    v_mfma_f32_32x32x16_bf16 v[128:143], v[176:179], v[32:35], v[128:143]
    s_waitcnt lgkmcnt(6)
    v_mfma_f32_32x32x16_bf16 v[128:143], v[180:183], v[40:43], v[128:143]
    s_waitcnt vmcnt(8) lgkmcnt(0)
    s_barrier
    ds_read_b128 v[192:195], v2 offset:32768
    ds_read_b64_tr_b16 v[32:33], v6 offset:32768
    ds_read_b64_tr_b16 v[34:35], v6 offset:33536
    v_mfma_f32_32x32x16_bf16 v[128:143], v[184:187], v[48:51], v[128:143]
    ds_read_b128 v[196:199], v3 offset:32768
    ds_read_b64_tr_b16 v[40:41], v6 offset:35840
    ds_read_b64_tr_b16 v[42:43], v6 offset:36608
    v_mfma_f32_32x32x16_bf16 v[128:143], v[188:191], v[56:59], v[128:143]
    ds_read_b128 v[200:203], v4 offset:32768
    ds_read_b64_tr_b16 v[48:49], v6 offset:38912
    ds_read_b64_tr_b16 v[50:51], v6 offset:39680
    ds_read_b128 v[204:207], v5 offset:32768
    ds_read_b64_tr_b16 v[56:57], v6 offset:41984
    ds_read_b64_tr_b16 v[58:59], v6 offset:42752
    s_add_u32 m0, s59, 17408
    s_add_u32 s60, s71, 14336
    buffer_load_dwordx4 v29, s[44:47], s60 offen lds
    s_add_u32 s19, s3, 4
    s_and_b32 s19, s19, 7
    s_lshl_b32 s15, s19, 7
    s_add_u32 s15, s15, s54
    s_mul_i32 s19, s19, 196608
    s_add_u32 m0, s57, 32768
    s_add_u32 s60, s15, 0
    buffer_load_dwordx4 v11, s[32:35], s60 offen lds
    s_add_u32 m0, s57, 33792
    s_add_u32 s60, s15, 8192
    buffer_load_dwordx4 v12, s[32:35], s60 offen lds
    s_waitcnt lgkmcnt(9)
    v_mfma_f32_32x32x16_bf16 v[128:143], v[192:195], v[32:35], v[128:143]
    s_waitcnt lgkmcnt(6)
    v_mfma_f32_32x32x16_bf16 v[128:143], v[196:199], v[40:43], v[128:143]
    s_waitcnt vmcnt(7) lgkmcnt(0)
    s_barrier
    v_add_u32 v2, 0x10000, v2
    v_add_u32 v3, 0x10000, v3
    v_add_u32 v4, 0x10000, v4
    v_add_u32 v5, 0x10000, v5
    v_add_u32 v6, 0x10000, v6
    ds_read_b128 v[208:211], v2 offset:0
    ds_read_b64_tr_b16 v[32:33], v6 offset:0
    ds_read_b64_tr_b16 v[34:35], v6 offset:768
    v_mfma_f32_32x32x16_bf16 v[128:143], v[200:203], v[48:51], v[128:143]
    ds_read_b128 v[212:215], v3 offset:0
    ds_read_b64_tr_b16 v[40:41], v6 offset:3072
    ds_read_b64_tr_b16 v[42:43], v6 offset:3840
    v_mfma_f32_32x32x16_bf16 v[128:143], v[204:207], v[56:59], v[128:143]
    ds_read_b128 v[216:219], v4 offset:0
    ds_read_b64_tr_b16 v[48:49], v6 offset:6144
    ds_read_b64_tr_b16 v[50:51], v6 offset:6912
    ds_read_b128 v[220:223], v5 offset:0
    ds_read_b64_tr_b16 v[56:57], v6 offset:9216
    ds_read_b64_tr_b16 v[58:59], v6 offset:9984
    s_add_u32 m0, s58, 50176
    s_add_u32 s60, s55, s19
    buffer_load_dwordx4 v14, s[36:39], s60 offen lds
    s_add_u32 m0, s58, 51200
    s_add_u32 s60, s55, s19
    buffer_load_dwordx4 v15, s[36:39], s60 offen lds
    s_add_u32 s19, s3, 5
    s_and_b32 s19, s19, 7
    s_lshl_b32 s15, s19, 7
    s_add_u32 s15, s15, s54
    s_mul_i32 s19, s19, 196608
    s_add_u32 m0, s57, 65536
    s_add_u32 s60, s15, 0
    buffer_load_dwordx4 v11, s[32:35], s60 offen lds
    s_waitcnt lgkmcnt(9)
    v_mfma_f32_32x32x16_bf16 v[128:143], v[208:211], v[32:35], v[128:143]
    s_waitcnt lgkmcnt(6)
    v_mfma_f32_32x32x16_bf16 v[128:143], v[212:215], v[40:43], v[128:143]
    s_waitcnt vmcnt(5) lgkmcnt(0)
    s_barrier
    v_mfma_f32_32x32x16_bf16 v[128:143], v[216:219], v[48:51], v[128:143]
    ds_read_b64_tr_b16 v[32:33], v7 offset:0
    ds_read_b64_tr_b16 v[34:35], v7 offset:1024
    ds_read_b64_tr_b16 v[36:37], v8 offset:0
    ds_read_b64_tr_b16 v[38:39], v8 offset:1024
    v_mfma_f32_32x32x16_bf16 v[128:143], v[220:223], v[56:59], v[128:143]
    ds_read_b64_tr_b16 v[40:41], v9 offset:0
    ds_read_b64_tr_b16 v[42:43], v9 offset:1024
    ds_read_b64_tr_b16 v[44:45], v10 offset:0
    ds_read_b64_tr_b16 v[46:47], v10 offset:1024
    s_add_u32 m0, s57, 66560
    s_add_u32 s60, s15, 8192
    buffer_load_dwordx4 v12, s[32:35], s60 offen lds
    s_add_u32 m0, s58, 82944
    s_add_u32 s60, s55, s19
    buffer_load_dwordx4 v14, s[36:39], s60 offen lds
    s_waitcnt lgkmcnt(0)
    v_mfma_f32_32x32x16_bf16 v[64:79], v[32:35], v[176:179], v[64:79]
    ds_read_b64_tr_b16 v[48:49], v7 offset:4096
    ds_read_b64_tr_b16 v[50:51], v7 offset:5120
    ds_read_b64_tr_b16 v[52:53], v8 offset:4096
    ds_read_b64_tr_b16 v[54:55], v8 offset:5120
    v_mfma_f32_32x32x16_bf16 v[80:95], v[36:39], v[176:179], v[80:95]
    ds_read_b64_tr_b16 v[56:57], v9 offset:4096
    ds_read_b64_tr_b16 v[58:59], v9 offset:5120
    ds_read_b64_tr_b16 v[60:61], v10 offset:4096
    ds_read_b64_tr_b16 v[62:63], v10 offset:5120
    v_mfma_f32_32x32x16_bf16 v[96:111], v[40:43], v[176:179], v[96:111]
    s_add_u32 m0, s58, 83968
    s_add_u32 s60, s55, s19
    buffer_load_dwordx4 v15, s[36:39], s60 offen lds
    v_mfma_f32_32x32x16_bf16 v[112:127], v[44:47], v[176:179], v[112:127]
    s_add_u32 s19, s3, 6
    s_and_b32 s19, s19, 7
    s_lshl_b32 s15, s19, 7
    s_add_u32 s15, s15, s54
    s_mul_i32 s19, s19, 196608
    s_add_u32 m0, s57, 98304
    s_add_u32 s60, s15, 0
    buffer_load_dwordx4 v11, s[32:35], s60 offen lds
    s_waitcnt lgkmcnt(0)
    v_mfma_f32_32x32x16_bf16 v[64:79], v[48:51], v[180:183], v[64:79]
    ds_read_b64_tr_b16 v[32:33], v7 offset:8192
    ds_read_b64_tr_b16 v[34:35], v7 offset:9216
    ds_read_b64_tr_b16 v[36:37], v8 offset:8192
    ds_read_b64_tr_b16 v[38:39], v8 offset:9216
    v_mfma_f32_32x32x16_bf16 v[80:95], v[52:55], v[180:183], v[80:95]
    ds_read_b64_tr_b16 v[40:41], v9 offset:8192
    ds_read_b64_tr_b16 v[42:43], v9 offset:9216
    ds_read_b64_tr_b16 v[44:45], v10 offset:8192
    ds_read_b64_tr_b16 v[46:47], v10 offset:9216
    v_mfma_f32_32x32x16_bf16 v[96:111], v[56:59], v[180:183], v[96:111]
    s_add_u32 m0, s57, 99328
    s_add_u32 s60, s15, 8192
    buffer_load_dwordx4 v12, s[32:35], s60 offen lds
    v_mfma_f32_32x32x16_bf16 v[112:127], v[60:63], v[180:183], v[112:127]
    s_add_u32 m0, s58, 115712
    s_add_u32 s60, s55, s19
    buffer_load_dwordx4 v14, s[36:39], s60 offen lds
    s_waitcnt lgkmcnt(0)
    v_mfma_f32_32x32x16_bf16 v[64:79], v[32:35], v[184:187], v[64:79]
    ds_read_b64_tr_b16 v[48:49], v7 offset:12288
    ds_read_b64_tr_b16 v[50:51], v7 offset:13312
    ds_read_b64_tr_b16 v[52:53], v8 offset:12288
    ds_read_b64_tr_b16 v[54:55], v8 offset:13312
    v_mfma_f32_32x32x16_bf16 v[80:95], v[36:39], v[184:187], v[80:95]
    ds_read_b64_tr_b16 v[56:57], v9 offset:12288
    ds_read_b64_tr_b16 v[58:59], v9 offset:13312
    ds_read_b64_tr_b16 v[60:61], v10 offset:12288
    ds_read_b64_tr_b16 v[62:63], v10 offset:13312
    v_mfma_f32_32x32x16_bf16 v[96:111], v[40:43], v[184:187], v[96:111]
    s_add_u32 m0, s58, 116736
    s_add_u32 s60, s55, s19
    buffer_load_dwordx4 v15, s[36:39], s60 offen lds
    v_mfma_f32_32x32x16_bf16 v[112:127], v[44:47], v[184:187], v[112:127]
    s_add_u32 s19, s3, 7
    s_and_b32 s19, s19, 7
    s_lshl_b32 s15, s19, 7
    s_add_u32 s15, s15, s54
    s_mul_i32 s19, s19, 196608
    s_add_u32 m0, s57, 131072
    s_add_u32 s60, s15, 0
    buffer_load_dwordx4 v11, s[32:35], s60 offen lds
    s_waitcnt vmcnt(9) lgkmcnt(0)
    s_barrier
    v_add_u32 v2, 0xfffe8000, v2
    v_add_u32 v3, 0xfffe8000, v3
    v_add_u32 v4, 0xfffe8000, v4
    v_add_u32 v5, 0xfffe8000, v5
    v_add_u32 v6, 0xfffe8000, v6
    ds_read_b128 v[224:227], v2 offset:0
    ds_read_b64_tr_b16 v[32:33], v6 offset:0
    ds_read_b64_tr_b16 v[34:35], v6 offset:768
    v_mfma_f32_32x32x16_bf16 v[64:79], v[48:51], v[188:191], v[64:79]
    v_mfma_f32_32x32x16_bf16 v[80:95], v[52:55], v[188:191], v[80:95]
    ds_read_b128 v[228:231], v3 offset:0
    ds_read_b64_tr_b16 v[40:41], v6 offset:3072
    ds_read_b64_tr_b16 v[42:43], v6 offset:3840
    v_mfma_f32_32x32x16_bf16 v[96:111], v[56:59], v[188:191], v[96:111]
    v_mfma_f32_32x32x16_bf16 v[112:127], v[60:63], v[188:191], v[112:127]
    ds_read_b128 v[232:235], v4 offset:0
    ds_read_b64_tr_b16 v[48:49], v6 offset:6144
    ds_read_b64_tr_b16 v[50:51], v6 offset:6912
    ds_read_b128 v[236:239], v5 offset:0
    ds_read_b64_tr_b16 v[56:57], v6 offset:9216
    ds_read_b64_tr_b16 v[58:59], v6 offset:9984
    s_add_u32 m0, s57, 132096
    s_add_u32 s60, s15, 8192
    buffer_load_dwordx4 v12, s[32:35], s60 offen lds
    s_add_u32 m0, s58, 148480
    s_add_u32 s60, s55, s19
    buffer_load_dwordx4 v14, s[36:39], s60 offen lds
    s_add_u32 m0, s58, 149504
    s_add_u32 s60, s55, s19
    buffer_load_dwordx4 v15, s[36:39], s60 offen lds
    s_waitcnt lgkmcnt(9)
    v_mfma_f32_32x32x16_bf16 v[128:143], v[224:227], v[32:35], v[128:143]
    s_waitcnt lgkmcnt(6)
    v_mfma_f32_32x32x16_bf16 v[128:143], v[228:231], v[40:43], v[128:143]
    v_readfirstlane_b32 s26, v25
    v_readfirstlane_b32 s60, v16
    s_nop 3
    s_mul_i32 s26, s26, 1664525
    s_add_u32 s26, s26, 1013904223
    s_or_b32 s26, s26, 1
    s_cmp_lg_u32 s60, 0
    s_cselect_b32 s26, s60, s26
    v_readfirstlane_b32 s22, v26
    s_waitcnt vmcnt(8) lgkmcnt(0)
    s_barrier
    ds_read_b128 v[240:243], v2 offset:32768
    ds_read_b64_tr_b16 v[32:33], v6 offset:32768
    ds_read_b64_tr_b16 v[34:35], v6 offset:33536
    v_mfma_f32_32x32x16_bf16 v[128:143], v[232:235], v[48:51], v[128:143]
    ds_read_b128 v[244:247], v3 offset:32768
    ds_read_b64_tr_b16 v[40:41], v6 offset:35840
    ds_read_b64_tr_b16 v[42:43], v6 offset:36608
    v_mfma_f32_32x32x16_bf16 v[128:143], v[236:239], v[56:59], v[128:143]
    ds_read_b128 v[248:251], v4 offset:32768
    ds_read_b64_tr_b16 v[48:49], v6 offset:38912
    ds_read_b64_tr_b16 v[50:51], v6 offset:39680
    ds_read_b128 v[252:255], v5 offset:32768
    ds_read_b64_tr_b16 v[56:57], v6 offset:41984
    ds_read_b64_tr_b16 v[58:59], v6 offset:42752
    s_add_u32 s71, s3, 2
    s_and_b32 s71, s71, 7
    s_mul_i32 s71, s71, 229376
    s_add_u32 s71, s71, s56
    s_add_u32 m0, s59, 0
    s_add_u32 s60, s71, 0
    buffer_load_dwordx4 v28, s[40:43], s60 offen lds
    s_add_u32 m0, s59, 16384
    s_add_u32 s60, s71, 0
    buffer_load_dwordx4 v29, s[44:47], s60 offen lds
    s_add_u32 m0, s59, 1024
    s_add_u32 s60, s71, 14336
    buffer_load_dwordx4 v28, s[40:43], s60 offen lds
    s_waitcnt lgkmcnt(9)
    v_mfma_f32_32x32x16_bf16 v[128:143], v[240:243], v[32:35], v[128:143]
    s_waitcnt lgkmcnt(6)
    v_mfma_f32_32x32x16_bf16 v[128:143], v[244:247], v[40:43], v[128:143]
    s_waitcnt vmcnt(7) lgkmcnt(0)
    s_barrier
    v_add_u32 v2, 0x10000, v2
    v_add_u32 v3, 0x10000, v3
    v_add_u32 v4, 0x10000, v4
    v_add_u32 v5, 0x10000, v5
    v_add_u32 v6, 0x10000, v6
    ds_read_b128 v[160:163], v2 offset:0
    ds_read_b64_tr_b16 v[32:33], v6 offset:0
    ds_read_b64_tr_b16 v[34:35], v6 offset:768
    v_mfma_f32_32x32x16_bf16 v[128:143], v[248:251], v[48:51], v[128:143]
    ds_read_b128 v[164:167], v3 offset:0
    ds_read_b64_tr_b16 v[40:41], v6 offset:3072
    ds_read_b64_tr_b16 v[42:43], v6 offset:3840
    v_mfma_f32_32x32x16_bf16 v[128:143], v[252:255], v[56:59], v[128:143]
    ds_read_b128 v[168:171], v4 offset:0
    ds_read_b64_tr_b16 v[48:49], v6 offset:6144
    ds_read_b64_tr_b16 v[50:51], v6 offset:6912
    ds_read_b128 v[172:175], v5 offset:0
    ds_read_b64_tr_b16 v[56:57], v6 offset:9216
    ds_read_b64_tr_b16 v[58:59], v6 offset:9984
    s_add_u32 m0, s59, 17408
    s_add_u32 s60, s71, 14336
    buffer_load_dwordx4 v29, s[44:47], s60 offen lds
    s_add_u32 s71, s3, 3
    s_and_b32 s71, s71, 7
    s_mul_i32 s71, s71, 229376
    s_add_u32 s71, s71, s56
    s_add_u32 m0, s59, 32768
    s_add_u32 s60, s71, 0
    buffer_load_dwordx4 v28, s[40:43], s60 offen lds
    s_add_u32 m0, s59, 49152
    s_add_u32 s60, s71, 0
    buffer_load_dwordx4 v29, s[44:47], s60 offen lds
    s_waitcnt lgkmcnt(9)
    v_mfma_f32_32x32x16_bf16 v[128:143], v[160:163], v[32:35], v[128:143]
    s_waitcnt lgkmcnt(6)
    v_mfma_f32_32x32x16_bf16 v[128:143], v[164:167], v[40:43], v[128:143]
    s_waitcnt vmcnt(6) lgkmcnt(0)
    s_barrier
    ds_read_b128 v[176:179], v2 offset:32768
    ds_read_b64_tr_b16 v[32:33], v6 offset:32768
    ds_read_b64_tr_b16 v[34:35], v6 offset:33536
    v_mfma_f32_32x32x16_bf16 v[128:143], v[168:171], v[48:51], v[128:143]
    ds_read_b128 v[180:183], v3 offset:32768
    ds_read_b64_tr_b16 v[40:41], v6 offset:35840
    ds_read_b64_tr_b16 v[42:43], v6 offset:36608
    v_mfma_f32_32x32x16_bf16 v[128:143], v[172:175], v[56:59], v[128:143]
    ds_read_b128 v[184:187], v4 offset:32768
    ds_read_b64_tr_b16 v[48:49], v6 offset:38912
    ds_read_b64_tr_b16 v[50:51], v6 offset:39680
    ds_read_b128 v[188:191], v5 offset:32768
    ds_read_b64_tr_b16 v[56:57], v6 offset:41984
    ds_read_b64_tr_b16 v[58:59], v6 offset:42752
    s_add_u32 m0, s59, 33792
    s_add_u32 s60, s71, 14336
    buffer_load_dwordx4 v28, s[40:43], s60 offen lds
    s_add_u32 m0, s59, 50176
    s_add_u32 s60, s71, 14336
    buffer_load_dwordx4 v29, s[44:47], s60 offen lds
    s_add_u32 s71, s3, 4
    s_and_b32 s71, s71, 7
    s_mul_i32 s71, s71, 229376
    s_add_u32 s71, s71, s56
    s_add_u32 m0, s59, 65536
    s_add_u32 s60, s71, 0
    buffer_load_dwordx4 v28, s[40:43], s60 offen lds
    s_waitcnt lgkmcnt(9)
    v_mfma_f32_32x32x16_bf16 v[128:143], v[176:179], v[32:35], v[128:143]
    s_waitcnt lgkmcnt(6)
    v_mfma_f32_32x32x16_bf16 v[128:143], v[180:183], v[40:43], v[128:143]
    s_waitcnt vmcnt(5) lgkmcnt(0)
    s_barrier
    v_mfma_f32_32x32x16_bf16 v[128:143], v[184:187], v[48:51], v[128:143]
    ds_read_b64_tr_b16 v[32:33], v7 offset:0
    ds_read_b64_tr_b16 v[34:35], v7 offset:1024
    ds_read_b64_tr_b16 v[36:37], v8 offset:0
    ds_read_b64_tr_b16 v[38:39], v8 offset:1024
    v_mfma_f32_32x32x16_bf16 v[128:143], v[188:191], v[56:59], v[128:143]
    ds_read_b64_tr_b16 v[40:41], v9 offset:0
    ds_read_b64_tr_b16 v[42:43], v9 offset:1024
    ds_read_b64_tr_b16 v[44:45], v10 offset:0
    ds_read_b64_tr_b16 v[46:47], v10 offset:1024
    s_add_u32 m0, s59, 81920
    s_add_u32 s60, s71, 0
    buffer_load_dwordx4 v29, s[44:47], s60 offen lds
    s_waitcnt lgkmcnt(0)
    v_mfma_f32_32x32x16_bf16 v[64:79], v[32:35], v[192:195], v[64:79]
    ds_read_b64_tr_b16 v[48:49], v7 offset:4096
    ds_read_b64_tr_b16 v[50:51], v7 offset:5120
    ds_read_b64_tr_b16 v[52:53], v8 offset:4096
    ds_read_b64_tr_b16 v[54:55], v8 offset:5120
    v_mfma_f32_32x32x16_bf16 v[80:95], v[36:39], v[192:195], v[80:95]
    ds_read_b64_tr_b16 v[56:57], v9 offset:4096
    ds_read_b64_tr_b16 v[58:59], v9 offset:5120
    ds_read_b64_tr_b16 v[60:61], v10 offset:4096
    ds_read_b64_tr_b16 v[62:63], v10 offset:5120
    v_mfma_f32_32x32x16_bf16 v[96:111], v[40:43], v[192:195], v[96:111]
    v_mfma_f32_32x32x16_bf16 v[112:127], v[44:47], v[192:195], v[112:127]
    s_add_u32 m0, s59, 66560
    s_add_u32 s60, s71, 14336
    buffer_load_dwordx4 v28, s[40:43], s60 offen lds
    s_mul_i32 s60, s49, 3
    s_add_u32 s60, s60, 2
    s_and_b32 s61, s60, 15
    s_lshl_b32 s61, s61, 7
    s_lshl_b32 s62, s48, 2
    s_add_u32 s62, s62, s51
    s_add_u32 s61, s61, s62
    s_lshl_b32 s61, s61, 11
    s_add_u32 s72, s61, 0x200400
    s_add_u32 s73, s72, 512
    v_bfe_u32 v30, v0, 4, 1
    v_lshlrev_b32 v30, 17, v30
    v_lshrrev_b32 v31, 5, v0
    v_lshl_add_u32 v30, v31, 8, v30
    v_and_b32 v31, 15, v0
    v_lshl_add_u32 v15, v31, 4, v30
    v_cvt_pk_bf16_f32 v128, v128, v129
    v_cvt_pk_bf16_f32 v129, v130, v131
    v_cvt_pk_bf16_f32 v130, v132, v133
    v_cvt_pk_bf16_f32 v131, v134, v135
    v_cvt_pk_bf16_f32 v132, v136, v137
    v_cvt_pk_bf16_f32 v133, v138, v139
    v_cvt_pk_bf16_f32 v134, v140, v141
    v_cvt_pk_bf16_f32 v135, v142, v143
    s_waitcnt lgkmcnt(0)
    v_mfma_f32_32x32x16_bf16 v[64:79], v[48:51], v[196:199], v[64:79]
    ds_read_b64_tr_b16 v[32:33], v7 offset:8192
    ds_read_b64_tr_b16 v[34:35], v7 offset:9216
    ds_read_b64_tr_b16 v[36:37], v8 offset:8192
    ds_read_b64_tr_b16 v[38:39], v8 offset:9216
    v_mfma_f32_32x32x16_bf16 v[80:95], v[52:55], v[196:199], v[80:95]
    ds_read_b64_tr_b16 v[40:41], v9 offset:8192
    ds_read_b64_tr_b16 v[42:43], v9 offset:9216
    ds_read_b64_tr_b16 v[44:45], v10 offset:8192
    ds_read_b64_tr_b16 v[46:47], v10 offset:9216
    v_mfma_f32_32x32x16_bf16 v[96:111], v[56:59], v[196:199], v[96:111]
    buffer_store_dwordx4 v[128:131], v15, s[28:31], s72 offen sc1
    v_mfma_f32_32x32x16_bf16 v[112:127], v[60:63], v[196:199], v[112:127]
    s_add_u32 m0, s59, 82944
    s_add_u32 s60, s71, 14336
    buffer_load_dwordx4 v29, s[44:47], s60 offen lds
    s_waitcnt lgkmcnt(0)
    v_mfma_f32_32x32x16_bf16 v[64:79], v[32:35], v[200:203], v[64:79]
    ds_read_b64_tr_b16 v[48:49], v7 offset:12288
    ds_read_b64_tr_b16 v[50:51], v7 offset:13312
    ds_read_b64_tr_b16 v[52:53], v8 offset:12288
    ds_read_b64_tr_b16 v[54:55], v8 offset:13312
    v_mfma_f32_32x32x16_bf16 v[80:95], v[36:39], v[200:203], v[80:95]
    ds_read_b64_tr_b16 v[56:57], v9 offset:12288
    ds_read_b64_tr_b16 v[58:59], v9 offset:13312
    ds_read_b64_tr_b16 v[60:61], v10 offset:12288
    ds_read_b64_tr_b16 v[62:63], v10 offset:13312
    v_mfma_f32_32x32x16_bf16 v[96:111], v[40:43], v[200:203], v[96:111]
    v_mfma_f32_32x32x16_bf16 v[112:127], v[44:47], v[200:203], v[112:127]
    s_add_u32 s71, s3, 5
    s_and_b32 s71, s71, 7
    s_mul_i32 s71, s71, 229376
    s_add_u32 s71, s71, s56
    s_add_u32 m0, s59, 98304
    s_add_u32 s60, s71, 0
    buffer_load_dwordx4 v28, s[40:43], s60 offen lds
    s_waitcnt vmcnt(6) lgkmcnt(0)
    s_barrier
    v_mfma_f32_32x32x16_bf16 v[64:79], v[48:51], v[204:207], v[64:79]
    ds_read_b64_tr_b16 v[32:33], v7 offset:32768
    ds_read_b64_tr_b16 v[34:35], v7 offset:33792
    ds_read_b64_tr_b16 v[36:37], v8 offset:32768
    ds_read_b64_tr_b16 v[38:39], v8 offset:33792
    v_mfma_f32_32x32x16_bf16 v[80:95], v[52:55], v[204:207], v[80:95]
    ds_read_b64_tr_b16 v[40:41], v9 offset:32768
    ds_read_b64_tr_b16 v[42:43], v9 offset:33792
    ds_read_b64_tr_b16 v[44:45], v10 offset:32768
    ds_read_b64_tr_b16 v[46:47], v10 offset:33792
    v_mfma_f32_32x32x16_bf16 v[96:111], v[56:59], v[204:207], v[96:111]
    buffer_store_dwordx4 v[132:135], v15, s[28:31], s73 offen sc1
    v_mfma_f32_32x32x16_bf16 v[112:127], v[60:63], v[204:207], v[112:127]
    s_add_u32 m0, s59, 114688
    s_add_u32 s60, s71, 0
    buffer_load_dwordx4 v29, s[44:47], s60 offen lds
    s_waitcnt lgkmcnt(0)
    v_mfma_f32_32x32x16_bf16 v[64:79], v[32:35], v[208:211], v[64:79]
    ds_read_b64_tr_b16 v[48:49], v7 offset:36864
    ds_read_b64_tr_b16 v[50:51], v7 offset:37888
    ds_read_b64_tr_b16 v[52:53], v8 offset:36864
    ds_read_b64_tr_b16 v[54:55], v8 offset:37888
    v_mfma_f32_32x32x16_bf16 v[80:95], v[36:39], v[208:211], v[80:95]
    ds_read_b64_tr_b16 v[56:57], v9 offset:36864
    ds_read_b64_tr_b16 v[58:59], v9 offset:37888
    ds_read_b64_tr_b16 v[60:61], v10 offset:36864
    ds_read_b64_tr_b16 v[62:63], v10 offset:37888
    v_mfma_f32_32x32x16_bf16 v[96:111], v[40:43], v[208:211], v[96:111]
    v_mfma_f32_32x32x16_bf16 v[112:127], v[44:47], v[208:211], v[112:127]
    s_add_u32 m0, s59, 99328
    s_add_u32 s60, s71, 14336
    buffer_load_dwordx4 v28, s[40:43], s60 offen lds
    s_waitcnt lgkmcnt(0)
    v_mfma_f32_32x32x16_bf16 v[64:79], v[48:51], v[212:215], v[64:79]
    ds_read_b64_tr_b16 v[32:33], v7 offset:40960
    ds_read_b64_tr_b16 v[34:35], v7 offset:41984
    ds_read_b64_tr_b16 v[36:37], v8 offset:40960
    ds_read_b64_tr_b16 v[38:39], v8 offset:41984
    v_mfma_f32_32x32x16_bf16 v[80:95], v[52:55], v[212:215], v[80:95]
    ds_read_b64_tr_b16 v[40:41], v9 offset:40960
    ds_read_b64_tr_b16 v[42:43], v9 offset:41984
    ds_read_b64_tr_b16 v[44:45], v10 offset:40960
    ds_read_b64_tr_b16 v[46:47], v10 offset:41984
    v_mfma_f32_32x32x16_bf16 v[96:111], v[56:59], v[212:215], v[96:111]
    v_mfma_f32_32x32x16_bf16 v[112:127], v[60:63], v[212:215], v[112:127]
    s_add_u32 m0, s59, 115712
    s_add_u32 s60, s71, 14336
    buffer_load_dwordx4 v29, s[44:47], s60 offen lds
    s_waitcnt lgkmcnt(0)
    v_mfma_f32_32x32x16_bf16 v[64:79], v[32:35], v[216:219], v[64:79]
    ds_read_b64_tr_b16 v[48:49], v7 offset:45056
    ds_read_b64_tr_b16 v[50:51], v7 offset:46080
    ds_read_b64_tr_b16 v[52:53], v8 offset:45056
    ds_read_b64_tr_b16 v[54:55], v8 offset:46080
    v_mfma_f32_32x32x16_bf16 v[80:95], v[36:39], v[216:219], v[80:95]
    ds_read_b64_tr_b16 v[56:57], v9 offset:45056
    ds_read_b64_tr_b16 v[58:59], v9 offset:46080
    ds_read_b64_tr_b16 v[60:61], v10 offset:45056
    ds_read_b64_tr_b16 v[62:63], v10 offset:46080
    v_mfma_f32_32x32x16_bf16 v[96:111], v[40:43], v[216:219], v[96:111]
    v_mfma_f32_32x32x16_bf16 v[112:127], v[44:47], v[216:219], v[112:127]
    s_add_u32 s71, s3, 6
    s_and_b32 s71, s71, 7
    s_mul_i32 s71, s71, 229376
    s_add_u32 s71, s71, s56
    s_add_u32 m0, s59, 131072
    s_add_u32 s60, s71, 0
    buffer_load_dwordx4 v28, s[40:43], s60 offen lds
    s_waitcnt vmcnt(6) lgkmcnt(0)
    s_barrier
    v_add_u32 v7, 0x10000, v7
    v_add_u32 v8, 0x10000, v8
    v_add_u32 v9, 0x10000, v9
    v_add_u32 v10, 0x10000, v10
    v_mfma_f32_32x32x16_bf16 v[64:79], v[48:51], v[220:223], v[64:79]
    ds_read_b64_tr_b16 v[32:33], v7 offset:0
    ds_read_b64_tr_b16 v[34:35], v7 offset:1024
    ds_read_b64_tr_b16 v[36:37], v8 offset:0
    ds_read_b64_tr_b16 v[38:39], v8 offset:1024
    v_mfma_f32_32x32x16_bf16 v[80:95], v[52:55], v[220:223], v[80:95]
    ds_read_b64_tr_b16 v[40:41], v9 offset:0
    ds_read_b64_tr_b16 v[42:43], v9 offset:1024
    ds_read_b64_tr_b16 v[44:45], v10 offset:0
    ds_read_b64_tr_b16 v[46:47], v10 offset:1024
    v_mfma_f32_32x32x16_bf16 v[96:111], v[56:59], v[220:223], v[96:111]
    v_mfma_f32_32x32x16_bf16 v[112:127], v[60:63], v[220:223], v[112:127]
    s_add_u32 m0, s59, 147456
    s_add_u32 s60, s71, 0
    buffer_load_dwordx4 v29, s[44:47], s60 offen lds
    s_waitcnt lgkmcnt(0)
    v_mfma_f32_32x32x16_bf16 v[64:79], v[32:35], v[224:227], v[64:79]
    ds_read_b64_tr_b16 v[48:49], v7 offset:4096
    ds_read_b64_tr_b16 v[50:51], v7 offset:5120
    ds_read_b64_tr_b16 v[52:53], v8 offset:4096
    ds_read_b64_tr_b16 v[54:55], v8 offset:5120
    v_mfma_f32_32x32x16_bf16 v[80:95], v[36:39], v[224:227], v[80:95]
    ds_read_b64_tr_b16 v[56:57], v9 offset:4096
    ds_read_b64_tr_b16 v[58:59], v9 offset:5120
    ds_read_b64_tr_b16 v[60:61], v10 offset:4096
    ds_read_b64_tr_b16 v[62:63], v10 offset:5120
    v_mfma_f32_32x32x16_bf16 v[96:111], v[40:43], v[224:227], v[96:111]
    v_mfma_f32_32x32x16_bf16 v[112:127], v[44:47], v[224:227], v[112:127]
    s_add_u32 m0, s59, 132096
    s_add_u32 s60, s71, 14336
    buffer_load_dwordx4 v28, s[40:43], s60 offen lds
    s_waitcnt lgkmcnt(0)
    v_mfma_f32_32x32x16_bf16 v[64:79], v[48:51], v[228:231], v[64:79]
    ds_read_b64_tr_b16 v[32:33], v7 offset:8192
    ds_read_b64_tr_b16 v[34:35], v7 offset:9216
    ds_read_b64_tr_b16 v[36:37], v8 offset:8192
    ds_read_b64_tr_b16 v[38:39], v8 offset:9216
    v_mfma_f32_32x32x16_bf16 v[80:95], v[52:55], v[228:231], v[80:95]
    ds_read_b64_tr_b16 v[40:41], v9 offset:8192
    ds_read_b64_tr_b16 v[42:43], v9 offset:9216
    ds_read_b64_tr_b16 v[44:45], v10 offset:8192
    ds_read_b64_tr_b16 v[46:47], v10 offset:9216
    v_mfma_f32_32x32x16_bf16 v[96:111], v[56:59], v[228:231], v[96:111]
    v_mfma_f32_32x32x16_bf16 v[112:127], v[60:63], v[228:231], v[112:127]
    s_add_u32 m0, s59, 148480
    s_add_u32 s60, s71, 14336
    buffer_load_dwordx4 v29, s[44:47], s60 offen lds
    s_waitcnt lgkmcnt(0)
    v_mfma_f32_32x32x16_bf16 v[64:79], v[32:35], v[232:235], v[64:79]
    ds_read_b64_tr_b16 v[48:49], v7 offset:12288
    ds_read_b64_tr_b16 v[50:51], v7 offset:13312
    ds_read_b64_tr_b16 v[52:53], v8 offset:12288
    ds_read_b64_tr_b16 v[54:55], v8 offset:13312
    v_mfma_f32_32x32x16_bf16 v[80:95], v[36:39], v[232:235], v[80:95]
    ds_read_b64_tr_b16 v[56:57], v9 offset:12288
    ds_read_b64_tr_b16 v[58:59], v9 offset:13312
    ds_read_b64_tr_b16 v[60:61], v10 offset:12288
    ds_read_b64_tr_b16 v[62:63], v10 offset:13312
    v_mfma_f32_32x32x16_bf16 v[96:111], v[40:43], v[232:235], v[96:111]
    v_mfma_f32_32x32x16_bf16 v[112:127], v[44:47], v[232:235], v[112:127]
    s_add_u32 s71, s3, 7
    s_and_b32 s71, s71, 7
    s_mul_i32 s71, s71, 229376
    s_add_u32 s71, s71, s56
    s_add_u32 m0, s59, 0
    s_add_u32 s60, s71, 0
    buffer_load_dwordx4 v28, s[40:43], s60 offen lds
    s_waitcnt vmcnt(5) lgkmcnt(0)
    s_barrier
    v_mfma_f32_32x32x16_bf16 v[64:79], v[48:51], v[236:239], v[64:79]
    ds_read_b64_tr_b16 v[32:33], v7 offset:32768
    ds_read_b64_tr_b16 v[34:35], v7 offset:33792
    ds_read_b64_tr_b16 v[36:37], v8 offset:32768
    ds_read_b64_tr_b16 v[38:39], v8 offset:33792
    v_mfma_f32_32x32x16_bf16 v[80:95], v[52:55], v[236:239], v[80:95]
    ds_read_b64_tr_b16 v[40:41], v9 offset:32768
    ds_read_b64_tr_b16 v[42:43], v9 offset:33792
    ds_read_b64_tr_b16 v[44:45], v10 offset:32768
    ds_read_b64_tr_b16 v[46:47], v10 offset:33792
    v_mfma_f32_32x32x16_bf16 v[96:111], v[56:59], v[236:239], v[96:111]
    v_mfma_f32_32x32x16_bf16 v[112:127], v[60:63], v[236:239], v[112:127]
    s_add_u32 m0, s59, 16384
    s_add_u32 s60, s71, 0
    buffer_load_dwordx4 v29, s[44:47], s60 offen lds
    s_waitcnt lgkmcnt(0)
    v_mfma_f32_32x32x16_bf16 v[64:79], v[32:35], v[240:243], v[64:79]
    ds_read_b64_tr_b16 v[48:49], v7 offset:36864
    ds_read_b64_tr_b16 v[50:51], v7 offset:37888
    ds_read_b64_tr_b16 v[52:53], v8 offset:36864
    ds_read_b64_tr_b16 v[54:55], v8 offset:37888
    s_mov_b32 s32, s16
    s_and_b32 s33, s17, 0xffff
    v_mfma_f32_32x32x16_bf16 v[80:95], v[36:39], v[240:243], v[80:95]
    ds_read_b64_tr_b16 v[56:57], v9 offset:36864
    ds_read_b64_tr_b16 v[58:59], v9 offset:37888
    ds_read_b64_tr_b16 v[60:61], v10 offset:36864
    ds_read_b64_tr_b16 v[62:63], v10 offset:37888
    s_mov_b32 s34, 0x1c0000
    s_mov_b32 s35, 0x00020000
    v_mfma_f32_32x32x16_bf16 v[96:111], v[40:43], v[240:243], v[96:111]
    s_mov_b32 s36, s8
    s_and_b32 s37, s9, 0xffff
    s_mov_b32 s38, 0x80000
    s_mov_b32 s39, 0x00020000
    v_mfma_f32_32x32x16_bf16 v[112:127], v[44:47], v[240:243], v[112:127]
    s_mul_i32 s54, s52, 16640
    s_add_u32 s54, s54, 32768
    v_add_u32 v2, s54, v1
    v_lshrrev_b32 v236, 5, v0
    s_add_u32 m0, s59, 1024
    s_add_u32 s60, s71, 14336
    buffer_load_dwordx4 v28, s[40:43], s60 offen lds
    s_waitcnt lgkmcnt(0)
    v_mfma_f32_32x32x16_bf16 v[64:79], v[48:51], v[244:247], v[64:79]
    ds_read_b64_tr_b16 v[32:33], v7 offset:40960
    ds_read_b64_tr_b16 v[34:35], v7 offset:41984
    ds_read_b64_tr_b16 v[36:37], v8 offset:40960
    ds_read_b64_tr_b16 v[38:39], v8 offset:41984
    v_lshlrev_b32 v232, 8, v236
    v_and_b32 v233, 15, v0
    v_mfma_f32_32x32x16_bf16 v[80:95], v[52:55], v[244:247], v[80:95]
    ds_read_b64_tr_b16 v[40:41], v9 offset:40960
    ds_read_b64_tr_b16 v[42:43], v9 offset:41984
    ds_read_b64_tr_b16 v[44:45], v10 offset:40960
    ds_read_b64_tr_b16 v[46:47], v10 offset:41984
    v_lshl_add_u32 v232, v233, 4, v232
    v_and_b32 v233, 11, v0
    v_mfma_f32_32x32x16_bf16 v[96:111], v[56:59], v[244:247], v[96:111]
    v_cmp_eq_u32 vcc, 0, v233
    v_mov_b32 v234, 16
    s_nop 0
    v_cndmask_b32 v234, v234, 0, vcc
    v_mfma_f32_32x32x16_bf16 v[112:127], v[60:63], v[244:247], v[112:127]
    v_add_u32 v235, 1024, v234
    v_add_u32 v234, 512, v234
    v_cndmask_b32 v3, v235, v232, s[0:1]
    v_cndmask_b32 v4, v234, v232, s[0:1]
    s_add_u32 m0, s59, 17408
    s_add_u32 s60, s71, 14336
    buffer_load_dwordx4 v29, s[44:47], s60 offen lds
    s_waitcnt lgkmcnt(0)
    v_mfma_f32_32x32x16_bf16 v[64:79], v[32:35], v[248:251], v[64:79]
    ds_read_b64_tr_b16 v[48:49], v7 offset:45056
    ds_read_b64_tr_b16 v[50:51], v7 offset:46080
    ds_read_b64_tr_b16 v[52:53], v8 offset:45056
    ds_read_b64_tr_b16 v[54:55], v8 offset:46080
    v_add_u32 v3, s54, v3
    v_add_u32 v4, s54, v4
    v_mfma_f32_32x32x16_bf16 v[80:95], v[36:39], v[248:251], v[80:95]
    ds_read_b64_tr_b16 v[56:57], v9 offset:45056
    ds_read_b64_tr_b16 v[58:59], v9 offset:46080
    ds_read_b64_tr_b16 v[60:61], v10 offset:45056
    ds_read_b64_tr_b16 v[62:63], v10 offset:46080
    v_lshrrev_b32 v232, 3, v0
    v_lshlrev_b32 v232, 10, v232
    v_mfma_f32_32x32x16_bf16 v[96:111], v[40:43], v[248:251], v[96:111]
    v_bfe_u32 v233, v0, 4, 1
    v_lshlrev_b32 v234, 2, v233
    v_and_b32 v235, 7, v0
    v_xor_b32 v234, v234, v235
    v_mfma_f32_32x32x16_bf16 v[112:127], v[44:47], v[248:251], v[112:127]
    v_lshl_add_u32 v11, v234, 4, v232
    v_add_u32 v12, 7168, v11
    s_mul_i32 s54, s13, 114688
    v_add_u32 v13, s54, v1
    s_waitcnt vmcnt(4) lgkmcnt(0)
    s_barrier
    v_add_u32 v7, 0x10000, v7
    v_add_u32 v8, 0x10000, v8
    v_add_u32 v9, 0x10000, v9
    v_add_u32 v10, 0x10000, v10
    v_mfma_f32_32x32x16_bf16 v[64:79], v[48:51], v[252:255], v[64:79]
    ds_read_b64_tr_b16 v[32:33], v7 offset:0
    ds_read_b64_tr_b16 v[34:35], v7 offset:1024
    ds_read_b64_tr_b16 v[36:37], v8 offset:0
    ds_read_b64_tr_b16 v[38:39], v8 offset:1024
    v_bfe_u32 v234, v0, 2, 2
    v_lshl_add_u32 v232, v236, 2, v234
    v_mfma_f32_32x32x16_bf16 v[80:95], v[52:55], v[252:255], v[80:95]
    ds_read_b64_tr_b16 v[40:41], v9 offset:0
    ds_read_b64_tr_b16 v[42:43], v9 offset:1024
    ds_read_b64_tr_b16 v[44:45], v10 offset:0
    ds_read_b64_tr_b16 v[46:47], v10 offset:1024
    v_lshlrev_b32 v232, 7, v232
    v_lshrrev_b32 v234, 1, v234
    v_mfma_f32_32x32x16_bf16 v[96:111], v[56:59], v[252:255], v[96:111]
    v_lshl_add_u32 v232, v234, 6, v232
    v_lshl_add_u32 v232, v233, 5, v232
    v_and_b32 v234, 3, v0
    v_lshl_add_u32 v232, v234, 3, v232
    v_mfma_f32_32x32x16_bf16 v[112:127], v[60:63], v[252:255], v[112:127]
    s_lshl_b32 s54, s14, 5
    v_xor_b32 v232, s54, v232
    v_add_u32 v5, s11, v232
    v_xor_b32 v6, 64, v5
    s_mul_i32 s54, s27, 14
    s_add_u32 s55, s54, 13
    s_lshr_b32 s54, s54, 2
    s_lshr_b32 s55, s55, 2
    v_and_b32 v14, 7, v0
    v_add_u32 v14, s54, v14
    v_min_u32 v14, s55, v14
    v_bfe_u32 v232, v0, 3, 1
    s_lshl_b32 s54, s4, 1
    v_add_u32 v232, s54, v232
    v_lshl_add_u32 v14, v232, 5, v14
    v_lshlrev_b32 v14, 7, v14
    s_waitcnt lgkmcnt(0)
    v_mfma_f32_32x32x16_bf16 v[64:79], v[32:35], v[160:163], v[64:79]
    ds_read_b64_tr_b16 v[48:49], v7 offset:4096
    ds_read_b64_tr_b16 v[50:51], v7 offset:5120
    ds_read_b64_tr_b16 v[52:53], v8 offset:4096
    ds_read_b64_tr_b16 v[54:55], v8 offset:5120
    v_and_b32 v232, 31, v0
    v_mul_u32_u24 v232, 2080, v232
    v_mfma_f32_32x32x16_bf16 v[80:95], v[36:39], v[160:163], v[80:95]
    ds_read_b64_tr_b16 v[56:57], v9 offset:4096
    ds_read_b64_tr_b16 v[58:59], v9 offset:5120
    ds_read_b64_tr_b16 v[60:61], v10 offset:4096
    ds_read_b64_tr_b16 v[62:63], v10 offset:5120
    v_lshrrev_b32 v233, 5, v0
    v_lshl_add_u32 v232, v233, 4, v232
    v_mfma_f32_32x32x16_bf16 v[96:111], v[40:43], v[160:163], v[96:111]
    v_cmp_eq_u32 vcc, 0, v233
    v_mov_b32 v236, 0x3f803f80
    s_nop 0
    v_cndmask_b32 v236, 0, v236, vcc
    v_mfma_f32_32x32x16_bf16 v[112:127], v[44:47], v[160:163], v[112:127]
    v_mov_b32 v237, v236
    v_mov_b32 v238, v236
    v_mov_b32 v239, v236
    ds_write_b128 v232, v[236:239] offset:34816
    s_waitcnt lgkmcnt(0)
    v_mfma_f32_32x32x16_bf16 v[64:79], v[48:51], v[164:167], v[64:79]
    ds_read_b64_tr_b16 v[32:33], v7 offset:8192
    ds_read_b64_tr_b16 v[34:35], v7 offset:9216
    ds_read_b64_tr_b16 v[36:37], v8 offset:8192
    ds_read_b64_tr_b16 v[38:39], v8 offset:9216
    s_mov_b32 s40, s20
    s_and_b32 s41, s21, 0xffff
    v_mfma_f32_32x32x16_bf16 v[80:95], v[52:55], v[164:167], v[80:95]
    ds_read_b64_tr_b16 v[40:41], v9 offset:8192
    ds_read_b64_tr_b16 v[42:43], v9 offset:9216
    ds_read_b64_tr_b16 v[44:45], v10 offset:8192
    ds_read_b64_tr_b16 v[46:47], v10 offset:9216
    s_mov_b32 s42, 0x200000
    s_mov_b32 s43, 0x00020000
    v_mfma_f32_32x32x16_bf16 v[96:111], v[56:59], v[164:167], v[96:111]
    s_lshl_b32 s72, s4, 1
    s_add_u32 s72, s72, s13
    s_lshl_b32 s73, s72, 5
    s_lshl_b32 s74, s14, 3
    v_mfma_f32_32x32x16_bf16 v[112:127], v[60:63], v[164:167], v[112:127]
    s_add_u32 s73, s73, s74
    s_lshl_b32 s54, s73, 10
    s_add_u32 s54, s54, 0x600000
    s_add_u32 s55, s54, 4096
    s_lshl_b32 s56, s72, 15
    s_lshl_b32 s74, s5, 7
    s_add_u32 s56, s56, s74
    s_lshl_b32 s74, s14, 5
    s_add_u32 s56, s56, s74
    s_lshl_b32 s59, s72, 8
    s_add_u32 s59, s59, 0xf00000
    s_lshl_b32 s58, s65, 3
    s_lshl_b32 s73, s51, 1
    s_add_u32 s58, s58, s73
    s_add_u32 s58, s58, s52
    s_lshl_b32 s58, s58, 8
    s_add_u32 s58, s58, 0xf00000
    s_lshl_b32 s72, s14, 1
    s_lshr_b32 s73, s4, 2
    s_lshl_b32 s73, s73, 5
    s_add_u32 s72, s72, s73
    s_lshl_b32 s73, s69, 3
    s_add_u32 s73, s73, 0xf00000
    s_waitcnt lgkmcnt(0)
    v_mfma_f32_32x32x16_bf16 v[64:79], v[32:35], v[168:171], v[64:79]
    ds_read_b64_tr_b16 v[48:49], v7 offset:12288
    ds_read_b64_tr_b16 v[50:51], v7 offset:13312
    ds_read_b64_tr_b16 v[52:53], v8 offset:12288
    ds_read_b64_tr_b16 v[54:55], v8 offset:13312
    v_mfma_f32_32x32x16_bf16 v[80:95], v[36:39], v[168:171], v[80:95]
    ds_read_b64_tr_b16 v[56:57], v9 offset:12288
    ds_read_b64_tr_b16 v[58:59], v9 offset:13312
    ds_read_b64_tr_b16 v[60:61], v10 offset:12288
    ds_read_b64_tr_b16 v[62:63], v10 offset:13312
    v_mfma_f32_32x32x16_bf16 v[96:111], v[40:43], v[168:171], v[96:111]
    v_mfma_f32_32x32x16_bf16 v[112:127], v[44:47], v[168:171], v[112:127]
    s_lshr_b32 s60, s64, 1
    v_lshrrev_b32 v30, 4, v0
    v_add_u32 v30, 1, v30
    v_cmp_gt_u32 vcc, 3, v30
    s_nop 1
    v_cndmask_b32 v30, 0, v30, vcc
    v_lshlrev_b32 v30, 4, v30
    v_add_u32 v30, s60, v30
    v_mul_u32_u24 v30, 43691, v30
    v_lshrrev_b32 v30, 17, v30
    v_and_b32 v31, 15, v0
    s_lshl_b32 s61, s65, 1
    v_add_u32 v24, s61, v31
    v_cndmask_b32 v31, v24, v31, vcc
    v_lshl_add_u32 v30, v30, 4, v31
    v_lshlrev_b32 v30, 7, v30
    s_mov_b32 s60, 0xf10000
    s_mov_b32 exec_lo, 0xffffffff
    s_mov_b32 exec_hi, 0x3
    buffer_load_dword v31, v30, s[28:31], s60 offen sc1
    s_mov_b64 exec, -1
    s_waitcnt vmcnt(1) lgkmcnt(0)
    s_barrier
    v_add_u32 v7, 0xfffe0000, v7
    v_add_u32 v8, 0xfffe0000, v8
    v_add_u32 v9, 0xfffe0000, v9
    v_add_u32 v10, 0xfffe0000, v10
    v_mfma_f32_32x32x16_bf16 v[64:79], v[48:51], v[172:175], v[64:79]
    ds_read_b64_tr_b16 v[32:33], v7 offset:0
    ds_read_b64_tr_b16 v[34:35], v7 offset:1024
    ds_read_b64_tr_b16 v[36:37], v8 offset:0
    ds_read_b64_tr_b16 v[38:39], v8 offset:1024
    v_mfma_f32_32x32x16_bf16 v[80:95], v[52:55], v[172:175], v[80:95]
    ds_read_b64_tr_b16 v[40:41], v9 offset:0
    ds_read_b64_tr_b16 v[42:43], v9 offset:1024
    ds_read_b64_tr_b16 v[44:45], v10 offset:0
    ds_read_b64_tr_b16 v[46:47], v10 offset:1024
    v_mfma_f32_32x32x16_bf16 v[96:111], v[56:59], v[172:175], v[96:111]
    v_mfma_f32_32x32x16_bf16 v[112:127], v[60:63], v[172:175], v[112:127]
    s_waitcnt lgkmcnt(0)
    v_mfma_f32_32x32x16_bf16 v[64:79], v[32:35], v[176:179], v[64:79]
    ds_read_b64_tr_b16 v[48:49], v7 offset:4096
    ds_read_b64_tr_b16 v[50:51], v7 offset:5120
    ds_read_b64_tr_b16 v[52:53], v8 offset:4096
    ds_read_b64_tr_b16 v[54:55], v8 offset:5120
    v_mfma_f32_32x32x16_bf16 v[80:95], v[36:39], v[176:179], v[80:95]
    ds_read_b64_tr_b16 v[56:57], v9 offset:4096
    ds_read_b64_tr_b16 v[58:59], v9 offset:5120
    ds_read_b64_tr_b16 v[60:61], v10 offset:4096
    ds_read_b64_tr_b16 v[62:63], v10 offset:5120
    v_mfma_f32_32x32x16_bf16 v[96:111], v[40:43], v[176:179], v[96:111]
    v_mfma_f32_32x32x16_bf16 v[112:127], v[44:47], v[176:179], v[112:127]
    s_waitcnt lgkmcnt(0)
    v_mfma_f32_32x32x16_bf16 v[64:79], v[48:51], v[180:183], v[64:79]
    ds_read_b64_tr_b16 v[32:33], v7 offset:8192
    ds_read_b64_tr_b16 v[34:35], v7 offset:9216
    ds_read_b64_tr_b16 v[36:37], v8 offset:8192
    ds_read_b64_tr_b16 v[38:39], v8 offset:9216
    v_mfma_f32_32x32x16_bf16 v[80:95], v[52:55], v[180:183], v[80:95]
    ds_read_b64_tr_b16 v[40:41], v9 offset:8192
    ds_read_b64_tr_b16 v[42:43], v9 offset:9216
    ds_read_b64_tr_b16 v[44:45], v10 offset:8192
    ds_read_b64_tr_b16 v[46:47], v10 offset:9216
    v_mfma_f32_32x32x16_bf16 v[96:111], v[56:59], v[180:183], v[96:111]
    v_mfma_f32_32x32x16_bf16 v[112:127], v[60:63], v[180:183], v[112:127]
    s_waitcnt vmcnt(0)
    v_cmp_ne_u32 vcc, s26, v31
    s_and_b32 vcc_lo, vcc_lo, 0xffffffff
    s_and_b32 vcc_hi, vcc_hi, 0x3
    s_or_b32 s60, vcc_lo, vcc_hi
    s_cbranch_scc0 FOK_8
    s_mov_b32 s60, 0xf10000
    s_mov_b32 s61, 0x80000
    s_mov_b32 exec_lo, 0xffffffff
    s_mov_b32 exec_hi, 0x3
POLL_9:
    buffer_load_dword v31, v30, s[28:31], s60 offen sc1
    s_waitcnt vmcnt(0)
    v_cmp_ne_u32 vcc, s26, v31
    s_cbranch_vccz POLLD_10
    s_mov_b64 exec, vcc
    s_sub_u32 s61, s61, 1
    s_cbranch_scc0 POLL_9
POLLD_10:
    s_mov_b64 exec, -1
FOK_8:
    s_xor_b32 s60, s68, 1024
    buffer_load_dwordx4 v[16:19], v1, s[28:31], s60 offen sc1
    buffer_load_dwordx4 v[20:23], v1, s[28:31], s68 offen sc1
    s_lshl_b32 s60, s64, 17
    s_add_u32 s60, s60, 0x200000
    buffer_load_dwordx4 v[224:227], v1, s[28:31], s60 offen sc1
    s_add_u32 m0, s67, 0
    s_nop 0
    buffer_load_dwordx4 v1, s[28:31], s66 offen sc1 lds
    buffer_load_dwordx4 v1, s[28:31], s66 offen offset:1024 sc1 lds
    s_add_u32 m0, s67, 8320
    s_add_u32 s66, s66, 8192
    buffer_load_dwordx4 v1, s[28:31], s66 offen sc1 lds
    buffer_load_dwordx4 v1, s[28:31], s66 offen offset:1024 sc1 lds
    s_add_u32 s66, s66, 8192
    s_waitcnt lgkmcnt(0)
    v_mfma_f32_32x32x16_bf16 v[64:79], v[32:35], v[184:187], v[64:79]
    ds_read_b64_tr_b16 v[48:49], v7 offset:12288
    ds_read_b64_tr_b16 v[50:51], v7 offset:13312
    ds_read_b64_tr_b16 v[52:53], v8 offset:12288
    ds_read_b64_tr_b16 v[54:55], v8 offset:13312
    v_mfma_f32_32x32x16_bf16 v[80:95], v[36:39], v[184:187], v[80:95]
    ds_read_b64_tr_b16 v[56:57], v9 offset:12288
    ds_read_b64_tr_b16 v[58:59], v9 offset:13312
    ds_read_b64_tr_b16 v[60:61], v10 offset:12288
    ds_read_b64_tr_b16 v[62:63], v10 offset:13312
    v_mfma_f32_32x32x16_bf16 v[96:111], v[40:43], v[184:187], v[96:111]
    v_mfma_f32_32x32x16_bf16 v[112:127], v[44:47], v[184:187], v[112:127]
    s_waitcnt lgkmcnt(0)
    v_mfma_f32_32x32x16_bf16 v[64:79], v[48:51], v[188:191], v[64:79]
    v_mfma_f32_32x32x16_bf16 v[80:95], v[52:55], v[188:191], v[80:95]
    v_mfma_f32_32x32x16_bf16 v[96:111], v[56:59], v[188:191], v[96:111]
    v_mfma_f32_32x32x16_bf16 v[112:127], v[60:63], v[188:191], v[112:127]
    s_setprio 3
    s_lshl_b32 s60, s48, 2
    s_add_u32 s60, s60, s51
    s_mul_i32 s60, s60, 112
    s_lshl_b32 s61, s50, 3
    s_add_u32 s60, s60, s61
    s_lshl_b32 s60, s60, 10
    s_add_u32 s57, s60, 0x801000
    s_nop 4
    s_xor_b32 s60, s13, 1
    s_mul_i32 s60, s60, 114688
    v_add_u32 v7, s60, v1
    s_mul_i32 s60, s27, 2560
    s_add_u32 s60, s60, 99328
    v_add_u32 v8, s60, v1
    s_xor_b32 s60, s27, 4
    s_mul_i32 s60, s60, 2560
    s_add_u32 s60, s60, 99328
    v_add_u32 v9, s60, v1
    v_bfe_u32 v10, v0, 2, 1
    v_and_b32 v232, 3, v0
    v_lshl_add_u32 v10, v232, 3, v10
    v_add_u32 v10, s72, v10
    v_lshlrev_b32 v10, 7, v10
    v_pk_mul_f32 v[64:65], v[64:65], v[72:73]
    v_pk_mul_f32 v[66:67], v[66:67], v[74:75]
    v_pk_mul_f32 v[68:69], v[68:69], v[76:77]
    v_pk_mul_f32 v[70:71], v[70:71], v[78:79]
    v_cvt_pk_bf16_f32 v72, v64, v65
    v_cvt_pk_bf16_f32 v73, v66, v67
    v_cvt_pk_bf16_f32 v74, v68, v69
    v_cvt_pk_bf16_f32 v75, v70, v71
    v_pk_mul_f32 v[80:81], v[80:81], v[88:89]
    v_pk_mul_f32 v[82:83], v[82:83], v[90:91]
    v_pk_mul_f32 v[84:85], v[84:85], v[92:93]
    v_pk_mul_f32 v[86:87], v[86:87], v[94:95]
    v_cvt_pk_bf16_f32 v88, v80, v81
    v_cvt_pk_bf16_f32 v89, v82, v83
    v_cvt_pk_bf16_f32 v90, v84, v85
    v_cvt_pk_bf16_f32 v91, v86, v87
    s_waitcnt vmcnt(4)
    v_mfma_f32_32x32x16_bf16 v[128:143], v[224:227], v[16:19], 0
    v_mfma_f32_32x32x16_bf16 v[144:159], v[224:227], v[20:23], 0
    v_pk_mul_f32 v[96:97], v[96:97], v[104:105]
    v_pk_mul_f32 v[98:99], v[98:99], v[106:107]
    v_pk_mul_f32 v[100:101], v[100:101], v[108:109]
    v_pk_mul_f32 v[102:103], v[102:103], v[110:111]
    v_cvt_pk_bf16_f32 v104, v96, v97
    v_cvt_pk_bf16_f32 v105, v98, v99
    v_cvt_pk_bf16_f32 v106, v100, v101
    v_cvt_pk_bf16_f32 v107, v102, v103
    v_pk_mul_f32 v[112:113], v[112:113], v[120:121]
    v_pk_mul_f32 v[114:115], v[114:115], v[122:123]
    v_pk_mul_f32 v[116:117], v[116:117], v[124:125]
    v_pk_mul_f32 v[118:119], v[118:119], v[126:127]
    v_cvt_pk_bf16_f32 v120, v112, v113
    v_cvt_pk_bf16_f32 v121, v114, v115
    v_cvt_pk_bf16_f32 v122, v116, v117
    v_cvt_pk_bf16_f32 v123, v118, v119
    s_nop 3
    v_max3_f32 v232, v128, v129, v130
    v_max3_f32 v232, v232, v131, v132
    v_max3_f32 v232, v232, v133, v134
    v_max3_f32 v232, v232, v135, v136
    v_max3_f32 v232, v232, v137, v138
    v_max3_f32 v232, v232, v139, v140
    v_max3_f32 v232, v232, v141, v142
    v_max_f32 v232, v232, v143
    v_mov_b32 v234, v232
    s_nop 1
    v_permlane32_swap_b32 v232, v234
    s_nop 1
    v_max_f32 v232, v232, v234
    v_max3_f32 v233, v144, v145, v146
    v_max3_f32 v233, v233, v147, v148
    v_max3_f32 v233, v233, v149, v150
    v_max3_f32 v233, v233, v151, v152
    v_max3_f32 v233, v233, v153, v154
    v_max3_f32 v233, v233, v155, v156
    v_max3_f32 v233, v233, v157, v158
    v_max_f32 v233, v233, v159
    v_mov_b32 v234, v233
    s_nop 1
    v_permlane32_swap_b32 v233, v234
    s_nop 1
    v_max_f32 v233, v233, v234
    v_min_f32 v232, v232, v233
    v_sub_f32 v240, 0, v232
    v_sub_f32 v241, 0, v232
    v_sub_f32 v242, 0, v232
    v_sub_f32 v243, 0, v232
    v_sub_f32 v244, 0, v232
    v_sub_f32 v245, 0, v232
    v_sub_f32 v246, 0, v232
    v_sub_f32 v247, 0, v232
    v_sub_f32 v248, 0, v232
    v_sub_f32 v249, 0, v232
    v_sub_f32 v250, 0, v232
    v_sub_f32 v251, 0, v232
    v_sub_f32 v252, 0, v232
    v_sub_f32 v253, 0, v232
    v_sub_f32 v254, 0, v232
    v_sub_f32 v255, 0, v232
    s_add_u32 m0, s67, 33280
    s_nop 0
    buffer_load_dwordx4 v1, s[28:31], s66 offen sc1 lds
    buffer_load_dwordx4 v1, s[28:31], s66 offen offset:1024 sc1 lds
    s_add_u32 m0, s67, 41600
    s_add_u32 s66, s66, 8192
    buffer_load_dwordx4 v1, s[28:31], s66 offen sc1 lds
    buffer_load_dwordx4 v1, s[28:31], s66 offen offset:1024 sc1 lds
    s_add_u32 s66, s66, 8192
    s_waitcnt vmcnt(4)
    s_barrier
    ds_read_b128 v[24:27], v2 offset:0
    ds_read_b128 v[208:211], v3 offset:1024
    ds_read_b128 v[212:215], v4 offset:1536
    s_waitcnt lgkmcnt(2)
    v_mfma_f32_32x32x16_bf16 v[128:143], v[24:27], v[16:19], v[240:255]
    buffer_store_dwordx4 v[72:75], v1, s[28:31], s57 offen offset:0 sc1
    buffer_store_dwordx4 v[88:91], v1, s[28:31], s57 offen offset:1024 sc1
    buffer_store_dwordx4 v[104:107], v1, s[28:31], s57 offen offset:2048 sc1
    buffer_store_dwordx4 v[120:123], v1, s[28:31], s57 offen offset:3072 sc1
    s_branch ATTN
CLS2:
    s_add_u32 s71, s3, 0
    s_and_b32 s71, s71, 7
    s_mul_i32 s71, s71, 229376
    s_add_u32 s71, s71, s56
    s_add_u32 m0, s59, 32768
    s_add_u32 s60, s71, 0
    buffer_load_dwordx4 v28, s[40:43], s60 offen lds
    s_add_u32 m0, s59, 49152
    s_add_u32 s60, s71, 0
    buffer_load_dwordx4 v29, s[44:47], s60 offen lds
    s_add_u32 m0, s59, 33792
    s_add_u32 s60, s71, 14336
    buffer_load_dwordx4 v28, s[40:43], s60 offen lds
    s_add_u32 m0, s59, 50176
    s_add_u32 s60, s71, 14336
    buffer_load_dwordx4 v29, s[44:47], s60 offen lds
    v_mov_b32 v24, 0
    s_mov_b32 s60, 0xf04000
    buffer_load_dword v25, v24, s[28:31], s60 offen sc1
    s_lshl_b32 s60, s69, 10
    buffer_load_dwordx4 v[16:19], v1, s[72:75], 0 offen
    buffer_load_dwordx4 v[20:23], v1, s[32:35], s60 offen
    s_and_b32 s60, s2, 7
    s_lshr_b32 s61, s2, 3
    s_lshl_b32 s4, s60, 2
    s_and_b32 s60, s61, 3
    s_add_u32 s4, s4, s60
    s_lshr_b32 s5, s61, 2
    s_mov_b32 s0, 0xffff
    s_mov_b32 s1, 0xffff
    s_and_b32 s13, s27, 1
    s_lshr_b32 s14, s27, 1
    s_mul_i32 s60, s4, 224
    s_mul_i32 s61, s27, 14
    s_add_u32 s60, s60, s61
    s_lshl_b32 s6, s60, 10
    s_add_u32 s6, s6, 0x800000
    s_lshl_b32 s7, s61, 14
    s_lshl_b32 s60, s5, 7
    s_add_u32 s7, s7, s60
    s_lshl_b32 s10, s27, 16
    s_add_u32 s10, s10, s60
    s_lshl_b32 s11, s51, 13
    s_lshl_b32 s60, s52, 17
    s_add_u32 s11, s11, s60
    s_lshl_b32 s60, s48, 2
    s_add_u32 s60, s60, s51
    s_lshl_b32 s60, s60, 5
    s_lshl_b32 s61, s50, 1
    s_add_u32 s60, s60, s61
    s_add_u32 s60, s60, s52
    s_lshl_b32 s60, s60, 7
    s_add_u32 s12, s60, 0xf70000
    s_lshl_b32 s60, s65, 3
    s_lshl_b32 s61, s51, 1
    s_add_u32 s60, s60, s61
    s_add_u32 s60, s60, s52
    s_lshl_b32 s60, s60, 5
    s_add_u32 s60, s60, s64
    s_lshl_b32 s18, s60, 10
    s_add_u32 s18, s18, 0x600000
    v_and_b32 v30, 31, v0
    v_lshrrev_b32 v31, 5, v0
    v_bfe_u32 v32, v0, 1, 3
    v_xor_b32 v32, v32, v31
    s_lshl_b32 s60, s51, 12
    v_lshlrev_b32 v33, 7, v30
    v_add_u32 v33, s60, v33
    v_xor_b32 v34, 0, v32
    v_lshl_add_u32 v2, v34, 4, v33
    v_xor_b32 v34, 2, v32
    v_lshl_add_u32 v3, v34, 4, v33
    v_xor_b32 v34, 4, v32
    v_lshl_add_u32 v4, v34, 4, v33
    v_xor_b32 v34, 6, v32
    v_lshl_add_u32 v5, v34, 4, v33
    v_bfe_u32 v32, v0, 2, 2
    v_lshl_add_u32 v33, v31, 3, v32
    v_mul_u32_u24 v34, 192, v33
    v_bfe_u32 v35, v0, 4, 1
    v_lshl_add_u32 v34, v35, 5, v34
    v_and_b32 v36, 3, v0
    v_lshl_add_u32 v34, v36, 3, v34
    v_add_u32 v6, 16384, v34
    v_lshlrev_b32 v33, 8, v33
    v_lshl_add_u32 v33, v35, 14, v33
    v_lshl_add_u32 v33, v36, 3, v33
    v_bfe_u32 v32, v0, 2, 3
    v_xor_b32 v34, 0, v32
    v_lshl_add_u32 v7, v34, 5, v33
    v_xor_b32 v34, 1, v32
    v_lshl_add_u32 v8, v34, 5, v33
    v_xor_b32 v34, 2, v32
    v_lshl_add_u32 v9, v34, 5, v33
    v_xor_b32 v34, 3, v32
    v_lshl_add_u32 v10, v34, 5, v33
    s_waitcnt vmcnt(7)
    s_barrier
    ds_read_b128 v[160:163], v2 offset:0
    ds_read_b64_tr_b16 v[32:33], v6 offset:0
    ds_read_b64_tr_b16 v[34:35], v6 offset:768
    ds_read_b64_tr_b16 v[36:37], v6 offset:64
    ds_read_b64_tr_b16 v[38:39], v6 offset:832
    ds_read_b128 v[164:167], v3 offset:0
    ds_read_b64_tr_b16 v[40:41], v6 offset:3072
    ds_read_b64_tr_b16 v[42:43], v6 offset:3840
    ds_read_b64_tr_b16 v[44:45], v6 offset:3136
    ds_read_b64_tr_b16 v[46:47], v6 offset:3904
    ds_read_b128 v[168:171], v4 offset:0
    ds_read_b64_tr_b16 v[48:49], v6 offset:6144
    ds_read_b64_tr_b16 v[50:51], v6 offset:6912
    ds_read_b64_tr_b16 v[52:53], v6 offset:6208
    ds_read_b64_tr_b16 v[54:55], v6 offset:6976
    s_waitcnt lgkmcnt(10)
    ds_read_b128 v[172:175], v5 offset:0
    ds_read_b64_tr_b16 v[56:57], v6 offset:9216
    ds_read_b64_tr_b16 v[58:59], v6 offset:9984
    ds_read_b64_tr_b16 v[60:61], v6 offset:9280
    ds_read_b64_tr_b16 v[62:63], v6 offset:10048
    s_add_u32 s19, s3, 1
    s_and_b32 s19, s19, 7
    s_lshl_b32 s15, s19, 7
    s_add_u32 s15, s15, s54
    s_mul_i32 s19, s19, 196608
    s_add_u32 m0, s57, 65536
    s_add_u32 s60, s15, 0
    buffer_load_dwordx4 v11, s[32:35], s60 offen lds
    s_add_u32 m0, s57, 66560
    s_add_u32 s60, s15, 8192
    buffer_load_dwordx4 v12, s[32:35], s60 offen lds
    s_add_u32 m0, s58, 81920
    s_add_u32 s60, s55, s19
    buffer_load_dwordx4 v13, s[36:39], s60 offen lds
    s_waitcnt lgkmcnt(15)
    v_mfma_f32_32x32x16_bf16 v[128:143], v[160:163], v[32:35], 0
    v_mfma_f32_32x32x16_bf16 v[144:159], v[160:163], v[36:39], 0
    s_waitcnt lgkmcnt(10)
    v_mfma_f32_32x32x16_bf16 v[128:143], v[164:167], v[40:43], v[128:143]
    v_mfma_f32_32x32x16_bf16 v[144:159], v[164:167], v[44:47], v[144:159]
    s_waitcnt vmcnt(6) lgkmcnt(0)
    s_barrier
    v_mfma_f32_32x32x16_bf16 v[128:143], v[168:171], v[48:51], v[128:143]
    ds_read_b64_tr_b16 v[32:33], v7 offset:32768
    ds_read_b64_tr_b16 v[34:35], v7 offset:33792
    ds_read_b64_tr_b16 v[36:37], v8 offset:32768
    ds_read_b64_tr_b16 v[38:39], v8 offset:33792
    v_mfma_f32_32x32x16_bf16 v[144:159], v[168:171], v[52:55], v[144:159]
    ds_read_b64_tr_b16 v[40:41], v9 offset:32768
    ds_read_b64_tr_b16 v[42:43], v9 offset:33792
    ds_read_b64_tr_b16 v[44:45], v10 offset:32768
    ds_read_b64_tr_b16 v[46:47], v10 offset:33792
    v_mfma_f32_32x32x16_bf16 v[128:143], v[172:175], v[56:59], v[128:143]
    s_add_u32 s19, s3, 2
    s_and_b32 s19, s19, 7
    s_lshl_b32 s15, s19, 7
    s_add_u32 s15, s15, s54
    s_mul_i32 s19, s19, 196608
    s_add_u32 m0, s57, 98304
    s_add_u32 s60, s15, 0
    buffer_load_dwordx4 v11, s[32:35], s60 offen lds
    v_mfma_f32_32x32x16_bf16 v[144:159], v[172:175], v[60:63], v[144:159]
    s_add_u32 m0, s57, 99328
    s_add_u32 s60, s15, 8192
    buffer_load_dwordx4 v12, s[32:35], s60 offen lds
    s_waitcnt lgkmcnt(0)
    v_mfma_f32_32x32x16_bf16 v[64:79], v[32:35], v[160:163], 0
    ds_read_b64_tr_b16 v[48:49], v7 offset:36864
    ds_read_b64_tr_b16 v[50:51], v7 offset:37888
    ds_read_b64_tr_b16 v[52:53], v8 offset:36864
    ds_read_b64_tr_b16 v[54:55], v8 offset:37888
    v_mfma_f32_32x32x16_bf16 v[80:95], v[36:39], v[160:163], 0
    ds_read_b64_tr_b16 v[56:57], v9 offset:36864
    ds_read_b64_tr_b16 v[58:59], v9 offset:37888
    ds_read_b64_tr_b16 v[60:61], v10 offset:36864
    ds_read_b64_tr_b16 v[62:63], v10 offset:37888
    v_mfma_f32_32x32x16_bf16 v[96:111], v[40:43], v[160:163], 0
    s_add_u32 m0, s58, 114688
    s_add_u32 s60, s55, s19
    buffer_load_dwordx4 v13, s[36:39], s60 offen lds
    v_mfma_f32_32x32x16_bf16 v[112:127], v[44:47], v[160:163], 0
    s_add_u32 s19, s3, 3
    s_and_b32 s19, s19, 7
    s_lshl_b32 s15, s19, 7
    s_add_u32 s15, s15, s54
    s_mul_i32 s19, s19, 196608
    s_add_u32 m0, s57, 131072
    s_add_u32 s60, s15, 0
    buffer_load_dwordx4 v11, s[32:35], s60 offen lds
    s_waitcnt vmcnt(7)
    s_mov_b32 s63, 0xffff0000
    v_lshlrev_b32 v30, 16, v16
    v_and_b32 v16, s63, v16
    v_lshlrev_b32 v31, 16, v20
    v_and_b32 v20, s63, v20
    v_mul_f32 v30, v30, v31
    v_mul_f32 v31, v16, v20
    v_cvt_pk_bf16_f32 v30, v30, v31
    v_and_b32 v31, s63, v30
    v_lshlrev_b32 v30, 16, v30
    v_add_f32 v26, v30, v31
    v_lshlrev_b32 v30, 16, v17
    v_and_b32 v17, s63, v17
    v_lshlrev_b32 v31, 16, v21
    v_and_b32 v21, s63, v21
    v_mul_f32 v30, v30, v31
    v_mul_f32 v31, v17, v21
    v_cvt_pk_bf16_f32 v30, v30, v31
    v_and_b32 v31, s63, v30
    v_lshlrev_b32 v30, 16, v30
    v_add_f32 v26, v26, v30
    v_add_f32 v26, v26, v31
    v_lshlrev_b32 v30, 16, v18
    v_and_b32 v18, s63, v18
    v_lshlrev_b32 v31, 16, v22
    v_and_b32 v22, s63, v22
    v_mul_f32 v30, v30, v31
    v_mul_f32 v31, v18, v22
    v_cvt_pk_bf16_f32 v30, v30, v31
    v_and_b32 v31, s63, v30
    v_lshlrev_b32 v30, 16, v30
    v_add_f32 v26, v26, v30
    v_add_f32 v26, v26, v31
    v_lshlrev_b32 v30, 16, v19
    v_and_b32 v19, s63, v19
    v_lshlrev_b32 v31, 16, v23
    v_and_b32 v23, s63, v23
    v_mul_f32 v30, v30, v31
    v_mul_f32 v31, v19, v23
    v_cvt_pk_bf16_f32 v30, v30, v31
    v_and_b32 v31, s63, v30
    v_lshlrev_b32 v30, 16, v30
    v_add_f32 v26, v26, v30
    v_add_f32 v26, v26, v31
    s_nop 1
    v_add_f32_dpp v26, v26, v26 row_ror:8 row_mask:0xf bank_mask:0xf
    s_nop 1
    v_add_f32_dpp v26, v26, v26 row_ror:4 row_mask:0xf bank_mask:0xf
    s_nop 1
    v_add_f32_dpp v26, v26, v26 row_ror:2 row_mask:0xf bank_mask:0xf
    s_nop 1
    v_add_f32_dpp v26, v26, v26 row_ror:1 row_mask:0xf bank_mask:0xf
    s_nop 1
    v_readlane_b32 s60, v26, 0
    v_readlane_b32 s61, v26, 16
    v_readlane_b32 s62, v26, 32
    v_readlane_b32 s63, v26, 48
    s_nop 1
    v_mov_b32 v26, s60
    v_add_f32 v26, s61, v26
    v_add_f32 v26, s62, v26
    v_add_f32 v26, s63, v26
    v_cvt_pk_bf16_f32 v26, v26, v26
    v_lshlrev_b32 v26, 16, v26
    v_mul_f32 v26, 0xbfb8aa3b, v26
    v_exp_f32 v26, v26
    s_nop 0
    v_add_f32 v26, 1.0, v26
    v_rcp_f32 v26, v26
    s_nop 0
    v_cvt_pk_bf16_f32 v26, v26, v26
    v_lshlrev_b32 v26, 16, v26
    s_mov_b32 s72, s22
    s_and_b32 s73, s23, 0xffff
    s_mov_b32 s74, 0x100
    s_mov_b32 s75, 0x00020000
    buffer_load_dword v16, v24, s[72:75], 0 offen sc1
    s_waitcnt lgkmcnt(0)
    v_mfma_f32_32x32x16_bf16 v[64:79], v[48:51], v[164:167], v[64:79]
    ds_read_b64_tr_b16 v[32:33], v7 offset:40960
    ds_read_b64_tr_b16 v[34:35], v7 offset:41984
    ds_read_b64_tr_b16 v[36:37], v8 offset:40960
    ds_read_b64_tr_b16 v[38:39], v8 offset:41984
    v_mfma_f32_32x32x16_bf16 v[80:95], v[52:55], v[164:167], v[80:95]
    ds_read_b64_tr_b16 v[40:41], v9 offset:40960
    ds_read_b64_tr_b16 v[42:43], v9 offset:41984
    ds_read_b64_tr_b16 v[44:45], v10 offset:40960
    ds_read_b64_tr_b16 v[46:47], v10 offset:41984
    v_mfma_f32_32x32x16_bf16 v[96:111], v[56:59], v[164:167], v[96:111]
    s_add_u32 m0, s57, 132096
    s_add_u32 s60, s15, 8192
    buffer_load_dwordx4 v12, s[32:35], s60 offen lds
    v_mfma_f32_32x32x16_bf16 v[112:127], v[60:63], v[164:167], v[112:127]
    s_add_u32 m0, s58, 147456
    s_add_u32 s60, s55, s19
    buffer_load_dwordx4 v13, s[36:39], s60 offen lds
    s_waitcnt lgkmcnt(0)
    v_mfma_f32_32x32x16_bf16 v[64:79], v[32:35], v[168:171], v[64:79]
    ds_read_b64_tr_b16 v[48:49], v7 offset:45056
    ds_read_b64_tr_b16 v[50:51], v7 offset:46080
    ds_read_b64_tr_b16 v[52:53], v8 offset:45056
    ds_read_b64_tr_b16 v[54:55], v8 offset:46080
    v_mfma_f32_32x32x16_bf16 v[80:95], v[36:39], v[168:171], v[80:95]
    ds_read_b64_tr_b16 v[56:57], v9 offset:45056
    ds_read_b64_tr_b16 v[58:59], v9 offset:46080
    ds_read_b64_tr_b16 v[60:61], v10 offset:45056
    ds_read_b64_tr_b16 v[62:63], v10 offset:46080
    v_mfma_f32_32x32x16_bf16 v[96:111], v[40:43], v[168:171], v[96:111]
    s_add_u32 s71, s3, 1
    s_and_b32 s71, s71, 7
    s_mul_i32 s71, s71, 229376
    s_add_u32 s71, s71, s56
    s_add_u32 m0, s59, 0
    s_add_u32 s60, s71, 0
    buffer_load_dwordx4 v28, s[40:43], s60 offen lds
    v_mfma_f32_32x32x16_bf16 v[112:127], v[44:47], v[168:171], v[112:127]
    s_add_u32 m0, s59, 16384
    s_add_u32 s60, s71, 0
    buffer_load_dwordx4 v29, s[44:47], s60 offen lds
    s_waitcnt vmcnt(9) lgkmcnt(0)
    s_barrier
    v_add_u32 v2, 0x10000, v2
    v_add_u32 v3, 0x10000, v3
    v_add_u32 v4, 0x10000, v4
    v_add_u32 v5, 0x10000, v5
    v_add_u32 v6, 0x10000, v6
    ds_read_b128 v[176:179], v2 offset:0
    ds_read_b64_tr_b16 v[32:33], v6 offset:0
    ds_read_b64_tr_b16 v[34:35], v6 offset:768
    ds_read_b64_tr_b16 v[36:37], v6 offset:64
    ds_read_b64_tr_b16 v[38:39], v6 offset:832
    v_mfma_f32_32x32x16_bf16 v[64:79], v[48:51], v[172:175], v[64:79]
    v_mfma_f32_32x32x16_bf16 v[80:95], v[52:55], v[172:175], v[80:95]
    ds_read_b128 v[180:183], v3 offset:0
    ds_read_b64_tr_b16 v[40:41], v6 offset:3072
    ds_read_b64_tr_b16 v[42:43], v6 offset:3840
    ds_read_b64_tr_b16 v[44:45], v6 offset:3136
    ds_read_b64_tr_b16 v[46:47], v6 offset:3904
    v_mfma_f32_32x32x16_bf16 v[96:111], v[56:59], v[172:175], v[96:111]
    v_mfma_f32_32x32x16_bf16 v[112:127], v[60:63], v[172:175], v[112:127]
    ds_read_b128 v[184:187], v4 offset:0
    ds_read_b64_tr_b16 v[48:49], v6 offset:6144
    ds_read_b64_tr_b16 v[50:51], v6 offset:6912
    ds_read_b64_tr_b16 v[52:53], v6 offset:6208
    ds_read_b64_tr_b16 v[54:55], v6 offset:6976
    s_waitcnt lgkmcnt(10)
    ds_read_b128 v[188:191], v5 offset:0
    ds_read_b64_tr_b16 v[56:57], v6 offset:9216
    ds_read_b64_tr_b16 v[58:59], v6 offset:9984
    ds_read_b64_tr_b16 v[60:61], v6 offset:9280
    ds_read_b64_tr_b16 v[62:63], v6 offset:10048
    s_add_u32 m0, s59, 1024
    s_add_u32 s60, s71, 14336
    buffer_load_dwordx4 v28, s[40:43], s60 offen lds
    s_add_u32 m0, s59, 17408
    s_add_u32 s60, s71, 14336
    buffer_load_dwordx4 v29, s[44:47], s60 offen lds
    s_add_u32 s19, s3, 4
    s_and_b32 s19, s19, 7
    s_lshl_b32 s15, s19, 7
    s_add_u32 s15, s15, s54
    s_mul_i32 s19, s19, 196608
    s_add_u32 m0, s57, 32768
    s_add_u32 s60, s15, 0
    buffer_load_dwordx4 v11, s[32:35], s60 offen lds
    s_waitcnt lgkmcnt(15)
    v_mfma_f32_32x32x16_bf16 v[128:143], v[176:179], v[32:35], v[128:143]
    v_mfma_f32_32x32x16_bf16 v[144:159], v[176:179], v[36:39], v[144:159]
    s_waitcnt lgkmcnt(10)
    v_mfma_f32_32x32x16_bf16 v[128:143], v[180:183], v[40:43], v[128:143]
    v_mfma_f32_32x32x16_bf16 v[144:159], v[180:183], v[44:47], v[144:159]
    s_waitcnt vmcnt(9) lgkmcnt(0)
    s_barrier
    ds_read_b128 v[192:195], v2 offset:32768
    ds_read_b64_tr_b16 v[32:33], v6 offset:32768
    ds_read_b64_tr_b16 v[34:35], v6 offset:33536
    ds_read_b64_tr_b16 v[36:37], v6 offset:32832
    ds_read_b64_tr_b16 v[38:39], v6 offset:33600
    v_mfma_f32_32x32x16_bf16 v[128:143], v[184:187], v[48:51], v[128:143]
    v_mfma_f32_32x32x16_bf16 v[144:159], v[184:187], v[52:55], v[144:159]
    ds_read_b128 v[196:199], v3 offset:32768
    ds_read_b64_tr_b16 v[40:41], v6 offset:35840
    ds_read_b64_tr_b16 v[42:43], v6 offset:36608
    ds_read_b64_tr_b16 v[44:45], v6 offset:35904
    ds_read_b64_tr_b16 v[46:47], v6 offset:36672
    v_mfma_f32_32x32x16_bf16 v[128:143], v[188:191], v[56:59], v[128:143]
    v_mfma_f32_32x32x16_bf16 v[144:159], v[188:191], v[60:63], v[144:159]
    ds_read_b128 v[200:203], v4 offset:32768
    ds_read_b64_tr_b16 v[48:49], v6 offset:38912
    ds_read_b64_tr_b16 v[50:51], v6 offset:39680
    ds_read_b64_tr_b16 v[52:53], v6 offset:38976
    ds_read_b64_tr_b16 v[54:55], v6 offset:39744
    s_waitcnt lgkmcnt(10)
    ds_read_b128 v[204:207], v5 offset:32768
    ds_read_b64_tr_b16 v[56:57], v6 offset:41984
    ds_read_b64_tr_b16 v[58:59], v6 offset:42752
    ds_read_b64_tr_b16 v[60:61], v6 offset:42048
    ds_read_b64_tr_b16 v[62:63], v6 offset:42816
    s_add_u32 m0, s57, 33792
    s_add_u32 s60, s15, 8192
    buffer_load_dwordx4 v12, s[32:35], s60 offen lds
    s_add_u32 m0, s58, 49152
    s_add_u32 s60, s55, s19
    buffer_load_dwordx4 v13, s[36:39], s60 offen lds
    s_add_u32 s19, s3, 5
    s_and_b32 s19, s19, 7
    s_lshl_b32 s15, s19, 7
    s_add_u32 s15, s15, s54
    s_mul_i32 s19, s19, 196608
    s_add_u32 m0, s57, 65536
    s_add_u32 s60, s15, 0
    buffer_load_dwordx4 v11, s[32:35], s60 offen lds
    s_waitcnt lgkmcnt(15)
    v_mfma_f32_32x32x16_bf16 v[128:143], v[192:195], v[32:35], v[128:143]
    v_mfma_f32_32x32x16_bf16 v[144:159], v[192:195], v[36:39], v[144:159]
    s_waitcnt lgkmcnt(10)
    v_mfma_f32_32x32x16_bf16 v[128:143], v[196:199], v[40:43], v[128:143]
    v_mfma_f32_32x32x16_bf16 v[144:159], v[196:199], v[44:47], v[144:159]
    s_waitcnt vmcnt(8) lgkmcnt(0)
    s_barrier
    v_add_u32 v2, 0x10000, v2
    v_add_u32 v3, 0x10000, v3
    v_add_u32 v4, 0x10000, v4
    v_add_u32 v5, 0x10000, v5
    v_add_u32 v6, 0x10000, v6
    ds_read_b128 v[208:211], v2 offset:0
    ds_read_b64_tr_b16 v[32:33], v6 offset:0
    ds_read_b64_tr_b16 v[34:35], v6 offset:768
    ds_read_b64_tr_b16 v[36:37], v6 offset:64
    ds_read_b64_tr_b16 v[38:39], v6 offset:832
    v_mfma_f32_32x32x16_bf16 v[128:143], v[200:203], v[48:51], v[128:143]
    v_mfma_f32_32x32x16_bf16 v[144:159], v[200:203], v[52:55], v[144:159]
    ds_read_b128 v[212:215], v3 offset:0
    ds_read_b64_tr_b16 v[40:41], v6 offset:3072
    ds_read_b64_tr_b16 v[42:43], v6 offset:3840
    ds_read_b64_tr_b16 v[44:45], v6 offset:3136
    ds_read_b64_tr_b16 v[46:47], v6 offset:3904
    v_mfma_f32_32x32x16_bf16 v[128:143], v[204:207], v[56:59], v[128:143]
    v_mfma_f32_32x32x16_bf16 v[144:159], v[204:207], v[60:63], v[144:159]
    ds_read_b128 v[216:219], v4 offset:0
    ds_read_b64_tr_b16 v[48:49], v6 offset:6144
    ds_read_b64_tr_b16 v[50:51], v6 offset:6912
    ds_read_b64_tr_b16 v[52:53], v6 offset:6208
    ds_read_b64_tr_b16 v[54:55], v6 offset:6976
    s_waitcnt lgkmcnt(10)
    ds_read_b128 v[220:223], v5 offset:0
    ds_read_b64_tr_b16 v[56:57], v6 offset:9216
    ds_read_b64_tr_b16 v[58:59], v6 offset:9984
    ds_read_b64_tr_b16 v[60:61], v6 offset:9280
    ds_read_b64_tr_b16 v[62:63], v6 offset:10048
    s_add_u32 m0, s57, 66560
    s_add_u32 s60, s15, 8192
    buffer_load_dwordx4 v12, s[32:35], s60 offen lds
    s_add_u32 m0, s58, 81920
    s_add_u32 s60, s55, s19
    buffer_load_dwordx4 v13, s[36:39], s60 offen lds
    s_add_u32 s19, s3, 6
    s_and_b32 s19, s19, 7
    s_lshl_b32 s15, s19, 7
    s_add_u32 s15, s15, s54
    s_mul_i32 s19, s19, 196608
    s_add_u32 m0, s57, 98304
    s_add_u32 s60, s15, 0
    buffer_load_dwordx4 v11, s[32:35], s60 offen lds
    s_waitcnt lgkmcnt(15)
    v_mfma_f32_32x32x16_bf16 v[128:143], v[208:211], v[32:35], v[128:143]
    v_mfma_f32_32x32x16_bf16 v[144:159], v[208:211], v[36:39], v[144:159]
    s_waitcnt lgkmcnt(10)
    v_mfma_f32_32x32x16_bf16 v[128:143], v[212:215], v[40:43], v[128:143]
    v_mfma_f32_32x32x16_bf16 v[144:159], v[212:215], v[44:47], v[144:159]
    s_waitcnt vmcnt(7) lgkmcnt(0)
    s_barrier
    v_mfma_f32_32x32x16_bf16 v[128:143], v[216:219], v[48:51], v[128:143]
    ds_read_b64_tr_b16 v[32:33], v7 offset:0
    ds_read_b64_tr_b16 v[34:35], v7 offset:1024
    ds_read_b64_tr_b16 v[36:37], v8 offset:0
    ds_read_b64_tr_b16 v[38:39], v8 offset:1024
    v_mfma_f32_32x32x16_bf16 v[144:159], v[216:219], v[52:55], v[144:159]
    ds_read_b64_tr_b16 v[40:41], v9 offset:0
    ds_read_b64_tr_b16 v[42:43], v9 offset:1024
    ds_read_b64_tr_b16 v[44:45], v10 offset:0
    ds_read_b64_tr_b16 v[46:47], v10 offset:1024
    v_mfma_f32_32x32x16_bf16 v[128:143], v[220:223], v[56:59], v[128:143]
    s_add_u32 m0, s57, 99328
    s_add_u32 s60, s15, 8192
    buffer_load_dwordx4 v12, s[32:35], s60 offen lds
    v_mfma_f32_32x32x16_bf16 v[144:159], v[220:223], v[60:63], v[144:159]
    s_add_u32 m0, s58, 114688
    s_add_u32 s60, s55, s19
    buffer_load_dwordx4 v13, s[36:39], s60 offen lds
    s_waitcnt lgkmcnt(0)
    v_mfma_f32_32x32x16_bf16 v[64:79], v[32:35], v[176:179], v[64:79]
    ds_read_b64_tr_b16 v[48:49], v7 offset:4096
    ds_read_b64_tr_b16 v[50:51], v7 offset:5120
    ds_read_b64_tr_b16 v[52:53], v8 offset:4096
    ds_read_b64_tr_b16 v[54:55], v8 offset:5120
    v_mfma_f32_32x32x16_bf16 v[80:95], v[36:39], v[176:179], v[80:95]
    ds_read_b64_tr_b16 v[56:57], v9 offset:4096
    ds_read_b64_tr_b16 v[58:59], v9 offset:5120
    ds_read_b64_tr_b16 v[60:61], v10 offset:4096
    ds_read_b64_tr_b16 v[62:63], v10 offset:5120
    v_mfma_f32_32x32x16_bf16 v[96:111], v[40:43], v[176:179], v[96:111]
    s_add_u32 s19, s3, 7
    s_and_b32 s19, s19, 7
    s_lshl_b32 s15, s19, 7
    s_add_u32 s15, s15, s54
    s_mul_i32 s19, s19, 196608
    s_add_u32 m0, s57, 131072
    s_add_u32 s60, s15, 0
    buffer_load_dwordx4 v11, s[32:35], s60 offen lds
    v_mfma_f32_32x32x16_bf16 v[112:127], v[44:47], v[176:179], v[112:127]
    s_add_u32 m0, s57, 132096
    s_add_u32 s60, s15, 8192
    buffer_load_dwordx4 v12, s[32:35], s60 offen lds
    s_waitcnt lgkmcnt(0)
    v_mfma_f32_32x32x16_bf16 v[64:79], v[48:51], v[180:183], v[64:79]
    ds_read_b64_tr_b16 v[32:33], v7 offset:8192
    ds_read_b64_tr_b16 v[34:35], v7 offset:9216
    ds_read_b64_tr_b16 v[36:37], v8 offset:8192
    ds_read_b64_tr_b16 v[38:39], v8 offset:9216
    v_mfma_f32_32x32x16_bf16 v[80:95], v[52:55], v[180:183], v[80:95]
    ds_read_b64_tr_b16 v[40:41], v9 offset:8192
    ds_read_b64_tr_b16 v[42:43], v9 offset:9216
    ds_read_b64_tr_b16 v[44:45], v10 offset:8192
    ds_read_b64_tr_b16 v[46:47], v10 offset:9216
    v_mfma_f32_32x32x16_bf16 v[96:111], v[56:59], v[180:183], v[96:111]
    s_add_u32 m0, s58, 147456
    s_add_u32 s60, s55, s19
    buffer_load_dwordx4 v13, s[36:39], s60 offen lds
    v_mfma_f32_32x32x16_bf16 v[112:127], v[60:63], v[180:183], v[112:127]
    s_waitcnt lgkmcnt(0)
    v_mfma_f32_32x32x16_bf16 v[64:79], v[32:35], v[184:187], v[64:79]
    ds_read_b64_tr_b16 v[48:49], v7 offset:12288
    ds_read_b64_tr_b16 v[50:51], v7 offset:13312
    ds_read_b64_tr_b16 v[52:53], v8 offset:12288
    ds_read_b64_tr_b16 v[54:55], v8 offset:13312
    v_mfma_f32_32x32x16_bf16 v[80:95], v[36:39], v[184:187], v[80:95]
    ds_read_b64_tr_b16 v[56:57], v9 offset:12288
    ds_read_b64_tr_b16 v[58:59], v9 offset:13312
    ds_read_b64_tr_b16 v[60:61], v10 offset:12288
    ds_read_b64_tr_b16 v[62:63], v10 offset:13312
    v_mfma_f32_32x32x16_bf16 v[96:111], v[40:43], v[184:187], v[96:111]
    v_mfma_f32_32x32x16_bf16 v[112:127], v[44:47], v[184:187], v[112:127]
    s_waitcnt vmcnt(9) lgkmcnt(0)
    s_barrier
    v_add_u32 v2, 0xfffe8000, v2
    v_add_u32 v3, 0xfffe8000, v3
    v_add_u32 v4, 0xfffe8000, v4
    v_add_u32 v5, 0xfffe8000, v5
    v_add_u32 v6, 0xfffe8000, v6
    ds_read_b128 v[224:227], v2 offset:0
    ds_read_b64_tr_b16 v[32:33], v6 offset:0
    ds_read_b64_tr_b16 v[34:35], v6 offset:768
    ds_read_b64_tr_b16 v[36:37], v6 offset:64
    ds_read_b64_tr_b16 v[38:39], v6 offset:832
    v_mfma_f32_32x32x16_bf16 v[64:79], v[48:51], v[188:191], v[64:79]
    v_mfma_f32_32x32x16_bf16 v[80:95], v[52:55], v[188:191], v[80:95]
    ds_read_b128 v[228:231], v3 offset:0
    ds_read_b64_tr_b16 v[40:41], v6 offset:3072
    ds_read_b64_tr_b16 v[42:43], v6 offset:3840
    ds_read_b64_tr_b16 v[44:45], v6 offset:3136
    ds_read_b64_tr_b16 v[46:47], v6 offset:3904
    v_mfma_f32_32x32x16_bf16 v[96:111], v[56:59], v[188:191], v[96:111]
    v_mfma_f32_32x32x16_bf16 v[112:127], v[60:63], v[188:191], v[112:127]
    ds_read_b128 v[232:235], v4 offset:0
    ds_read_b64_tr_b16 v[48:49], v6 offset:6144
    ds_read_b64_tr_b16 v[50:51], v6 offset:6912
    ds_read_b64_tr_b16 v[52:53], v6 offset:6208
    ds_read_b64_tr_b16 v[54:55], v6 offset:6976
    s_waitcnt lgkmcnt(10)
    ds_read_b128 v[236:239], v5 offset:0
    ds_read_b64_tr_b16 v[56:57], v6 offset:9216
    ds_read_b64_tr_b16 v[58:59], v6 offset:9984
    ds_read_b64_tr_b16 v[60:61], v6 offset:9280
    ds_read_b64_tr_b16 v[62:63], v6 offset:10048
    s_add_u32 s71, s3, 2
    s_and_b32 s71, s71, 7
    s_mul_i32 s71, s71, 229376
    s_add_u32 s71, s71, s56
    s_add_u32 m0, s59, 0
    s_add_u32 s60, s71, 0
    buffer_load_dwordx4 v28, s[40:43], s60 offen lds
    s_add_u32 m0, s59, 16384
    s_add_u32 s60, s71, 0
    buffer_load_dwordx4 v29, s[44:47], s60 offen lds
    s_add_u32 m0, s59, 1024
    s_add_u32 s60, s71, 14336
    buffer_load_dwordx4 v28, s[40:43], s60 offen lds
    s_waitcnt lgkmcnt(15)
    v_mfma_f32_32x32x16_bf16 v[128:143], v[224:227], v[32:35], v[128:143]
    v_mfma_f32_32x32x16_bf16 v[144:159], v[224:227], v[36:39], v[144:159]
    s_waitcnt lgkmcnt(10)
    v_mfma_f32_32x32x16_bf16 v[128:143], v[228:231], v[40:43], v[128:143]
    v_mfma_f32_32x32x16_bf16 v[144:159], v[228:231], v[44:47], v[144:159]
    v_readfirstlane_b32 s26, v25
    v_readfirstlane_b32 s60, v16
    s_nop 3
    s_mul_i32 s26, s26, 1664525
    s_add_u32 s26, s26, 1013904223
    s_or_b32 s26, s26, 1
    s_cmp_lg_u32 s60, 0
    s_cselect_b32 s26, s60, s26
    v_readfirstlane_b32 s22, v26
    s_waitcnt vmcnt(9) lgkmcnt(0)
    s_barrier
    ds_read_b128 v[240:243], v2 offset:32768
    ds_read_b64_tr_b16 v[32:33], v6 offset:32768
    ds_read_b64_tr_b16 v[34:35], v6 offset:33536
    ds_read_b64_tr_b16 v[36:37], v6 offset:32832
    ds_read_b64_tr_b16 v[38:39], v6 offset:33600
    v_mfma_f32_32x32x16_bf16 v[128:143], v[232:235], v[48:51], v[128:143]
    v_mfma_f32_32x32x16_bf16 v[144:159], v[232:235], v[52:55], v[144:159]
    ds_read_b128 v[244:247], v3 offset:32768
    ds_read_b64_tr_b16 v[40:41], v6 offset:35840
    ds_read_b64_tr_b16 v[42:43], v6 offset:36608
    ds_read_b64_tr_b16 v[44:45], v6 offset:35904
    ds_read_b64_tr_b16 v[46:47], v6 offset:36672
    v_mfma_f32_32x32x16_bf16 v[128:143], v[236:239], v[56:59], v[128:143]
    v_mfma_f32_32x32x16_bf16 v[144:159], v[236:239], v[60:63], v[144:159]
    ds_read_b128 v[248:251], v4 offset:32768
    ds_read_b64_tr_b16 v[48:49], v6 offset:38912
    ds_read_b64_tr_b16 v[50:51], v6 offset:39680
    ds_read_b64_tr_b16 v[52:53], v6 offset:38976
    ds_read_b64_tr_b16 v[54:55], v6 offset:39744
    s_waitcnt lgkmcnt(10)
    ds_read_b128 v[252:255], v5 offset:32768
    ds_read_b64_tr_b16 v[56:57], v6 offset:41984
    ds_read_b64_tr_b16 v[58:59], v6 offset:42752
    ds_read_b64_tr_b16 v[60:61], v6 offset:42048
    ds_read_b64_tr_b16 v[62:63], v6 offset:42816
    s_add_u32 m0, s59, 17408
    s_add_u32 s60, s71, 14336
    buffer_load_dwordx4 v29, s[44:47], s60 offen lds
    s_add_u32 s71, s3, 3
    s_and_b32 s71, s71, 7
    s_mul_i32 s71, s71, 229376
    s_add_u32 s71, s71, s56
    s_add_u32 m0, s59, 32768
    s_add_u32 s60, s71, 0
    buffer_load_dwordx4 v28, s[40:43], s60 offen lds
    s_add_u32 m0, s59, 49152
    s_add_u32 s60, s71, 0
    buffer_load_dwordx4 v29, s[44:47], s60 offen lds
    s_waitcnt lgkmcnt(15)
    v_mfma_f32_32x32x16_bf16 v[128:143], v[240:243], v[32:35], v[128:143]
    v_mfma_f32_32x32x16_bf16 v[144:159], v[240:243], v[36:39], v[144:159]
    s_waitcnt lgkmcnt(10)
    v_mfma_f32_32x32x16_bf16 v[128:143], v[244:247], v[40:43], v[128:143]
    v_mfma_f32_32x32x16_bf16 v[144:159], v[244:247], v[44:47], v[144:159]
    s_waitcnt vmcnt(9) lgkmcnt(0)
    s_barrier
    v_add_u32 v2, 0x10000, v2
    v_add_u32 v3, 0x10000, v3
    v_add_u32 v4, 0x10000, v4
    v_add_u32 v5, 0x10000, v5
    v_add_u32 v6, 0x10000, v6
    ds_read_b128 v[160:163], v2 offset:0
    ds_read_b64_tr_b16 v[32:33], v6 offset:0
    ds_read_b64_tr_b16 v[34:35], v6 offset:768
    ds_read_b64_tr_b16 v[36:37], v6 offset:64
    ds_read_b64_tr_b16 v[38:39], v6 offset:832
    v_mfma_f32_32x32x16_bf16 v[128:143], v[248:251], v[48:51], v[128:143]
    v_mfma_f32_32x32x16_bf16 v[144:159], v[248:251], v[52:55], v[144:159]
    ds_read_b128 v[164:167], v3 offset:0
    ds_read_b64_tr_b16 v[40:41], v6 offset:3072
    ds_read_b64_tr_b16 v[42:43], v6 offset:3840
    ds_read_b64_tr_b16 v[44:45], v6 offset:3136
    ds_read_b64_tr_b16 v[46:47], v6 offset:3904
    v_mfma_f32_32x32x16_bf16 v[128:143], v[252:255], v[56:59], v[128:143]
    v_mfma_f32_32x32x16_bf16 v[144:159], v[252:255], v[60:63], v[144:159]
    ds_read_b128 v[168:171], v4 offset:0
    ds_read_b64_tr_b16 v[48:49], v6 offset:6144
    ds_read_b64_tr_b16 v[50:51], v6 offset:6912
    ds_read_b64_tr_b16 v[52:53], v6 offset:6208
    ds_read_b64_tr_b16 v[54:55], v6 offset:6976
    s_waitcnt lgkmcnt(10)
    ds_read_b128 v[172:175], v5 offset:0
    ds_read_b64_tr_b16 v[56:57], v6 offset:9216
    ds_read_b64_tr_b16 v[58:59], v6 offset:9984
    ds_read_b64_tr_b16 v[60:61], v6 offset:9280
    ds_read_b64_tr_b16 v[62:63], v6 offset:10048
    s_add_u32 m0, s59, 33792
    s_add_u32 s60, s71, 14336
    buffer_load_dwordx4 v28, s[40:43], s60 offen lds
    s_add_u32 m0, s59, 50176
    s_add_u32 s60, s71, 14336
    buffer_load_dwordx4 v29, s[44:47], s60 offen lds
    s_add_u32 s71, s3, 4
    s_and_b32 s71, s71, 7
    s_mul_i32 s71, s71, 229376
    s_add_u32 s71, s71, s56
    s_add_u32 m0, s59, 65536
    s_add_u32 s60, s71, 0
    buffer_load_dwordx4 v28, s[40:43], s60 offen lds
    s_waitcnt lgkmcnt(15)
    v_mfma_f32_32x32x16_bf16 v[128:143], v[160:163], v[32:35], v[128:143]
    v_mfma_f32_32x32x16_bf16 v[144:159], v[160:163], v[36:39], v[144:159]
    s_waitcnt lgkmcnt(10)
    v_mfma_f32_32x32x16_bf16 v[128:143], v[164:167], v[40:43], v[128:143]
    v_mfma_f32_32x32x16_bf16 v[144:159], v[164:167], v[44:47], v[144:159]
    s_waitcnt vmcnt(9) lgkmcnt(0)
    s_barrier
    ds_read_b128 v[176:179], v2 offset:32768
    ds_read_b64_tr_b16 v[32:33], v6 offset:32768
    ds_read_b64_tr_b16 v[34:35], v6 offset:33536
    ds_read_b64_tr_b16 v[36:37], v6 offset:32832
    ds_read_b64_tr_b16 v[38:39], v6 offset:33600
    v_mfma_f32_32x32x16_bf16 v[128:143], v[168:171], v[48:51], v[128:143]
    v_mfma_f32_32x32x16_bf16 v[144:159], v[168:171], v[52:55], v[144:159]
    ds_read_b128 v[180:183], v3 offset:32768
    ds_read_b64_tr_b16 v[40:41], v6 offset:35840
    ds_read_b64_tr_b16 v[42:43], v6 offset:36608
    ds_read_b64_tr_b16 v[44:45], v6 offset:35904
    ds_read_b64_tr_b16 v[46:47], v6 offset:36672
    v_mfma_f32_32x32x16_bf16 v[128:143], v[172:175], v[56:59], v[128:143]
    v_mfma_f32_32x32x16_bf16 v[144:159], v[172:175], v[60:63], v[144:159]
    ds_read_b128 v[184:187], v4 offset:32768
    ds_read_b64_tr_b16 v[48:49], v6 offset:38912
    ds_read_b64_tr_b16 v[50:51], v6 offset:39680
    ds_read_b64_tr_b16 v[52:53], v6 offset:38976
    ds_read_b64_tr_b16 v[54:55], v6 offset:39744
    s_waitcnt lgkmcnt(10)
    ds_read_b128 v[188:191], v5 offset:32768
    ds_read_b64_tr_b16 v[56:57], v6 offset:41984
    ds_read_b64_tr_b16 v[58:59], v6 offset:42752
    ds_read_b64_tr_b16 v[60:61], v6 offset:42048
    ds_read_b64_tr_b16 v[62:63], v6 offset:42816
    s_add_u32 m0, s59, 81920
    s_add_u32 s60, s71, 0
    buffer_load_dwordx4 v29, s[44:47], s60 offen lds
    s_add_u32 m0, s59, 66560
    s_add_u32 s60, s71, 14336
    buffer_load_dwordx4 v28, s[40:43], s60 offen lds
    s_add_u32 m0, s59, 82944
    s_add_u32 s60, s71, 14336
    buffer_load_dwordx4 v29, s[44:47], s60 offen lds
    s_waitcnt lgkmcnt(15)
    v_mfma_f32_32x32x16_bf16 v[128:143], v[176:179], v[32:35], v[128:143]
    v_mfma_f32_32x32x16_bf16 v[144:159], v[176:179], v[36:39], v[144:159]
    s_waitcnt lgkmcnt(10)
    v_mfma_f32_32x32x16_bf16 v[128:143], v[180:183], v[40:43], v[128:143]
    v_mfma_f32_32x32x16_bf16 v[144:159], v[180:183], v[44:47], v[144:159]
    s_waitcnt vmcnt(8) lgkmcnt(0)
    s_barrier
    v_mfma_f32_32x32x16_bf16 v[128:143], v[184:187], v[48:51], v[128:143]
    ds_read_b64_tr_b16 v[32:33], v7 offset:0
    ds_read_b64_tr_b16 v[34:35], v7 offset:1024
    ds_read_b64_tr_b16 v[36:37], v8 offset:0
    ds_read_b64_tr_b16 v[38:39], v8 offset:1024
    v_mfma_f32_32x32x16_bf16 v[144:159], v[184:187], v[52:55], v[144:159]
    ds_read_b64_tr_b16 v[40:41], v9 offset:0
    ds_read_b64_tr_b16 v[42:43], v9 offset:1024
    ds_read_b64_tr_b16 v[44:45], v10 offset:0
    ds_read_b64_tr_b16 v[46:47], v10 offset:1024
    v_mfma_f32_32x32x16_bf16 v[128:143], v[188:191], v[56:59], v[128:143]
    v_mfma_f32_32x32x16_bf16 v[144:159], v[188:191], v[60:63], v[144:159]
    s_add_u32 s71, s3, 5
    s_and_b32 s71, s71, 7
    s_mul_i32 s71, s71, 229376
    s_add_u32 s71, s71, s56
    s_add_u32 m0, s59, 98304
    s_add_u32 s60, s71, 0
    buffer_load_dwordx4 v28, s[40:43], s60 offen lds
    s_waitcnt lgkmcnt(0)
    v_mfma_f32_32x32x16_bf16 v[64:79], v[32:35], v[192:195], v[64:79]
    ds_read_b64_tr_b16 v[48:49], v7 offset:4096
    ds_read_b64_tr_b16 v[50:51], v7 offset:5120
    ds_read_b64_tr_b16 v[52:53], v8 offset:4096
    ds_read_b64_tr_b16 v[54:55], v8 offset:5120
    v_mfma_f32_32x32x16_bf16 v[80:95], v[36:39], v[192:195], v[80:95]
    ds_read_b64_tr_b16 v[56:57], v9 offset:4096
    ds_read_b64_tr_b16 v[58:59], v9 offset:5120
    ds_read_b64_tr_b16 v[60:61], v10 offset:4096
    ds_read_b64_tr_b16 v[62:63], v10 offset:5120
    v_mfma_f32_32x32x16_bf16 v[96:111], v[40:43], v[192:195], v[96:111]
    v_mfma_f32_32x32x16_bf16 v[112:127], v[44:47], v[192:195], v[112:127]
    s_add_u32 m0, s59, 114688
    s_add_u32 s60, s71, 0
    buffer_load_dwordx4 v29, s[44:47], s60 offen lds
    s_mul_i32 s60, s49, 3
    s_add_u32 s60, s60, 0
    s_and_b32 s61, s60, 15
    s_lshl_b32 s61, s61, 7
    s_lshl_b32 s62, s48, 2
    s_add_u32 s62, s62, s51
    s_add_u32 s61, s61, s62
    s_lshl_b32 s61, s61, 11
    s_add_u32 s72, s61, 0x200400
    s_add_u32 s73, s72, 512
    v_bfe_u32 v30, v0, 4, 1
    v_lshlrev_b32 v30, 17, v30
    v_lshrrev_b32 v31, 5, v0
    v_lshl_add_u32 v30, v31, 8, v30
    v_and_b32 v31, 15, v0
    v_lshl_add_u32 v15, v31, 4, v30
    v_cvt_pk_bf16_f32 v128, v128, v129
    v_cvt_pk_bf16_f32 v129, v130, v131
    v_cvt_pk_bf16_f32 v130, v132, v133
    v_cvt_pk_bf16_f32 v131, v134, v135
    v_cvt_pk_bf16_f32 v132, v136, v137
    v_cvt_pk_bf16_f32 v133, v138, v139
    v_cvt_pk_bf16_f32 v134, v140, v141
    v_cvt_pk_bf16_f32 v135, v142, v143
    s_mul_i32 s60, s49, 3
    s_add_u32 s60, s60, 1
    s_and_b32 s61, s60, 15
    s_lshl_b32 s61, s61, 7
    s_lshl_b32 s62, s48, 2
    s_add_u32 s62, s62, s51
    s_add_u32 s61, s61, s62
    s_lshl_b32 s61, s61, 11
    s_add_u32 s74, s61, 0x200400
    s_add_u32 s75, s74, 512
    v_cvt_pk_bf16_f32 v144, v144, v145
    v_cvt_pk_bf16_f32 v145, v146, v147
    v_cvt_pk_bf16_f32 v146, v148, v149
    v_cvt_pk_bf16_f32 v147, v150, v151
    v_cvt_pk_bf16_f32 v148, v152, v153
    v_cvt_pk_bf16_f32 v149, v154, v155
    v_cvt_pk_bf16_f32 v150, v156, v157
    v_cvt_pk_bf16_f32 v151, v158, v159
    s_waitcnt lgkmcnt(0)
    v_mfma_f32_32x32x16_bf16 v[64:79], v[48:51], v[196:199], v[64:79]
    ds_read_b64_tr_b16 v[32:33], v7 offset:8192
    ds_read_b64_tr_b16 v[34:35], v7 offset:9216
    ds_read_b64_tr_b16 v[36:37], v8 offset:8192
    ds_read_b64_tr_b16 v[38:39], v8 offset:9216
    v_mfma_f32_32x32x16_bf16 v[80:95], v[52:55], v[196:199], v[80:95]
    ds_read_b64_tr_b16 v[40:41], v9 offset:8192
    ds_read_b64_tr_b16 v[42:43], v9 offset:9216
    ds_read_b64_tr_b16 v[44:45], v10 offset:8192
    ds_read_b64_tr_b16 v[46:47], v10 offset:9216
    v_mfma_f32_32x32x16_bf16 v[96:111], v[56:59], v[196:199], v[96:111]
    buffer_store_dwordx4 v[128:131], v15, s[28:31], s72 offen sc1
    v_mfma_f32_32x32x16_bf16 v[112:127], v[60:63], v[196:199], v[112:127]
    s_add_u32 m0, s59, 99328
    s_add_u32 s60, s71, 14336
    buffer_load_dwordx4 v28, s[40:43], s60 offen lds
    s_waitcnt lgkmcnt(0)
    v_mfma_f32_32x32x16_bf16 v[64:79], v[32:35], v[200:203], v[64:79]
    ds_read_b64_tr_b16 v[48:49], v7 offset:12288
    ds_read_b64_tr_b16 v[50:51], v7 offset:13312
    ds_read_b64_tr_b16 v[52:53], v8 offset:12288
    ds_read_b64_tr_b16 v[54:55], v8 offset:13312
    v_mfma_f32_32x32x16_bf16 v[80:95], v[36:39], v[200:203], v[80:95]
    ds_read_b64_tr_b16 v[56:57], v9 offset:12288
    ds_read_b64_tr_b16 v[58:59], v9 offset:13312
    ds_read_b64_tr_b16 v[60:61], v10 offset:12288
    ds_read_b64_tr_b16 v[62:63], v10 offset:13312
    v_mfma_f32_32x32x16_bf16 v[96:111], v[40:43], v[200:203], v[96:111]
    buffer_store_dwordx4 v[132:135], v15, s[28:31], s73 offen sc1
    v_mfma_f32_32x32x16_bf16 v[112:127], v[44:47], v[200:203], v[112:127]
    s_add_u32 m0, s59, 115712
    s_add_u32 s60, s71, 14336
    buffer_load_dwordx4 v29, s[44:47], s60 offen lds
    s_waitcnt vmcnt(10) lgkmcnt(0)
    s_barrier
    v_mfma_f32_32x32x16_bf16 v[64:79], v[48:51], v[204:207], v[64:79]
    ds_read_b64_tr_b16 v[32:33], v7 offset:32768
    ds_read_b64_tr_b16 v[34:35], v7 offset:33792
    ds_read_b64_tr_b16 v[36:37], v8 offset:32768
    ds_read_b64_tr_b16 v[38:39], v8 offset:33792
    v_mfma_f32_32x32x16_bf16 v[80:95], v[52:55], v[204:207], v[80:95]
    ds_read_b64_tr_b16 v[40:41], v9 offset:32768
    ds_read_b64_tr_b16 v[42:43], v9 offset:33792
    ds_read_b64_tr_b16 v[44:45], v10 offset:32768
    ds_read_b64_tr_b16 v[46:47], v10 offset:33792
    v_mfma_f32_32x32x16_bf16 v[96:111], v[56:59], v[204:207], v[96:111]
    buffer_store_dwordx4 v[144:147], v15, s[28:31], s74 offen sc1
    v_mfma_f32_32x32x16_bf16 v[112:127], v[60:63], v[204:207], v[112:127]
    s_add_u32 s71, s3, 6
    s_and_b32 s71, s71, 7
    s_mul_i32 s71, s71, 229376
    s_add_u32 s71, s71, s56
    s_add_u32 m0, s59, 131072
    s_add_u32 s60, s71, 0
    buffer_load_dwordx4 v28, s[40:43], s60 offen lds
    s_waitcnt lgkmcnt(0)
    v_mfma_f32_32x32x16_bf16 v[64:79], v[32:35], v[208:211], v[64:79]
    ds_read_b64_tr_b16 v[48:49], v7 offset:36864
    ds_read_b64_tr_b16 v[50:51], v7 offset:37888
    ds_read_b64_tr_b16 v[52:53], v8 offset:36864
    ds_read_b64_tr_b16 v[54:55], v8 offset:37888
    v_mfma_f32_32x32x16_bf16 v[80:95], v[36:39], v[208:211], v[80:95]
    ds_read_b64_tr_b16 v[56:57], v9 offset:36864
    ds_read_b64_tr_b16 v[58:59], v9 offset:37888
    ds_read_b64_tr_b16 v[60:61], v10 offset:36864
    ds_read_b64_tr_b16 v[62:63], v10 offset:37888
    v_mfma_f32_32x32x16_bf16 v[96:111], v[40:43], v[208:211], v[96:111]
    buffer_store_dwordx4 v[148:151], v15, s[28:31], s75 offen sc1
    v_mfma_f32_32x32x16_bf16 v[112:127], v[44:47], v[208:211], v[112:127]
    s_add_u32 m0, s59, 147456
    s_add_u32 s60, s71, 0
    buffer_load_dwordx4 v29, s[44:47], s60 offen lds
    s_waitcnt lgkmcnt(0)
    v_mfma_f32_32x32x16_bf16 v[64:79], v[48:51], v[212:215], v[64:79]
    ds_read_b64_tr_b16 v[32:33], v7 offset:40960
    ds_read_b64_tr_b16 v[34:35], v7 offset:41984
    ds_read_b64_tr_b16 v[36:37], v8 offset:40960
    ds_read_b64_tr_b16 v[38:39], v8 offset:41984
    v_mfma_f32_32x32x16_bf16 v[80:95], v[52:55], v[212:215], v[80:95]
    ds_read_b64_tr_b16 v[40:41], v9 offset:40960
    ds_read_b64_tr_b16 v[42:43], v9 offset:41984
    ds_read_b64_tr_b16 v[44:45], v10 offset:40960
    ds_read_b64_tr_b16 v[46:47], v10 offset:41984
    v_mfma_f32_32x32x16_bf16 v[96:111], v[56:59], v[212:215], v[96:111]
    v_mfma_f32_32x32x16_bf16 v[112:127], v[60:63], v[212:215], v[112:127]
    s_add_u32 m0, s59, 132096
    s_add_u32 s60, s71, 14336
    buffer_load_dwordx4 v28, s[40:43], s60 offen lds
    s_waitcnt lgkmcnt(0)
    v_mfma_f32_32x32x16_bf16 v[64:79], v[32:35], v[216:219], v[64:79]
    ds_read_b64_tr_b16 v[48:49], v7 offset:45056
    ds_read_b64_tr_b16 v[50:51], v7 offset:46080
    ds_read_b64_tr_b16 v[52:53], v8 offset:45056
    ds_read_b64_tr_b16 v[54:55], v8 offset:46080
    v_mfma_f32_32x32x16_bf16 v[80:95], v[36:39], v[216:219], v[80:95]
    ds_read_b64_tr_b16 v[56:57], v9 offset:45056
    ds_read_b64_tr_b16 v[58:59], v9 offset:46080
    ds_read_b64_tr_b16 v[60:61], v10 offset:45056
    ds_read_b64_tr_b16 v[62:63], v10 offset:46080
    v_mfma_f32_32x32x16_bf16 v[96:111], v[40:43], v[216:219], v[96:111]
    v_mfma_f32_32x32x16_bf16 v[112:127], v[44:47], v[216:219], v[112:127]
    s_add_u32 m0, s59, 148480
    s_add_u32 s60, s71, 14336
    buffer_load_dwordx4 v29, s[44:47], s60 offen lds
    s_waitcnt vmcnt(12) lgkmcnt(0)
    s_barrier
    v_add_u32 v7, 0x10000, v7
    v_add_u32 v8, 0x10000, v8
    v_add_u32 v9, 0x10000, v9
    v_add_u32 v10, 0x10000, v10
    v_mfma_f32_32x32x16_bf16 v[64:79], v[48:51], v[220:223], v[64:79]
    ds_read_b64_tr_b16 v[32:33], v7 offset:0
    ds_read_b64_tr_b16 v[34:35], v7 offset:1024
    ds_read_b64_tr_b16 v[36:37], v8 offset:0
    ds_read_b64_tr_b16 v[38:39], v8 offset:1024
    v_mfma_f32_32x32x16_bf16 v[80:95], v[52:55], v[220:223], v[80:95]
    ds_read_b64_tr_b16 v[40:41], v9 offset:0
    ds_read_b64_tr_b16 v[42:43], v9 offset:1024
    ds_read_b64_tr_b16 v[44:45], v10 offset:0
    ds_read_b64_tr_b16 v[46:47], v10 offset:1024
    v_mfma_f32_32x32x16_bf16 v[96:111], v[56:59], v[220:223], v[96:111]
    v_mfma_f32_32x32x16_bf16 v[112:127], v[60:63], v[220:223], v[112:127]
    s_add_u32 s71, s3, 7
    s_and_b32 s71, s71, 7
    s_mul_i32 s71, s71, 229376
    s_add_u32 s71, s71, s56
    s_add_u32 m0, s59, 0
    s_add_u32 s60, s71, 0
    buffer_load_dwordx4 v28, s[40:43], s60 offen lds
    s_waitcnt lgkmcnt(0)
    v_mfma_f32_32x32x16_bf16 v[64:79], v[32:35], v[224:227], v[64:79]
    ds_read_b64_tr_b16 v[48:49], v7 offset:4096
    ds_read_b64_tr_b16 v[50:51], v7 offset:5120
    ds_read_b64_tr_b16 v[52:53], v8 offset:4096
    ds_read_b64_tr_b16 v[54:55], v8 offset:5120
    v_mfma_f32_32x32x16_bf16 v[80:95], v[36:39], v[224:227], v[80:95]
    ds_read_b64_tr_b16 v[56:57], v9 offset:4096
    ds_read_b64_tr_b16 v[58:59], v9 offset:5120
    ds_read_b64_tr_b16 v[60:61], v10 offset:4096
    ds_read_b64_tr_b16 v[62:63], v10 offset:5120
    v_mfma_f32_32x32x16_bf16 v[96:111], v[40:43], v[224:227], v[96:111]
    v_mfma_f32_32x32x16_bf16 v[112:127], v[44:47], v[224:227], v[112:127]
    s_add_u32 m0, s59, 16384
    s_add_u32 s60, s71, 0
    buffer_load_dwordx4 v29, s[44:47], s60 offen lds
    s_waitcnt lgkmcnt(0)
    v_mfma_f32_32x32x16_bf16 v[64:79], v[48:51], v[228:231], v[64:79]
    ds_read_b64_tr_b16 v[32:33], v7 offset:8192
    ds_read_b64_tr_b16 v[34:35], v7 offset:9216
    ds_read_b64_tr_b16 v[36:37], v8 offset:8192
    ds_read_b64_tr_b16 v[38:39], v8 offset:9216
    v_mfma_f32_32x32x16_bf16 v[80:95], v[52:55], v[228:231], v[80:95]
    ds_read_b64_tr_b16 v[40:41], v9 offset:8192
    ds_read_b64_tr_b16 v[42:43], v9 offset:9216
    ds_read_b64_tr_b16 v[44:45], v10 offset:8192
    ds_read_b64_tr_b16 v[46:47], v10 offset:9216
    v_mfma_f32_32x32x16_bf16 v[96:111], v[56:59], v[228:231], v[96:111]
    v_mfma_f32_32x32x16_bf16 v[112:127], v[60:63], v[228:231], v[112:127]
    s_add_u32 m0, s59, 1024
    s_add_u32 s60, s71, 14336
    buffer_load_dwordx4 v28, s[40:43], s60 offen lds
    s_waitcnt lgkmcnt(0)
    v_mfma_f32_32x32x16_bf16 v[64:79], v[32:35], v[232:235], v[64:79]
    ds_read_b64_tr_b16 v[48:49], v7 offset:12288
    ds_read_b64_tr_b16 v[50:51], v7 offset:13312
    ds_read_b64_tr_b16 v[52:53], v8 offset:12288
    ds_read_b64_tr_b16 v[54:55], v8 offset:13312
    v_mfma_f32_32x32x16_bf16 v[80:95], v[36:39], v[232:235], v[80:95]
    ds_read_b64_tr_b16 v[56:57], v9 offset:12288
    ds_read_b64_tr_b16 v[58:59], v9 offset:13312
    ds_read_b64_tr_b16 v[60:61], v10 offset:12288
    ds_read_b64_tr_b16 v[62:63], v10 offset:13312
    v_mfma_f32_32x32x16_bf16 v[96:111], v[40:43], v[232:235], v[96:111]
    v_mfma_f32_32x32x16_bf16 v[112:127], v[44:47], v[232:235], v[112:127]
    s_add_u32 m0, s59, 17408
    s_add_u32 s60, s71, 14336
    buffer_load_dwordx4 v29, s[44:47], s60 offen lds
    s_waitcnt vmcnt(7) lgkmcnt(0)
    s_barrier
    v_mfma_f32_32x32x16_bf16 v[64:79], v[48:51], v[236:239], v[64:79]
    ds_read_b64_tr_b16 v[32:33], v7 offset:32768
    ds_read_b64_tr_b16 v[34:35], v7 offset:33792
    ds_read_b64_tr_b16 v[36:37], v8 offset:32768
    ds_read_b64_tr_b16 v[38:39], v8 offset:33792
    v_mfma_f32_32x32x16_bf16 v[80:95], v[52:55], v[236:239], v[80:95]
    ds_read_b64_tr_b16 v[40:41], v9 offset:32768
    ds_read_b64_tr_b16 v[42:43], v9 offset:33792
    ds_read_b64_tr_b16 v[44:45], v10 offset:32768
    ds_read_b64_tr_b16 v[46:47], v10 offset:33792
    v_mfma_f32_32x32x16_bf16 v[96:111], v[56:59], v[236:239], v[96:111]
    v_mfma_f32_32x32x16_bf16 v[112:127], v[60:63], v[236:239], v[112:127]
    s_cmp_lg_u32 s27, 0
    s_cbranch_scc1 QF_11
    v_mov_b32 v30, 0
    v_mov_b32 v31, s26
    s_mov_b64 exec, 1
    buffer_store_dword v31, v30, s[28:31], s70 offen sc1
    s_mov_b64 exec, -1
QF_11:
    s_waitcnt lgkmcnt(0)
    v_mfma_f32_32x32x16_bf16 v[64:79], v[32:35], v[240:243], v[64:79]
    ds_read_b64_tr_b16 v[48:49], v7 offset:36864
    ds_read_b64_tr_b16 v[50:51], v7 offset:37888
    ds_read_b64_tr_b16 v[52:53], v8 offset:36864
    ds_read_b64_tr_b16 v[54:55], v8 offset:37888
    s_mov_b32 s32, s16
    s_and_b32 s33, s17, 0xffff
    v_mfma_f32_32x32x16_bf16 v[80:95], v[36:39], v[240:243], v[80:95]
    ds_read_b64_tr_b16 v[56:57], v9 offset:36864
    ds_read_b64_tr_b16 v[58:59], v9 offset:37888
    ds_read_b64_tr_b16 v[60:61], v10 offset:36864
    ds_read_b64_tr_b16 v[62:63], v10 offset:37888
    s_mov_b32 s34, 0x1c0000
    s_mov_b32 s35, 0x00020000
    v_mfma_f32_32x32x16_bf16 v[96:111], v[40:43], v[240:243], v[96:111]
    s_mov_b32 s36, s8
    s_and_b32 s37, s9, 0xffff
    s_mov_b32 s38, 0x80000
    s_mov_b32 s39, 0x00020000
    v_mfma_f32_32x32x16_bf16 v[112:127], v[44:47], v[240:243], v[112:127]
    s_mul_i32 s54, s52, 16640
    s_add_u32 s54, s54, 32768
    v_add_u32 v2, s54, v1
    v_lshrrev_b32 v236, 5, v0
    s_waitcnt lgkmcnt(0)
    v_mfma_f32_32x32x16_bf16 v[64:79], v[48:51], v[244:247], v[64:79]
    ds_read_b64_tr_b16 v[32:33], v7 offset:40960
    ds_read_b64_tr_b16 v[34:35], v7 offset:41984
    ds_read_b64_tr_b16 v[36:37], v8 offset:40960
    ds_read_b64_tr_b16 v[38:39], v8 offset:41984
    v_lshlrev_b32 v232, 8, v236
    v_and_b32 v233, 15, v0
    v_mfma_f32_32x32x16_bf16 v[80:95], v[52:55], v[244:247], v[80:95]
    ds_read_b64_tr_b16 v[40:41], v9 offset:40960
    ds_read_b64_tr_b16 v[42:43], v9 offset:41984
    ds_read_b64_tr_b16 v[44:45], v10 offset:40960
    ds_read_b64_tr_b16 v[46:47], v10 offset:41984
    v_lshl_add_u32 v232, v233, 4, v232
    v_and_b32 v233, 11, v0
    v_mfma_f32_32x32x16_bf16 v[96:111], v[56:59], v[244:247], v[96:111]
    v_cmp_eq_u32 vcc, 0, v233
    v_mov_b32 v234, 16
    s_nop 0
    v_cndmask_b32 v234, v234, 0, vcc
    v_mfma_f32_32x32x16_bf16 v[112:127], v[60:63], v[244:247], v[112:127]
    v_add_u32 v235, 1024, v234
    v_add_u32 v234, 512, v234
    v_cndmask_b32 v3, v235, v232, s[0:1]
    v_cndmask_b32 v4, v234, v232, s[0:1]
    s_waitcnt lgkmcnt(0)
    v_mfma_f32_32x32x16_bf16 v[64:79], v[32:35], v[248:251], v[64:79]
    ds_read_b64_tr_b16 v[48:49], v7 offset:45056
    ds_read_b64_tr_b16 v[50:51], v7 offset:46080
    ds_read_b64_tr_b16 v[52:53], v8 offset:45056
    ds_read_b64_tr_b16 v[54:55], v8 offset:46080
    v_add_u32 v3, s54, v3
    v_add_u32 v4, s54, v4
    v_mfma_f32_32x32x16_bf16 v[80:95], v[36:39], v[248:251], v[80:95]
    ds_read_b64_tr_b16 v[56:57], v9 offset:45056
    ds_read_b64_tr_b16 v[58:59], v9 offset:46080
    ds_read_b64_tr_b16 v[60:61], v10 offset:45056
    ds_read_b64_tr_b16 v[62:63], v10 offset:46080
    v_lshrrev_b32 v232, 3, v0
    v_lshlrev_b32 v232, 10, v232
    v_mfma_f32_32x32x16_bf16 v[96:111], v[40:43], v[248:251], v[96:111]
    v_bfe_u32 v233, v0, 4, 1
    v_lshlrev_b32 v234, 2, v233
    v_and_b32 v235, 7, v0
    v_xor_b32 v234, v234, v235
    v_mfma_f32_32x32x16_bf16 v[112:127], v[44:47], v[248:251], v[112:127]
    v_lshl_add_u32 v11, v234, 4, v232
    v_add_u32 v12, 7168, v11
    s_mul_i32 s54, s13, 114688
    v_add_u32 v13, s54, v1
    s_waitcnt vmcnt(4) lgkmcnt(0)
    s_barrier
    v_add_u32 v7, 0x10000, v7
    v_add_u32 v8, 0x10000, v8
    v_add_u32 v9, 0x10000, v9
    v_add_u32 v10, 0x10000, v10
    v_mfma_f32_32x32x16_bf16 v[64:79], v[48:51], v[252:255], v[64:79]
    ds_read_b64_tr_b16 v[32:33], v7 offset:0
    ds_read_b64_tr_b16 v[34:35], v7 offset:1024
    ds_read_b64_tr_b16 v[36:37], v8 offset:0
    ds_read_b64_tr_b16 v[38:39], v8 offset:1024
    v_bfe_u32 v234, v0, 2, 2
    v_lshl_add_u32 v232, v236, 2, v234
    v_mfma_f32_32x32x16_bf16 v[80:95], v[52:55], v[252:255], v[80:95]
    ds_read_b64_tr_b16 v[40:41], v9 offset:0
    ds_read_b64_tr_b16 v[42:43], v9 offset:1024
    ds_read_b64_tr_b16 v[44:45], v10 offset:0
    ds_read_b64_tr_b16 v[46:47], v10 offset:1024
    v_lshlrev_b32 v232, 7, v232
    v_lshrrev_b32 v234, 1, v234
    v_mfma_f32_32x32x16_bf16 v[96:111], v[56:59], v[252:255], v[96:111]
    v_lshl_add_u32 v232, v234, 6, v232
    v_lshl_add_u32 v232, v233, 5, v232
    v_and_b32 v234, 3, v0
    v_lshl_add_u32 v232, v234, 3, v232
    v_mfma_f32_32x32x16_bf16 v[112:127], v[60:63], v[252:255], v[112:127]
    s_lshl_b32 s54, s14, 5
    v_xor_b32 v232, s54, v232
    v_add_u32 v5, s11, v232
    v_xor_b32 v6, 64, v5
    s_mul_i32 s54, s27, 14
    s_add_u32 s55, s54, 13
    s_lshr_b32 s54, s54, 2
    s_lshr_b32 s55, s55, 2
    v_and_b32 v14, 7, v0
    v_add_u32 v14, s54, v14
    v_min_u32 v14, s55, v14
    v_bfe_u32 v232, v0, 3, 1
    s_lshl_b32 s54, s4, 1
    v_add_u32 v232, s54, v232
    v_lshl_add_u32 v14, v232, 5, v14
    v_lshlrev_b32 v14, 7, v14
    s_waitcnt lgkmcnt(0)
    v_mfma_f32_32x32x16_bf16 v[64:79], v[32:35], v[160:163], v[64:79]
    ds_read_b64_tr_b16 v[48:49], v7 offset:4096
    ds_read_b64_tr_b16 v[50:51], v7 offset:5120
    ds_read_b64_tr_b16 v[52:53], v8 offset:4096
    ds_read_b64_tr_b16 v[54:55], v8 offset:5120
    v_and_b32 v232, 31, v0
    v_mul_u32_u24 v232, 2080, v232
    v_mfma_f32_32x32x16_bf16 v[80:95], v[36:39], v[160:163], v[80:95]
    ds_read_b64_tr_b16 v[56:57], v9 offset:4096
    ds_read_b64_tr_b16 v[58:59], v9 offset:5120
    ds_read_b64_tr_b16 v[60:61], v10 offset:4096
    ds_read_b64_tr_b16 v[62:63], v10 offset:5120
    v_lshrrev_b32 v233, 5, v0
    v_lshl_add_u32 v232, v233, 4, v232
    v_mfma_f32_32x32x16_bf16 v[96:111], v[40:43], v[160:163], v[96:111]
    v_cmp_eq_u32 vcc, 0, v233
    v_mov_b32 v236, 0x3f803f80
    s_nop 0
    v_cndmask_b32 v236, 0, v236, vcc
    v_mfma_f32_32x32x16_bf16 v[112:127], v[44:47], v[160:163], v[112:127]
    v_mov_b32 v237, v236
    v_mov_b32 v238, v236
    v_mov_b32 v239, v236
    ds_write_b128 v232, v[236:239] offset:34816
    s_waitcnt lgkmcnt(0)
    v_mfma_f32_32x32x16_bf16 v[64:79], v[48:51], v[164:167], v[64:79]
    ds_read_b64_tr_b16 v[32:33], v7 offset:8192
    ds_read_b64_tr_b16 v[34:35], v7 offset:9216
    ds_read_b64_tr_b16 v[36:37], v8 offset:8192
    ds_read_b64_tr_b16 v[38:39], v8 offset:9216
    s_mov_b32 s40, s20
    s_and_b32 s41, s21, 0xffff
    v_mfma_f32_32x32x16_bf16 v[80:95], v[52:55], v[164:167], v[80:95]
    ds_read_b64_tr_b16 v[40:41], v9 offset:8192
    ds_read_b64_tr_b16 v[42:43], v9 offset:9216
    ds_read_b64_tr_b16 v[44:45], v10 offset:8192
    ds_read_b64_tr_b16 v[46:47], v10 offset:9216
    s_mov_b32 s42, 0x200000
    s_mov_b32 s43, 0x00020000
    v_mfma_f32_32x32x16_bf16 v[96:111], v[56:59], v[164:167], v[96:111]
    s_lshl_b32 s72, s4, 1
    s_add_u32 s72, s72, s13
    s_lshl_b32 s73, s72, 5
    s_lshl_b32 s74, s14, 3
    v_mfma_f32_32x32x16_bf16 v[112:127], v[60:63], v[164:167], v[112:127]
    s_add_u32 s73, s73, s74
    s_lshl_b32 s54, s73, 10
    s_add_u32 s54, s54, 0x600000
    s_add_u32 s55, s54, 4096
    s_lshl_b32 s56, s72, 15
    s_lshl_b32 s74, s5, 7
    s_add_u32 s56, s56, s74
    s_lshl_b32 s74, s14, 5
    s_add_u32 s56, s56, s74
    s_lshl_b32 s59, s72, 8
    s_add_u32 s59, s59, 0xf00000
    s_lshl_b32 s58, s65, 3
    s_lshl_b32 s73, s51, 1
    s_add_u32 s58, s58, s73
    s_add_u32 s58, s58, s52
    s_lshl_b32 s58, s58, 8
    s_add_u32 s58, s58, 0xf00000
    s_lshl_b32 s72, s14, 1
    s_lshr_b32 s73, s4, 2
    s_lshl_b32 s73, s73, 5
    s_add_u32 s72, s72, s73
    s_lshl_b32 s73, s69, 3
    s_add_u32 s73, s73, 0xf00000
    s_waitcnt lgkmcnt(0)
    v_mfma_f32_32x32x16_bf16 v[64:79], v[32:35], v[168:171], v[64:79]
    ds_read_b64_tr_b16 v[48:49], v7 offset:12288
    ds_read_b64_tr_b16 v[50:51], v7 offset:13312
    ds_read_b64_tr_b16 v[52:53], v8 offset:12288
    ds_read_b64_tr_b16 v[54:55], v8 offset:13312
    v_mfma_f32_32x32x16_bf16 v[80:95], v[36:39], v[168:171], v[80:95]
    ds_read_b64_tr_b16 v[56:57], v9 offset:12288
    ds_read_b64_tr_b16 v[58:59], v9 offset:13312
    ds_read_b64_tr_b16 v[60:61], v10 offset:12288
    ds_read_b64_tr_b16 v[62:63], v10 offset:13312
    v_mfma_f32_32x32x16_bf16 v[96:111], v[40:43], v[168:171], v[96:111]
    v_mfma_f32_32x32x16_bf16 v[112:127], v[44:47], v[168:171], v[112:127]
    s_lshr_b32 s60, s64, 1
    v_lshrrev_b32 v30, 4, v0
    v_add_u32 v30, 1, v30
    v_cmp_gt_u32 vcc, 3, v30
    s_nop 1
    v_cndmask_b32 v30, 0, v30, vcc
    v_lshlrev_b32 v30, 4, v30
    v_add_u32 v30, s60, v30
    v_mul_u32_u24 v30, 43691, v30
    v_lshrrev_b32 v30, 17, v30
    v_and_b32 v31, 15, v0
    s_lshl_b32 s61, s65, 1
    v_add_u32 v24, s61, v31
    v_cndmask_b32 v31, v24, v31, vcc
    v_lshl_add_u32 v30, v30, 4, v31
    v_lshlrev_b32 v30, 7, v30
    s_mov_b32 s60, 0xf10000
    s_mov_b32 exec_lo, 0xffffffff
    s_mov_b32 exec_hi, 0x3
    buffer_load_dword v31, v30, s[28:31], s60 offen sc1
    s_mov_b64 exec, -1
    s_waitcnt vmcnt(1) lgkmcnt(0)
    s_barrier
    v_add_u32 v7, 0xfffe0000, v7
    v_add_u32 v8, 0xfffe0000, v8
    v_add_u32 v9, 0xfffe0000, v9
    v_add_u32 v10, 0xfffe0000, v10
    v_mfma_f32_32x32x16_bf16 v[64:79], v[48:51], v[172:175], v[64:79]
    ds_read_b64_tr_b16 v[32:33], v7 offset:0
    ds_read_b64_tr_b16 v[34:35], v7 offset:1024
    ds_read_b64_tr_b16 v[36:37], v8 offset:0
    ds_read_b64_tr_b16 v[38:39], v8 offset:1024
    v_mfma_f32_32x32x16_bf16 v[80:95], v[52:55], v[172:175], v[80:95]
    ds_read_b64_tr_b16 v[40:41], v9 offset:0
    ds_read_b64_tr_b16 v[42:43], v9 offset:1024
    ds_read_b64_tr_b16 v[44:45], v10 offset:0
    ds_read_b64_tr_b16 v[46:47], v10 offset:1024
    v_mfma_f32_32x32x16_bf16 v[96:111], v[56:59], v[172:175], v[96:111]
    v_mfma_f32_32x32x16_bf16 v[112:127], v[60:63], v[172:175], v[112:127]
    s_waitcnt lgkmcnt(0)
    v_mfma_f32_32x32x16_bf16 v[64:79], v[32:35], v[176:179], v[64:79]
    ds_read_b64_tr_b16 v[48:49], v7 offset:4096
    ds_read_b64_tr_b16 v[50:51], v7 offset:5120
    ds_read_b64_tr_b16 v[52:53], v8 offset:4096
    ds_read_b64_tr_b16 v[54:55], v8 offset:5120
    v_mfma_f32_32x32x16_bf16 v[80:95], v[36:39], v[176:179], v[80:95]
    ds_read_b64_tr_b16 v[56:57], v9 offset:4096
    ds_read_b64_tr_b16 v[58:59], v9 offset:5120
    ds_read_b64_tr_b16 v[60:61], v10 offset:4096
    ds_read_b64_tr_b16 v[62:63], v10 offset:5120
    v_mfma_f32_32x32x16_bf16 v[96:111], v[40:43], v[176:179], v[96:111]
    v_mfma_f32_32x32x16_bf16 v[112:127], v[44:47], v[176:179], v[112:127]
    s_waitcnt lgkmcnt(0)
    v_mfma_f32_32x32x16_bf16 v[64:79], v[48:51], v[180:183], v[64:79]
    ds_read_b64_tr_b16 v[32:33], v7 offset:8192
    ds_read_b64_tr_b16 v[34:35], v7 offset:9216
    ds_read_b64_tr_b16 v[36:37], v8 offset:8192
    ds_read_b64_tr_b16 v[38:39], v8 offset:9216
    v_mfma_f32_32x32x16_bf16 v[80:95], v[52:55], v[180:183], v[80:95]
    ds_read_b64_tr_b16 v[40:41], v9 offset:8192
    ds_read_b64_tr_b16 v[42:43], v9 offset:9216
    ds_read_b64_tr_b16 v[44:45], v10 offset:8192
    ds_read_b64_tr_b16 v[46:47], v10 offset:9216
    v_mfma_f32_32x32x16_bf16 v[96:111], v[56:59], v[180:183], v[96:111]
    v_mfma_f32_32x32x16_bf16 v[112:127], v[60:63], v[180:183], v[112:127]
    s_waitcnt vmcnt(0)
    v_cmp_ne_u32 vcc, s26, v31
    s_and_b32 vcc_lo, vcc_lo, 0xffffffff
    s_and_b32 vcc_hi, vcc_hi, 0x3
    s_or_b32 s60, vcc_lo, vcc_hi
    s_cbranch_scc0 FOK_12
    s_mov_b32 s60, 0xf10000
    s_mov_b32 s61, 0x80000
    s_mov_b32 exec_lo, 0xffffffff
    s_mov_b32 exec_hi, 0x3
POLL_13:
    buffer_load_dword v31, v30, s[28:31], s60 offen sc1
    s_waitcnt vmcnt(0)
    v_cmp_ne_u32 vcc, s26, v31
    s_cbranch_vccz POLLD_14
    s_mov_b64 exec, vcc
    s_sub_u32 s61, s61, 1
    s_cbranch_scc0 POLL_13
POLLD_14:
    s_mov_b64 exec, -1
FOK_12:
    s_xor_b32 s60, s68, 1024
    buffer_load_dwordx4 v[16:19], v1, s[28:31], s60 offen sc1
    buffer_load_dwordx4 v[20:23], v1, s[28:31], s68 offen sc1
    s_lshl_b32 s60, s64, 17
    s_add_u32 s60, s60, 0x200000
    buffer_load_dwordx4 v[224:227], v1, s[28:31], s60 offen sc1
    s_add_u32 m0, s67, 0
    s_nop 0
    buffer_load_dwordx4 v1, s[28:31], s66 offen sc1 lds
    buffer_load_dwordx4 v1, s[28:31], s66 offen offset:1024 sc1 lds
    s_add_u32 m0, s67, 8320
    s_add_u32 s66, s66, 8192
    buffer_load_dwordx4 v1, s[28:31], s66 offen sc1 lds
    buffer_load_dwordx4 v1, s[28:31], s66 offen offset:1024 sc1 lds
    s_add_u32 s66, s66, 8192
    s_waitcnt lgkmcnt(0)
    v_mfma_f32_32x32x16_bf16 v[64:79], v[32:35], v[184:187], v[64:79]
    ds_read_b64_tr_b16 v[48:49], v7 offset:12288
    ds_read_b64_tr_b16 v[50:51], v7 offset:13312
    ds_read_b64_tr_b16 v[52:53], v8 offset:12288
    ds_read_b64_tr_b16 v[54:55], v8 offset:13312
    v_mfma_f32_32x32x16_bf16 v[80:95], v[36:39], v[184:187], v[80:95]
    ds_read_b64_tr_b16 v[56:57], v9 offset:12288
    ds_read_b64_tr_b16 v[58:59], v9 offset:13312
    ds_read_b64_tr_b16 v[60:61], v10 offset:12288
    ds_read_b64_tr_b16 v[62:63], v10 offset:13312
    v_mfma_f32_32x32x16_bf16 v[96:111], v[40:43], v[184:187], v[96:111]
    v_mfma_f32_32x32x16_bf16 v[112:127], v[44:47], v[184:187], v[112:127]
    s_waitcnt lgkmcnt(0)
    v_mfma_f32_32x32x16_bf16 v[64:79], v[48:51], v[188:191], v[64:79]
    v_mfma_f32_32x32x16_bf16 v[80:95], v[52:55], v[188:191], v[80:95]
    v_mfma_f32_32x32x16_bf16 v[96:111], v[56:59], v[188:191], v[96:111]
    v_mfma_f32_32x32x16_bf16 v[112:127], v[60:63], v[188:191], v[112:127]
    s_setprio 3
    s_lshl_b32 s60, s48, 2
    s_add_u32 s60, s60, s51
    s_mul_i32 s60, s60, 112
    s_lshl_b32 s61, s50, 3
    s_add_u32 s60, s60, s61
    s_lshl_b32 s60, s60, 10
    s_add_u32 s57, s60, 0x800000
    s_nop 4
    s_xor_b32 s60, s13, 1
    s_mul_i32 s60, s60, 114688
    v_add_u32 v7, s60, v1
    s_mul_i32 s60, s27, 2560
    s_add_u32 s60, s60, 99328
    v_add_u32 v8, s60, v1
    s_xor_b32 s60, s27, 4
    s_mul_i32 s60, s60, 2560
    s_add_u32 s60, s60, 99328
    v_add_u32 v9, s60, v1
    v_bfe_u32 v10, v0, 2, 1
    v_and_b32 v232, 3, v0
    v_lshl_add_u32 v10, v232, 3, v10
    v_add_u32 v10, s72, v10
    v_lshlrev_b32 v10, 7, v10
    v_pk_mul_f32 v[64:65], v[64:65], v[72:73]
    v_pk_mul_f32 v[66:67], v[66:67], v[74:75]
    v_pk_mul_f32 v[68:69], v[68:69], v[76:77]
    v_pk_mul_f32 v[70:71], v[70:71], v[78:79]
    v_cvt_pk_bf16_f32 v72, v64, v65
    v_cvt_pk_bf16_f32 v73, v66, v67
    v_cvt_pk_bf16_f32 v74, v68, v69
    v_cvt_pk_bf16_f32 v75, v70, v71
    v_pk_mul_f32 v[80:81], v[80:81], v[88:89]
    v_pk_mul_f32 v[82:83], v[82:83], v[90:91]
    v_pk_mul_f32 v[84:85], v[84:85], v[92:93]
    v_pk_mul_f32 v[86:87], v[86:87], v[94:95]
    v_cvt_pk_bf16_f32 v88, v80, v81
    v_cvt_pk_bf16_f32 v89, v82, v83
    v_cvt_pk_bf16_f32 v90, v84, v85
    v_cvt_pk_bf16_f32 v91, v86, v87
    s_waitcnt vmcnt(4)
    v_mfma_f32_32x32x16_bf16 v[128:143], v[224:227], v[16:19], 0
    v_mfma_f32_32x32x16_bf16 v[144:159], v[224:227], v[20:23], 0
    v_pk_mul_f32 v[96:97], v[96:97], v[104:105]
    v_pk_mul_f32 v[98:99], v[98:99], v[106:107]
    v_pk_mul_f32 v[100:101], v[100:101], v[108:109]
    v_pk_mul_f32 v[102:103], v[102:103], v[110:111]
    v_cvt_pk_bf16_f32 v104, v96, v97
    v_cvt_pk_bf16_f32 v105, v98, v99
    v_cvt_pk_bf16_f32 v106, v100, v101
    v_cvt_pk_bf16_f32 v107, v102, v103
    v_pk_mul_f32 v[112:113], v[112:113], v[120:121]
    v_pk_mul_f32 v[114:115], v[114:115], v[122:123]
    v_pk_mul_f32 v[116:117], v[116:117], v[124:125]
    v_pk_mul_f32 v[118:119], v[118:119], v[126:127]
    v_cvt_pk_bf16_f32 v120, v112, v113
    v_cvt_pk_bf16_f32 v121, v114, v115
    v_cvt_pk_bf16_f32 v122, v116, v117
    v_cvt_pk_bf16_f32 v123, v118, v119
    s_nop 3
    v_max3_f32 v232, v128, v129, v130
    v_max3_f32 v232, v232, v131, v132
    v_max3_f32 v232, v232, v133, v134
    v_max3_f32 v232, v232, v135, v136
    v_max3_f32 v232, v232, v137, v138
    v_max3_f32 v232, v232, v139, v140
    v_max3_f32 v232, v232, v141, v142
    v_max_f32 v232, v232, v143
    v_mov_b32 v234, v232
    s_nop 1
    v_permlane32_swap_b32 v232, v234
    s_nop 1
    v_max_f32 v232, v232, v234
    v_max3_f32 v233, v144, v145, v146
    v_max3_f32 v233, v233, v147, v148
    v_max3_f32 v233, v233, v149, v150
    v_max3_f32 v233, v233, v151, v152
    v_max3_f32 v233, v233, v153, v154
    v_max3_f32 v233, v233, v155, v156
    v_max3_f32 v233, v233, v157, v158
    v_max_f32 v233, v233, v159
    v_mov_b32 v234, v233
    s_nop 1
    v_permlane32_swap_b32 v233, v234
    s_nop 1
    v_max_f32 v233, v233, v234
    v_min_f32 v232, v232, v233
    v_sub_f32 v240, 0, v232
    v_sub_f32 v241, 0, v232
    v_sub_f32 v242, 0, v232
    v_sub_f32 v243, 0, v232
    v_sub_f32 v244, 0, v232
    v_sub_f32 v245, 0, v232
    v_sub_f32 v246, 0, v232
    v_sub_f32 v247, 0, v232
    v_sub_f32 v248, 0, v232
    v_sub_f32 v249, 0, v232
    v_sub_f32 v250, 0, v232
    v_sub_f32 v251, 0, v232
    v_sub_f32 v252, 0, v232
    v_sub_f32 v253, 0, v232
    v_sub_f32 v254, 0, v232
    v_sub_f32 v255, 0, v232
    s_add_u32 m0, s67, 33280
    s_nop 0
    buffer_load_dwordx4 v1, s[28:31], s66 offen sc1 lds
    buffer_load_dwordx4 v1, s[28:31], s66 offen offset:1024 sc1 lds
    s_add_u32 m0, s67, 41600
    s_add_u32 s66, s66, 8192
    buffer_load_dwordx4 v1, s[28:31], s66 offen sc1 lds
    buffer_load_dwordx4 v1, s[28:31], s66 offen offset:1024 sc1 lds
    s_add_u32 s66, s66, 8192
    buffer_store_dwordx4 v[72:75], v1, s[28:31], s57 offen offset:0 sc1
    buffer_store_dwordx4 v[88:91], v1, s[28:31], s57 offen offset:1024 sc1
    buffer_store_dwordx4 v[104:107], v1, s[28:31], s57 offen offset:2048 sc1
    buffer_store_dwordx4 v[120:123], v1, s[28:31], s57 offen offset:3072 sc1
    s_waitcnt vmcnt(8)
    s_barrier
    ds_read_b128 v[24:27], v2 offset:0
    ds_read_b128 v[208:211], v3 offset:1024
    ds_read_b128 v[212:215], v4 offset:1536
    s_waitcnt lgkmcnt(2)
    v_mfma_f32_32x32x16_bf16 v[128:143], v[24:27], v[16:19], v[240:255]
    s_branch ATTN
CLS5:
    s_add_u32 s19, s3, 1
    s_and_b32 s19, s19, 7
    s_lshl_b32 s15, s19, 7
    s_add_u32 s15, s15, s54
    s_mul_i32 s19, s19, 196608
    s_add_u32 m0, s57, 32768
    s_add_u32 s60, s15, 0
    buffer_load_dwordx4 v11, s[32:35], s60 offen lds
    s_add_u32 m0, s57, 33792
    s_add_u32 s60, s15, 8192
    buffer_load_dwordx4 v12, s[32:35], s60 offen lds
    s_add_u32 m0, s58, 50176
    s_add_u32 s60, s55, s19
    buffer_load_dwordx4 v14, s[36:39], s60 offen lds
    s_add_u32 m0, s58, 51200
    s_add_u32 s60, s55, s19
    buffer_load_dwordx4 v15, s[36:39], s60 offen lds
    v_mov_b32 v24, 0
    s_mov_b32 s60, 0xf04000
    buffer_load_dword v25, v24, s[28:31], s60 offen sc1
    s_lshl_b32 s60, s69, 10
    buffer_load_dwordx4 v[16:19], v1, s[72:75], 0 offen
    buffer_load_dwordx4 v[20:23], v1, s[32:35], s60 offen
    s_and_b32 s60, s2, 7
    s_lshr_b32 s61, s2, 3
    s_lshl_b32 s4, s60, 2
    s_and_b32 s60, s61, 3
    s_add_u32 s4, s4, s60
    s_lshr_b32 s5, s61, 2
    s_mov_b32 s0, 0xffff
    s_mov_b32 s1, 0xffff
    s_and_b32 s13, s27, 1
    s_lshr_b32 s14, s27, 1
    s_mul_i32 s60, s4, 224
    s_mul_i32 s61, s27, 14
    s_add_u32 s60, s60, s61
    s_lshl_b32 s6, s60, 10
    s_add_u32 s6, s6, 0x800000
    s_lshl_b32 s7, s61, 14
    s_lshl_b32 s60, s5, 7
    s_add_u32 s7, s7, s60
    s_lshl_b32 s10, s27, 16
    s_add_u32 s10, s10, s60
    s_lshl_b32 s11, s51, 13
    s_lshl_b32 s60, s52, 17
    s_add_u32 s11, s11, s60
    s_lshl_b32 s60, s48, 2
    s_add_u32 s60, s60, s51
    s_lshl_b32 s60, s60, 5
    s_lshl_b32 s61, s50, 1
    s_add_u32 s60, s60, s61
    s_add_u32 s60, s60, s52
    s_lshl_b32 s60, s60, 7
    s_add_u32 s12, s60, 0xf70000
    s_lshl_b32 s60, s65, 3
    s_lshl_b32 s61, s51, 1
    s_add_u32 s60, s60, s61
    s_add_u32 s60, s60, s52
    s_lshl_b32 s60, s60, 5
    s_add_u32 s60, s60, s64
    s_lshl_b32 s18, s60, 10
    s_add_u32 s18, s18, 0x600000
    v_and_b32 v30, 31, v0
    v_lshrrev_b32 v31, 5, v0
    v_bfe_u32 v32, v0, 1, 3
    v_xor_b32 v32, v32, v31
    s_lshl_b32 s60, s51, 12
    v_lshlrev_b32 v33, 7, v30
    v_add_u32 v33, s60, v33
    v_xor_b32 v34, 0, v32
    v_lshl_add_u32 v2, v34, 4, v33
    v_xor_b32 v34, 2, v32
    v_lshl_add_u32 v3, v34, 4, v33
    v_xor_b32 v34, 4, v32
    v_lshl_add_u32 v4, v34, 4, v33
    v_xor_b32 v34, 6, v32
    v_lshl_add_u32 v5, v34, 4, v33
    v_bfe_u32 v32, v0, 2, 2
    v_lshl_add_u32 v33, v31, 3, v32
    v_mul_u32_u24 v34, 192, v33
    v_bfe_u32 v35, v0, 4, 1
    v_lshl_add_u32 v34, v35, 5, v34
    v_and_b32 v36, 3, v0
    v_lshl_add_u32 v34, v36, 3, v34
    v_add_u32 v6, 16512, v34
    v_lshlrev_b32 v33, 8, v33
    v_lshl_add_u32 v33, v35, 14, v33
    v_lshl_add_u32 v33, v36, 3, v33
    v_bfe_u32 v32, v0, 2, 3
    v_xor_b32 v34, 4, v32
    v_lshl_add_u32 v7, v34, 5, v33
    v_xor_b32 v34, 5, v32
    v_lshl_add_u32 v8, v34, 5, v33
    v_xor_b32 v34, 6, v32
    v_lshl_add_u32 v9, v34, 5, v33
    v_xor_b32 v34, 7, v32
    v_lshl_add_u32 v10, v34, 5, v33
    s_waitcnt vmcnt(7)
    s_barrier
    ds_read_b128 v[160:163], v2 offset:0
    ds_read_b64_tr_b16 v[32:33], v6 offset:0
    ds_read_b64_tr_b16 v[34:35], v6 offset:768
    ds_read_b128 v[164:167], v3 offset:0
    ds_read_b64_tr_b16 v[40:41], v6 offset:3072
    ds_read_b64_tr_b16 v[42:43], v6 offset:3840
    ds_read_b128 v[168:171], v4 offset:0
    ds_read_b64_tr_b16 v[48:49], v6 offset:6144
    ds_read_b64_tr_b16 v[50:51], v6 offset:6912
    ds_read_b128 v[172:175], v5 offset:0
    ds_read_b64_tr_b16 v[56:57], v6 offset:9216
    ds_read_b64_tr_b16 v[58:59], v6 offset:9984
    s_add_u32 s19, s3, 2
    s_and_b32 s19, s19, 7
    s_lshl_b32 s15, s19, 7
    s_add_u32 s15, s15, s54
    s_mul_i32 s19, s19, 196608
    s_add_u32 m0, s57, 65536
    s_add_u32 s60, s15, 0
    buffer_load_dwordx4 v11, s[32:35], s60 offen lds
    s_add_u32 m0, s57, 66560
    s_add_u32 s60, s15, 8192
    buffer_load_dwordx4 v12, s[32:35], s60 offen lds
    s_add_u32 m0, s58, 82944
    s_add_u32 s60, s55, s19
    buffer_load_dwordx4 v14, s[36:39], s60 offen lds
    s_waitcnt lgkmcnt(9)
    v_mfma_f32_32x32x16_bf16 v[128:143], v[32:35], v[160:163], 0
    s_waitcnt lgkmcnt(6)
    v_mfma_f32_32x32x16_bf16 v[128:143], v[40:43], v[164:167], v[128:143]
    s_add_u32 m0, s58, 83968
    s_add_u32 s60, s55, s19
    buffer_load_dwordx4 v15, s[36:39], s60 offen lds
    s_waitcnt vmcnt(7) lgkmcnt(0)
    s_barrier
    ds_read_b128 v[176:179], v2 offset:32768
    ds_read_b64_tr_b16 v[32:33], v6 offset:32768
    ds_read_b64_tr_b16 v[34:35], v6 offset:33536
    v_mfma_f32_32x32x16_bf16 v[128:143], v[48:51], v[168:171], v[128:143]
    ds_read_b128 v[180:183], v3 offset:32768
    ds_read_b64_tr_b16 v[40:41], v6 offset:35840
    ds_read_b64_tr_b16 v[42:43], v6 offset:36608
    v_mfma_f32_32x32x16_bf16 v[128:143], v[56:59], v[172:175], v[128:143]
    ds_read_b128 v[184:187], v4 offset:32768
    ds_read_b64_tr_b16 v[48:49], v6 offset:38912
    ds_read_b64_tr_b16 v[50:51], v6 offset:39680
    ds_read_b128 v[188:191], v5 offset:32768
    ds_read_b64_tr_b16 v[56:57], v6 offset:41984
    ds_read_b64_tr_b16 v[58:59], v6 offset:42752
    s_add_u32 s19, s3, 3
    s_and_b32 s19, s19, 7
    s_lshl_b32 s15, s19, 7
    s_add_u32 s15, s15, s54
    s_mul_i32 s19, s19, 196608
    s_add_u32 m0, s57, 98304
    s_add_u32 s60, s15, 0
    buffer_load_dwordx4 v11, s[32:35], s60 offen lds
    s_add_u32 m0, s57, 99328
    s_add_u32 s60, s15, 8192
    buffer_load_dwordx4 v12, s[32:35], s60 offen lds
    s_add_u32 m0, s58, 115712
    s_add_u32 s60, s55, s19
    buffer_load_dwordx4 v14, s[36:39], s60 offen lds
    s_waitcnt lgkmcnt(9)
    v_mfma_f32_32x32x16_bf16 v[128:143], v[32:35], v[176:179], v[128:143]
    s_waitcnt lgkmcnt(6)
    v_mfma_f32_32x32x16_bf16 v[128:143], v[40:43], v[180:183], v[128:143]
    s_add_u32 m0, s58, 116736
    s_add_u32 s60, s55, s19
    buffer_load_dwordx4 v15, s[36:39], s60 offen lds
    s_waitcnt vmcnt(8)
    s_mov_b32 s63, 0xffff0000
    v_lshlrev_b32 v30, 16, v16
    v_and_b32 v16, s63, v16
    v_lshlrev_b32 v31, 16, v20
    v_and_b32 v20, s63, v20
    v_mul_f32 v30, v30, v31
    v_mul_f32 v31, v16, v20
    v_cvt_pk_bf16_f32 v30, v30, v31
    v_and_b32 v31, s63, v30
    v_lshlrev_b32 v30, 16, v30
    v_add_f32 v26, v30, v31
    v_lshlrev_b32 v30, 16, v17
    v_and_b32 v17, s63, v17
    v_lshlrev_b32 v31, 16, v21
    v_and_b32 v21, s63, v21
    v_mul_f32 v30, v30, v31
    v_mul_f32 v31, v17, v21
    v_cvt_pk_bf16_f32 v30, v30, v31
    v_and_b32 v31, s63, v30
    v_lshlrev_b32 v30, 16, v30
    v_add_f32 v26, v26, v30
    v_add_f32 v26, v26, v31
    v_lshlrev_b32 v30, 16, v18
    v_and_b32 v18, s63, v18
    v_lshlrev_b32 v31, 16, v22
    v_and_b32 v22, s63, v22
    v_mul_f32 v30, v30, v31
    v_mul_f32 v31, v18, v22
    v_cvt_pk_bf16_f32 v30, v30, v31
    v_and_b32 v31, s63, v30
    v_lshlrev_b32 v30, 16, v30
    v_add_f32 v26, v26, v30
    v_add_f32 v26, v26, v31
    v_lshlrev_b32 v30, 16, v19
    v_and_b32 v19, s63, v19
    v_lshlrev_b32 v31, 16, v23
    v_and_b32 v23, s63, v23
    v_mul_f32 v30, v30, v31
    v_mul_f32 v31, v19, v23
    v_cvt_pk_bf16_f32 v30, v30, v31
    v_and_b32 v31, s63, v30
    v_lshlrev_b32 v30, 16, v30
    v_add_f32 v26, v26, v30
    v_add_f32 v26, v26, v31
    s_nop 1
    v_add_f32_dpp v26, v26, v26 row_ror:8 row_mask:0xf bank_mask:0xf
    s_nop 1
    v_add_f32_dpp v26, v26, v26 row_ror:4 row_mask:0xf bank_mask:0xf
    s_nop 1
    v_add_f32_dpp v26, v26, v26 row_ror:2 row_mask:0xf bank_mask:0xf
    s_nop 1
    v_add_f32_dpp v26, v26, v26 row_ror:1 row_mask:0xf bank_mask:0xf
    s_nop 1
    v_readlane_b32 s60, v26, 0
    v_readlane_b32 s61, v26, 16
    v_readlane_b32 s62, v26, 32
    v_readlane_b32 s63, v26, 48
    s_nop 1
    v_mov_b32 v26, s60
    v_add_f32 v26, s61, v26
    v_add_f32 v26, s62, v26
    v_add_f32 v26, s63, v26
    v_cvt_pk_bf16_f32 v26, v26, v26
    v_lshlrev_b32 v26, 16, v26
    v_mul_f32 v26, 0xbfb8aa3b, v26
    v_exp_f32 v26, v26
    s_nop 0
    v_add_f32 v26, 1.0, v26
    v_rcp_f32 v26, v26
    s_nop 0
    v_cvt_pk_bf16_f32 v26, v26, v26
    v_lshlrev_b32 v26, 16, v26
    s_mov_b32 s72, s22
    s_and_b32 s73, s23, 0xffff
    s_mov_b32 s74, 0x100
    s_mov_b32 s75, 0x00020000
    buffer_load_dword v16, v24, s[72:75], 0 offen sc1
    s_waitcnt vmcnt(5) lgkmcnt(0)
    s_barrier
    v_add_u32 v2, 0x10000, v2
    v_add_u32 v3, 0x10000, v3
    v_add_u32 v4, 0x10000, v4
    v_add_u32 v5, 0x10000, v5
    v_add_u32 v6, 0x10000, v6
    ds_read_b128 v[192:195], v2 offset:0
    ds_read_b64_tr_b16 v[32:33], v6 offset:0
    ds_read_b64_tr_b16 v[34:35], v6 offset:768
    v_mfma_f32_32x32x16_bf16 v[128:143], v[48:51], v[184:187], v[128:143]
    ds_read_b128 v[196:199], v3 offset:0
    ds_read_b64_tr_b16 v[40:41], v6 offset:3072
    ds_read_b64_tr_b16 v[42:43], v6 offset:3840
    v_mfma_f32_32x32x16_bf16 v[128:143], v[56:59], v[188:191], v[128:143]
    ds_read_b128 v[200:203], v4 offset:0
    ds_read_b64_tr_b16 v[48:49], v6 offset:6144
    ds_read_b64_tr_b16 v[50:51], v6 offset:6912
    ds_read_b128 v[204:207], v5 offset:0
    ds_read_b64_tr_b16 v[56:57], v6 offset:9216
    ds_read_b64_tr_b16 v[58:59], v6 offset:9984
    s_add_u32 s19, s3, 4
    s_and_b32 s19, s19, 7
    s_lshl_b32 s15, s19, 7
    s_add_u32 s15, s15, s54
    s_mul_i32 s19, s19, 196608
    s_add_u32 m0, s57, 131072
    s_add_u32 s60, s15, 0
    buffer_load_dwordx4 v11, s[32:35], s60 offen lds
    s_add_u32 m0, s57, 132096
    s_add_u32 s60, s15, 8192
    buffer_load_dwordx4 v12, s[32:35], s60 offen lds
    s_add_u32 m0, s58, 148480
    s_add_u32 s60, s55, s19
    buffer_load_dwordx4 v14, s[36:39], s60 offen lds
    s_waitcnt lgkmcnt(9)
    v_mfma_f32_32x32x16_bf16 v[128:143], v[32:35], v[192:195], v[128:143]
    s_waitcnt lgkmcnt(6)
    v_mfma_f32_32x32x16_bf16 v[128:143], v[40:43], v[196:199], v[128:143]
    s_add_u32 m0, s58, 149504
    s_add_u32 s60, s55, s19
    buffer_load_dwordx4 v15, s[36:39], s60 offen lds
    s_waitcnt vmcnt(5) lgkmcnt(0)
    s_barrier
    ds_read_b128 v[208:211], v2 offset:32768
    ds_read_b64_tr_b16 v[32:33], v6 offset:32768
    ds_read_b64_tr_b16 v[34:35], v6 offset:33536
    v_mfma_f32_32x32x16_bf16 v[128:143], v[48:51], v[200:203], v[128:143]
    ds_read_b128 v[212:215], v3 offset:32768
    ds_read_b64_tr_b16 v[40:41], v6 offset:35840
    ds_read_b64_tr_b16 v[42:43], v6 offset:36608
    v_mfma_f32_32x32x16_bf16 v[128:143], v[56:59], v[204:207], v[128:143]
    ds_read_b128 v[216:219], v4 offset:32768
    ds_read_b64_tr_b16 v[48:49], v6 offset:38912
    ds_read_b64_tr_b16 v[50:51], v6 offset:39680
    ds_read_b128 v[220:223], v5 offset:32768
    ds_read_b64_tr_b16 v[56:57], v6 offset:41984
    ds_read_b64_tr_b16 v[58:59], v6 offset:42752
    s_add_u32 s19, s3, 5
    s_and_b32 s19, s19, 7
    s_lshl_b32 s15, s19, 7
    s_add_u32 s15, s15, s54
    s_mul_i32 s19, s19, 196608
    s_add_u32 m0, s57, 0
    s_add_u32 s60, s15, 0
    buffer_load_dwordx4 v11, s[32:35], s60 offen lds
    s_add_u32 m0, s57, 1024
    s_add_u32 s60, s15, 8192
    buffer_load_dwordx4 v12, s[32:35], s60 offen lds
    s_add_u32 m0, s58, 17408
    s_add_u32 s60, s55, s19
    buffer_load_dwordx4 v14, s[36:39], s60 offen lds
    s_waitcnt lgkmcnt(9)
    v_mfma_f32_32x32x16_bf16 v[128:143], v[32:35], v[208:211], v[128:143]
    s_waitcnt lgkmcnt(6)
    v_mfma_f32_32x32x16_bf16 v[128:143], v[40:43], v[212:215], v[128:143]
    s_add_u32 m0, s58, 18432
    s_add_u32 s60, s55, s19
    buffer_load_dwordx4 v15, s[36:39], s60 offen lds
    s_waitcnt vmcnt(4) lgkmcnt(0)
    s_barrier
    v_add_u32 v2, 0x10000, v2
    v_add_u32 v3, 0x10000, v3
    v_add_u32 v4, 0x10000, v4
    v_add_u32 v5, 0x10000, v5
    v_add_u32 v6, 0x10000, v6
    ds_read_b128 v[224:227], v2 offset:0
    ds_read_b64_tr_b16 v[32:33], v6 offset:0
    ds_read_b64_tr_b16 v[34:35], v6 offset:768
    v_mfma_f32_32x32x16_bf16 v[128:143], v[48:51], v[216:219], v[128:143]
    ds_read_b128 v[228:231], v3 offset:0
    ds_read_b64_tr_b16 v[40:41], v6 offset:3072
    ds_read_b64_tr_b16 v[42:43], v6 offset:3840
    v_mfma_f32_32x32x16_bf16 v[128:143], v[56:59], v[220:223], v[128:143]
    ds_read_b128 v[232:235], v4 offset:0
    ds_read_b64_tr_b16 v[48:49], v6 offset:6144
    ds_read_b64_tr_b16 v[50:51], v6 offset:6912
    ds_read_b128 v[236:239], v5 offset:0
    ds_read_b64_tr_b16 v[56:57], v6 offset:9216
    ds_read_b64_tr_b16 v[58:59], v6 offset:9984
    s_add_u32 s19, s3, 6
    s_and_b32 s19, s19, 7
    s_lshl_b32 s15, s19, 7
    s_add_u32 s15, s15, s54
    s_mul_i32 s19, s19, 196608
    s_add_u32 m0, s57, 32768
    s_add_u32 s60, s15, 0
    buffer_load_dwordx4 v11, s[32:35], s60 offen lds
    s_add_u32 m0, s57, 33792
    s_add_u32 s60, s15, 8192
    buffer_load_dwordx4 v12, s[32:35], s60 offen lds
    s_add_u32 m0, s58, 50176
    s_add_u32 s60, s55, s19
    buffer_load_dwordx4 v14, s[36:39], s60 offen lds
    s_waitcnt lgkmcnt(9)
    v_mfma_f32_32x32x16_bf16 v[128:143], v[32:35], v[224:227], v[128:143]
    s_waitcnt lgkmcnt(6)
    v_mfma_f32_32x32x16_bf16 v[128:143], v[40:43], v[228:231], v[128:143]
    s_add_u32 m0, s58, 51200
    s_add_u32 s60, s55, s19
    buffer_load_dwordx4 v15, s[36:39], s60 offen lds
    s_waitcnt vmcnt(4) lgkmcnt(0)
    s_barrier
    v_add_u32 v2, 0xfffe0000, v2
    v_add_u32 v3, 0xfffe0000, v3
    v_add_u32 v4, 0xfffe0000, v4
    v_add_u32 v5, 0xfffe0000, v5
    v_add_u32 v6, 0xfffe0000, v6
    ds_read_b128 v[240:243], v2 offset:0
    ds_read_b64_tr_b16 v[32:33], v6 offset:0
    ds_read_b64_tr_b16 v[34:35], v6 offset:768
    v_mfma_f32_32x32x16_bf16 v[128:143], v[48:51], v[232:235], v[128:143]
    ds_read_b128 v[244:247], v3 offset:0
    ds_read_b64_tr_b16 v[40:41], v6 offset:3072
    ds_read_b64_tr_b16 v[42:43], v6 offset:3840
    v_mfma_f32_32x32x16_bf16 v[128:143], v[56:59], v[236:239], v[128:143]
    ds_read_b128 v[248:251], v4 offset:0
    ds_read_b64_tr_b16 v[48:49], v6 offset:6144
    ds_read_b64_tr_b16 v[50:51], v6 offset:6912
    ds_read_b128 v[252:255], v5 offset:0
    ds_read_b64_tr_b16 v[56:57], v6 offset:9216
    ds_read_b64_tr_b16 v[58:59], v6 offset:9984
    s_add_u32 s19, s3, 7
    s_and_b32 s19, s19, 7
    s_lshl_b32 s15, s19, 7
    s_add_u32 s15, s15, s54
    s_mul_i32 s19, s19, 196608
    s_add_u32 m0, s57, 65536
    s_add_u32 s60, s15, 0
    buffer_load_dwordx4 v11, s[32:35], s60 offen lds
    s_add_u32 m0, s57, 66560
    s_add_u32 s60, s15, 8192
    buffer_load_dwordx4 v12, s[32:35], s60 offen lds
    s_add_u32 m0, s58, 82944
    s_add_u32 s60, s55, s19
    buffer_load_dwordx4 v14, s[36:39], s60 offen lds
    s_waitcnt lgkmcnt(9)
    v_mfma_f32_32x32x16_bf16 v[128:143], v[32:35], v[240:243], v[128:143]
    s_waitcnt lgkmcnt(6)
    v_mfma_f32_32x32x16_bf16 v[128:143], v[40:43], v[244:247], v[128:143]
    s_add_u32 m0, s58, 83968
    s_add_u32 s60, s55, s19
    buffer_load_dwordx4 v15, s[36:39], s60 offen lds
    s_waitcnt vmcnt(4) lgkmcnt(0)
    s_barrier
    ds_read_b128 v[160:163], v2 offset:32768
    ds_read_b64_tr_b16 v[32:33], v6 offset:32768
    ds_read_b64_tr_b16 v[34:35], v6 offset:33536
    v_mfma_f32_32x32x16_bf16 v[128:143], v[48:51], v[248:251], v[128:143]
    ds_read_b128 v[164:167], v3 offset:32768
    ds_read_b64_tr_b16 v[40:41], v6 offset:35840
    ds_read_b64_tr_b16 v[42:43], v6 offset:36608
    v_mfma_f32_32x32x16_bf16 v[128:143], v[56:59], v[252:255], v[128:143]
    ds_read_b128 v[168:171], v4 offset:32768
    ds_read_b64_tr_b16 v[48:49], v6 offset:38912
    ds_read_b64_tr_b16 v[50:51], v6 offset:39680
    ds_read_b128 v[172:175], v5 offset:32768
    ds_read_b64_tr_b16 v[56:57], v6 offset:41984
    ds_read_b64_tr_b16 v[58:59], v6 offset:42752
    s_waitcnt lgkmcnt(9)
    v_mfma_f32_32x32x16_bf16 v[128:143], v[32:35], v[160:163], v[128:143]
    s_waitcnt lgkmcnt(6)
    v_mfma_f32_32x32x16_bf16 v[128:143], v[40:43], v[164:167], v[128:143]
    v_readfirstlane_b32 s26, v25
    v_readfirstlane_b32 s60, v16
    s_nop 3
    s_mul_i32 s26, s26, 1664525
    s_add_u32 s26, s26, 1013904223
    s_or_b32 s26, s26, 1
    s_cmp_lg_u32 s60, 0
    s_cselect_b32 s26, s60, s26
    v_readfirstlane_b32 s22, v26
    s_waitcnt vmcnt(0) lgkmcnt(0)
    s_barrier
    v_add_u32 v2, 0x10000, v2
    v_add_u32 v3, 0x10000, v3
    v_add_u32 v4, 0x10000, v4
    v_add_u32 v5, 0x10000, v5
    v_add_u32 v6, 0x10000, v6
    ds_read_b128 v[176:179], v2 offset:0
    ds_read_b64_tr_b16 v[32:33], v6 offset:0
    ds_read_b64_tr_b16 v[34:35], v6 offset:768
    v_mfma_f32_32x32x16_bf16 v[128:143], v[48:51], v[168:171], v[128:143]
    ds_read_b128 v[180:183], v3 offset:0
    ds_read_b64_tr_b16 v[40:41], v6 offset:3072
    ds_read_b64_tr_b16 v[42:43], v6 offset:3840
    v_mfma_f32_32x32x16_bf16 v[128:143], v[56:59], v[172:175], v[128:143]
    ds_read_b128 v[184:187], v4 offset:0
    ds_read_b64_tr_b16 v[48:49], v6 offset:6144
    ds_read_b64_tr_b16 v[50:51], v6 offset:6912
    ds_read_b128 v[188:191], v5 offset:0
    ds_read_b64_tr_b16 v[56:57], v6 offset:9216
    ds_read_b64_tr_b16 v[58:59], v6 offset:9984
    s_waitcnt lgkmcnt(9)
    v_mfma_f32_32x32x16_bf16 v[128:143], v[32:35], v[176:179], v[128:143]
    s_waitcnt lgkmcnt(6)
    v_mfma_f32_32x32x16_bf16 v[128:143], v[40:43], v[180:183], v[128:143]
    s_waitcnt lgkmcnt(0)
    v_mfma_f32_32x32x16_bf16 v[128:143], v[48:51], v[184:187], v[128:143]
    v_mfma_f32_32x32x16_bf16 v[128:143], v[56:59], v[188:191], v[128:143]
    s_nop 7
    s_nop 3
    s_mul_i32 s60, s49, 3
    s_add_u32 s60, s60, 2
    s_and_b32 s61, s60, 15
    s_lshl_b32 s61, s61, 7
    s_lshl_b32 s62, s48, 2
    s_add_u32 s62, s62, s51
    s_add_u32 s61, s61, s62
    s_lshl_b32 s62, s61, 10
    s_lshl_b32 s61, s61, 11
    s_add_u32 s61, s61, 0x200000
    s_cmp_lt_u32 s60, 16
    s_cselect_b32 s72, s62, s61
    s_cselect_b32 s62, 1, 2
    s_cselect_b32 s63, 0x3eb8aa3b, 1.0
    s_lshl_b32 s62, s62, 16
    s_add_u32 s73, s62, s72
    v_mul_f32 v128, s63, v128
    v_mul_f32 v129, s63, v129
    v_mul_f32 v130, s63, v130
    v_mul_f32 v131, s63, v131
    v_mul_f32 v132, s63, v132
    v_mul_f32 v133, s63, v133
    v_mul_f32 v134, s63, v134
    v_mul_f32 v135, s63, v135
    v_mul_f32 v136, s63, v136
    v_mul_f32 v137, s63, v137
    v_mul_f32 v138, s63, v138
    v_mul_f32 v139, s63, v139
    v_mul_f32 v140, s63, v140
    v_mul_f32 v141, s63, v141
    v_mul_f32 v142, s63, v142
    v_mul_f32 v143, s63, v143
    v_cvt_pk_bf16_f32 v128, v128, v129
    v_cvt_pk_bf16_f32 v129, v130, v131
    v_cvt_pk_bf16_f32 v130, v132, v133
    v_cvt_pk_bf16_f32 v131, v134, v135
    v_cvt_pk_bf16_f32 v132, v136, v137
    v_cvt_pk_bf16_f32 v133, v138, v139
    v_cvt_pk_bf16_f32 v134, v140, v141
    v_cvt_pk_bf16_f32 v135, v142, v143
    buffer_store_dwordx4 v[128:131], v1, s[28:31], s72 offen sc1
    buffer_store_dwordx4 v[132:135], v1, s[28:31], s73 offen sc1
    s_waitcnt vmcnt(0)
    s_barrier
    s_lshl_b32 s57, s69, 12
    s_add_u32 s57, s57, 0xfb0000
    s_lshr_b32 s60, s64, 1
    v_lshrrev_b32 v30, 4, v0
    v_add_u32 v30, 1, v30
    v_cmp_gt_u32 vcc, 3, v30
    s_nop 1
    v_cndmask_b32 v30, 0, v30, vcc
    v_lshlrev_b32 v30, 4, v30
    v_add_u32 v30, s60, v30
    v_mul_u32_u24 v30, 43691, v30
    v_lshrrev_b32 v30, 17, v30
    v_and_b32 v31, 15, v0
    s_lshl_b32 s61, s65, 1
    v_add_u32 v24, s61, v31
    v_cndmask_b32 v31, v24, v31, vcc
    v_lshl_add_u32 v30, v30, 4, v31
    v_lshlrev_b32 v30, 7, v30
    s_mov_b32 s60, 0xf10000
    s_mov_b32 exec_lo, 0xffffffff
    s_mov_b32 exec_hi, 0x3
    buffer_load_dword v31, v30, s[28:31], s60 offen sc1
    s_mov_b64 exec, -1
    s_mov_b32 s32, s16
    s_and_b32 s33, s17, 0xffff
    s_mov_b32 s34, 0x1c0000
    s_mov_b32 s35, 0x00020000
    s_mov_b32 s36, s8
    s_and_b32 s37, s9, 0xffff
    s_mov_b32 s38, 0x80000
    s_mov_b32 s39, 0x00020000
    s_mul_i32 s54, s52, 16640
    s_add_u32 s54, s54, 32768
    v_add_u32 v2, s54, v1
    v_lshrrev_b32 v236, 5, v0
    v_lshlrev_b32 v232, 8, v236
    v_and_b32 v233, 15, v0
    v_lshl_add_u32 v232, v233, 4, v232
    v_and_b32 v233, 11, v0
    v_cmp_eq_u32 vcc, 0, v233
    v_mov_b32 v234, 16
    s_nop 0
    v_cndmask_b32 v234, v234, 0, vcc
    v_add_u32 v235, 1024, v234
    v_add_u32 v234, 512, v234
    v_cndmask_b32 v3, v235, v232, s[0:1]
    v_cndmask_b32 v4, v234, v232, s[0:1]
    v_add_u32 v3, s54, v3
    v_add_u32 v4, s54, v4
    v_lshrrev_b32 v232, 3, v0
    v_lshlrev_b32 v232, 10, v232
    v_bfe_u32 v233, v0, 4, 1
    v_lshlrev_b32 v234, 2, v233
    v_and_b32 v235, 7, v0
    v_xor_b32 v234, v234, v235
    v_lshl_add_u32 v11, v234, 4, v232
    v_add_u32 v12, 7168, v11
    s_mul_i32 s54, s13, 114688
    v_add_u32 v13, s54, v1
    v_bfe_u32 v234, v0, 2, 2
    v_lshl_add_u32 v232, v236, 2, v234
    v_lshlrev_b32 v232, 7, v232
    v_lshrrev_b32 v234, 1, v234
    v_lshl_add_u32 v232, v234, 6, v232
    v_lshl_add_u32 v232, v233, 5, v232
    v_and_b32 v234, 3, v0
    v_lshl_add_u32 v232, v234, 3, v232
    s_lshl_b32 s54, s14, 5
    v_xor_b32 v232, s54, v232
    v_add_u32 v5, s11, v232
    v_xor_b32 v6, 64, v5
    s_mul_i32 s54, s27, 14
    s_add_u32 s55, s54, 13
    s_lshr_b32 s54, s54, 2
    s_lshr_b32 s55, s55, 2
    v_and_b32 v14, 7, v0
    v_add_u32 v14, s54, v14
    v_min_u32 v14, s55, v14
    v_bfe_u32 v232, v0, 3, 1
    s_lshl_b32 s54, s4, 1
    v_add_u32 v232, s54, v232
    v_lshl_add_u32 v14, v232, 5, v14
    v_lshlrev_b32 v14, 7, v14
    v_and_b32 v232, 31, v0
    v_mul_u32_u24 v232, 2080, v232
    v_lshrrev_b32 v233, 5, v0
    v_lshl_add_u32 v232, v233, 4, v232
    v_cmp_eq_u32 vcc, 0, v233
    v_mov_b32 v236, 0x3f803f80
    s_nop 0
    v_cndmask_b32 v236, 0, v236, vcc
    v_mov_b32 v237, v236
    v_mov_b32 v238, v236
    v_mov_b32 v239, v236
    ds_write_b128 v232, v[236:239] offset:34816
    s_mov_b32 s40, s20
    s_and_b32 s41, s21, 0xffff
    s_mov_b32 s42, 0x200000
    s_mov_b32 s43, 0x00020000
    s_lshl_b32 s72, s4, 1
    s_add_u32 s72, s72, s13
    s_lshl_b32 s73, s72, 5
    s_lshl_b32 s74, s14, 3
    s_add_u32 s73, s73, s74
    s_lshl_b32 s54, s73, 10
    s_add_u32 s54, s54, 0x600000
    s_add_u32 s55, s54, 4096
    s_lshl_b32 s56, s72, 15
    s_lshl_b32 s74, s5, 7
    s_add_u32 s56, s56, s74
    s_lshl_b32 s74, s14, 5
    s_add_u32 s56, s56, s74
    s_lshl_b32 s59, s72, 8
    s_add_u32 s59, s59, 0xf00000
    s_lshl_b32 s58, s65, 3
    s_lshl_b32 s73, s51, 1
    s_add_u32 s58, s58, s73
    s_add_u32 s58, s58, s52
    s_lshl_b32 s58, s58, 8
    s_add_u32 s58, s58, 0xf00000
    s_lshl_b32 s72, s14, 1
    s_lshr_b32 s73, s4, 2
    s_lshl_b32 s73, s73, 5
    s_add_u32 s72, s72, s73
    s_lshl_b32 s73, s69, 3
    s_add_u32 s73, s73, 0xf00000
    s_xor_b32 s60, s13, 1
    s_mul_i32 s60, s60, 114688
    v_add_u32 v7, s60, v1
    s_mul_i32 s60, s27, 2560
    s_add_u32 s60, s60, 99328
    v_add_u32 v8, s60, v1
    s_xor_b32 s60, s27, 4
    s_mul_i32 s60, s60, 2560
    s_add_u32 s60, s60, 99328
    v_add_u32 v9, s60, v1
    v_bfe_u32 v10, v0, 2, 1
    v_and_b32 v232, 3, v0
    v_lshl_add_u32 v10, v232, 3, v10
    v_add_u32 v10, s72, v10
    v_lshlrev_b32 v10, 7, v10
    s_waitcnt vmcnt(0)
    v_cmp_ne_u32 vcc, s26, v31
    s_and_b32 vcc_lo, vcc_lo, 0xffffffff
    s_and_b32 vcc_hi, vcc_hi, 0x3
    s_or_b32 s60, vcc_lo, vcc_hi
    s_cbranch_scc0 FOK_15
    s_mov_b32 s60, 0xf10000
    s_mov_b32 s61, 0x80000
    s_mov_b32 exec_lo, 0xffffffff
    s_mov_b32 exec_hi, 0x3
POLL_16:
    buffer_load_dword v31, v30, s[28:31], s60 offen sc1
    s_waitcnt vmcnt(0)
    v_cmp_ne_u32 vcc, s26, v31
    s_cbranch_vccz POLLD_17
    s_mov_b64 exec, vcc
    s_sub_u32 s61, s61, 1
    s_cbranch_scc0 POLL_16
POLLD_17:
    s_mov_b64 exec, -1
FOK_15:
    s_xor_b32 s60, s68, 1024
    buffer_load_dwordx4 v[16:19], v1, s[28:31], s60 offen sc1
    buffer_load_dwordx4 v[20:23], v1, s[28:31], s68 offen sc1
    s_lshl_b32 s60, s64, 17
    s_add_u32 s60, s60, 0x200000
    buffer_load_dwordx4 v[224:227], v1, s[28:31], s60 offen sc1
    s_add_u32 m0, s67, 0
    s_nop 0
    buffer_load_dwordx4 v1, s[28:31], s66 offen sc1 lds
    buffer_load_dwordx4 v1, s[28:31], s66 offen offset:1024 sc1 lds
    s_add_u32 m0, s67, 8320
    s_add_u32 s66, s66, 8192
    buffer_load_dwordx4 v1, s[28:31], s66 offen sc1 lds
    buffer_load_dwordx4 v1, s[28:31], s66 offen offset:1024 sc1 lds
    s_add_u32 s66, s66, 8192
    s_waitcnt vmcnt(0) lgkmcnt(0)
    s_barrier
    v_mfma_f32_32x32x16_bf16 v[128:143], v[224:227], v[16:19], 0
    v_mfma_f32_32x32x16_bf16 v[144:159], v[224:227], v[20:23], 0
    s_nop 7
    s_nop 7
    v_max3_f32 v232, v128, v129, v130
    v_max3_f32 v232, v232, v131, v132
    v_max3_f32 v232, v232, v133, v134
    v_max3_f32 v232, v232, v135, v136
    v_max3_f32 v232, v232, v137, v138
    v_max3_f32 v232, v232, v139, v140
    v_max3_f32 v232, v232, v141, v142
    v_max_f32 v232, v232, v143
    v_mov_b32 v234, v232
    s_nop 1
    v_permlane32_swap_b32 v232, v234
    s_nop 1
    v_max_f32 v232, v232, v234
    v_max3_f32 v233, v144, v145, v146
    v_max3_f32 v233, v233, v147, v148
    v_max3_f32 v233, v233, v149, v150
    v_max3_f32 v233, v233, v151, v152
    v_max3_f32 v233, v233, v153, v154
    v_max3_f32 v233, v233, v155, v156
    v_max3_f32 v233, v233, v157, v158
    v_max_f32 v233, v233, v159
    v_mov_b32 v234, v233
    s_nop 1
    v_permlane32_swap_b32 v233, v234
    s_nop 1
    v_max_f32 v233, v233, v234
    v_min_f32 v232, v232, v233
    v_sub_f32 v240, 0, v232
    v_sub_f32 v241, 0, v232
    v_sub_f32 v242, 0, v232
    v_sub_f32 v243, 0, v232
    v_sub_f32 v244, 0, v232
    v_sub_f32 v245, 0, v232
    v_sub_f32 v246, 0, v232
    v_sub_f32 v247, 0, v232
    v_sub_f32 v248, 0, v232
    v_sub_f32 v249, 0, v232
    v_sub_f32 v250, 0, v232
    v_sub_f32 v251, 0, v232
    v_sub_f32 v252, 0, v232
    v_sub_f32 v253, 0, v232
    v_sub_f32 v254, 0, v232
    v_sub_f32 v255, 0, v232
    ds_read_b128 v[24:27], v2 offset:0
    ds_read_b128 v[208:211], v3 offset:1024
    ds_read_b128 v[212:215], v4 offset:1536
    s_waitcnt lgkmcnt(2)
    v_mfma_f32_32x32x16_bf16 v[128:143], v[24:27], v[16:19], v[240:255]
    s_add_u32 m0, s67, 33280
    s_nop 0
    buffer_load_dwordx4 v1, s[28:31], s66 offen sc1 lds
    buffer_load_dwordx4 v1, s[28:31], s66 offen offset:1024 sc1 lds
    s_add_u32 m0, s67, 41600
    s_add_u32 s66, s66, 8192
    buffer_load_dwordx4 v1, s[28:31], s66 offen sc1 lds
    buffer_load_dwordx4 v1, s[28:31], s66 offen offset:1024 sc1 lds
    s_add_u32 s66, s66, 8192
    s_waitcnt vmcnt(0)
    s_branch ATTN
CLS1:
    s_add_u32 s19, s3, 1
    s_and_b32 s19, s19, 7
    s_lshl_b32 s15, s19, 7
    s_add_u32 s15, s15, s54
    s_mul_i32 s19, s19, 196608
    s_add_u32 m0, s57, 32768
    s_add_u32 s60, s15, 0
    buffer_load_dwordx4 v11, s[32:35], s60 offen lds
    s_add_u32 m0, s57, 33792
    s_add_u32 s60, s15, 8192
    buffer_load_dwordx4 v12, s[32:35], s60 offen lds
    s_add_u32 m0, s58, 49152
    s_add_u32 s60, s55, s19
    buffer_load_dwordx4 v13, s[36:39], s60 offen lds
    v_mov_b32 v24, 0
    s_mov_b32 s60, 0xf04000
    buffer_load_dword v25, v24, s[28:31], s60 offen sc1
    s_lshl_b32 s60, s69, 10
    buffer_load_dwordx4 v[16:19], v1, s[72:75], 0 offen
    buffer_load_dwordx4 v[20:23], v1, s[32:35], s60 offen
    s_and_b32 s60, s2, 7
    s_lshr_b32 s61, s2, 3
    s_lshl_b32 s4, s60, 2
    s_and_b32 s60, s61, 3
    s_add_u32 s4, s4, s60
    s_lshr_b32 s5, s61, 2
    s_mov_b32 s0, 0xffff
    s_mov_b32 s1, 0xffff
    s_and_b32 s13, s27, 1
    s_lshr_b32 s14, s27, 1
    s_mul_i32 s60, s4, 224
    s_mul_i32 s61, s27, 14
    s_add_u32 s60, s60, s61
    s_lshl_b32 s6, s60, 10
    s_add_u32 s6, s6, 0x800000
    s_lshl_b32 s7, s61, 14
    s_lshl_b32 s60, s5, 7
    s_add_u32 s7, s7, s60
    s_lshl_b32 s10, s27, 16
    s_add_u32 s10, s10, s60
    s_lshl_b32 s11, s51, 13
    s_lshl_b32 s60, s52, 17
    s_add_u32 s11, s11, s60
    s_lshl_b32 s60, s48, 2
    s_add_u32 s60, s60, s51
    s_lshl_b32 s60, s60, 5
    s_lshl_b32 s61, s50, 1
    s_add_u32 s60, s60, s61
    s_add_u32 s60, s60, s52
    s_lshl_b32 s60, s60, 7
    s_add_u32 s12, s60, 0xf70000
    s_lshl_b32 s60, s65, 3
    s_lshl_b32 s61, s51, 1
    s_add_u32 s60, s60, s61
    s_add_u32 s60, s60, s52
    s_lshl_b32 s60, s60, 5
    s_add_u32 s60, s60, s64
    s_lshl_b32 s18, s60, 10
    s_add_u32 s18, s18, 0x600000
    v_and_b32 v30, 31, v0
    v_lshrrev_b32 v31, 5, v0
    v_bfe_u32 v32, v0, 1, 3
    v_xor_b32 v32, v32, v31
    s_lshl_b32 s60, s51, 12
    v_lshlrev_b32 v33, 7, v30
    v_add_u32 v33, s60, v33
    v_xor_b32 v34, 0, v32
    v_lshl_add_u32 v2, v34, 4, v33
    v_xor_b32 v34, 2, v32
    v_lshl_add_u32 v3, v34, 4, v33
    v_xor_b32 v34, 4, v32
    v_lshl_add_u32 v4, v34, 4, v33
    v_xor_b32 v34, 6, v32
    v_lshl_add_u32 v5, v34, 4, v33
    v_bfe_u32 v32, v0, 2, 2
    v_lshl_add_u32 v33, v31, 3, v32
    v_mul_u32_u24 v34, 192, v33
    v_bfe_u32 v35, v0, 4, 1
    v_lshl_add_u32 v34, v35, 5, v34
    v_and_b32 v36, 3, v0
    v_lshl_add_u32 v34, v36, 3, v34
    v_add_u32 v6, 16384, v34
    v_lshlrev_b32 v33, 8, v33
    v_lshl_add_u32 v33, v35, 14, v33
    v_lshl_add_u32 v33, v36, 3, v33
    v_bfe_u32 v32, v0, 2, 3
    v_xor_b32 v34, 0, v32
    v_lshl_add_u32 v7, v34, 5, v33
    v_xor_b32 v34, 1, v32
    v_lshl_add_u32 v8, v34, 5, v33
    v_xor_b32 v34, 2, v32
    v_lshl_add_u32 v9, v34, 5, v33
    v_xor_b32 v34, 3, v32
    v_lshl_add_u32 v10, v34, 5, v33
    s_waitcnt vmcnt(6)
    s_barrier
    ds_read_b128 v[160:163], v2 offset:0
    ds_read_b64_tr_b16 v[32:33], v6 offset:0
    ds_read_b64_tr_b16 v[34:35], v6 offset:768
    ds_read_b64_tr_b16 v[36:37], v6 offset:64
    ds_read_b64_tr_b16 v[38:39], v6 offset:832
    ds_read_b128 v[164:167], v3 offset:0
    ds_read_b64_tr_b16 v[40:41], v6 offset:3072
    ds_read_b64_tr_b16 v[42:43], v6 offset:3840
    ds_read_b64_tr_b16 v[44:45], v6 offset:3136
    ds_read_b64_tr_b16 v[46:47], v6 offset:3904
    ds_read_b128 v[168:171], v4 offset:0
    ds_read_b64_tr_b16 v[48:49], v6 offset:6144
    ds_read_b64_tr_b16 v[50:51], v6 offset:6912
    ds_read_b64_tr_b16 v[52:53], v6 offset:6208
    ds_read_b64_tr_b16 v[54:55], v6 offset:6976
    s_waitcnt lgkmcnt(10)
    ds_read_b128 v[172:175], v5 offset:0
    ds_read_b64_tr_b16 v[56:57], v6 offset:9216
    ds_read_b64_tr_b16 v[58:59], v6 offset:9984
    ds_read_b64_tr_b16 v[60:61], v6 offset:9280
    ds_read_b64_tr_b16 v[62:63], v6 offset:10048
    s_add_u32 s19, s3, 2
    s_and_b32 s19, s19, 7
    s_lshl_b32 s15, s19, 7
    s_add_u32 s15, s15, s54
    s_mul_i32 s19, s19, 196608
    s_add_u32 m0, s57, 65536
    s_add_u32 s60, s15, 0
    buffer_load_dwordx4 v11, s[32:35], s60 offen lds
    s_add_u32 m0, s57, 66560
    s_add_u32 s60, s15, 8192
    buffer_load_dwordx4 v12, s[32:35], s60 offen lds
    s_add_u32 m0, s58, 81920
    s_add_u32 s60, s55, s19
    buffer_load_dwordx4 v13, s[36:39], s60 offen lds
    s_waitcnt lgkmcnt(15)
    v_mfma_f32_32x32x16_bf16 v[128:143], v[32:35], v[160:163], 0
    v_mfma_f32_32x32x16_bf16 v[144:159], v[36:39], v[160:163], 0
    s_waitcnt lgkmcnt(10)
    v_mfma_f32_32x32x16_bf16 v[128:143], v[40:43], v[164:167], v[128:143]
    v_mfma_f32_32x32x16_bf16 v[144:159], v[44:47], v[164:167], v[144:159]
    s_waitcnt vmcnt(6) lgkmcnt(0)
    s_barrier
    ds_read_b128 v[176:179], v2 offset:32768
    ds_read_b64_tr_b16 v[32:33], v6 offset:32768
    ds_read_b64_tr_b16 v[34:35], v6 offset:33536
    ds_read_b64_tr_b16 v[36:37], v6 offset:32832
    ds_read_b64_tr_b16 v[38:39], v6 offset:33600
    v_mfma_f32_32x32x16_bf16 v[128:143], v[48:51], v[168:171], v[128:143]
    v_mfma_f32_32x32x16_bf16 v[144:159], v[52:55], v[168:171], v[144:159]
    ds_read_b128 v[180:183], v3 offset:32768
    ds_read_b64_tr_b16 v[40:41], v6 offset:35840
    ds_read_b64_tr_b16 v[42:43], v6 offset:36608
    ds_read_b64_tr_b16 v[44:45], v6 offset:35904
    ds_read_b64_tr_b16 v[46:47], v6 offset:36672
    v_mfma_f32_32x32x16_bf16 v[128:143], v[56:59], v[172:175], v[128:143]
    v_mfma_f32_32x32x16_bf16 v[144:159], v[60:63], v[172:175], v[144:159]
    ds_read_b128 v[184:187], v4 offset:32768
    ds_read_b64_tr_b16 v[48:49], v6 offset:38912
    ds_read_b64_tr_b16 v[50:51], v6 offset:39680
    ds_read_b64_tr_b16 v[52:53], v6 offset:38976
    ds_read_b64_tr_b16 v[54:55], v6 offset:39744
    s_waitcnt lgkmcnt(10)
    ds_read_b128 v[188:191], v5 offset:32768
    ds_read_b64_tr_b16 v[56:57], v6 offset:41984
    ds_read_b64_tr_b16 v[58:59], v6 offset:42752
    ds_read_b64_tr_b16 v[60:61], v6 offset:42048
    ds_read_b64_tr_b16 v[62:63], v6 offset:42816
    s_add_u32 s19, s3, 3
    s_and_b32 s19, s19, 7
    s_lshl_b32 s15, s19, 7
    s_add_u32 s15, s15, s54
    s_mul_i32 s19, s19, 196608
    s_add_u32 m0, s57, 98304
    s_add_u32 s60, s15, 0
    buffer_load_dwordx4 v11, s[32:35], s60 offen lds
    s_add_u32 m0, s57, 99328
    s_add_u32 s60, s15, 8192
    buffer_load_dwordx4 v12, s[32:35], s60 offen lds
    s_add_u32 m0, s58, 114688
    s_add_u32 s60, s55, s19
    buffer_load_dwordx4 v13, s[36:39], s60 offen lds
    s_waitcnt lgkmcnt(15)
    v_mfma_f32_32x32x16_bf16 v[128:143], v[32:35], v[176:179], v[128:143]
    v_mfma_f32_32x32x16_bf16 v[144:159], v[36:39], v[176:179], v[144:159]
    s_waitcnt vmcnt(6)
    s_mov_b32 s63, 0xffff0000
    v_lshlrev_b32 v30, 16, v16
    v_and_b32 v16, s63, v16
    v_lshlrev_b32 v31, 16, v20
    v_and_b32 v20, s63, v20
    v_mul_f32 v30, v30, v31
    v_mul_f32 v31, v16, v20
    v_cvt_pk_bf16_f32 v30, v30, v31
    v_and_b32 v31, s63, v30
    v_lshlrev_b32 v30, 16, v30
    v_add_f32 v26, v30, v31
    v_lshlrev_b32 v30, 16, v17
    v_and_b32 v17, s63, v17
    v_lshlrev_b32 v31, 16, v21
    v_and_b32 v21, s63, v21
    v_mul_f32 v30, v30, v31
    v_mul_f32 v31, v17, v21
    v_cvt_pk_bf16_f32 v30, v30, v31
    v_and_b32 v31, s63, v30
    v_lshlrev_b32 v30, 16, v30
    v_add_f32 v26, v26, v30
    v_add_f32 v26, v26, v31
    v_lshlrev_b32 v30, 16, v18
    v_and_b32 v18, s63, v18
    v_lshlrev_b32 v31, 16, v22
    v_and_b32 v22, s63, v22
    v_mul_f32 v30, v30, v31
    v_mul_f32 v31, v18, v22
    v_cvt_pk_bf16_f32 v30, v30, v31
    v_and_b32 v31, s63, v30
    v_lshlrev_b32 v30, 16, v30
    v_add_f32 v26, v26, v30
    v_add_f32 v26, v26, v31
    v_lshlrev_b32 v30, 16, v19
    v_and_b32 v19, s63, v19
    v_lshlrev_b32 v31, 16, v23
    v_and_b32 v23, s63, v23
    v_mul_f32 v30, v30, v31
    v_mul_f32 v31, v19, v23
    v_cvt_pk_bf16_f32 v30, v30, v31
    v_and_b32 v31, s63, v30
    v_lshlrev_b32 v30, 16, v30
    v_add_f32 v26, v26, v30
    v_add_f32 v26, v26, v31
    s_nop 1
    v_add_f32_dpp v26, v26, v26 row_ror:8 row_mask:0xf bank_mask:0xf
    s_nop 1
    v_add_f32_dpp v26, v26, v26 row_ror:4 row_mask:0xf bank_mask:0xf
    s_nop 1
    v_add_f32_dpp v26, v26, v26 row_ror:2 row_mask:0xf bank_mask:0xf
    s_nop 1
    v_add_f32_dpp v26, v26, v26 row_ror:1 row_mask:0xf bank_mask:0xf
    s_nop 1
    v_readlane_b32 s60, v26, 0
    v_readlane_b32 s61, v26, 16
    v_readlane_b32 s62, v26, 32
    v_readlane_b32 s63, v26, 48
    s_nop 1
    v_mov_b32 v26, s60
    v_add_f32 v26, s61, v26
    v_add_f32 v26, s62, v26
    v_add_f32 v26, s63, v26
    v_cvt_pk_bf16_f32 v26, v26, v26
    v_lshlrev_b32 v26, 16, v26
    v_mul_f32 v26, 0xbfb8aa3b, v26
    v_exp_f32 v26, v26
    s_nop 0
    v_add_f32 v26, 1.0, v26
    v_rcp_f32 v26, v26
    s_nop 0
    v_cvt_pk_bf16_f32 v26, v26, v26
    v_lshlrev_b32 v26, 16, v26
    s_mov_b32 s72, s22
    s_and_b32 s73, s23, 0xffff
    s_mov_b32 s74, 0x100
    s_mov_b32 s75, 0x00020000
    buffer_load_dword v16, v24, s[72:75], 0 offen sc1
    s_waitcnt lgkmcnt(10)
    v_mfma_f32_32x32x16_bf16 v[128:143], v[40:43], v[180:183], v[128:143]
    v_mfma_f32_32x32x16_bf16 v[144:159], v[44:47], v[180:183], v[144:159]
    s_waitcnt vmcnt(4) lgkmcnt(0)
    s_barrier
    v_add_u32 v2, 0x10000, v2
    v_add_u32 v3, 0x10000, v3
    v_add_u32 v4, 0x10000, v4
    v_add_u32 v5, 0x10000, v5
    v_add_u32 v6, 0x10000, v6
    ds_read_b128 v[192:195], v2 offset:0
    ds_read_b64_tr_b16 v[32:33], v6 offset:0
    ds_read_b64_tr_b16 v[34:35], v6 offset:768
    ds_read_b64_tr_b16 v[36:37], v6 offset:64
    ds_read_b64_tr_b16 v[38:39], v6 offset:832
    v_mfma_f32_32x32x16_bf16 v[128:143], v[48:51], v[184:187], v[128:143]
    v_mfma_f32_32x32x16_bf16 v[144:159], v[52:55], v[184:187], v[144:159]
    ds_read_b128 v[196:199], v3 offset:0
    ds_read_b64_tr_b16 v[40:41], v6 offset:3072
    ds_read_b64_tr_b16 v[42:43], v6 offset:3840
    ds_read_b64_tr_b16 v[44:45], v6 offset:3136
    ds_read_b64_tr_b16 v[46:47], v6 offset:3904
    v_mfma_f32_32x32x16_bf16 v[128:143], v[56:59], v[188:191], v[128:143]
    v_mfma_f32_32x32x16_bf16 v[144:159], v[60:63], v[188:191], v[144:159]
    ds_read_b128 v[200:203], v4 offset:0
    ds_read_b64_tr_b16 v[48:49], v6 offset:6144
    ds_read_b64_tr_b16 v[50:51], v6 offset:6912
    ds_read_b64_tr_b16 v[52:53], v6 offset:6208
    ds_read_b64_tr_b16 v[54:55], v6 offset:6976
    s_waitcnt lgkmcnt(10)
    ds_read_b128 v[204:207], v5 offset:0
    ds_read_b64_tr_b16 v[56:57], v6 offset:9216
    ds_read_b64_tr_b16 v[58:59], v6 offset:9984
    ds_read_b64_tr_b16 v[60:61], v6 offset:9280
    ds_read_b64_tr_b16 v[62:63], v6 offset:10048
    s_add_u32 s19, s3, 4
    s_and_b32 s19, s19, 7
    s_lshl_b32 s15, s19, 7
    s_add_u32 s15, s15, s54
    s_mul_i32 s19, s19, 196608
    s_add_u32 m0, s57, 131072
    s_add_u32 s60, s15, 0
    buffer_load_dwordx4 v11, s[32:35], s60 offen lds
    s_add_u32 m0, s57, 132096
    s_add_u32 s60, s15, 8192
    buffer_load_dwordx4 v12, s[32:35], s60 offen lds
    s_add_u32 m0, s58, 147456
    s_add_u32 s60, s55, s19
    buffer_load_dwordx4 v13, s[36:39], s60 offen lds
    s_waitcnt lgkmcnt(15)
    v_mfma_f32_32x32x16_bf16 v[128:143], v[32:35], v[192:195], v[128:143]
    v_mfma_f32_32x32x16_bf16 v[144:159], v[36:39], v[192:195], v[144:159]
    s_waitcnt lgkmcnt(10)
    v_mfma_f32_32x32x16_bf16 v[128:143], v[40:43], v[196:199], v[128:143]
    v_mfma_f32_32x32x16_bf16 v[144:159], v[44:47], v[196:199], v[144:159]
    s_waitcnt vmcnt(4) lgkmcnt(0)
    s_barrier
    ds_read_b128 v[208:211], v2 offset:32768
    ds_read_b64_tr_b16 v[32:33], v6 offset:32768
    ds_read_b64_tr_b16 v[34:35], v6 offset:33536
    ds_read_b64_tr_b16 v[36:37], v6 offset:32832
    ds_read_b64_tr_b16 v[38:39], v6 offset:33600
    v_mfma_f32_32x32x16_bf16 v[128:143], v[48:51], v[200:203], v[128:143]
    v_mfma_f32_32x32x16_bf16 v[144:159], v[52:55], v[200:203], v[144:159]
    ds_read_b128 v[212:215], v3 offset:32768
    ds_read_b64_tr_b16 v[40:41], v6 offset:35840
    ds_read_b64_tr_b16 v[42:43], v6 offset:36608
    ds_read_b64_tr_b16 v[44:45], v6 offset:35904
    ds_read_b64_tr_b16 v[46:47], v6 offset:36672
    v_mfma_f32_32x32x16_bf16 v[128:143], v[56:59], v[204:207], v[128:143]
    v_mfma_f32_32x32x16_bf16 v[144:159], v[60:63], v[204:207], v[144:159]
    ds_read_b128 v[216:219], v4 offset:32768
    ds_read_b64_tr_b16 v[48:49], v6 offset:38912
    ds_read_b64_tr_b16 v[50:51], v6 offset:39680
    ds_read_b64_tr_b16 v[52:53], v6 offset:38976
    ds_read_b64_tr_b16 v[54:55], v6 offset:39744
    s_waitcnt lgkmcnt(10)
    ds_read_b128 v[220:223], v5 offset:32768
    ds_read_b64_tr_b16 v[56:57], v6 offset:41984
    ds_read_b64_tr_b16 v[58:59], v6 offset:42752
    ds_read_b64_tr_b16 v[60:61], v6 offset:42048
    ds_read_b64_tr_b16 v[62:63], v6 offset:42816
    s_add_u32 s19, s3, 5
    s_and_b32 s19, s19, 7
    s_lshl_b32 s15, s19, 7
    s_add_u32 s15, s15, s54
    s_mul_i32 s19, s19, 196608
    s_add_u32 m0, s57, 0
    s_add_u32 s60, s15, 0
    buffer_load_dwordx4 v11, s[32:35], s60 offen lds
    s_add_u32 m0, s57, 1024
    s_add_u32 s60, s15, 8192
    buffer_load_dwordx4 v12, s[32:35], s60 offen lds
    s_add_u32 m0, s58, 16384
    s_add_u32 s60, s55, s19
    buffer_load_dwordx4 v13, s[36:39], s60 offen lds
    s_waitcnt lgkmcnt(15)
    v_mfma_f32_32x32x16_bf16 v[128:143], v[32:35], v[208:211], v[128:143]
    v_mfma_f32_32x32x16_bf16 v[144:159], v[36:39], v[208:211], v[144:159]
    s_waitcnt lgkmcnt(10)
    v_mfma_f32_32x32x16_bf16 v[128:143], v[40:43], v[212:215], v[128:143]
    v_mfma_f32_32x32x16_bf16 v[144:159], v[44:47], v[212:215], v[144:159]
    s_waitcnt vmcnt(3) lgkmcnt(0)
    s_barrier
    v_add_u32 v2, 0x10000, v2
    v_add_u32 v3, 0x10000, v3
    v_add_u32 v4, 0x10000, v4
    v_add_u32 v5, 0x10000, v5
    v_add_u32 v6, 0x10000, v6
    ds_read_b128 v[224:227], v2 offset:0
    ds_read_b64_tr_b16 v[32:33], v6 offset:0
    ds_read_b64_tr_b16 v[34:35], v6 offset:768
    ds_read_b64_tr_b16 v[36:37], v6 offset:64
    ds_read_b64_tr_b16 v[38:39], v6 offset:832
    v_mfma_f32_32x32x16_bf16 v[128:143], v[48:51], v[216:219], v[128:143]
    v_mfma_f32_32x32x16_bf16 v[144:159], v[52:55], v[216:219], v[144:159]
    ds_read_b128 v[228:231], v3 offset:0
    ds_read_b64_tr_b16 v[40:41], v6 offset:3072
    ds_read_b64_tr_b16 v[42:43], v6 offset:3840
    ds_read_b64_tr_b16 v[44:45], v6 offset:3136
    ds_read_b64_tr_b16 v[46:47], v6 offset:3904
    v_mfma_f32_32x32x16_bf16 v[128:143], v[56:59], v[220:223], v[128:143]
    v_mfma_f32_32x32x16_bf16 v[144:159], v[60:63], v[220:223], v[144:159]
    ds_read_b128 v[232:235], v4 offset:0
    ds_read_b64_tr_b16 v[48:49], v6 offset:6144
    ds_read_b64_tr_b16 v[50:51], v6 offset:6912
    ds_read_b64_tr_b16 v[52:53], v6 offset:6208
    ds_read_b64_tr_b16 v[54:55], v6 offset:6976
    s_waitcnt lgkmcnt(10)
    ds_read_b128 v[236:239], v5 offset:0
    ds_read_b64_tr_b16 v[56:57], v6 offset:9216
    ds_read_b64_tr_b16 v[58:59], v6 offset:9984
    ds_read_b64_tr_b16 v[60:61], v6 offset:9280
    ds_read_b64_tr_b16 v[62:63], v6 offset:10048
    s_add_u32 s19, s3, 6
    s_and_b32 s19, s19, 7
    s_lshl_b32 s15, s19, 7
    s_add_u32 s15, s15, s54
    s_mul_i32 s19, s19, 196608
    s_add_u32 m0, s57, 32768
    s_add_u32 s60, s15, 0
    buffer_load_dwordx4 v11, s[32:35], s60 offen lds
    s_add_u32 m0, s57, 33792
    s_add_u32 s60, s15, 8192
    buffer_load_dwordx4 v12, s[32:35], s60 offen lds
    s_add_u32 m0, s58, 49152
    s_add_u32 s60, s55, s19
    buffer_load_dwordx4 v13, s[36:39], s60 offen lds
    s_waitcnt lgkmcnt(15)
    v_mfma_f32_32x32x16_bf16 v[128:143], v[32:35], v[224:227], v[128:143]
    v_mfma_f32_32x32x16_bf16 v[144:159], v[36:39], v[224:227], v[144:159]
    s_waitcnt lgkmcnt(10)
    v_mfma_f32_32x32x16_bf16 v[128:143], v[40:43], v[228:231], v[128:143]
    v_mfma_f32_32x32x16_bf16 v[144:159], v[44:47], v[228:231], v[144:159]
    s_waitcnt vmcnt(3) lgkmcnt(0)
    s_barrier
    v_add_u32 v2, 0xfffe0000, v2
    v_add_u32 v3, 0xfffe0000, v3
    v_add_u32 v4, 0xfffe0000, v4
    v_add_u32 v5, 0xfffe0000, v5
    v_add_u32 v6, 0xfffe0000, v6
    ds_read_b128 v[240:243], v2 offset:0
    ds_read_b64_tr_b16 v[32:33], v6 offset:0
    ds_read_b64_tr_b16 v[34:35], v6 offset:768
    ds_read_b64_tr_b16 v[36:37], v6 offset:64
    ds_read_b64_tr_b16 v[38:39], v6 offset:832
    v_mfma_f32_32x32x16_bf16 v[128:143], v[48:51], v[232:235], v[128:143]
    v_mfma_f32_32x32x16_bf16 v[144:159], v[52:55], v[232:235], v[144:159]
    ds_read_b128 v[244:247], v3 offset:0
    ds_read_b64_tr_b16 v[40:41], v6 offset:3072
    ds_read_b64_tr_b16 v[42:43], v6 offset:3840
    ds_read_b64_tr_b16 v[44:45], v6 offset:3136
    ds_read_b64_tr_b16 v[46:47], v6 offset:3904
    v_mfma_f32_32x32x16_bf16 v[128:143], v[56:59], v[236:239], v[128:143]
    v_mfma_f32_32x32x16_bf16 v[144:159], v[60:63], v[236:239], v[144:159]
    ds_read_b128 v[248:251], v4 offset:0
    ds_read_b64_tr_b16 v[48:49], v6 offset:6144
    ds_read_b64_tr_b16 v[50:51], v6 offset:6912
    ds_read_b64_tr_b16 v[52:53], v6 offset:6208
    ds_read_b64_tr_b16 v[54:55], v6 offset:6976
    s_waitcnt lgkmcnt(10)
    ds_read_b128 v[252:255], v5 offset:0
    ds_read_b64_tr_b16 v[56:57], v6 offset:9216
    ds_read_b64_tr_b16 v[58:59], v6 offset:9984
    ds_read_b64_tr_b16 v[60:61], v6 offset:9280
    ds_read_b64_tr_b16 v[62:63], v6 offset:10048
    s_add_u32 s19, s3, 7
    s_and_b32 s19, s19, 7
    s_lshl_b32 s15, s19, 7
    s_add_u32 s15, s15, s54
    s_mul_i32 s19, s19, 196608
    s_add_u32 m0, s57, 65536
    s_add_u32 s60, s15, 0
    buffer_load_dwordx4 v11, s[32:35], s60 offen lds
    s_add_u32 m0, s57, 66560
    s_add_u32 s60, s15, 8192
    buffer_load_dwordx4 v12, s[32:35], s60 offen lds
    s_add_u32 m0, s58, 81920
    s_add_u32 s60, s55, s19
    buffer_load_dwordx4 v13, s[36:39], s60 offen lds
    s_waitcnt lgkmcnt(15)
    v_mfma_f32_32x32x16_bf16 v[128:143], v[32:35], v[240:243], v[128:143]
    v_mfma_f32_32x32x16_bf16 v[144:159], v[36:39], v[240:243], v[144:159]
    s_waitcnt lgkmcnt(10)
    v_mfma_f32_32x32x16_bf16 v[128:143], v[40:43], v[244:247], v[128:143]
    v_mfma_f32_32x32x16_bf16 v[144:159], v[44:47], v[244:247], v[144:159]
    s_waitcnt vmcnt(3) lgkmcnt(0)
    s_barrier
    ds_read_b128 v[160:163], v2 offset:32768
    ds_read_b64_tr_b16 v[32:33], v6 offset:32768
    ds_read_b64_tr_b16 v[34:35], v6 offset:33536
    ds_read_b64_tr_b16 v[36:37], v6 offset:32832
    ds_read_b64_tr_b16 v[38:39], v6 offset:33600
    v_mfma_f32_32x32x16_bf16 v[128:143], v[48:51], v[248:251], v[128:143]
    v_mfma_f32_32x32x16_bf16 v[144:159], v[52:55], v[248:251], v[144:159]
    ds_read_b128 v[164:167], v3 offset:32768
    ds_read_b64_tr_b16 v[40:41], v6 offset:35840
    ds_read_b64_tr_b16 v[42:43], v6 offset:36608
    ds_read_b64_tr_b16 v[44:45], v6 offset:35904
    ds_read_b64_tr_b16 v[46:47], v6 offset:36672
    v_mfma_f32_32x32x16_bf16 v[128:143], v[56:59], v[252:255], v[128:143]
    v_mfma_f32_32x32x16_bf16 v[144:159], v[60:63], v[252:255], v[144:159]
    ds_read_b128 v[168:171], v4 offset:32768
    ds_read_b64_tr_b16 v[48:49], v6 offset:38912
    ds_read_b64_tr_b16 v[50:51], v6 offset:39680
    ds_read_b64_tr_b16 v[52:53], v6 offset:38976
    ds_read_b64_tr_b16 v[54:55], v6 offset:39744
    s_waitcnt lgkmcnt(10)
    ds_read_b128 v[172:175], v5 offset:32768
    ds_read_b64_tr_b16 v[56:57], v6 offset:41984
    ds_read_b64_tr_b16 v[58:59], v6 offset:42752
    ds_read_b64_tr_b16 v[60:61], v6 offset:42048
    ds_read_b64_tr_b16 v[62:63], v6 offset:42816
    s_waitcnt lgkmcnt(15)
    v_mfma_f32_32x32x16_bf16 v[128:143], v[32:35], v[160:163], v[128:143]
    v_mfma_f32_32x32x16_bf16 v[144:159], v[36:39], v[160:163], v[144:159]
    s_waitcnt lgkmcnt(10)
    v_mfma_f32_32x32x16_bf16 v[128:143], v[40:43], v[164:167], v[128:143]
    v_mfma_f32_32x32x16_bf16 v[144:159], v[44:47], v[164:167], v[144:159]
    v_readfirstlane_b32 s26, v25
    v_readfirstlane_b32 s60, v16
    s_nop 3
    s_mul_i32 s26, s26, 1664525
    s_add_u32 s26, s26, 1013904223
    s_or_b32 s26, s26, 1
    s_cmp_lg_u32 s60, 0
    s_cselect_b32 s26, s60, s26
    v_readfirstlane_b32 s22, v26
    s_cmp_lg_u32 s69, 1793
    s_cbranch_scc1 NOUPD_18
    v_mov_b32 v30, s26
    s_mov_b32 s60, 0xf04000
    s_mov_b64 exec, 1
    buffer_store_dword v30, v24, s[72:75], 0 offen sc1
    s_waitcnt vmcnt(0)
    buffer_store_dword v30, v24, s[28:31], s60 offen sc1
    s_mov_b64 exec, -1
    s_waitcnt vmcnt(0)
NOUPD_18:
    s_waitcnt vmcnt(0) lgkmcnt(0)
    s_barrier
    v_add_u32 v2, 0x10000, v2
    v_add_u32 v3, 0x10000, v3
    v_add_u32 v4, 0x10000, v4
    v_add_u32 v5, 0x10000, v5
    v_add_u32 v6, 0x10000, v6
    ds_read_b128 v[176:179], v2 offset:0
    ds_read_b64_tr_b16 v[32:33], v6 offset:0
    ds_read_b64_tr_b16 v[34:35], v6 offset:768
    ds_read_b64_tr_b16 v[36:37], v6 offset:64
    ds_read_b64_tr_b16 v[38:39], v6 offset:832
    v_mfma_f32_32x32x16_bf16 v[128:143], v[48:51], v[168:171], v[128:143]
    v_mfma_f32_32x32x16_bf16 v[144:159], v[52:55], v[168:171], v[144:159]
    ds_read_b128 v[180:183], v3 offset:0
    ds_read_b64_tr_b16 v[40:41], v6 offset:3072
    ds_read_b64_tr_b16 v[42:43], v6 offset:3840
    ds_read_b64_tr_b16 v[44:45], v6 offset:3136
    ds_read_b64_tr_b16 v[46:47], v6 offset:3904
    v_mfma_f32_32x32x16_bf16 v[128:143], v[56:59], v[172:175], v[128:143]
    v_mfma_f32_32x32x16_bf16 v[144:159], v[60:63], v[172:175], v[144:159]
    ds_read_b128 v[184:187], v4 offset:0
    ds_read_b64_tr_b16 v[48:49], v6 offset:6144
    ds_read_b64_tr_b16 v[50:51], v6 offset:6912
    ds_read_b64_tr_b16 v[52:53], v6 offset:6208
    ds_read_b64_tr_b16 v[54:55], v6 offset:6976
    s_waitcnt lgkmcnt(10)
    ds_read_b128 v[188:191], v5 offset:0
    ds_read_b64_tr_b16 v[56:57], v6 offset:9216
    ds_read_b64_tr_b16 v[58:59], v6 offset:9984
    ds_read_b64_tr_b16 v[60:61], v6 offset:9280
    ds_read_b64_tr_b16 v[62:63], v6 offset:10048
    s_waitcnt lgkmcnt(15)
    v_mfma_f32_32x32x16_bf16 v[128:143], v[32:35], v[176:179], v[128:143]
    v_mfma_f32_32x32x16_bf16 v[144:159], v[36:39], v[176:179], v[144:159]
    s_waitcnt lgkmcnt(10)
    v_mfma_f32_32x32x16_bf16 v[128:143], v[40:43], v[180:183], v[128:143]
    v_mfma_f32_32x32x16_bf16 v[144:159], v[44:47], v[180:183], v[144:159]
    s_waitcnt lgkmcnt(0)
    v_mfma_f32_32x32x16_bf16 v[128:143], v[48:51], v[184:187], v[128:143]
    v_mfma_f32_32x32x16_bf16 v[144:159], v[52:55], v[184:187], v[144:159]
    v_mfma_f32_32x32x16_bf16 v[128:143], v[56:59], v[188:191], v[128:143]
    v_mfma_f32_32x32x16_bf16 v[144:159], v[60:63], v[188:191], v[144:159]
    s_nop 7
    s_nop 3
    s_mul_i32 s60, s49, 3
    s_add_u32 s60, s60, 0
    s_and_b32 s61, s60, 15
    s_lshl_b32 s61, s61, 7
    s_lshl_b32 s62, s48, 2
    s_add_u32 s62, s62, s51
    s_add_u32 s61, s61, s62
    s_lshl_b32 s62, s61, 10
    s_lshl_b32 s61, s61, 11
    s_add_u32 s61, s61, 0x200000
    s_cmp_lt_u32 s60, 16
    s_cselect_b32 s72, s62, s61
    s_cselect_b32 s62, 1, 2
    s_cselect_b32 s63, 0x3eb8aa3b, 1.0
    s_lshl_b32 s62, s62, 16
    s_add_u32 s73, s62, s72
    v_mul_f32 v128, s63, v128
    v_mul_f32 v129, s63, v129
    v_mul_f32 v130, s63, v130
    v_mul_f32 v131, s63, v131
    v_mul_f32 v132, s63, v132
    v_mul_f32 v133, s63, v133
    v_mul_f32 v134, s63, v134
    v_mul_f32 v135, s63, v135
    v_mul_f32 v136, s63, v136
    v_mul_f32 v137, s63, v137
    v_mul_f32 v138, s63, v138
    v_mul_f32 v139, s63, v139
    v_mul_f32 v140, s63, v140
    v_mul_f32 v141, s63, v141
    v_mul_f32 v142, s63, v142
    v_mul_f32 v143, s63, v143
    v_cvt_pk_bf16_f32 v128, v128, v129
    v_cvt_pk_bf16_f32 v129, v130, v131
    v_cvt_pk_bf16_f32 v130, v132, v133
    v_cvt_pk_bf16_f32 v131, v134, v135
    v_cvt_pk_bf16_f32 v132, v136, v137
    v_cvt_pk_bf16_f32 v133, v138, v139
    v_cvt_pk_bf16_f32 v134, v140, v141
    v_cvt_pk_bf16_f32 v135, v142, v143
    s_mul_i32 s60, s49, 3
    s_add_u32 s60, s60, 1
    s_and_b32 s61, s60, 15
    s_lshl_b32 s61, s61, 7
    s_lshl_b32 s62, s48, 2
    s_add_u32 s62, s62, s51
    s_add_u32 s61, s61, s62
    s_lshl_b32 s62, s61, 10
    s_lshl_b32 s61, s61, 11
    s_add_u32 s61, s61, 0x200000
    s_cmp_lt_u32 s60, 16
    s_cselect_b32 s74, s62, s61
    s_cselect_b32 s62, 1, 2
    s_cselect_b32 s63, 0x3eb8aa3b, 1.0
    s_lshl_b32 s62, s62, 16
    s_add_u32 s75, s62, s74
    v_mul_f32 v144, s63, v144
    v_mul_f32 v145, s63, v145
    v_mul_f32 v146, s63, v146
    v_mul_f32 v147, s63, v147
    v_mul_f32 v148, s63, v148
    v_mul_f32 v149, s63, v149
    v_mul_f32 v150, s63, v150
    v_mul_f32 v151, s63, v151
    v_mul_f32 v152, s63, v152
    v_mul_f32 v153, s63, v153
    v_mul_f32 v154, s63, v154
    v_mul_f32 v155, s63, v155
    v_mul_f32 v156, s63, v156
    v_mul_f32 v157, s63, v157
    v_mul_f32 v158, s63, v158
    v_mul_f32 v159, s63, v159
    v_cvt_pk_bf16_f32 v144, v144, v145
    v_cvt_pk_bf16_f32 v145, v146, v147
    v_cvt_pk_bf16_f32 v146, v148, v149
    v_cvt_pk_bf16_f32 v147, v150, v151
    v_cvt_pk_bf16_f32 v148, v152, v153
    v_cvt_pk_bf16_f32 v149, v154, v155
    v_cvt_pk_bf16_f32 v150, v156, v157
    v_cvt_pk_bf16_f32 v151, v158, v159
    buffer_store_dwordx4 v[128:131], v1, s[28:31], s72 offen sc1
    buffer_store_dwordx4 v[132:135], v1, s[28:31], s73 offen sc1
    buffer_store_dwordx4 v[144:147], v1, s[28:31], s74 offen sc1
    buffer_store_dwordx4 v[148:151], v1, s[28:31], s75 offen sc1
    s_waitcnt vmcnt(0)
    s_barrier
    s_cmp_lg_u32 s27, 0
    s_cbranch_scc1 QF_19
    v_mov_b32 v30, 0
    v_mov_b32 v31, s26
    s_mov_b64 exec, 1
    buffer_store_dword v31, v30, s[28:31], s70 offen sc1
    s_mov_b64 exec, -1
QF_19:
    s_lshl_b32 s57, s69, 12
    s_add_u32 s57, s57, 0xfb0000
    s_lshr_b32 s60, s64, 1
    v_lshrrev_b32 v30, 4, v0
    v_add_u32 v30, 1, v30
    v_cmp_gt_u32 vcc, 3, v30
    s_nop 1
    v_cndmask_b32 v30, 0, v30, vcc
    v_lshlrev_b32 v30, 4, v30
    v_add_u32 v30, s60, v30
    v_mul_u32_u24 v30, 43691, v30
    v_lshrrev_b32 v30, 17, v30
    v_and_b32 v31, 15, v0
    s_lshl_b32 s61, s65, 1
    v_add_u32 v24, s61, v31
    v_cndmask_b32 v31, v24, v31, vcc
    v_lshl_add_u32 v30, v30, 4, v31
    v_lshlrev_b32 v30, 7, v30
    s_mov_b32 s60, 0xf10000
    s_mov_b32 exec_lo, 0xffffffff
    s_mov_b32 exec_hi, 0x3
    buffer_load_dword v31, v30, s[28:31], s60 offen sc1
    s_mov_b64 exec, -1
    s_mov_b32 s32, s16
    s_and_b32 s33, s17, 0xffff
    s_mov_b32 s34, 0x1c0000
    s_mov_b32 s35, 0x00020000
    s_mov_b32 s36, s8
    s_and_b32 s37, s9, 0xffff
    s_mov_b32 s38, 0x80000
    s_mov_b32 s39, 0x00020000
    s_mul_i32 s54, s52, 16640
    s_add_u32 s54, s54, 32768
    v_add_u32 v2, s54, v1
    v_lshrrev_b32 v236, 5, v0
    v_lshlrev_b32 v232, 8, v236
    v_and_b32 v233, 15, v0
    v_lshl_add_u32 v232, v233, 4, v232
    v_and_b32 v233, 11, v0
    v_cmp_eq_u32 vcc, 0, v233
    v_mov_b32 v234, 16
    s_nop 0
    v_cndmask_b32 v234, v234, 0, vcc
    v_add_u32 v235, 1024, v234
    v_add_u32 v234, 512, v234
    v_cndmask_b32 v3, v235, v232, s[0:1]
    v_cndmask_b32 v4, v234, v232, s[0:1]
    v_add_u32 v3, s54, v3
    v_add_u32 v4, s54, v4
    v_lshrrev_b32 v232, 3, v0
    v_lshlrev_b32 v232, 10, v232
    v_bfe_u32 v233, v0, 4, 1
    v_lshlrev_b32 v234, 2, v233
    v_and_b32 v235, 7, v0
    v_xor_b32 v234, v234, v235
    v_lshl_add_u32 v11, v234, 4, v232
    v_add_u32 v12, 7168, v11
    s_mul_i32 s54, s13, 114688
    v_add_u32 v13, s54, v1
    v_bfe_u32 v234, v0, 2, 2
    v_lshl_add_u32 v232, v236, 2, v234
    v_lshlrev_b32 v232, 7, v232
    v_lshrrev_b32 v234, 1, v234
    v_lshl_add_u32 v232, v234, 6, v232
    v_lshl_add_u32 v232, v233, 5, v232
    v_and_b32 v234, 3, v0
    v_lshl_add_u32 v232, v234, 3, v232
    s_lshl_b32 s54, s14, 5
    v_xor_b32 v232, s54, v232
    v_add_u32 v5, s11, v232
    v_xor_b32 v6, 64, v5
    s_mul_i32 s54, s27, 14
    s_add_u32 s55, s54, 13
    s_lshr_b32 s54, s54, 2
    s_lshr_b32 s55, s55, 2
    v_and_b32 v14, 7, v0
    v_add_u32 v14, s54, v14
    v_min_u32 v14, s55, v14
    v_bfe_u32 v232, v0, 3, 1
    s_lshl_b32 s54, s4, 1
    v_add_u32 v232, s54, v232
    v_lshl_add_u32 v14, v232, 5, v14
    v_lshlrev_b32 v14, 7, v14
    v_and_b32 v232, 31, v0
    v_mul_u32_u24 v232, 2080, v232
    v_lshrrev_b32 v233, 5, v0
    v_lshl_add_u32 v232, v233, 4, v232
    v_cmp_eq_u32 vcc, 0, v233
    v_mov_b32 v236, 0x3f803f80
    s_nop 0
    v_cndmask_b32 v236, 0, v236, vcc
    v_mov_b32 v237, v236
    v_mov_b32 v238, v236
    v_mov_b32 v239, v236
    ds_write_b128 v232, v[236:239] offset:34816
    s_mov_b32 s40, s20
    s_and_b32 s41, s21, 0xffff
    s_mov_b32 s42, 0x200000
    s_mov_b32 s43, 0x00020000
    s_lshl_b32 s72, s4, 1
    s_add_u32 s72, s72, s13
    s_lshl_b32 s73, s72, 5
    s_lshl_b32 s74, s14, 3
    s_add_u32 s73, s73, s74
    s_lshl_b32 s54, s73, 10
    s_add_u32 s54, s54, 0x600000
    s_add_u32 s55, s54, 4096
    s_lshl_b32 s56, s72, 15
    s_lshl_b32 s74, s5, 7
    s_add_u32 s56, s56, s74
    s_lshl_b32 s74, s14, 5
    s_add_u32 s56, s56, s74
    s_lshl_b32 s59, s72, 8
    s_add_u32 s59, s59, 0xf00000
    s_lshl_b32 s58, s65, 3
    s_lshl_b32 s73, s51, 1
    s_add_u32 s58, s58, s73
    s_add_u32 s58, s58, s52
    s_lshl_b32 s58, s58, 8
    s_add_u32 s58, s58, 0xf00000
    s_lshl_b32 s72, s14, 1
    s_lshr_b32 s73, s4, 2
    s_lshl_b32 s73, s73, 5
    s_add_u32 s72, s72, s73
    s_lshl_b32 s73, s69, 3
    s_add_u32 s73, s73, 0xf00000
    s_xor_b32 s60, s13, 1
    s_mul_i32 s60, s60, 114688
    v_add_u32 v7, s60, v1
    s_mul_i32 s60, s27, 2560
    s_add_u32 s60, s60, 99328
    v_add_u32 v8, s60, v1
    s_xor_b32 s60, s27, 4
    s_mul_i32 s60, s60, 2560
    s_add_u32 s60, s60, 99328
    v_add_u32 v9, s60, v1
    v_bfe_u32 v10, v0, 2, 1
    v_and_b32 v232, 3, v0
    v_lshl_add_u32 v10, v232, 3, v10
    v_add_u32 v10, s72, v10
    v_lshlrev_b32 v10, 7, v10
    s_waitcnt vmcnt(0)
    v_cmp_ne_u32 vcc, s26, v31
    s_and_b32 vcc_lo, vcc_lo, 0xffffffff
    s_and_b32 vcc_hi, vcc_hi, 0x3
    s_or_b32 s60, vcc_lo, vcc_hi
    s_cbranch_scc0 FOK_20
    s_mov_b32 s60, 0xf10000
    s_mov_b32 s61, 0x80000
    s_mov_b32 exec_lo, 0xffffffff
    s_mov_b32 exec_hi, 0x3
POLL_21:
    buffer_load_dword v31, v30, s[28:31], s60 offen sc1
    s_waitcnt vmcnt(0)
    v_cmp_ne_u32 vcc, s26, v31
    s_cbranch_vccz POLLD_22
    s_mov_b64 exec, vcc
    s_sub_u32 s61, s61, 1
    s_cbranch_scc0 POLL_21
POLLD_22:
    s_mov_b64 exec, -1
FOK_20:
    s_xor_b32 s60, s68, 1024
    buffer_load_dwordx4 v[16:19], v1, s[28:31], s60 offen sc1
    buffer_load_dwordx4 v[20:23], v1, s[28:31], s68 offen sc1
    s_lshl_b32 s60, s64, 17
    s_add_u32 s60, s60, 0x200000
    buffer_load_dwordx4 v[224:227], v1, s[28:31], s60 offen sc1
    s_add_u32 m0, s67, 0
    s_nop 0
    buffer_load_dwordx4 v1, s[28:31], s66 offen sc1 lds
    buffer_load_dwordx4 v1, s[28:31], s66 offen offset:1024 sc1 lds
    s_add_u32 m0, s67, 8320
    s_add_u32 s66, s66, 8192
    buffer_load_dwordx4 v1, s[28:31], s66 offen sc1 lds
    buffer_load_dwordx4 v1, s[28:31], s66 offen offset:1024 sc1 lds
    s_add_u32 s66, s66, 8192
    s_waitcnt vmcnt(0) lgkmcnt(0)
    s_barrier
    v_mfma_f32_32x32x16_bf16 v[128:143], v[224:227], v[16:19], 0
    v_mfma_f32_32x32x16_bf16 v[144:159], v[224:227], v[20:23], 0
    s_nop 7
    s_nop 7
    v_max3_f32 v232, v128, v129, v130
    v_max3_f32 v232, v232, v131, v132
    v_max3_f32 v232, v232, v133, v134
    v_max3_f32 v232, v232, v135, v136
    v_max3_f32 v232, v232, v137, v138
    v_max3_f32 v232, v232, v139, v140
    v_max3_f32 v232, v232, v141, v142
    v_max_f32 v232, v232, v143
    v_mov_b32 v234, v232
    s_nop 1
    v_permlane32_swap_b32 v232, v234
    s_nop 1
    v_max_f32 v232, v232, v234
    v_max3_f32 v233, v144, v145, v146
    v_max3_f32 v233, v233, v147, v148
    v_max3_f32 v233, v233, v149, v150
    v_max3_f32 v233, v233, v151, v152
    v_max3_f32 v233, v233, v153, v154
    v_max3_f32 v233, v233, v155, v156
    v_max3_f32 v233, v233, v157, v158
    v_max_f32 v233, v233, v159
    v_mov_b32 v234, v233
    s_nop 1
    v_permlane32_swap_b32 v233, v234
    s_nop 1
    v_max_f32 v233, v233, v234
    v_min_f32 v232, v232, v233
    v_sub_f32 v240, 0, v232
    v_sub_f32 v241, 0, v232
    v_sub_f32 v242, 0, v232
    v_sub_f32 v243, 0, v232
    v_sub_f32 v244, 0, v232
    v_sub_f32 v245, 0, v232
    v_sub_f32 v246, 0, v232
    v_sub_f32 v247, 0, v232
    v_sub_f32 v248, 0, v232
    v_sub_f32 v249, 0, v232
    v_sub_f32 v250, 0, v232
    v_sub_f32 v251, 0, v232
    v_sub_f32 v252, 0, v232
    v_sub_f32 v253, 0, v232
    v_sub_f32 v254, 0, v232
    v_sub_f32 v255, 0, v232
    ds_read_b128 v[24:27], v2 offset:0
    ds_read_b128 v[208:211], v3 offset:1024
    ds_read_b128 v[212:215], v4 offset:1536
    s_waitcnt lgkmcnt(2)
    v_mfma_f32_32x32x16_bf16 v[128:143], v[24:27], v[16:19], v[240:255]
    s_add_u32 m0, s67, 33280
    s_nop 0
    buffer_load_dwordx4 v1, s[28:31], s66 offen sc1 lds
    buffer_load_dwordx4 v1, s[28:31], s66 offen offset:1024 sc1 lds
    s_add_u32 m0, s67, 41600
    s_add_u32 s66, s66, 8192
    buffer_load_dwordx4 v1, s[28:31], s66 offen sc1 lds
    buffer_load_dwordx4 v1, s[28:31], s66 offen offset:1024 sc1 lds
    s_add_u32 s66, s66, 8192
    s_waitcnt vmcnt(0)
    s_branch ATTN
CLS7:
    s_add_u32 s19, s3, 1
    s_and_b32 s19, s19, 7
    s_lshl_b32 s15, s19, 7
    s_add_u32 s15, s15, s54
    s_mul_i32 s19, s19, 196608
    s_add_u32 m0, s57, 32768
    s_add_u32 s60, s15, 0
    buffer_load_dwordx4 v11, s[32:35], s60 offen lds
    s_add_u32 m0, s57, 33792
    s_add_u32 s60, s15, 8192
    buffer_load_dwordx4 v12, s[32:35], s60 offen lds
    s_add_u32 m0, s58, 50176
    s_add_u32 s60, s55, s19
    buffer_load_dwordx4 v14, s[36:39], s60 offen lds
    s_add_u32 m0, s58, 51200
    s_add_u32 s60, s55, s19
    buffer_load_dwordx4 v15, s[36:39], s60 offen lds
    v_mov_b32 v24, 0
    s_mov_b32 s60, 0xf04000
    buffer_load_dword v25, v24, s[28:31], s60 offen sc1
    s_lshl_b32 s60, s69, 10
    buffer_load_dwordx4 v[16:19], v1, s[72:75], 0 offen
    buffer_load_dwordx4 v[20:23], v1, s[32:35], s60 offen
    s_and_b32 s60, s2, 7
    s_lshr_b32 s61, s2, 3
    s_lshl_b32 s4, s60, 2
    s_and_b32 s60, s61, 3
    s_add_u32 s4, s4, s60
    s_lshr_b32 s5, s61, 2
    s_mov_b32 s0, 0xffff
    s_mov_b32 s1, 0xffff
    s_and_b32 s13, s27, 1
    s_lshr_b32 s14, s27, 1
    s_mul_i32 s60, s4, 224
    s_mul_i32 s61, s27, 14
    s_add_u32 s60, s60, s61
    s_lshl_b32 s6, s60, 10
    s_add_u32 s6, s6, 0x800000
    s_lshl_b32 s7, s61, 14
    s_lshl_b32 s60, s5, 7
    s_add_u32 s7, s7, s60
    s_lshl_b32 s10, s27, 16
    s_add_u32 s10, s10, s60
    s_lshl_b32 s11, s51, 13
    s_lshl_b32 s60, s52, 17
    s_add_u32 s11, s11, s60
    s_lshl_b32 s60, s48, 2
    s_add_u32 s60, s60, s51
    s_lshl_b32 s60, s60, 5
    s_lshl_b32 s61, s50, 1
    s_add_u32 s60, s60, s61
    s_add_u32 s60, s60, s52
    s_lshl_b32 s60, s60, 7
    s_add_u32 s12, s60, 0xf70000
    s_lshl_b32 s60, s65, 3
    s_lshl_b32 s61, s51, 1
    s_add_u32 s60, s60, s61
    s_add_u32 s60, s60, s52
    s_lshl_b32 s60, s60, 5
    s_add_u32 s60, s60, s64
    s_lshl_b32 s18, s60, 10
    s_add_u32 s18, s18, 0x600000
    v_and_b32 v30, 31, v0
    v_lshrrev_b32 v31, 5, v0
    v_bfe_u32 v32, v0, 1, 3
    v_xor_b32 v32, v32, v31
    s_lshl_b32 s60, s51, 12
    v_lshlrev_b32 v33, 7, v30
    v_add_u32 v33, s60, v33
    v_xor_b32 v34, 0, v32
    v_lshl_add_u32 v2, v34, 4, v33
    v_xor_b32 v34, 2, v32
    v_lshl_add_u32 v3, v34, 4, v33
    v_xor_b32 v34, 4, v32
    v_lshl_add_u32 v4, v34, 4, v33
    v_xor_b32 v34, 6, v32
    v_lshl_add_u32 v5, v34, 4, v33
    v_bfe_u32 v32, v0, 2, 2
    v_lshl_add_u32 v33, v31, 3, v32
    v_mul_u32_u24 v34, 192, v33
    v_bfe_u32 v35, v0, 4, 1
    v_lshl_add_u32 v34, v35, 5, v34
    v_and_b32 v36, 3, v0
    v_lshl_add_u32 v34, v36, 3, v34
    v_add_u32 v6, 16512, v34
    v_lshlrev_b32 v33, 8, v33
    v_lshl_add_u32 v33, v35, 14, v33
    v_lshl_add_u32 v33, v36, 3, v33
    v_bfe_u32 v32, v0, 2, 3
    v_xor_b32 v34, 4, v32
    v_lshl_add_u32 v7, v34, 5, v33
    v_xor_b32 v34, 5, v32
    v_lshl_add_u32 v8, v34, 5, v33
    v_xor_b32 v34, 6, v32
    v_lshl_add_u32 v9, v34, 5, v33
    v_xor_b32 v34, 7, v32
    v_lshl_add_u32 v10, v34, 5, v33
    s_waitcnt vmcnt(7)
    s_barrier
    ds_read_b128 v[160:163], v2 offset:0
    ds_read_b64_tr_b16 v[32:33], v6 offset:0
    ds_read_b64_tr_b16 v[34:35], v6 offset:768
    ds_read_b128 v[164:167], v3 offset:0
    ds_read_b64_tr_b16 v[40:41], v6 offset:3072
    ds_read_b64_tr_b16 v[42:43], v6 offset:3840
    ds_read_b128 v[168:171], v4 offset:0
    ds_read_b64_tr_b16 v[48:49], v6 offset:6144
    ds_read_b64_tr_b16 v[50:51], v6 offset:6912
    ds_read_b128 v[172:175], v5 offset:0
    ds_read_b64_tr_b16 v[56:57], v6 offset:9216
    ds_read_b64_tr_b16 v[58:59], v6 offset:9984
    s_add_u32 s19, s3, 2
    s_and_b32 s19, s19, 7
    s_lshl_b32 s15, s19, 7
    s_add_u32 s15, s15, s54
    s_mul_i32 s19, s19, 196608
    s_add_u32 m0, s57, 65536
    s_add_u32 s60, s15, 0
    buffer_load_dwordx4 v11, s[32:35], s60 offen lds
    s_add_u32 m0, s57, 66560
    s_add_u32 s60, s15, 8192
    buffer_load_dwordx4 v12, s[32:35], s60 offen lds
    s_add_u32 m0, s58, 82944
    s_add_u32 s60, s55, s19
    buffer_load_dwordx4 v14, s[36:39], s60 offen lds
    s_waitcnt lgkmcnt(9)
    v_mfma_f32_32x32x16_bf16 v[128:143], v[160:163], v[32:35], 0
    s_waitcnt lgkmcnt(6)
    v_mfma_f32_32x32x16_bf16 v[128:143], v[164:167], v[40:43], v[128:143]
    s_add_u32 m0, s58, 83968
    s_add_u32 s60, s55, s19
    buffer_load_dwordx4 v15, s[36:39], s60 offen lds
    s_waitcnt vmcnt(7) lgkmcnt(0)
    s_barrier
    ds_read_b128 v[176:179], v2 offset:32768
    ds_read_b64_tr_b16 v[32:33], v6 offset:32768
    ds_read_b64_tr_b16 v[34:35], v6 offset:33536
    v_mfma_f32_32x32x16_bf16 v[128:143], v[168:171], v[48:51], v[128:143]
    ds_read_b128 v[180:183], v3 offset:32768
    ds_read_b64_tr_b16 v[40:41], v6 offset:35840
    ds_read_b64_tr_b16 v[42:43], v6 offset:36608
    v_mfma_f32_32x32x16_bf16 v[128:143], v[172:175], v[56:59], v[128:143]
    ds_read_b128 v[184:187], v4 offset:32768
    ds_read_b64_tr_b16 v[48:49], v6 offset:38912
    ds_read_b64_tr_b16 v[50:51], v6 offset:39680
    ds_read_b128 v[188:191], v5 offset:32768
    ds_read_b64_tr_b16 v[56:57], v6 offset:41984
    ds_read_b64_tr_b16 v[58:59], v6 offset:42752
    s_add_u32 s19, s3, 3
    s_and_b32 s19, s19, 7
    s_lshl_b32 s15, s19, 7
    s_add_u32 s15, s15, s54
    s_mul_i32 s19, s19, 196608
    s_add_u32 m0, s57, 98304
    s_add_u32 s60, s15, 0
    buffer_load_dwordx4 v11, s[32:35], s60 offen lds
    s_add_u32 m0, s57, 99328
    s_add_u32 s60, s15, 8192
    buffer_load_dwordx4 v12, s[32:35], s60 offen lds
    s_add_u32 m0, s58, 115712
    s_add_u32 s60, s55, s19
    buffer_load_dwordx4 v14, s[36:39], s60 offen lds
    s_waitcnt lgkmcnt(9)
    v_mfma_f32_32x32x16_bf16 v[128:143], v[176:179], v[32:35], v[128:143]
    s_waitcnt lgkmcnt(6)
    v_mfma_f32_32x32x16_bf16 v[128:143], v[180:183], v[40:43], v[128:143]
    s_add_u32 m0, s58, 116736
    s_add_u32 s60, s55, s19
    buffer_load_dwordx4 v15, s[36:39], s60 offen lds
    s_waitcnt vmcnt(8)
    s_mov_b32 s63, 0xffff0000
    v_lshlrev_b32 v30, 16, v16
    v_and_b32 v16, s63, v16
    v_lshlrev_b32 v31, 16, v20
    v_and_b32 v20, s63, v20
    v_mul_f32 v30, v30, v31
    v_mul_f32 v31, v16, v20
    v_cvt_pk_bf16_f32 v30, v30, v31
    v_and_b32 v31, s63, v30
    v_lshlrev_b32 v30, 16, v30
    v_add_f32 v26, v30, v31
    v_lshlrev_b32 v30, 16, v17
    v_and_b32 v17, s63, v17
    v_lshlrev_b32 v31, 16, v21
    v_and_b32 v21, s63, v21
    v_mul_f32 v30, v30, v31
    v_mul_f32 v31, v17, v21
    v_cvt_pk_bf16_f32 v30, v30, v31
    v_and_b32 v31, s63, v30
    v_lshlrev_b32 v30, 16, v30
    v_add_f32 v26, v26, v30
    v_add_f32 v26, v26, v31
    v_lshlrev_b32 v30, 16, v18
    v_and_b32 v18, s63, v18
    v_lshlrev_b32 v31, 16, v22
    v_and_b32 v22, s63, v22
    v_mul_f32 v30, v30, v31
    v_mul_f32 v31, v18, v22
    v_cvt_pk_bf16_f32 v30, v30, v31
    v_and_b32 v31, s63, v30
    v_lshlrev_b32 v30, 16, v30
    v_add_f32 v26, v26, v30
    v_add_f32 v26, v26, v31
    v_lshlrev_b32 v30, 16, v19
    v_and_b32 v19, s63, v19
    v_lshlrev_b32 v31, 16, v23
    v_and_b32 v23, s63, v23
    v_mul_f32 v30, v30, v31
    v_mul_f32 v31, v19, v23
    v_cvt_pk_bf16_f32 v30, v30, v31
    v_and_b32 v31, s63, v30
    v_lshlrev_b32 v30, 16, v30
    v_add_f32 v26, v26, v30
    v_add_f32 v26, v26, v31
    s_nop 1
    v_add_f32_dpp v26, v26, v26 row_ror:8 row_mask:0xf bank_mask:0xf
    s_nop 1
    v_add_f32_dpp v26, v26, v26 row_ror:4 row_mask:0xf bank_mask:0xf
    s_nop 1
    v_add_f32_dpp v26, v26, v26 row_ror:2 row_mask:0xf bank_mask:0xf
    s_nop 1
    v_add_f32_dpp v26, v26, v26 row_ror:1 row_mask:0xf bank_mask:0xf
    s_nop 1
    v_readlane_b32 s60, v26, 0
    v_readlane_b32 s61, v26, 16
    v_readlane_b32 s62, v26, 32
    v_readlane_b32 s63, v26, 48
    s_nop 1
    v_mov_b32 v26, s60
    v_add_f32 v26, s61, v26
    v_add_f32 v26, s62, v26
    v_add_f32 v26, s63, v26
    v_cvt_pk_bf16_f32 v26, v26, v26
    v_lshlrev_b32 v26, 16, v26
    v_mul_f32 v26, 0xbfb8aa3b, v26
    v_exp_f32 v26, v26
    s_nop 0
    v_add_f32 v26, 1.0, v26
    v_rcp_f32 v26, v26
    s_nop 0
    v_cvt_pk_bf16_f32 v26, v26, v26
    v_lshlrev_b32 v26, 16, v26
    s_mov_b32 s72, s22
    s_and_b32 s73, s23, 0xffff
    s_mov_b32 s74, 0x100
    s_mov_b32 s75, 0x00020000
    buffer_load_dword v16, v24, s[72:75], 0 offen sc1
    s_waitcnt vmcnt(5) lgkmcnt(0)
    s_barrier
    v_add_u32 v2, 0x10000, v2
    v_add_u32 v3, 0x10000, v3
    v_add_u32 v4, 0x10000, v4
    v_add_u32 v5, 0x10000, v5
    v_add_u32 v6, 0x10000, v6
    ds_read_b128 v[192:195], v2 offset:0
    ds_read_b64_tr_b16 v[32:33], v6 offset:0
    ds_read_b64_tr_b16 v[34:35], v6 offset:768
    v_mfma_f32_32x32x16_bf16 v[128:143], v[184:187], v[48:51], v[128:143]
    ds_read_b128 v[196:199], v3 offset:0
    ds_read_b64_tr_b16 v[40:41], v6 offset:3072
    ds_read_b64_tr_b16 v[42:43], v6 offset:3840
    v_mfma_f32_32x32x16_bf16 v[128:143], v[188:191], v[56:59], v[128:143]
    ds_read_b128 v[200:203], v4 offset:0
    ds_read_b64_tr_b16 v[48:49], v6 offset:6144
    ds_read_b64_tr_b16 v[50:51], v6 offset:6912
    ds_read_b128 v[204:207], v5 offset:0
    ds_read_b64_tr_b16 v[56:57], v6 offset:9216
    ds_read_b64_tr_b16 v[58:59], v6 offset:9984
    s_add_u32 s19, s3, 4
    s_and_b32 s19, s19, 7
    s_lshl_b32 s15, s19, 7
    s_add_u32 s15, s15, s54
    s_mul_i32 s19, s19, 196608
    s_add_u32 m0, s57, 131072
    s_add_u32 s60, s15, 0
    buffer_load_dwordx4 v11, s[32:35], s60 offen lds
    s_add_u32 m0, s57, 132096
    s_add_u32 s60, s15, 8192
    buffer_load_dwordx4 v12, s[32:35], s60 offen lds
    s_add_u32 m0, s58, 148480
    s_add_u32 s60, s55, s19
    buffer_load_dwordx4 v14, s[36:39], s60 offen lds
    s_waitcnt lgkmcnt(9)
    v_mfma_f32_32x32x16_bf16 v[128:143], v[192:195], v[32:35], v[128:143]
    s_waitcnt lgkmcnt(6)
    v_mfma_f32_32x32x16_bf16 v[128:143], v[196:199], v[40:43], v[128:143]
    s_add_u32 m0, s58, 149504
    s_add_u32 s60, s55, s19
    buffer_load_dwordx4 v15, s[36:39], s60 offen lds
    s_waitcnt vmcnt(5) lgkmcnt(0)
    s_barrier
    ds_read_b128 v[208:211], v2 offset:32768
    ds_read_b64_tr_b16 v[32:33], v6 offset:32768
    ds_read_b64_tr_b16 v[34:35], v6 offset:33536
    v_mfma_f32_32x32x16_bf16 v[128:143], v[200:203], v[48:51], v[128:143]
    ds_read_b128 v[212:215], v3 offset:32768
    ds_read_b64_tr_b16 v[40:41], v6 offset:35840
    ds_read_b64_tr_b16 v[42:43], v6 offset:36608
    v_mfma_f32_32x32x16_bf16 v[128:143], v[204:207], v[56:59], v[128:143]
    ds_read_b128 v[216:219], v4 offset:32768
    ds_read_b64_tr_b16 v[48:49], v6 offset:38912
    ds_read_b64_tr_b16 v[50:51], v6 offset:39680
    ds_read_b128 v[220:223], v5 offset:32768
    ds_read_b64_tr_b16 v[56:57], v6 offset:41984
    ds_read_b64_tr_b16 v[58:59], v6 offset:42752
    s_add_u32 s19, s3, 5
    s_and_b32 s19, s19, 7
    s_lshl_b32 s15, s19, 7
    s_add_u32 s15, s15, s54
    s_mul_i32 s19, s19, 196608
    s_add_u32 m0, s57, 0
    s_add_u32 s60, s15, 0
    buffer_load_dwordx4 v11, s[32:35], s60 offen lds
    s_add_u32 m0, s57, 1024
    s_add_u32 s60, s15, 8192
    buffer_load_dwordx4 v12, s[32:35], s60 offen lds
    s_add_u32 m0, s58, 17408
    s_add_u32 s60, s55, s19
    buffer_load_dwordx4 v14, s[36:39], s60 offen lds
    s_waitcnt lgkmcnt(9)
    v_mfma_f32_32x32x16_bf16 v[128:143], v[208:211], v[32:35], v[128:143]
    s_waitcnt lgkmcnt(6)
    v_mfma_f32_32x32x16_bf16 v[128:143], v[212:215], v[40:43], v[128:143]
    s_add_u32 m0, s58, 18432
    s_add_u32 s60, s55, s19
    buffer_load_dwordx4 v15, s[36:39], s60 offen lds
    s_waitcnt vmcnt(4) lgkmcnt(0)
    s_barrier
    v_add_u32 v2, 0x10000, v2
    v_add_u32 v3, 0x10000, v3
    v_add_u32 v4, 0x10000, v4
    v_add_u32 v5, 0x10000, v5
    v_add_u32 v6, 0x10000, v6
    ds_read_b128 v[224:227], v2 offset:0
    ds_read_b64_tr_b16 v[32:33], v6 offset:0
    ds_read_b64_tr_b16 v[34:35], v6 offset:768
    v_mfma_f32_32x32x16_bf16 v[128:143], v[216:219], v[48:51], v[128:143]
    ds_read_b128 v[228:231], v3 offset:0
    ds_read_b64_tr_b16 v[40:41], v6 offset:3072
    ds_read_b64_tr_b16 v[42:43], v6 offset:3840
    v_mfma_f32_32x32x16_bf16 v[128:143], v[220:223], v[56:59], v[128:143]
    ds_read_b128 v[232:235], v4 offset:0
    ds_read_b64_tr_b16 v[48:49], v6 offset:6144
    ds_read_b64_tr_b16 v[50:51], v6 offset:6912
    ds_read_b128 v[236:239], v5 offset:0
    ds_read_b64_tr_b16 v[56:57], v6 offset:9216
    ds_read_b64_tr_b16 v[58:59], v6 offset:9984
    s_add_u32 s19, s3, 6
    s_and_b32 s19, s19, 7
    s_lshl_b32 s15, s19, 7
    s_add_u32 s15, s15, s54
    s_mul_i32 s19, s19, 196608
    s_add_u32 m0, s57, 32768
    s_add_u32 s60, s15, 0
    buffer_load_dwordx4 v11, s[32:35], s60 offen lds
    s_add_u32 m0, s57, 33792
    s_add_u32 s60, s15, 8192
    buffer_load_dwordx4 v12, s[32:35], s60 offen lds
    s_add_u32 m0, s58, 50176
    s_add_u32 s60, s55, s19
    buffer_load_dwordx4 v14, s[36:39], s60 offen lds
    s_waitcnt lgkmcnt(9)
    v_mfma_f32_32x32x16_bf16 v[128:143], v[224:227], v[32:35], v[128:143]
    s_waitcnt lgkmcnt(6)
    v_mfma_f32_32x32x16_bf16 v[128:143], v[228:231], v[40:43], v[128:143]
    s_add_u32 m0, s58, 51200
    s_add_u32 s60, s55, s19
    buffer_load_dwordx4 v15, s[36:39], s60 offen lds
    s_waitcnt vmcnt(4) lgkmcnt(0)
    s_barrier
    v_add_u32 v2, 0xfffe0000, v2
    v_add_u32 v3, 0xfffe0000, v3
    v_add_u32 v4, 0xfffe0000, v4
    v_add_u32 v5, 0xfffe0000, v5
    v_add_u32 v6, 0xfffe0000, v6
    ds_read_b128 v[240:243], v2 offset:0
    ds_read_b64_tr_b16 v[32:33], v6 offset:0
    ds_read_b64_tr_b16 v[34:35], v6 offset:768
    v_mfma_f32_32x32x16_bf16 v[128:143], v[232:235], v[48:51], v[128:143]
    ds_read_b128 v[244:247], v3 offset:0
    ds_read_b64_tr_b16 v[40:41], v6 offset:3072
    ds_read_b64_tr_b16 v[42:43], v6 offset:3840
    v_mfma_f32_32x32x16_bf16 v[128:143], v[236:239], v[56:59], v[128:143]
    ds_read_b128 v[248:251], v4 offset:0
    ds_read_b64_tr_b16 v[48:49], v6 offset:6144
    ds_read_b64_tr_b16 v[50:51], v6 offset:6912
    ds_read_b128 v[252:255], v5 offset:0
    ds_read_b64_tr_b16 v[56:57], v6 offset:9216
    ds_read_b64_tr_b16 v[58:59], v6 offset:9984
    s_add_u32 s19, s3, 7
    s_and_b32 s19, s19, 7
    s_lshl_b32 s15, s19, 7
    s_add_u32 s15, s15, s54
    s_mul_i32 s19, s19, 196608
    s_add_u32 m0, s57, 65536
    s_add_u32 s60, s15, 0
    buffer_load_dwordx4 v11, s[32:35], s60 offen lds
    s_add_u32 m0, s57, 66560
    s_add_u32 s60, s15, 8192
    buffer_load_dwordx4 v12, s[32:35], s60 offen lds
    s_add_u32 m0, s58, 82944
    s_add_u32 s60, s55, s19
    buffer_load_dwordx4 v14, s[36:39], s60 offen lds
    s_waitcnt lgkmcnt(9)
    v_mfma_f32_32x32x16_bf16 v[128:143], v[240:243], v[32:35], v[128:143]
    s_waitcnt lgkmcnt(6)
    v_mfma_f32_32x32x16_bf16 v[128:143], v[244:247], v[40:43], v[128:143]
    s_add_u32 m0, s58, 83968
    s_add_u32 s60, s55, s19
    buffer_load_dwordx4 v15, s[36:39], s60 offen lds
    s_waitcnt vmcnt(4) lgkmcnt(0)
    s_barrier
    ds_read_b128 v[160:163], v2 offset:32768
    ds_read_b64_tr_b16 v[32:33], v6 offset:32768
    ds_read_b64_tr_b16 v[34:35], v6 offset:33536
    v_mfma_f32_32x32x16_bf16 v[128:143], v[248:251], v[48:51], v[128:143]
    ds_read_b128 v[164:167], v3 offset:32768
    ds_read_b64_tr_b16 v[40:41], v6 offset:35840
    ds_read_b64_tr_b16 v[42:43], v6 offset:36608
    v_mfma_f32_32x32x16_bf16 v[128:143], v[252:255], v[56:59], v[128:143]
    ds_read_b128 v[168:171], v4 offset:32768
    ds_read_b64_tr_b16 v[48:49], v6 offset:38912
    ds_read_b64_tr_b16 v[50:51], v6 offset:39680
    ds_read_b128 v[172:175], v5 offset:32768
    ds_read_b64_tr_b16 v[56:57], v6 offset:41984
    ds_read_b64_tr_b16 v[58:59], v6 offset:42752
    s_waitcnt lgkmcnt(9)
    v_mfma_f32_32x32x16_bf16 v[128:143], v[160:163], v[32:35], v[128:143]
    s_waitcnt lgkmcnt(6)
    v_mfma_f32_32x32x16_bf16 v[128:143], v[164:167], v[40:43], v[128:143]
    v_readfirstlane_b32 s26, v25
    v_readfirstlane_b32 s60, v16
    s_nop 3
    s_mul_i32 s26, s26, 1664525
    s_add_u32 s26, s26, 1013904223
    s_or_b32 s26, s26, 1
    s_cmp_lg_u32 s60, 0
    s_cselect_b32 s26, s60, s26
    v_readfirstlane_b32 s22, v26
    s_waitcnt vmcnt(0) lgkmcnt(0)
    s_barrier
    v_add_u32 v2, 0x10000, v2
    v_add_u32 v3, 0x10000, v3
    v_add_u32 v4, 0x10000, v4
    v_add_u32 v5, 0x10000, v5
    v_add_u32 v6, 0x10000, v6
    ds_read_b128 v[176:179], v2 offset:0
    ds_read_b64_tr_b16 v[32:33], v6 offset:0
    ds_read_b64_tr_b16 v[34:35], v6 offset:768
    v_mfma_f32_32x32x16_bf16 v[128:143], v[168:171], v[48:51], v[128:143]
    ds_read_b128 v[180:183], v3 offset:0
    ds_read_b64_tr_b16 v[40:41], v6 offset:3072
    ds_read_b64_tr_b16 v[42:43], v6 offset:3840
    v_mfma_f32_32x32x16_bf16 v[128:143], v[172:175], v[56:59], v[128:143]
    ds_read_b128 v[184:187], v4 offset:0
    ds_read_b64_tr_b16 v[48:49], v6 offset:6144
    ds_read_b64_tr_b16 v[50:51], v6 offset:6912
    ds_read_b128 v[188:191], v5 offset:0
    ds_read_b64_tr_b16 v[56:57], v6 offset:9216
    ds_read_b64_tr_b16 v[58:59], v6 offset:9984
    s_waitcnt lgkmcnt(9)
    v_mfma_f32_32x32x16_bf16 v[128:143], v[176:179], v[32:35], v[128:143]
    s_waitcnt lgkmcnt(6)
    v_mfma_f32_32x32x16_bf16 v[128:143], v[180:183], v[40:43], v[128:143]
    s_waitcnt lgkmcnt(0)
    v_mfma_f32_32x32x16_bf16 v[128:143], v[184:187], v[48:51], v[128:143]
    v_mfma_f32_32x32x16_bf16 v[128:143], v[188:191], v[56:59], v[128:143]
    s_nop 7
    s_nop 3
    s_mul_i32 s60, s49, 3
    s_add_u32 s60, s60, 2
    s_and_b32 s61, s60, 15
    s_lshl_b32 s61, s61, 7
    s_lshl_b32 s62, s48, 2
    s_add_u32 s62, s62, s51
    s_add_u32 s61, s61, s62
    s_lshl_b32 s61, s61, 11
    s_add_u32 s72, s61, 0x200400
    s_add_u32 s73, s72, 512
    v_bfe_u32 v30, v0, 4, 1
    v_lshlrev_b32 v30, 17, v30
    v_lshrrev_b32 v31, 5, v0
    v_lshl_add_u32 v30, v31, 8, v30
    v_and_b32 v31, 15, v0
    v_lshl_add_u32 v15, v31, 4, v30
    v_cvt_pk_bf16_f32 v128, v128, v129
    v_cvt_pk_bf16_f32 v129, v130, v131
    v_cvt_pk_bf16_f32 v130, v132, v133
    v_cvt_pk_bf16_f32 v131, v134, v135
    v_cvt_pk_bf16_f32 v132, v136, v137
    v_cvt_pk_bf16_f32 v133, v138, v139
    v_cvt_pk_bf16_f32 v134, v140, v141
    v_cvt_pk_bf16_f32 v135, v142, v143
    buffer_store_dwordx4 v[128:131], v15, s[28:31], s72 offen sc1
    buffer_store_dwordx4 v[132:135], v15, s[28:31], s73 offen sc1
    s_waitcnt vmcnt(0)
    s_barrier
    s_lshl_b32 s57, s69, 12
    s_add_u32 s57, s57, 0xfb0000
    s_lshr_b32 s60, s64, 1
    v_lshrrev_b32 v30, 4, v0
    v_add_u32 v30, 1, v30
    v_cmp_gt_u32 vcc, 3, v30
    s_nop 1
    v_cndmask_b32 v30, 0, v30, vcc
    v_lshlrev_b32 v30, 4, v30
    v_add_u32 v30, s60, v30
    v_mul_u32_u24 v30, 43691, v30
    v_lshrrev_b32 v30, 17, v30
    v_and_b32 v31, 15, v0
    s_lshl_b32 s61, s65, 1
    v_add_u32 v24, s61, v31
    v_cndmask_b32 v31, v24, v31, vcc
    v_lshl_add_u32 v30, v30, 4, v31
    v_lshlrev_b32 v30, 7, v30
    s_mov_b32 s60, 0xf10000
    s_mov_b32 exec_lo, 0xffffffff
    s_mov_b32 exec_hi, 0x3
    buffer_load_dword v31, v30, s[28:31], s60 offen sc1
    s_mov_b64 exec, -1
    s_mov_b32 s32, s16
    s_and_b32 s33, s17, 0xffff
    s_mov_b32 s34, 0x1c0000
    s_mov_b32 s35, 0x00020000
    s_mov_b32 s36, s8
    s_and_b32 s37, s9, 0xffff
    s_mov_b32 s38, 0x80000
    s_mov_b32 s39, 0x00020000
    s_mul_i32 s54, s52, 16640
    s_add_u32 s54, s54, 32768
    v_add_u32 v2, s54, v1
    v_lshrrev_b32 v236, 5, v0
    v_lshlrev_b32 v232, 8, v236
    v_and_b32 v233, 15, v0
    v_lshl_add_u32 v232, v233, 4, v232
    v_and_b32 v233, 11, v0
    v_cmp_eq_u32 vcc, 0, v233
    v_mov_b32 v234, 16
    s_nop 0
    v_cndmask_b32 v234, v234, 0, vcc
    v_add_u32 v235, 1024, v234
    v_add_u32 v234, 512, v234
    v_cndmask_b32 v3, v235, v232, s[0:1]
    v_cndmask_b32 v4, v234, v232, s[0:1]
    v_add_u32 v3, s54, v3
    v_add_u32 v4, s54, v4
    v_lshrrev_b32 v232, 3, v0
    v_lshlrev_b32 v232, 10, v232
    v_bfe_u32 v233, v0, 4, 1
    v_lshlrev_b32 v234, 2, v233
    v_and_b32 v235, 7, v0
    v_xor_b32 v234, v234, v235
    v_lshl_add_u32 v11, v234, 4, v232
    v_add_u32 v12, 7168, v11
    s_mul_i32 s54, s13, 114688
    v_add_u32 v13, s54, v1
    v_bfe_u32 v234, v0, 2, 2
    v_lshl_add_u32 v232, v236, 2, v234
    v_lshlrev_b32 v232, 7, v232
    v_lshrrev_b32 v234, 1, v234
    v_lshl_add_u32 v232, v234, 6, v232
    v_lshl_add_u32 v232, v233, 5, v232
    v_and_b32 v234, 3, v0
    v_lshl_add_u32 v232, v234, 3, v232
    s_lshl_b32 s54, s14, 5
    v_xor_b32 v232, s54, v232
    v_add_u32 v5, s11, v232
    v_xor_b32 v6, 64, v5
    s_mul_i32 s54, s27, 14
    s_add_u32 s55, s54, 13
    s_lshr_b32 s54, s54, 2
    s_lshr_b32 s55, s55, 2
    v_and_b32 v14, 7, v0
    v_add_u32 v14, s54, v14
    v_min_u32 v14, s55, v14
    v_bfe_u32 v232, v0, 3, 1
    s_lshl_b32 s54, s4, 1
    v_add_u32 v232, s54, v232
    v_lshl_add_u32 v14, v232, 5, v14
    v_lshlrev_b32 v14, 7, v14
    v_and_b32 v232, 31, v0
    v_mul_u32_u24 v232, 2080, v232
    v_lshrrev_b32 v233, 5, v0
    v_lshl_add_u32 v232, v233, 4, v232
    v_cmp_eq_u32 vcc, 0, v233
    v_mov_b32 v236, 0x3f803f80
    s_nop 0
    v_cndmask_b32 v236, 0, v236, vcc
    v_mov_b32 v237, v236
    v_mov_b32 v238, v236
    v_mov_b32 v239, v236
    ds_write_b128 v232, v[236:239] offset:34816
    s_mov_b32 s40, s20
    s_and_b32 s41, s21, 0xffff
    s_mov_b32 s42, 0x200000
    s_mov_b32 s43, 0x00020000
    s_lshl_b32 s72, s4, 1
    s_add_u32 s72, s72, s13
    s_lshl_b32 s73, s72, 5
    s_lshl_b32 s74, s14, 3
    s_add_u32 s73, s73, s74
    s_lshl_b32 s54, s73, 10
    s_add_u32 s54, s54, 0x600000
    s_add_u32 s55, s54, 4096
    s_lshl_b32 s56, s72, 15
    s_lshl_b32 s74, s5, 7
    s_add_u32 s56, s56, s74
    s_lshl_b32 s74, s14, 5
    s_add_u32 s56, s56, s74
    s_lshl_b32 s59, s72, 8
    s_add_u32 s59, s59, 0xf00000
    s_lshl_b32 s58, s65, 3
    s_lshl_b32 s73, s51, 1
    s_add_u32 s58, s58, s73
    s_add_u32 s58, s58, s52
    s_lshl_b32 s58, s58, 8
    s_add_u32 s58, s58, 0xf00000
    s_lshl_b32 s72, s14, 1
    s_lshr_b32 s73, s4, 2
    s_lshl_b32 s73, s73, 5
    s_add_u32 s72, s72, s73
    s_lshl_b32 s73, s69, 3
    s_add_u32 s73, s73, 0xf00000
    s_xor_b32 s60, s13, 1
    s_mul_i32 s60, s60, 114688
    v_add_u32 v7, s60, v1
    s_mul_i32 s60, s27, 2560
    s_add_u32 s60, s60, 99328
    v_add_u32 v8, s60, v1
    s_xor_b32 s60, s27, 4
    s_mul_i32 s60, s60, 2560
    s_add_u32 s60, s60, 99328
    v_add_u32 v9, s60, v1
    v_bfe_u32 v10, v0, 2, 1
    v_and_b32 v232, 3, v0
    v_lshl_add_u32 v10, v232, 3, v10
    v_add_u32 v10, s72, v10
    v_lshlrev_b32 v10, 7, v10
    s_waitcnt vmcnt(0)
    v_cmp_ne_u32 vcc, s26, v31
    s_and_b32 vcc_lo, vcc_lo, 0xffffffff
    s_and_b32 vcc_hi, vcc_hi, 0x3
    s_or_b32 s60, vcc_lo, vcc_hi
    s_cbranch_scc0 FOK_23
    s_mov_b32 s60, 0xf10000
    s_mov_b32 s61, 0x80000
    s_mov_b32 exec_lo, 0xffffffff
    s_mov_b32 exec_hi, 0x3
POLL_24:
    buffer_load_dword v31, v30, s[28:31], s60 offen sc1
    s_waitcnt vmcnt(0)
    v_cmp_ne_u32 vcc, s26, v31
    s_cbranch_vccz POLLD_25
    s_mov_b64 exec, vcc
    s_sub_u32 s61, s61, 1
    s_cbranch_scc0 POLL_24
POLLD_25:
    s_mov_b64 exec, -1
FOK_23:
    s_xor_b32 s60, s68, 1024
    buffer_load_dwordx4 v[16:19], v1, s[28:31], s60 offen sc1
    buffer_load_dwordx4 v[20:23], v1, s[28:31], s68 offen sc1
    s_lshl_b32 s60, s64, 17
    s_add_u32 s60, s60, 0x200000
    buffer_load_dwordx4 v[224:227], v1, s[28:31], s60 offen sc1
    s_add_u32 m0, s67, 0
    s_nop 0
    buffer_load_dwordx4 v1, s[28:31], s66 offen sc1 lds
    buffer_load_dwordx4 v1, s[28:31], s66 offen offset:1024 sc1 lds
    s_add_u32 m0, s67, 8320
    s_add_u32 s66, s66, 8192
    buffer_load_dwordx4 v1, s[28:31], s66 offen sc1 lds
    buffer_load_dwordx4 v1, s[28:31], s66 offen offset:1024 sc1 lds
    s_add_u32 s66, s66, 8192
    s_waitcnt vmcnt(0) lgkmcnt(0)
    s_barrier
    v_mfma_f32_32x32x16_bf16 v[128:143], v[224:227], v[16:19], 0
    v_mfma_f32_32x32x16_bf16 v[144:159], v[224:227], v[20:23], 0
    s_nop 7
    s_nop 7
    v_max3_f32 v232, v128, v129, v130
    v_max3_f32 v232, v232, v131, v132
    v_max3_f32 v232, v232, v133, v134
    v_max3_f32 v232, v232, v135, v136
    v_max3_f32 v232, v232, v137, v138
    v_max3_f32 v232, v232, v139, v140
    v_max3_f32 v232, v232, v141, v142
    v_max_f32 v232, v232, v143
    v_mov_b32 v234, v232
    s_nop 1
    v_permlane32_swap_b32 v232, v234
    s_nop 1
    v_max_f32 v232, v232, v234
    v_max3_f32 v233, v144, v145, v146
    v_max3_f32 v233, v233, v147, v148
    v_max3_f32 v233, v233, v149, v150
    v_max3_f32 v233, v233, v151, v152
    v_max3_f32 v233, v233, v153, v154
    v_max3_f32 v233, v233, v155, v156
    v_max3_f32 v233, v233, v157, v158
    v_max_f32 v233, v233, v159
    v_mov_b32 v234, v233
    s_nop 1
    v_permlane32_swap_b32 v233, v234
    s_nop 1
    v_max_f32 v233, v233, v234
    v_min_f32 v232, v232, v233
    v_sub_f32 v240, 0, v232
    v_sub_f32 v241, 0, v232
    v_sub_f32 v242, 0, v232
    v_sub_f32 v243, 0, v232
    v_sub_f32 v244, 0, v232
    v_sub_f32 v245, 0, v232
    v_sub_f32 v246, 0, v232
    v_sub_f32 v247, 0, v232
    v_sub_f32 v248, 0, v232
    v_sub_f32 v249, 0, v232
    v_sub_f32 v250, 0, v232
    v_sub_f32 v251, 0, v232
    v_sub_f32 v252, 0, v232
    v_sub_f32 v253, 0, v232
    v_sub_f32 v254, 0, v232
    v_sub_f32 v255, 0, v232
    ds_read_b128 v[24:27], v2 offset:0
    ds_read_b128 v[208:211], v3 offset:1024
    ds_read_b128 v[212:215], v4 offset:1536
    s_waitcnt lgkmcnt(2)
    v_mfma_f32_32x32x16_bf16 v[128:143], v[24:27], v[16:19], v[240:255]
    s_add_u32 m0, s67, 33280
    s_nop 0
    buffer_load_dwordx4 v1, s[28:31], s66 offen sc1 lds
    buffer_load_dwordx4 v1, s[28:31], s66 offen offset:1024 sc1 lds
    s_add_u32 m0, s67, 41600
    s_add_u32 s66, s66, 8192
    buffer_load_dwordx4 v1, s[28:31], s66 offen sc1 lds
    buffer_load_dwordx4 v1, s[28:31], s66 offen offset:1024 sc1 lds
    s_add_u32 s66, s66, 8192
    s_waitcnt vmcnt(0)
    s_branch ATTN
CLS3:
    s_add_u32 s19, s3, 1
    s_and_b32 s19, s19, 7
    s_lshl_b32 s15, s19, 7
    s_add_u32 s15, s15, s54
    s_mul_i32 s19, s19, 196608
    s_add_u32 m0, s57, 32768
    s_add_u32 s60, s15, 0
    buffer_load_dwordx4 v11, s[32:35], s60 offen lds
    s_add_u32 m0, s57, 33792
    s_add_u32 s60, s15, 8192
    buffer_load_dwordx4 v12, s[32:35], s60 offen lds
    s_add_u32 m0, s58, 49152
    s_add_u32 s60, s55, s19
    buffer_load_dwordx4 v13, s[36:39], s60 offen lds
    v_mov_b32 v24, 0
    s_mov_b32 s60, 0xf04000
    buffer_load_dword v25, v24, s[28:31], s60 offen sc1
    s_lshl_b32 s60, s69, 10
    buffer_load_dwordx4 v[16:19], v1, s[72:75], 0 offen
    buffer_load_dwordx4 v[20:23], v1, s[32:35], s60 offen
    s_and_b32 s60, s2, 7
    s_lshr_b32 s61, s2, 3
    s_lshl_b32 s4, s60, 2
    s_and_b32 s60, s61, 3
    s_add_u32 s4, s4, s60
    s_lshr_b32 s5, s61, 2
    s_mov_b32 s0, 0xffff
    s_mov_b32 s1, 0xffff
    s_and_b32 s13, s27, 1
    s_lshr_b32 s14, s27, 1
    s_mul_i32 s60, s4, 224
    s_mul_i32 s61, s27, 14
    s_add_u32 s60, s60, s61
    s_lshl_b32 s6, s60, 10
    s_add_u32 s6, s6, 0x800000
    s_lshl_b32 s7, s61, 14
    s_lshl_b32 s60, s5, 7
    s_add_u32 s7, s7, s60
    s_lshl_b32 s10, s27, 16
    s_add_u32 s10, s10, s60
    s_lshl_b32 s11, s51, 13
    s_lshl_b32 s60, s52, 17
    s_add_u32 s11, s11, s60
    s_lshl_b32 s60, s48, 2
    s_add_u32 s60, s60, s51
    s_lshl_b32 s60, s60, 5
    s_lshl_b32 s61, s50, 1
    s_add_u32 s60, s60, s61
    s_add_u32 s60, s60, s52
    s_lshl_b32 s60, s60, 7
    s_add_u32 s12, s60, 0xf70000
    s_lshl_b32 s60, s65, 3
    s_lshl_b32 s61, s51, 1
    s_add_u32 s60, s60, s61
    s_add_u32 s60, s60, s52
    s_lshl_b32 s60, s60, 5
    s_add_u32 s60, s60, s64
    s_lshl_b32 s18, s60, 10
    s_add_u32 s18, s18, 0x600000
    v_and_b32 v30, 31, v0
    v_lshrrev_b32 v31, 5, v0
    v_bfe_u32 v32, v0, 1, 3
    v_xor_b32 v32, v32, v31
    s_lshl_b32 s60, s51, 12
    v_lshlrev_b32 v33, 7, v30
    v_add_u32 v33, s60, v33
    v_xor_b32 v34, 0, v32
    v_lshl_add_u32 v2, v34, 4, v33
    v_xor_b32 v34, 2, v32
    v_lshl_add_u32 v3, v34, 4, v33
    v_xor_b32 v34, 4, v32
    v_lshl_add_u32 v4, v34, 4, v33
    v_xor_b32 v34, 6, v32
    v_lshl_add_u32 v5, v34, 4, v33
    v_bfe_u32 v32, v0, 2, 2
    v_lshl_add_u32 v33, v31, 3, v32
    v_mul_u32_u24 v34, 192, v33
    v_bfe_u32 v35, v0, 4, 1
    v_lshl_add_u32 v34, v35, 5, v34
    v_and_b32 v36, 3, v0
    v_lshl_add_u32 v34, v36, 3, v34
    v_add_u32 v6, 16384, v34
    v_lshlrev_b32 v33, 8, v33
    v_lshl_add_u32 v33, v35, 14, v33
    v_lshl_add_u32 v33, v36, 3, v33
    v_bfe_u32 v32, v0, 2, 3
    v_xor_b32 v34, 0, v32
    v_lshl_add_u32 v7, v34, 5, v33
    v_xor_b32 v34, 1, v32
    v_lshl_add_u32 v8, v34, 5, v33
    v_xor_b32 v34, 2, v32
    v_lshl_add_u32 v9, v34, 5, v33
    v_xor_b32 v34, 3, v32
    v_lshl_add_u32 v10, v34, 5, v33
    s_waitcnt vmcnt(6)
    s_barrier
    ds_read_b128 v[160:163], v2 offset:0
    ds_read_b64_tr_b16 v[32:33], v6 offset:0
    ds_read_b64_tr_b16 v[34:35], v6 offset:768
    ds_read_b64_tr_b16 v[36:37], v6 offset:64
    ds_read_b64_tr_b16 v[38:39], v6 offset:832
    ds_read_b128 v[164:167], v3 offset:0
    ds_read_b64_tr_b16 v[40:41], v6 offset:3072
    ds_read_b64_tr_b16 v[42:43], v6 offset:3840
    ds_read_b64_tr_b16 v[44:45], v6 offset:3136
    ds_read_b64_tr_b16 v[46:47], v6 offset:3904
    ds_read_b128 v[168:171], v4 offset:0
    ds_read_b64_tr_b16 v[48:49], v6 offset:6144
    ds_read_b64_tr_b16 v[50:51], v6 offset:6912
    ds_read_b64_tr_b16 v[52:53], v6 offset:6208
    ds_read_b64_tr_b16 v[54:55], v6 offset:6976
    s_waitcnt lgkmcnt(10)
    ds_read_b128 v[172:175], v5 offset:0
    ds_read_b64_tr_b16 v[56:57], v6 offset:9216
    ds_read_b64_tr_b16 v[58:59], v6 offset:9984
    ds_read_b64_tr_b16 v[60:61], v6 offset:9280
    ds_read_b64_tr_b16 v[62:63], v6 offset:10048
    s_add_u32 s19, s3, 2
    s_and_b32 s19, s19, 7
    s_lshl_b32 s15, s19, 7
    s_add_u32 s15, s15, s54
    s_mul_i32 s19, s19, 196608
    s_add_u32 m0, s57, 65536
    s_add_u32 s60, s15, 0
    buffer_load_dwordx4 v11, s[32:35], s60 offen lds
    s_add_u32 m0, s57, 66560
    s_add_u32 s60, s15, 8192
    buffer_load_dwordx4 v12, s[32:35], s60 offen lds
    s_add_u32 m0, s58, 81920
    s_add_u32 s60, s55, s19
    buffer_load_dwordx4 v13, s[36:39], s60 offen lds
    s_waitcnt lgkmcnt(15)
    v_mfma_f32_32x32x16_bf16 v[128:143], v[160:163], v[32:35], 0
    v_mfma_f32_32x32x16_bf16 v[144:159], v[160:163], v[36:39], 0
    s_waitcnt lgkmcnt(10)
    v_mfma_f32_32x32x16_bf16 v[128:143], v[164:167], v[40:43], v[128:143]
    v_mfma_f32_32x32x16_bf16 v[144:159], v[164:167], v[44:47], v[144:159]
    s_waitcnt vmcnt(6) lgkmcnt(0)
    s_barrier
    ds_read_b128 v[176:179], v2 offset:32768
    ds_read_b64_tr_b16 v[32:33], v6 offset:32768
    ds_read_b64_tr_b16 v[34:35], v6 offset:33536
    ds_read_b64_tr_b16 v[36:37], v6 offset:32832
    ds_read_b64_tr_b16 v[38:39], v6 offset:33600
    v_mfma_f32_32x32x16_bf16 v[128:143], v[168:171], v[48:51], v[128:143]
    v_mfma_f32_32x32x16_bf16 v[144:159], v[168:171], v[52:55], v[144:159]
    ds_read_b128 v[180:183], v3 offset:32768
    ds_read_b64_tr_b16 v[40:41], v6 offset:35840
    ds_read_b64_tr_b16 v[42:43], v6 offset:36608
    ds_read_b64_tr_b16 v[44:45], v6 offset:35904
    ds_read_b64_tr_b16 v[46:47], v6 offset:36672
    v_mfma_f32_32x32x16_bf16 v[128:143], v[172:175], v[56:59], v[128:143]
    v_mfma_f32_32x32x16_bf16 v[144:159], v[172:175], v[60:63], v[144:159]
    ds_read_b128 v[184:187], v4 offset:32768
    ds_read_b64_tr_b16 v[48:49], v6 offset:38912
    ds_read_b64_tr_b16 v[50:51], v6 offset:39680
    ds_read_b64_tr_b16 v[52:53], v6 offset:38976
    ds_read_b64_tr_b16 v[54:55], v6 offset:39744
    s_waitcnt lgkmcnt(10)
    ds_read_b128 v[188:191], v5 offset:32768
    ds_read_b64_tr_b16 v[56:57], v6 offset:41984
    ds_read_b64_tr_b16 v[58:59], v6 offset:42752
    ds_read_b64_tr_b16 v[60:61], v6 offset:42048
    ds_read_b64_tr_b16 v[62:63], v6 offset:42816
    s_add_u32 s19, s3, 3
    s_and_b32 s19, s19, 7
    s_lshl_b32 s15, s19, 7
    s_add_u32 s15, s15, s54
    s_mul_i32 s19, s19, 196608
    s_add_u32 m0, s57, 98304
    s_add_u32 s60, s15, 0
    buffer_load_dwordx4 v11, s[32:35], s60 offen lds
    s_add_u32 m0, s57, 99328
    s_add_u32 s60, s15, 8192
    buffer_load_dwordx4 v12, s[32:35], s60 offen lds
    s_add_u32 m0, s58, 114688
    s_add_u32 s60, s55, s19
    buffer_load_dwordx4 v13, s[36:39], s60 offen lds
    s_waitcnt lgkmcnt(15)
    v_mfma_f32_32x32x16_bf16 v[128:143], v[176:179], v[32:35], v[128:143]
    v_mfma_f32_32x32x16_bf16 v[144:159], v[176:179], v[36:39], v[144:159]
    s_waitcnt vmcnt(6)
    s_mov_b32 s63, 0xffff0000
    v_lshlrev_b32 v30, 16, v16
    v_and_b32 v16, s63, v16
    v_lshlrev_b32 v31, 16, v20
    v_and_b32 v20, s63, v20
    v_mul_f32 v30, v30, v31
    v_mul_f32 v31, v16, v20
    v_cvt_pk_bf16_f32 v30, v30, v31
    v_and_b32 v31, s63, v30
    v_lshlrev_b32 v30, 16, v30
    v_add_f32 v26, v30, v31
    v_lshlrev_b32 v30, 16, v17
    v_and_b32 v17, s63, v17
    v_lshlrev_b32 v31, 16, v21
    v_and_b32 v21, s63, v21
    v_mul_f32 v30, v30, v31
    v_mul_f32 v31, v17, v21
    v_cvt_pk_bf16_f32 v30, v30, v31
    v_and_b32 v31, s63, v30
    v_lshlrev_b32 v30, 16, v30
    v_add_f32 v26, v26, v30
    v_add_f32 v26, v26, v31
    v_lshlrev_b32 v30, 16, v18
    v_and_b32 v18, s63, v18
    v_lshlrev_b32 v31, 16, v22
    v_and_b32 v22, s63, v22
    v_mul_f32 v30, v30, v31
    v_mul_f32 v31, v18, v22
    v_cvt_pk_bf16_f32 v30, v30, v31
    v_and_b32 v31, s63, v30
    v_lshlrev_b32 v30, 16, v30
    v_add_f32 v26, v26, v30
    v_add_f32 v26, v26, v31
    v_lshlrev_b32 v30, 16, v19
    v_and_b32 v19, s63, v19
    v_lshlrev_b32 v31, 16, v23
    v_and_b32 v23, s63, v23
    v_mul_f32 v30, v30, v31
    v_mul_f32 v31, v19, v23
    v_cvt_pk_bf16_f32 v30, v30, v31
    v_and_b32 v31, s63, v30
    v_lshlrev_b32 v30, 16, v30
    v_add_f32 v26, v26, v30
    v_add_f32 v26, v26, v31
    s_nop 1
    v_add_f32_dpp v26, v26, v26 row_ror:8 row_mask:0xf bank_mask:0xf
    s_nop 1
    v_add_f32_dpp v26, v26, v26 row_ror:4 row_mask:0xf bank_mask:0xf
    s_nop 1
    v_add_f32_dpp v26, v26, v26 row_ror:2 row_mask:0xf bank_mask:0xf
    s_nop 1
    v_add_f32_dpp v26, v26, v26 row_ror:1 row_mask:0xf bank_mask:0xf
    s_nop 1
    v_readlane_b32 s60, v26, 0
    v_readlane_b32 s61, v26, 16
    v_readlane_b32 s62, v26, 32
    v_readlane_b32 s63, v26, 48
    s_nop 1
    v_mov_b32 v26, s60
    v_add_f32 v26, s61, v26
    v_add_f32 v26, s62, v26
    v_add_f32 v26, s63, v26
    v_cvt_pk_bf16_f32 v26, v26, v26
    v_lshlrev_b32 v26, 16, v26
    v_mul_f32 v26, 0xbfb8aa3b, v26
    v_exp_f32 v26, v26
    s_nop 0
    v_add_f32 v26, 1.0, v26
    v_rcp_f32 v26, v26
    s_nop 0
    v_cvt_pk_bf16_f32 v26, v26, v26
    v_lshlrev_b32 v26, 16, v26
    s_mov_b32 s72, s22
    s_and_b32 s73, s23, 0xffff
    s_mov_b32 s74, 0x100
    s_mov_b32 s75, 0x00020000
    buffer_load_dword v16, v24, s[72:75], 0 offen sc1
    s_waitcnt lgkmcnt(10)
    v_mfma_f32_32x32x16_bf16 v[128:143], v[180:183], v[40:43], v[128:143]
    v_mfma_f32_32x32x16_bf16 v[144:159], v[180:183], v[44:47], v[144:159]
    s_waitcnt vmcnt(4) lgkmcnt(0)
    s_barrier
    v_add_u32 v2, 0x10000, v2
    v_add_u32 v3, 0x10000, v3
    v_add_u32 v4, 0x10000, v4
    v_add_u32 v5, 0x10000, v5
    v_add_u32 v6, 0x10000, v6
    ds_read_b128 v[192:195], v2 offset:0
    ds_read_b64_tr_b16 v[32:33], v6 offset:0
    ds_read_b64_tr_b16 v[34:35], v6 offset:768
    ds_read_b64_tr_b16 v[36:37], v6 offset:64
    ds_read_b64_tr_b16 v[38:39], v6 offset:832
    v_mfma_f32_32x32x16_bf16 v[128:143], v[184:187], v[48:51], v[128:143]
    v_mfma_f32_32x32x16_bf16 v[144:159], v[184:187], v[52:55], v[144:159]
    ds_read_b128 v[196:199], v3 offset:0
    ds_read_b64_tr_b16 v[40:41], v6 offset:3072
    ds_read_b64_tr_b16 v[42:43], v6 offset:3840
    ds_read_b64_tr_b16 v[44:45], v6 offset:3136
    ds_read_b64_tr_b16 v[46:47], v6 offset:3904
    v_mfma_f32_32x32x16_bf16 v[128:143], v[188:191], v[56:59], v[128:143]
    v_mfma_f32_32x32x16_bf16 v[144:159], v[188:191], v[60:63], v[144:159]
    ds_read_b128 v[200:203], v4 offset:0
    ds_read_b64_tr_b16 v[48:49], v6 offset:6144
    ds_read_b64_tr_b16 v[50:51], v6 offset:6912
    ds_read_b64_tr_b16 v[52:53], v6 offset:6208
    ds_read_b64_tr_b16 v[54:55], v6 offset:6976
    s_waitcnt lgkmcnt(10)
    ds_read_b128 v[204:207], v5 offset:0
    ds_read_b64_tr_b16 v[56:57], v6 offset:9216
    ds_read_b64_tr_b16 v[58:59], v6 offset:9984
    ds_read_b64_tr_b16 v[60:61], v6 offset:9280
    ds_read_b64_tr_b16 v[62:63], v6 offset:10048
    s_add_u32 s19, s3, 4
    s_and_b32 s19, s19, 7
    s_lshl_b32 s15, s19, 7
    s_add_u32 s15, s15, s54
    s_mul_i32 s19, s19, 196608
    s_add_u32 m0, s57, 131072
    s_add_u32 s60, s15, 0
    buffer_load_dwordx4 v11, s[32:35], s60 offen lds
    s_add_u32 m0, s57, 132096
    s_add_u32 s60, s15, 8192
    buffer_load_dwordx4 v12, s[32:35], s60 offen lds
    s_add_u32 m0, s58, 147456
    s_add_u32 s60, s55, s19
    buffer_load_dwordx4 v13, s[36:39], s60 offen lds
    s_waitcnt lgkmcnt(15)
    v_mfma_f32_32x32x16_bf16 v[128:143], v[192:195], v[32:35], v[128:143]
    v_mfma_f32_32x32x16_bf16 v[144:159], v[192:195], v[36:39], v[144:159]
    s_waitcnt lgkmcnt(10)
    v_mfma_f32_32x32x16_bf16 v[128:143], v[196:199], v[40:43], v[128:143]
    v_mfma_f32_32x32x16_bf16 v[144:159], v[196:199], v[44:47], v[144:159]
    s_waitcnt vmcnt(4) lgkmcnt(0)
    s_barrier
    ds_read_b128 v[208:211], v2 offset:32768
    ds_read_b64_tr_b16 v[32:33], v6 offset:32768
    ds_read_b64_tr_b16 v[34:35], v6 offset:33536
    ds_read_b64_tr_b16 v[36:37], v6 offset:32832
    ds_read_b64_tr_b16 v[38:39], v6 offset:33600
    v_mfma_f32_32x32x16_bf16 v[128:143], v[200:203], v[48:51], v[128:143]
    v_mfma_f32_32x32x16_bf16 v[144:159], v[200:203], v[52:55], v[144:159]
    ds_read_b128 v[212:215], v3 offset:32768
    ds_read_b64_tr_b16 v[40:41], v6 offset:35840
    ds_read_b64_tr_b16 v[42:43], v6 offset:36608
    ds_read_b64_tr_b16 v[44:45], v6 offset:35904
    ds_read_b64_tr_b16 v[46:47], v6 offset:36672
    v_mfma_f32_32x32x16_bf16 v[128:143], v[204:207], v[56:59], v[128:143]
    v_mfma_f32_32x32x16_bf16 v[144:159], v[204:207], v[60:63], v[144:159]
    ds_read_b128 v[216:219], v4 offset:32768
    ds_read_b64_tr_b16 v[48:49], v6 offset:38912
    ds_read_b64_tr_b16 v[50:51], v6 offset:39680
    ds_read_b64_tr_b16 v[52:53], v6 offset:38976
    ds_read_b64_tr_b16 v[54:55], v6 offset:39744
    s_waitcnt lgkmcnt(10)
    ds_read_b128 v[220:223], v5 offset:32768
    ds_read_b64_tr_b16 v[56:57], v6 offset:41984
    ds_read_b64_tr_b16 v[58:59], v6 offset:42752
    ds_read_b64_tr_b16 v[60:61], v6 offset:42048
    ds_read_b64_tr_b16 v[62:63], v6 offset:42816
    s_add_u32 s19, s3, 5
    s_and_b32 s19, s19, 7
    s_lshl_b32 s15, s19, 7
    s_add_u32 s15, s15, s54
    s_mul_i32 s19, s19, 196608
    s_add_u32 m0, s57, 0
    s_add_u32 s60, s15, 0
    buffer_load_dwordx4 v11, s[32:35], s60 offen lds
    s_add_u32 m0, s57, 1024
    s_add_u32 s60, s15, 8192
    buffer_load_dwordx4 v12, s[32:35], s60 offen lds
    s_add_u32 m0, s58, 16384
    s_add_u32 s60, s55, s19
    buffer_load_dwordx4 v13, s[36:39], s60 offen lds
    s_waitcnt lgkmcnt(15)
    v_mfma_f32_32x32x16_bf16 v[128:143], v[208:211], v[32:35], v[128:143]
    v_mfma_f32_32x32x16_bf16 v[144:159], v[208:211], v[36:39], v[144:159]
    s_waitcnt lgkmcnt(10)
    v_mfma_f32_32x32x16_bf16 v[128:143], v[212:215], v[40:43], v[128:143]
    v_mfma_f32_32x32x16_bf16 v[144:159], v[212:215], v[44:47], v[144:159]
    s_waitcnt vmcnt(3) lgkmcnt(0)
    s_barrier
    v_add_u32 v2, 0x10000, v2
    v_add_u32 v3, 0x10000, v3
    v_add_u32 v4, 0x10000, v4
    v_add_u32 v5, 0x10000, v5
    v_add_u32 v6, 0x10000, v6
    ds_read_b128 v[224:227], v2 offset:0
    ds_read_b64_tr_b16 v[32:33], v6 offset:0
    ds_read_b64_tr_b16 v[34:35], v6 offset:768
    ds_read_b64_tr_b16 v[36:37], v6 offset:64
    ds_read_b64_tr_b16 v[38:39], v6 offset:832
    v_mfma_f32_32x32x16_bf16 v[128:143], v[216:219], v[48:51], v[128:143]
    v_mfma_f32_32x32x16_bf16 v[144:159], v[216:219], v[52:55], v[144:159]
    ds_read_b128 v[228:231], v3 offset:0
    ds_read_b64_tr_b16 v[40:41], v6 offset:3072
    ds_read_b64_tr_b16 v[42:43], v6 offset:3840
    ds_read_b64_tr_b16 v[44:45], v6 offset:3136
    ds_read_b64_tr_b16 v[46:47], v6 offset:3904
    v_mfma_f32_32x32x16_bf16 v[128:143], v[220:223], v[56:59], v[128:143]
    v_mfma_f32_32x32x16_bf16 v[144:159], v[220:223], v[60:63], v[144:159]
    ds_read_b128 v[232:235], v4 offset:0
    ds_read_b64_tr_b16 v[48:49], v6 offset:6144
    ds_read_b64_tr_b16 v[50:51], v6 offset:6912
    ds_read_b64_tr_b16 v[52:53], v6 offset:6208
    ds_read_b64_tr_b16 v[54:55], v6 offset:6976
    s_waitcnt lgkmcnt(10)
    ds_read_b128 v[236:239], v5 offset:0
    ds_read_b64_tr_b16 v[56:57], v6 offset:9216
    ds_read_b64_tr_b16 v[58:59], v6 offset:9984
    ds_read_b64_tr_b16 v[60:61], v6 offset:9280
    ds_read_b64_tr_b16 v[62:63], v6 offset:10048
    s_add_u32 s19, s3, 6
    s_and_b32 s19, s19, 7
    s_lshl_b32 s15, s19, 7
    s_add_u32 s15, s15, s54
    s_mul_i32 s19, s19, 196608
    s_add_u32 m0, s57, 32768
    s_add_u32 s60, s15, 0
    buffer_load_dwordx4 v11, s[32:35], s60 offen lds
    s_add_u32 m0, s57, 33792
    s_add_u32 s60, s15, 8192
    buffer_load_dwordx4 v12, s[32:35], s60 offen lds
    s_add_u32 m0, s58, 49152
    s_add_u32 s60, s55, s19
    buffer_load_dwordx4 v13, s[36:39], s60 offen lds
    s_waitcnt lgkmcnt(15)
    v_mfma_f32_32x32x16_bf16 v[128:143], v[224:227], v[32:35], v[128:143]
    v_mfma_f32_32x32x16_bf16 v[144:159], v[224:227], v[36:39], v[144:159]
    s_waitcnt lgkmcnt(10)
    v_mfma_f32_32x32x16_bf16 v[128:143], v[228:231], v[40:43], v[128:143]
    v_mfma_f32_32x32x16_bf16 v[144:159], v[228:231], v[44:47], v[144:159]
    s_waitcnt vmcnt(3) lgkmcnt(0)
    s_barrier
    v_add_u32 v2, 0xfffe0000, v2
    v_add_u32 v3, 0xfffe0000, v3
    v_add_u32 v4, 0xfffe0000, v4
    v_add_u32 v5, 0xfffe0000, v5
    v_add_u32 v6, 0xfffe0000, v6
    ds_read_b128 v[240:243], v2 offset:0
    ds_read_b64_tr_b16 v[32:33], v6 offset:0
    ds_read_b64_tr_b16 v[34:35], v6 offset:768
    ds_read_b64_tr_b16 v[36:37], v6 offset:64
    ds_read_b64_tr_b16 v[38:39], v6 offset:832
    v_mfma_f32_32x32x16_bf16 v[128:143], v[232:235], v[48:51], v[128:143]
    v_mfma_f32_32x32x16_bf16 v[144:159], v[232:235], v[52:55], v[144:159]
    ds_read_b128 v[244:247], v3 offset:0
    ds_read_b64_tr_b16 v[40:41], v6 offset:3072
    ds_read_b64_tr_b16 v[42:43], v6 offset:3840
    ds_read_b64_tr_b16 v[44:45], v6 offset:3136
    ds_read_b64_tr_b16 v[46:47], v6 offset:3904
    v_mfma_f32_32x32x16_bf16 v[128:143], v[236:239], v[56:59], v[128:143]
    v_mfma_f32_32x32x16_bf16 v[144:159], v[236:239], v[60:63], v[144:159]
    ds_read_b128 v[248:251], v4 offset:0
    ds_read_b64_tr_b16 v[48:49], v6 offset:6144
    ds_read_b64_tr_b16 v[50:51], v6 offset:6912
    ds_read_b64_tr_b16 v[52:53], v6 offset:6208
    ds_read_b64_tr_b16 v[54:55], v6 offset:6976
    s_waitcnt lgkmcnt(10)
    ds_read_b128 v[252:255], v5 offset:0
    ds_read_b64_tr_b16 v[56:57], v6 offset:9216
    ds_read_b64_tr_b16 v[58:59], v6 offset:9984
    ds_read_b64_tr_b16 v[60:61], v6 offset:9280
    ds_read_b64_tr_b16 v[62:63], v6 offset:10048
    s_add_u32 s19, s3, 7
    s_and_b32 s19, s19, 7
    s_lshl_b32 s15, s19, 7
    s_add_u32 s15, s15, s54
    s_mul_i32 s19, s19, 196608
    s_add_u32 m0, s57, 65536
    s_add_u32 s60, s15, 0
    buffer_load_dwordx4 v11, s[32:35], s60 offen lds
    s_add_u32 m0, s57, 66560
    s_add_u32 s60, s15, 8192
    buffer_load_dwordx4 v12, s[32:35], s60 offen lds
    s_add_u32 m0, s58, 81920
    s_add_u32 s60, s55, s19
    buffer_load_dwordx4 v13, s[36:39], s60 offen lds
    s_waitcnt lgkmcnt(15)
    v_mfma_f32_32x32x16_bf16 v[128:143], v[240:243], v[32:35], v[128:143]
    v_mfma_f32_32x32x16_bf16 v[144:159], v[240:243], v[36:39], v[144:159]
    s_waitcnt lgkmcnt(10)
    v_mfma_f32_32x32x16_bf16 v[128:143], v[244:247], v[40:43], v[128:143]
    v_mfma_f32_32x32x16_bf16 v[144:159], v[244:247], v[44:47], v[144:159]
    s_waitcnt vmcnt(3) lgkmcnt(0)
    s_barrier
    ds_read_b128 v[160:163], v2 offset:32768
    ds_read_b64_tr_b16 v[32:33], v6 offset:32768
    ds_read_b64_tr_b16 v[34:35], v6 offset:33536
    ds_read_b64_tr_b16 v[36:37], v6 offset:32832
    ds_read_b64_tr_b16 v[38:39], v6 offset:33600
    v_mfma_f32_32x32x16_bf16 v[128:143], v[248:251], v[48:51], v[128:143]
    v_mfma_f32_32x32x16_bf16 v[144:159], v[248:251], v[52:55], v[144:159]
    ds_read_b128 v[164:167], v3 offset:32768
    ds_read_b64_tr_b16 v[40:41], v6 offset:35840
    ds_read_b64_tr_b16 v[42:43], v6 offset:36608
    ds_read_b64_tr_b16 v[44:45], v6 offset:35904
    ds_read_b64_tr_b16 v[46:47], v6 offset:36672
    v_mfma_f32_32x32x16_bf16 v[128:143], v[252:255], v[56:59], v[128:143]
    v_mfma_f32_32x32x16_bf16 v[144:159], v[252:255], v[60:63], v[144:159]
    ds_read_b128 v[168:171], v4 offset:32768
    ds_read_b64_tr_b16 v[48:49], v6 offset:38912
    ds_read_b64_tr_b16 v[50:51], v6 offset:39680
    ds_read_b64_tr_b16 v[52:53], v6 offset:38976
    ds_read_b64_tr_b16 v[54:55], v6 offset:39744
    s_waitcnt lgkmcnt(10)
    ds_read_b128 v[172:175], v5 offset:32768
    ds_read_b64_tr_b16 v[56:57], v6 offset:41984
    ds_read_b64_tr_b16 v[58:59], v6 offset:42752
    ds_read_b64_tr_b16 v[60:61], v6 offset:42048
    ds_read_b64_tr_b16 v[62:63], v6 offset:42816
    s_waitcnt lgkmcnt(15)
    v_mfma_f32_32x32x16_bf16 v[128:143], v[160:163], v[32:35], v[128:143]
    v_mfma_f32_32x32x16_bf16 v[144:159], v[160:163], v[36:39], v[144:159]
    s_waitcnt lgkmcnt(10)
    v_mfma_f32_32x32x16_bf16 v[128:143], v[164:167], v[40:43], v[128:143]
    v_mfma_f32_32x32x16_bf16 v[144:159], v[164:167], v[44:47], v[144:159]
    v_readfirstlane_b32 s26, v25
    v_readfirstlane_b32 s60, v16
    s_nop 3
    s_mul_i32 s26, s26, 1664525
    s_add_u32 s26, s26, 1013904223
    s_or_b32 s26, s26, 1
    s_cmp_lg_u32 s60, 0
    s_cselect_b32 s26, s60, s26
    v_readfirstlane_b32 s22, v26
    s_cmp_lg_u32 s69, 1793
    s_cbranch_scc1 NOUPD_26
    v_mov_b32 v30, s26
    s_mov_b32 s60, 0xf04000
    s_mov_b64 exec, 1
    buffer_store_dword v30, v24, s[72:75], 0 offen sc1
    s_waitcnt vmcnt(0)
    buffer_store_dword v30, v24, s[28:31], s60 offen sc1
    s_mov_b64 exec, -1
    s_waitcnt vmcnt(0)
NOUPD_26:
    s_waitcnt vmcnt(0) lgkmcnt(0)
    s_barrier
    v_add_u32 v2, 0x10000, v2
    v_add_u32 v3, 0x10000, v3
    v_add_u32 v4, 0x10000, v4
    v_add_u32 v5, 0x10000, v5
    v_add_u32 v6, 0x10000, v6
    ds_read_b128 v[176:179], v2 offset:0
    ds_read_b64_tr_b16 v[32:33], v6 offset:0
    ds_read_b64_tr_b16 v[34:35], v6 offset:768
    ds_read_b64_tr_b16 v[36:37], v6 offset:64
    ds_read_b64_tr_b16 v[38:39], v6 offset:832
    v_mfma_f32_32x32x16_bf16 v[128:143], v[168:171], v[48:51], v[128:143]
    v_mfma_f32_32x32x16_bf16 v[144:159], v[168:171], v[52:55], v[144:159]
    ds_read_b128 v[180:183], v3 offset:0
    ds_read_b64_tr_b16 v[40:41], v6 offset:3072
    ds_read_b64_tr_b16 v[42:43], v6 offset:3840
    ds_read_b64_tr_b16 v[44:45], v6 offset:3136
    ds_read_b64_tr_b16 v[46:47], v6 offset:3904
    v_mfma_f32_32x32x16_bf16 v[128:143], v[172:175], v[56:59], v[128:143]
    v_mfma_f32_32x32x16_bf16 v[144:159], v[172:175], v[60:63], v[144:159]
    ds_read_b128 v[184:187], v4 offset:0
    ds_read_b64_tr_b16 v[48:49], v6 offset:6144
    ds_read_b64_tr_b16 v[50:51], v6 offset:6912
    ds_read_b64_tr_b16 v[52:53], v6 offset:6208
    ds_read_b64_tr_b16 v[54:55], v6 offset:6976
    s_waitcnt lgkmcnt(10)
    ds_read_b128 v[188:191], v5 offset:0
    ds_read_b64_tr_b16 v[56:57], v6 offset:9216
    ds_read_b64_tr_b16 v[58:59], v6 offset:9984
    ds_read_b64_tr_b16 v[60:61], v6 offset:9280
    ds_read_b64_tr_b16 v[62:63], v6 offset:10048
    s_waitcnt lgkmcnt(15)
    v_mfma_f32_32x32x16_bf16 v[128:143], v[176:179], v[32:35], v[128:143]
    v_mfma_f32_32x32x16_bf16 v[144:159], v[176:179], v[36:39], v[144:159]
    s_waitcnt lgkmcnt(10)
    v_mfma_f32_32x32x16_bf16 v[128:143], v[180:183], v[40:43], v[128:143]
    v_mfma_f32_32x32x16_bf16 v[144:159], v[180:183], v[44:47], v[144:159]
    s_waitcnt lgkmcnt(0)
    v_mfma_f32_32x32x16_bf16 v[128:143], v[184:187], v[48:51], v[128:143]
    v_mfma_f32_32x32x16_bf16 v[144:159], v[184:187], v[52:55], v[144:159]
    v_mfma_f32_32x32x16_bf16 v[128:143], v[188:191], v[56:59], v[128:143]
    v_mfma_f32_32x32x16_bf16 v[144:159], v[188:191], v[60:63], v[144:159]
    s_nop 7
    s_nop 3
    s_mul_i32 s60, s49, 3
    s_add_u32 s60, s60, 0
    s_and_b32 s61, s60, 15
    s_lshl_b32 s61, s61, 7
    s_lshl_b32 s62, s48, 2
    s_add_u32 s62, s62, s51
    s_add_u32 s61, s61, s62
    s_lshl_b32 s61, s61, 11
    s_add_u32 s72, s61, 0x200400
    s_add_u32 s73, s72, 512
    v_bfe_u32 v30, v0, 4, 1
    v_lshlrev_b32 v30, 17, v30
    v_lshrrev_b32 v31, 5, v0
    v_lshl_add_u32 v30, v31, 8, v30
    v_and_b32 v31, 15, v0
    v_lshl_add_u32 v15, v31, 4, v30
    v_cvt_pk_bf16_f32 v128, v128, v129
    v_cvt_pk_bf16_f32 v129, v130, v131
    v_cvt_pk_bf16_f32 v130, v132, v133
    v_cvt_pk_bf16_f32 v131, v134, v135
    v_cvt_pk_bf16_f32 v132, v136, v137
    v_cvt_pk_bf16_f32 v133, v138, v139
    v_cvt_pk_bf16_f32 v134, v140, v141
    v_cvt_pk_bf16_f32 v135, v142, v143
    s_mul_i32 s60, s49, 3
    s_add_u32 s60, s60, 1
    s_and_b32 s61, s60, 15
    s_lshl_b32 s61, s61, 7
    s_lshl_b32 s62, s48, 2
    s_add_u32 s62, s62, s51
    s_add_u32 s61, s61, s62
    s_lshl_b32 s61, s61, 11
    s_add_u32 s74, s61, 0x200400
    s_add_u32 s75, s74, 512
    v_cvt_pk_bf16_f32 v144, v144, v145
    v_cvt_pk_bf16_f32 v145, v146, v147
    v_cvt_pk_bf16_f32 v146, v148, v149
    v_cvt_pk_bf16_f32 v147, v150, v151
    v_cvt_pk_bf16_f32 v148, v152, v153
    v_cvt_pk_bf16_f32 v149, v154, v155
    v_cvt_pk_bf16_f32 v150, v156, v157
    v_cvt_pk_bf16_f32 v151, v158, v159
    buffer_store_dwordx4 v[128:131], v15, s[28:31], s72 offen sc1
    buffer_store_dwordx4 v[132:135], v15, s[28:31], s73 offen sc1
    buffer_store_dwordx4 v[144:147], v15, s[28:31], s74 offen sc1
    buffer_store_dwordx4 v[148:151], v15, s[28:31], s75 offen sc1
    s_waitcnt vmcnt(0)
    s_barrier
    s_cmp_lg_u32 s27, 0
    s_cbranch_scc1 QF_27
    v_mov_b32 v30, 0
    v_mov_b32 v31, s26
    s_mov_b64 exec, 1
    buffer_store_dword v31, v30, s[28:31], s70 offen sc1
    s_mov_b64 exec, -1
QF_27:
    s_lshl_b32 s57, s69, 12
    s_add_u32 s57, s57, 0xfb0000
    s_lshr_b32 s60, s64, 1
    v_lshrrev_b32 v30, 4, v0
    v_add_u32 v30, 1, v30
    v_cmp_gt_u32 vcc, 3, v30
    s_nop 1
    v_cndmask_b32 v30, 0, v30, vcc
    v_lshlrev_b32 v30, 4, v30
    v_add_u32 v30, s60, v30
    v_mul_u32_u24 v30, 43691, v30
    v_lshrrev_b32 v30, 17, v30
    v_and_b32 v31, 15, v0
    s_lshl_b32 s61, s65, 1
    v_add_u32 v24, s61, v31
    v_cndmask_b32 v31, v24, v31, vcc
    v_lshl_add_u32 v30, v30, 4, v31
    v_lshlrev_b32 v30, 7, v30
    s_mov_b32 s60, 0xf10000
    s_mov_b32 exec_lo, 0xffffffff
    s_mov_b32 exec_hi, 0x3
    buffer_load_dword v31, v30, s[28:31], s60 offen sc1
    s_mov_b64 exec, -1
    s_mov_b32 s32, s16
    s_and_b32 s33, s17, 0xffff
    s_mov_b32 s34, 0x1c0000
    s_mov_b32 s35, 0x00020000
    s_mov_b32 s36, s8
    s_and_b32 s37, s9, 0xffff
    s_mov_b32 s38, 0x80000
    s_mov_b32 s39, 0x00020000
    s_mul_i32 s54, s52, 16640
    s_add_u32 s54, s54, 32768
    v_add_u32 v2, s54, v1
    v_lshrrev_b32 v236, 5, v0
    v_lshlrev_b32 v232, 8, v236
    v_and_b32 v233, 15, v0
    v_lshl_add_u32 v232, v233, 4, v232
    v_and_b32 v233, 11, v0
    v_cmp_eq_u32 vcc, 0, v233
    v_mov_b32 v234, 16
    s_nop 0
    v_cndmask_b32 v234, v234, 0, vcc
    v_add_u32 v235, 1024, v234
    v_add_u32 v234, 512, v234
    v_cndmask_b32 v3, v235, v232, s[0:1]
    v_cndmask_b32 v4, v234, v232, s[0:1]
    v_add_u32 v3, s54, v3
    v_add_u32 v4, s54, v4
    v_lshrrev_b32 v232, 3, v0
    v_lshlrev_b32 v232, 10, v232
    v_bfe_u32 v233, v0, 4, 1
    v_lshlrev_b32 v234, 2, v233
    v_and_b32 v235, 7, v0
    v_xor_b32 v234, v234, v235
    v_lshl_add_u32 v11, v234, 4, v232
    v_add_u32 v12, 7168, v11
    s_mul_i32 s54, s13, 114688
    v_add_u32 v13, s54, v1
    v_bfe_u32 v234, v0, 2, 2
    v_lshl_add_u32 v232, v236, 2, v234
    v_lshlrev_b32 v232, 7, v232
    v_lshrrev_b32 v234, 1, v234
    v_lshl_add_u32 v232, v234, 6, v232
    v_lshl_add_u32 v232, v233, 5, v232
    v_and_b32 v234, 3, v0
    v_lshl_add_u32 v232, v234, 3, v232
    s_lshl_b32 s54, s14, 5
    v_xor_b32 v232, s54, v232
    v_add_u32 v5, s11, v232
    v_xor_b32 v6, 64, v5
    s_mul_i32 s54, s27, 14
    s_add_u32 s55, s54, 13
    s_lshr_b32 s54, s54, 2
    s_lshr_b32 s55, s55, 2
    v_and_b32 v14, 7, v0
    v_add_u32 v14, s54, v14
    v_min_u32 v14, s55, v14
    v_bfe_u32 v232, v0, 3, 1
    s_lshl_b32 s54, s4, 1
    v_add_u32 v232, s54, v232
    v_lshl_add_u32 v14, v232, 5, v14
    v_lshlrev_b32 v14, 7, v14
    v_and_b32 v232, 31, v0
    v_mul_u32_u24 v232, 2080, v232
    v_lshrrev_b32 v233, 5, v0
    v_lshl_add_u32 v232, v233, 4, v232
    v_cmp_eq_u32 vcc, 0, v233
    v_mov_b32 v236, 0x3f803f80
    s_nop 0
    v_cndmask_b32 v236, 0, v236, vcc
    v_mov_b32 v237, v236
    v_mov_b32 v238, v236
    v_mov_b32 v239, v236
    ds_write_b128 v232, v[236:239] offset:34816
    s_mov_b32 s40, s20
    s_and_b32 s41, s21, 0xffff
    s_mov_b32 s42, 0x200000
    s_mov_b32 s43, 0x00020000
    s_lshl_b32 s72, s4, 1
    s_add_u32 s72, s72, s13
    s_lshl_b32 s73, s72, 5
    s_lshl_b32 s74, s14, 3
    s_add_u32 s73, s73, s74
    s_lshl_b32 s54, s73, 10
    s_add_u32 s54, s54, 0x600000
    s_add_u32 s55, s54, 4096
    s_lshl_b32 s56, s72, 15
    s_lshl_b32 s74, s5, 7
    s_add_u32 s56, s56, s74
    s_lshl_b32 s74, s14, 5
    s_add_u32 s56, s56, s74
    s_lshl_b32 s59, s72, 8
    s_add_u32 s59, s59, 0xf00000
    s_lshl_b32 s58, s65, 3
    s_lshl_b32 s73, s51, 1
    s_add_u32 s58, s58, s73
    s_add_u32 s58, s58, s52
    s_lshl_b32 s58, s58, 8
    s_add_u32 s58, s58, 0xf00000
    s_lshl_b32 s72, s14, 1
    s_lshr_b32 s73, s4, 2
    s_lshl_b32 s73, s73, 5
    s_add_u32 s72, s72, s73
    s_lshl_b32 s73, s69, 3
    s_add_u32 s73, s73, 0xf00000
    s_xor_b32 s60, s13, 1
    s_mul_i32 s60, s60, 114688
    v_add_u32 v7, s60, v1
    s_mul_i32 s60, s27, 2560
    s_add_u32 s60, s60, 99328
    v_add_u32 v8, s60, v1
    s_xor_b32 s60, s27, 4
    s_mul_i32 s60, s60, 2560
    s_add_u32 s60, s60, 99328
    v_add_u32 v9, s60, v1
    v_bfe_u32 v10, v0, 2, 1
    v_and_b32 v232, 3, v0
    v_lshl_add_u32 v10, v232, 3, v10
    v_add_u32 v10, s72, v10
    v_lshlrev_b32 v10, 7, v10
    s_waitcnt vmcnt(0)
    v_cmp_ne_u32 vcc, s26, v31
    s_and_b32 vcc_lo, vcc_lo, 0xffffffff
    s_and_b32 vcc_hi, vcc_hi, 0x3
    s_or_b32 s60, vcc_lo, vcc_hi
    s_cbranch_scc0 FOK_28
    s_mov_b32 s60, 0xf10000
    s_mov_b32 s61, 0x80000
    s_mov_b32 exec_lo, 0xffffffff
    s_mov_b32 exec_hi, 0x3
POLL_29:
    buffer_load_dword v31, v30, s[28:31], s60 offen sc1
    s_waitcnt vmcnt(0)
    v_cmp_ne_u32 vcc, s26, v31
    s_cbranch_vccz POLLD_30
    s_mov_b64 exec, vcc
    s_sub_u32 s61, s61, 1
    s_cbranch_scc0 POLL_29
POLLD_30:
    s_mov_b64 exec, -1
FOK_28:
    s_xor_b32 s60, s68, 1024
    buffer_load_dwordx4 v[16:19], v1, s[28:31], s60 offen sc1
    buffer_load_dwordx4 v[20:23], v1, s[28:31], s68 offen sc1
    s_lshl_b32 s60, s64, 17
    s_add_u32 s60, s60, 0x200000
    buffer_load_dwordx4 v[224:227], v1, s[28:31], s60 offen sc1
    s_add_u32 m0, s67, 0
    s_nop 0
    buffer_load_dwordx4 v1, s[28:31], s66 offen sc1 lds
    buffer_load_dwordx4 v1, s[28:31], s66 offen offset:1024 sc1 lds
    s_add_u32 m0, s67, 8320
    s_add_u32 s66, s66, 8192
    buffer_load_dwordx4 v1, s[28:31], s66 offen sc1 lds
    buffer_load_dwordx4 v1, s[28:31], s66 offen offset:1024 sc1 lds
    s_add_u32 s66, s66, 8192
    s_waitcnt vmcnt(0) lgkmcnt(0)
    s_barrier
    v_mfma_f32_32x32x16_bf16 v[128:143], v[224:227], v[16:19], 0
    v_mfma_f32_32x32x16_bf16 v[144:159], v[224:227], v[20:23], 0
    s_nop 7
    s_nop 7
    v_max3_f32 v232, v128, v129, v130
    v_max3_f32 v232, v232, v131, v132
    v_max3_f32 v232, v232, v133, v134
    v_max3_f32 v232, v232, v135, v136
    v_max3_f32 v232, v232, v137, v138
    v_max3_f32 v232, v232, v139, v140
    v_max3_f32 v232, v232, v141, v142
    v_max_f32 v232, v232, v143
    v_mov_b32 v234, v232
    s_nop 1
    v_permlane32_swap_b32 v232, v234
    s_nop 1
    v_max_f32 v232, v232, v234
    v_max3_f32 v233, v144, v145, v146
    v_max3_f32 v233, v233, v147, v148
    v_max3_f32 v233, v233, v149, v150
    v_max3_f32 v233, v233, v151, v152
    v_max3_f32 v233, v233, v153, v154
    v_max3_f32 v233, v233, v155, v156
    v_max3_f32 v233, v233, v157, v158
    v_max_f32 v233, v233, v159
    v_mov_b32 v234, v233
    s_nop 1
    v_permlane32_swap_b32 v233, v234
    s_nop 1
    v_max_f32 v233, v233, v234
    v_min_f32 v232, v232, v233
    v_sub_f32 v240, 0, v232
    v_sub_f32 v241, 0, v232
    v_sub_f32 v242, 0, v232
    v_sub_f32 v243, 0, v232
    v_sub_f32 v244, 0, v232
    v_sub_f32 v245, 0, v232
    v_sub_f32 v246, 0, v232
    v_sub_f32 v247, 0, v232
    v_sub_f32 v248, 0, v232
    v_sub_f32 v249, 0, v232
    v_sub_f32 v250, 0, v232
    v_sub_f32 v251, 0, v232
    v_sub_f32 v252, 0, v232
    v_sub_f32 v253, 0, v232
    v_sub_f32 v254, 0, v232
    v_sub_f32 v255, 0, v232
    ds_read_b128 v[24:27], v2 offset:0
    ds_read_b128 v[208:211], v3 offset:1024
    ds_read_b128 v[212:215], v4 offset:1536
    s_waitcnt lgkmcnt(2)
    v_mfma_f32_32x32x16_bf16 v[128:143], v[24:27], v[16:19], v[240:255]
    s_add_u32 m0, s67, 33280
    s_nop 0
    buffer_load_dwordx4 v1, s[28:31], s66 offen sc1 lds
    buffer_load_dwordx4 v1, s[28:31], s66 offen offset:1024 sc1 lds
    s_add_u32 m0, s67, 41600
    s_add_u32 s66, s66, 8192
    buffer_load_dwordx4 v1, s[28:31], s66 offen sc1 lds
    buffer_load_dwordx4 v1, s[28:31], s66 offen offset:1024 sc1 lds
    s_add_u32 s66, s66, 8192
    s_waitcnt vmcnt(0)
    s_branch ATTN
.p2align 6
ATTN:
    s_waitcnt lgkmcnt(0)
    s_nop 7
    s_nop 5
    s_setprio 2
    v_exp_f32 v128, v128
    v_exp_f32 v129, v129
    v_exp_f32 v130, v130
    v_exp_f32 v131, v131
    v_cvt_pk_bf16_f32 v224, v128, v129
    v_exp_f32 v132, v132
    v_exp_f32 v133, v133
    v_cvt_pk_bf16_f32 v225, v130, v131
    v_mfma_f32_32x32x16_bf16 v[144:159], v[24:27], v[20:23], v[240:255]
    ds_read_b128 v[24:27], v2 offset:2080
    ds_read_b128 v[216:219], v3 offset:3104
    ds_read_b128 v[220:223], v4 offset:3616
    v_exp_f32 v134, v134
    v_exp_f32 v135, v135
    v_cvt_pk_bf16_f32 v226, v132, v133
    v_exp_f32 v136, v136
    v_exp_f32 v137, v137
    v_cvt_pk_bf16_f32 v227, v134, v135
    v_exp_f32 v138, v138
    v_exp_f32 v139, v139
    v_cvt_pk_bf16_f32 v228, v136, v137
    v_exp_f32 v140, v140
    v_mfma_f32_32x32x16_bf16 v[160:175], v[208:211], v[224:227], 0
    v_exp_f32 v141, v141
    v_cvt_pk_bf16_f32 v229, v138, v139
    v_exp_f32 v142, v142
    v_exp_f32 v143, v143
    v_cvt_pk_bf16_f32 v230, v140, v141
    v_cvt_pk_bf16_f32 v231, v142, v143
    v_exp_f32 v144, v144
    v_exp_f32 v145, v145
    v_mfma_f32_32x32x16_bf16 v[160:175], v[212:215], v[228:231], v[160:175]
    v_exp_f32 v146, v146
    v_exp_f32 v147, v147
    v_cvt_pk_bf16_f32 v224, v144, v145
    v_exp_f32 v148, v148
    v_exp_f32 v149, v149
    s_waitcnt lgkmcnt(0)
    v_cvt_pk_bf16_f32 v225, v146, v147
    v_mfma_f32_32x32x16_bf16 v[128:143], v[24:27], v[16:19], v[240:255]
    v_exp_f32 v150, v150
    v_exp_f32 v151, v151
    v_cvt_pk_bf16_f32 v226, v148, v149
    v_exp_f32 v152, v152
    v_exp_f32 v153, v153
    v_cvt_pk_bf16_f32 v227, v150, v151
    v_exp_f32 v154, v154
    v_exp_f32 v155, v155
    v_cvt_pk_bf16_f32 v228, v152, v153
    v_exp_f32 v156, v156
    v_mfma_f32_32x32x16_bf16 v[176:191], v[208:211], v[224:227], 0
    v_exp_f32 v157, v157
    v_cvt_pk_bf16_f32 v229, v154, v155
    v_exp_f32 v158, v158
    v_exp_f32 v159, v159
    v_cvt_pk_bf16_f32 v230, v156, v157
    v_cvt_pk_bf16_f32 v231, v158, v159
    v_exp_f32 v128, v128
    v_exp_f32 v129, v129
    v_mfma_f32_32x32x16_bf16 v[176:191], v[212:215], v[228:231], v[176:191]
    v_exp_f32 v130, v130
    v_exp_f32 v131, v131
    v_cvt_pk_bf16_f32 v224, v128, v129
    v_exp_f32 v132, v132
    v_exp_f32 v133, v133
    v_cvt_pk_bf16_f32 v225, v130, v131
    v_mfma_f32_32x32x16_bf16 v[144:159], v[24:27], v[20:23], v[240:255]
    ds_read_b128 v[24:27], v2 offset:4160
    ds_read_b128 v[208:211], v3 offset:5184
    ds_read_b128 v[212:215], v4 offset:5696
    v_exp_f32 v134, v134
    v_exp_f32 v135, v135
    v_cvt_pk_bf16_f32 v226, v132, v133
    v_exp_f32 v136, v136
    v_exp_f32 v137, v137
    v_cvt_pk_bf16_f32 v227, v134, v135
    v_exp_f32 v138, v138
    v_exp_f32 v139, v139
    v_cvt_pk_bf16_f32 v228, v136, v137
    v_exp_f32 v140, v140
    v_mfma_f32_32x32x16_bf16 v[160:175], v[216:219], v[224:227], v[160:175]
    v_exp_f32 v141, v141
    v_cvt_pk_bf16_f32 v229, v138, v139
    v_exp_f32 v142, v142
    v_exp_f32 v143, v143
    v_cvt_pk_bf16_f32 v230, v140, v141
    v_cvt_pk_bf16_f32 v231, v142, v143
    v_exp_f32 v144, v144
    v_exp_f32 v145, v145
    v_mfma_f32_32x32x16_bf16 v[160:175], v[220:223], v[228:231], v[160:175]
    v_exp_f32 v146, v146
    v_exp_f32 v147, v147
    v_cvt_pk_bf16_f32 v224, v144, v145
    v_exp_f32 v148, v148
    v_exp_f32 v149, v149
    s_waitcnt lgkmcnt(0)
    v_cvt_pk_bf16_f32 v225, v146, v147
    v_mfma_f32_32x32x16_bf16 v[128:143], v[24:27], v[16:19], v[240:255]
    s_add_u32 m0, s11, 0
    s_nop 0
    buffer_load_dwordx4 v11, s[32:35], s7 offen lds
    buffer_load_dwordx4 v12, s[32:35], s7 offen offset:1024 lds
    v_exp_f32 v150, v150
    v_exp_f32 v151, v151
    v_cvt_pk_bf16_f32 v226, v148, v149
    v_exp_f32 v152, v152
    v_exp_f32 v153, v153
    v_cvt_pk_bf16_f32 v227, v150, v151
    v_exp_f32 v154, v154
    v_exp_f32 v155, v155
    v_cvt_pk_bf16_f32 v228, v152, v153
    v_exp_f32 v156, v156
    v_mfma_f32_32x32x16_bf16 v[176:191], v[216:219], v[224:227], v[176:191]
    v_exp_f32 v157, v157
    v_cvt_pk_bf16_f32 v229, v154, v155
    v_exp_f32 v158, v158
    v_exp_f32 v159, v159
    v_cvt_pk_bf16_f32 v230, v156, v157
    v_cvt_pk_bf16_f32 v231, v158, v159
    s_setprio 1
    v_exp_f32 v128, v128
    v_exp_f32 v129, v129
    v_mfma_f32_32x32x16_bf16 v[176:191], v[220:223], v[228:231], v[176:191]
    v_exp_f32 v130, v130
    v_exp_f32 v131, v131
    v_cvt_pk_bf16_f32 v224, v128, v129
    v_exp_f32 v132, v132
    v_exp_f32 v133, v133
    v_cvt_pk_bf16_f32 v225, v130, v131
    v_mfma_f32_32x32x16_bf16 v[144:159], v[24:27], v[20:23], v[240:255]
    ds_read_b128 v[24:27], v2 offset:6240
    ds_read_b128 v[216:219], v3 offset:7264
    ds_read_b128 v[220:223], v4 offset:7776
    v_exp_f32 v134, v134
    v_exp_f32 v135, v135
    v_cvt_pk_bf16_f32 v226, v132, v133
    v_exp_f32 v136, v136
    v_exp_f32 v137, v137
    v_cvt_pk_bf16_f32 v227, v134, v135
    v_exp_f32 v138, v138
    v_exp_f32 v139, v139
    v_cvt_pk_bf16_f32 v228, v136, v137
    v_exp_f32 v140, v140
    v_mfma_f32_32x32x16_bf16 v[160:175], v[208:211], v[224:227], v[160:175]
    v_exp_f32 v141, v141
    v_cvt_pk_bf16_f32 v229, v138, v139
    v_exp_f32 v142, v142
    v_exp_f32 v143, v143
    v_cvt_pk_bf16_f32 v230, v140, v141
    v_cvt_pk_bf16_f32 v231, v142, v143
    v_exp_f32 v144, v144
    v_exp_f32 v145, v145
    v_mfma_f32_32x32x16_bf16 v[160:175], v[212:215], v[228:231], v[160:175]
    v_exp_f32 v146, v146
    v_exp_f32 v147, v147
    v_cvt_pk_bf16_f32 v224, v144, v145
    v_exp_f32 v148, v148
    v_exp_f32 v149, v149
    s_waitcnt lgkmcnt(0)
    v_cvt_pk_bf16_f32 v225, v146, v147
    v_mfma_f32_32x32x16_bf16 v[128:143], v[24:27], v[16:19], v[240:255]
    s_add_u32 m0, s11, 2048
    s_add_u32 s7, s7, 16384
    buffer_load_dwordx4 v11, s[32:35], s7 offen lds
    buffer_load_dwordx4 v12, s[32:35], s7 offen offset:1024 lds
    v_exp_f32 v150, v150
    v_exp_f32 v151, v151
    v_cvt_pk_bf16_f32 v226, v148, v149
    v_exp_f32 v152, v152
    v_exp_f32 v153, v153
    v_cvt_pk_bf16_f32 v227, v150, v151
    v_exp_f32 v154, v154
    v_exp_f32 v155, v155
    v_cvt_pk_bf16_f32 v228, v152, v153
    v_exp_f32 v156, v156
    v_mfma_f32_32x32x16_bf16 v[176:191], v[208:211], v[224:227], v[176:191]
    v_exp_f32 v157, v157
    v_cvt_pk_bf16_f32 v229, v154, v155
    v_exp_f32 v158, v158
    v_exp_f32 v159, v159
    v_cvt_pk_bf16_f32 v230, v156, v157
    v_cvt_pk_bf16_f32 v231, v158, v159
    v_exp_f32 v128, v128
    v_exp_f32 v129, v129
    v_mfma_f32_32x32x16_bf16 v[176:191], v[212:215], v[228:231], v[176:191]
    v_exp_f32 v130, v130
    v_exp_f32 v131, v131
    v_cvt_pk_bf16_f32 v224, v128, v129
    v_exp_f32 v132, v132
    v_exp_f32 v133, v133
    v_cvt_pk_bf16_f32 v225, v130, v131
    v_mfma_f32_32x32x16_bf16 v[144:159], v[24:27], v[20:23], v[240:255]
    ds_read_b128 v[24:27], v2 offset:8320
    ds_read_b128 v[208:211], v3 offset:9344
    ds_read_b128 v[212:215], v4 offset:9856
    v_exp_f32 v134, v134
    v_exp_f32 v135, v135
    v_cvt_pk_bf16_f32 v226, v132, v133
    v_exp_f32 v136, v136
    v_exp_f32 v137, v137
    v_cvt_pk_bf16_f32 v227, v134, v135
    v_exp_f32 v138, v138
    v_exp_f32 v139, v139
    v_cvt_pk_bf16_f32 v228, v136, v137
    v_exp_f32 v140, v140
    v_mfma_f32_32x32x16_bf16 v[160:175], v[216:219], v[224:227], v[160:175]
    v_exp_f32 v141, v141
    v_cvt_pk_bf16_f32 v229, v138, v139
    v_exp_f32 v142, v142
    v_exp_f32 v143, v143
    v_cvt_pk_bf16_f32 v230, v140, v141
    v_cvt_pk_bf16_f32 v231, v142, v143
    v_exp_f32 v144, v144
    v_exp_f32 v145, v145
    v_mfma_f32_32x32x16_bf16 v[160:175], v[220:223], v[228:231], v[160:175]
    v_exp_f32 v146, v146
    v_exp_f32 v147, v147
    v_cvt_pk_bf16_f32 v224, v144, v145
    v_exp_f32 v148, v148
    v_exp_f32 v149, v149
    s_waitcnt lgkmcnt(0)
    v_cvt_pk_bf16_f32 v225, v146, v147
    v_mfma_f32_32x32x16_bf16 v[128:143], v[24:27], v[16:19], v[240:255]
    s_add_u32 m0, s11, 4096
    s_add_u32 s7, s7, 16384
    buffer_load_dwordx4 v11, s[32:35], s7 offen lds
    buffer_load_dwordx4 v12, s[32:35], s7 offen offset:1024 lds
    s_waitcnt vmcnt(6)
    s_cmp_eq_u32 s53, 0
    s_cbranch_scc1 NOH_31
    v_mov_b32 v232, 0
    v_mov_b32 v233, s26
    s_mov_b64 exec, 1
    buffer_store_dword v233, v232, s[28:31], s12 offen sc1
    s_mov_b64 exec, -1
NOH_31:
    v_exp_f32 v150, v150
    v_exp_f32 v151, v151
    v_cvt_pk_bf16_f32 v226, v148, v149
    v_exp_f32 v152, v152
    v_exp_f32 v153, v153
    v_cvt_pk_bf16_f32 v227, v150, v151
    v_exp_f32 v154, v154
    v_exp_f32 v155, v155
    v_cvt_pk_bf16_f32 v228, v152, v153
    v_exp_f32 v156, v156
    v_mfma_f32_32x32x16_bf16 v[176:191], v[216:219], v[224:227], v[176:191]
    v_exp_f32 v157, v157
    v_cvt_pk_bf16_f32 v229, v154, v155
    v_exp_f32 v158, v158
    v_exp_f32 v159, v159
    v_cvt_pk_bf16_f32 v230, v156, v157
    v_cvt_pk_bf16_f32 v231, v158, v159
    v_exp_f32 v128, v128
    v_exp_f32 v129, v129
    v_mfma_f32_32x32x16_bf16 v[176:191], v[220:223], v[228:231], v[176:191]
    v_exp_f32 v130, v130
    v_exp_f32 v131, v131
    v_cvt_pk_bf16_f32 v224, v128, v129
    v_exp_f32 v132, v132
    v_exp_f32 v133, v133
    v_cvt_pk_bf16_f32 v225, v130, v131
    v_mfma_f32_32x32x16_bf16 v[144:159], v[24:27], v[20:23], v[240:255]
    ds_read_b128 v[24:27], v2 offset:10400
    ds_read_b128 v[216:219], v3 offset:11424
    ds_read_b128 v[220:223], v4 offset:11936
    v_exp_f32 v134, v134
    v_exp_f32 v135, v135
    v_cvt_pk_bf16_f32 v226, v132, v133
    v_exp_f32 v136, v136
    v_exp_f32 v137, v137
    v_cvt_pk_bf16_f32 v227, v134, v135
    v_exp_f32 v138, v138
    v_exp_f32 v139, v139
    v_cvt_pk_bf16_f32 v228, v136, v137
    v_exp_f32 v140, v140
    v_mfma_f32_32x32x16_bf16 v[160:175], v[208:211], v[224:227], v[160:175]
    v_exp_f32 v141, v141
    v_cvt_pk_bf16_f32 v229, v138, v139
    v_exp_f32 v142, v142
    v_exp_f32 v143, v143
    v_cvt_pk_bf16_f32 v230, v140, v141
    v_cvt_pk_bf16_f32 v231, v142, v143
    v_exp_f32 v144, v144
    v_exp_f32 v145, v145
    v_mfma_f32_32x32x16_bf16 v[160:175], v[212:215], v[228:231], v[160:175]
    v_exp_f32 v146, v146
    v_exp_f32 v147, v147
    v_cvt_pk_bf16_f32 v224, v144, v145
    v_exp_f32 v148, v148
    v_exp_f32 v149, v149
    s_waitcnt lgkmcnt(0)
    v_cvt_pk_bf16_f32 v225, v146, v147
    v_mfma_f32_32x32x16_bf16 v[128:143], v[24:27], v[16:19], v[240:255]
    s_add_u32 m0, s11, 6144
    s_add_u32 s7, s7, 16384
    buffer_load_dwordx4 v11, s[32:35], s7 offen lds
    buffer_load_dwordx4 v12, s[32:35], s7 offen offset:1024 lds
    v_exp_f32 v150, v150
    v_exp_f32 v151, v151
    v_cvt_pk_bf16_f32 v226, v148, v149
    v_exp_f32 v152, v152
    v_exp_f32 v153, v153
    v_cvt_pk_bf16_f32 v227, v150, v151
    v_exp_f32 v154, v154
    v_exp_f32 v155, v155
    v_cvt_pk_bf16_f32 v228, v152, v153
    v_exp_f32 v156, v156
    v_mfma_f32_32x32x16_bf16 v[176:191], v[208:211], v[224:227], v[176:191]
    v_exp_f32 v157, v157
    v_cvt_pk_bf16_f32 v229, v154, v155
    v_exp_f32 v158, v158
    v_exp_f32 v159, v159
    v_cvt_pk_bf16_f32 v230, v156, v157
    v_cvt_pk_bf16_f32 v231, v158, v159
    s_setprio 0
    v_exp_f32 v128, v128
    v_exp_f32 v129, v129
    v_mfma_f32_32x32x16_bf16 v[176:191], v[212:215], v[228:231], v[176:191]
    v_exp_f32 v130, v130
    v_exp_f32 v131, v131
    v_cvt_pk_bf16_f32 v224, v128, v129
    v_exp_f32 v132, v132
    v_exp_f32 v133, v133
    v_cvt_pk_bf16_f32 v225, v130, v131
    v_mfma_f32_32x32x16_bf16 v[144:159], v[24:27], v[20:23], v[240:255]
    ds_read_b128 v[24:27], v2 offset:12480
    ds_read_b128 v[208:211], v3 offset:13504
    ds_read_b128 v[212:215], v4 offset:14016
    v_exp_f32 v134, v134
    v_exp_f32 v135, v135
    v_cvt_pk_bf16_f32 v226, v132, v133
    v_exp_f32 v136, v136
    v_exp_f32 v137, v137
    v_cvt_pk_bf16_f32 v227, v134, v135
    v_exp_f32 v138, v138
    v_exp_f32 v139, v139
    v_cvt_pk_bf16_f32 v228, v136, v137
    v_exp_f32 v140, v140
    v_mfma_f32_32x32x16_bf16 v[160:175], v[216:219], v[224:227], v[160:175]
    v_exp_f32 v141, v141
    v_cvt_pk_bf16_f32 v229, v138, v139
    v_exp_f32 v142, v142
    v_exp_f32 v143, v143
    v_cvt_pk_bf16_f32 v230, v140, v141
    v_cvt_pk_bf16_f32 v231, v142, v143
    v_exp_f32 v144, v144
    v_exp_f32 v145, v145
    v_mfma_f32_32x32x16_bf16 v[160:175], v[220:223], v[228:231], v[160:175]
    v_exp_f32 v146, v146
    v_exp_f32 v147, v147
    v_cvt_pk_bf16_f32 v224, v144, v145
    v_exp_f32 v148, v148
    v_exp_f32 v149, v149
    s_waitcnt lgkmcnt(0)
    v_cvt_pk_bf16_f32 v225, v146, v147
    v_mfma_f32_32x32x16_bf16 v[128:143], v[24:27], v[16:19], v[240:255]
    v_mov_b32 v236, -1
    v_mov_b32 v237, -1
    v_mov_b32 v238, -1
    v_mov_b32 v239, -1
    buffer_store_dwordx4 v[236:239], v1, s[28:31], s18 offen sc1
    v_mov_b32 v234, s22
    v_mov_b32 v235, s26
    s_mov_b64 exec, 1
    buffer_store_dwordx2 v[234:235], v1, s[28:31], s73 offen sc1
    s_mov_b64 exec, -1
    v_exp_f32 v150, v150
    v_exp_f32 v151, v151
    v_cvt_pk_bf16_f32 v226, v148, v149
    v_exp_f32 v152, v152
    v_exp_f32 v153, v153
    v_cvt_pk_bf16_f32 v227, v150, v151
    v_exp_f32 v154, v154
    v_exp_f32 v155, v155
    v_cvt_pk_bf16_f32 v228, v152, v153
    v_exp_f32 v156, v156
    v_mfma_f32_32x32x16_bf16 v[176:191], v[216:219], v[224:227], v[176:191]
    v_exp_f32 v157, v157
    v_cvt_pk_bf16_f32 v229, v154, v155
    v_exp_f32 v158, v158
    v_exp_f32 v159, v159
    v_cvt_pk_bf16_f32 v230, v156, v157
    v_cvt_pk_bf16_f32 v231, v158, v159
    v_exp_f32 v128, v128
    v_exp_f32 v129, v129
    v_mfma_f32_32x32x16_bf16 v[176:191], v[220:223], v[228:231], v[176:191]
    v_exp_f32 v130, v130
    v_exp_f32 v131, v131
    v_cvt_pk_bf16_f32 v224, v128, v129
    v_exp_f32 v132, v132
    v_exp_f32 v133, v133
    v_cvt_pk_bf16_f32 v225, v130, v131
    v_mfma_f32_32x32x16_bf16 v[144:159], v[24:27], v[20:23], v[240:255]
    ds_read_b128 v[24:27], v2 offset:14560
    ds_read_b128 v[216:219], v3 offset:15584
    ds_read_b128 v[220:223], v4 offset:16096
    v_exp_f32 v134, v134
    v_exp_f32 v135, v135
    v_cvt_pk_bf16_f32 v226, v132, v133
    v_exp_f32 v136, v136
    v_exp_f32 v137, v137
    v_cvt_pk_bf16_f32 v227, v134, v135
    v_exp_f32 v138, v138
    v_exp_f32 v139, v139
    v_cvt_pk_bf16_f32 v228, v136, v137
    v_exp_f32 v140, v140
    v_mfma_f32_32x32x16_bf16 v[160:175], v[208:211], v[224:227], v[160:175]
    v_exp_f32 v141, v141
    v_cvt_pk_bf16_f32 v229, v138, v139
    v_exp_f32 v142, v142
    v_exp_f32 v143, v143
    v_cvt_pk_bf16_f32 v230, v140, v141
    v_cvt_pk_bf16_f32 v231, v142, v143
    v_exp_f32 v144, v144
    v_exp_f32 v145, v145
    v_mfma_f32_32x32x16_bf16 v[160:175], v[212:215], v[228:231], v[160:175]
    v_exp_f32 v146, v146
    v_exp_f32 v147, v147
    v_cvt_pk_bf16_f32 v224, v144, v145
    v_exp_f32 v148, v148
    v_exp_f32 v149, v149
    s_waitcnt lgkmcnt(0)
    v_cvt_pk_bf16_f32 v225, v146, v147
    v_mfma_f32_32x32x16_bf16 v[128:143], v[24:27], v[16:19], v[240:255]
    v_exp_f32 v150, v150
    v_exp_f32 v151, v151
    v_cvt_pk_bf16_f32 v226, v148, v149
    v_exp_f32 v152, v152
    v_exp_f32 v153, v153
    v_cvt_pk_bf16_f32 v227, v150, v151
    v_exp_f32 v154, v154
    v_exp_f32 v155, v155
    v_cvt_pk_bf16_f32 v228, v152, v153
    v_exp_f32 v156, v156
    v_mfma_f32_32x32x16_bf16 v[176:191], v[208:211], v[224:227], v[176:191]
    v_exp_f32 v157, v157
    v_cvt_pk_bf16_f32 v229, v154, v155
    v_exp_f32 v158, v158
    v_exp_f32 v159, v159
    v_cvt_pk_bf16_f32 v230, v156, v157
    v_cvt_pk_bf16_f32 v231, v158, v159
    v_exp_f32 v128, v128
    v_exp_f32 v129, v129
    v_mfma_f32_32x32x16_bf16 v[176:191], v[212:215], v[228:231], v[176:191]
    v_exp_f32 v130, v130
    v_exp_f32 v131, v131
    v_cvt_pk_bf16_f32 v224, v128, v129
    v_exp_f32 v132, v132
    v_exp_f32 v133, v133
    v_cvt_pk_bf16_f32 v225, v130, v131
    v_mfma_f32_32x32x16_bf16 v[144:159], v[24:27], v[20:23], v[240:255]
    s_barrier
    s_add_u32 m0, s67, 0
    s_nop 0
    buffer_load_dwordx4 v1, s[28:31], s66 offen offset:0 sc1 lds
    s_add_u32 m0, s67, 0
    s_nop 0
    buffer_load_dwordx4 v1, s[28:31], s66 offen offset:1024 sc1 lds
    s_add_u32 s66, s66, 8192
    s_add_u32 m0, s67, 8320
    s_nop 0
    buffer_load_dwordx4 v1, s[28:31], s66 offen offset:0 sc1 lds
    s_add_u32 m0, s67, 8320
    s_nop 0
    buffer_load_dwordx4 v1, s[28:31], s66 offen offset:1024 sc1 lds
    s_add_u32 s66, s66, 8192
    ds_read_b128 v[24:27], v2 offset:33280
    ds_read_b128 v[208:211], v3 offset:34304
    ds_read_b128 v[212:215], v4 offset:34816
    v_exp_f32 v134, v134
    v_exp_f32 v135, v135
    v_cvt_pk_bf16_f32 v226, v132, v133
    v_exp_f32 v136, v136
    v_exp_f32 v137, v137
    v_cvt_pk_bf16_f32 v227, v134, v135
    v_exp_f32 v138, v138
    v_exp_f32 v139, v139
    v_cvt_pk_bf16_f32 v228, v136, v137
    v_exp_f32 v140, v140
    v_mfma_f32_32x32x16_bf16 v[160:175], v[216:219], v[224:227], v[160:175]
    v_exp_f32 v141, v141
    v_cvt_pk_bf16_f32 v229, v138, v139
    v_exp_f32 v142, v142
    v_exp_f32 v143, v143
    v_cvt_pk_bf16_f32 v230, v140, v141
    v_cvt_pk_bf16_f32 v231, v142, v143
    v_exp_f32 v144, v144
    v_exp_f32 v145, v145
    v_mfma_f32_32x32x16_bf16 v[160:175], v[220:223], v[228:231], v[160:175]
    v_exp_f32 v146, v146
    v_exp_f32 v147, v147
    v_cvt_pk_bf16_f32 v224, v144, v145
    v_exp_f32 v148, v148
    v_exp_f32 v149, v149
    s_waitcnt lgkmcnt(0)
    v_cvt_pk_bf16_f32 v225, v146, v147
    v_mfma_f32_32x32x16_bf16 v[128:143], v[24:27], v[16:19], v[240:255]
    v_exp_f32 v150, v150
    v_exp_f32 v151, v151
    v_cvt_pk_bf16_f32 v226, v148, v149
    v_exp_f32 v152, v152
    v_exp_f32 v153, v153
    v_cvt_pk_bf16_f32 v227, v150, v151
    v_exp_f32 v154, v154
    v_exp_f32 v155, v155
    v_cvt_pk_bf16_f32 v228, v152, v153
    v_exp_f32 v156, v156
    v_mfma_f32_32x32x16_bf16 v[176:191], v[216:219], v[224:227], v[176:191]
    v_exp_f32 v157, v157
    v_cvt_pk_bf16_f32 v229, v154, v155
    v_exp_f32 v158, v158
    v_exp_f32 v159, v159
    v_cvt_pk_bf16_f32 v230, v156, v157
    v_cvt_pk_bf16_f32 v231, v158, v159
    s_setprio 3
    v_exp_f32 v128, v128
    v_exp_f32 v129, v129
    v_mfma_f32_32x32x16_bf16 v[176:191], v[220:223], v[228:231], v[176:191]
    v_exp_f32 v130, v130
    v_exp_f32 v131, v131
    v_cvt_pk_bf16_f32 v224, v128, v129
    v_exp_f32 v132, v132
    v_exp_f32 v133, v133
    v_cvt_pk_bf16_f32 v225, v130, v131
    v_mfma_f32_32x32x16_bf16 v[144:159], v[24:27], v[20:23], v[240:255]
    ds_read_b128 v[24:27], v2 offset:35360
    ds_read_b128 v[216:219], v3 offset:36384
    ds_read_b128 v[220:223], v4 offset:36896
    v_exp_f32 v134, v134
    v_exp_f32 v135, v135
    v_cvt_pk_bf16_f32 v226, v132, v133
    v_exp_f32 v136, v136
    v_exp_f32 v137, v137
    v_cvt_pk_bf16_f32 v227, v134, v135
    v_exp_f32 v138, v138
    v_exp_f32 v139, v139
    v_cvt_pk_bf16_f32 v228, v136, v137
    v_exp_f32 v140, v140
    v_mfma_f32_32x32x16_bf16 v[160:175], v[208:211], v[224:227], v[160:175]
    v_exp_f32 v141, v141
    v_cvt_pk_bf16_f32 v229, v138, v139
    v_exp_f32 v142, v142
    v_exp_f32 v143, v143
    v_cvt_pk_bf16_f32 v230, v140, v141
    v_cvt_pk_bf16_f32 v231, v142, v143
    v_exp_f32 v144, v144
    v_exp_f32 v145, v145
    v_mfma_f32_32x32x16_bf16 v[160:175], v[212:215], v[228:231], v[160:175]
    v_exp_f32 v146, v146
    v_exp_f32 v147, v147
    v_cvt_pk_bf16_f32 v224, v144, v145
    v_exp_f32 v148, v148
    v_exp_f32 v149, v149
    s_waitcnt lgkmcnt(0)
    v_cvt_pk_bf16_f32 v225, v146, v147
    v_mfma_f32_32x32x16_bf16 v[128:143], v[24:27], v[16:19], v[240:255]
    s_mov_b32 s60, 0xf70000
    s_mov_b32 exec_lo, 0x1f1f
    s_mov_b32 exec_hi, 0x0
    buffer_load_dword v15, v14, s[28:31], s60 offen sc1
    s_mov_b64 exec, -1
    v_exp_f32 v150, v150
    v_exp_f32 v151, v151
    v_cvt_pk_bf16_f32 v226, v148, v149
    v_exp_f32 v152, v152
    v_exp_f32 v153, v153
    v_cvt_pk_bf16_f32 v227, v150, v151
    v_exp_f32 v154, v154
    v_exp_f32 v155, v155
    v_cvt_pk_bf16_f32 v228, v152, v153
    v_exp_f32 v156, v156
    v_mfma_f32_32x32x16_bf16 v[176:191], v[208:211], v[224:227], v[176:191]
    v_exp_f32 v157, v157
    v_cvt_pk_bf16_f32 v229, v154, v155
    v_exp_f32 v158, v158
    v_exp_f32 v159, v159
    v_cvt_pk_bf16_f32 v230, v156, v157
    v_cvt_pk_bf16_f32 v231, v158, v159
    v_exp_f32 v128, v128
    v_exp_f32 v129, v129
    v_mfma_f32_32x32x16_bf16 v[176:191], v[212:215], v[228:231], v[176:191]
    v_exp_f32 v130, v130
    v_exp_f32 v131, v131
    v_cvt_pk_bf16_f32 v224, v128, v129
    v_exp_f32 v132, v132
    v_exp_f32 v133, v133
    v_cvt_pk_bf16_f32 v225, v130, v131
    v_mfma_f32_32x32x16_bf16 v[144:159], v[24:27], v[20:23], v[240:255]
    ds_read_b128 v[24:27], v2 offset:37440
    ds_read_b128 v[208:211], v3 offset:38464
    ds_read_b128 v[212:215], v4 offset:38976
    v_exp_f32 v134, v134
    v_exp_f32 v135, v135
    v_cvt_pk_bf16_f32 v226, v132, v133
    v_exp_f32 v136, v136
    v_exp_f32 v137, v137
    v_cvt_pk_bf16_f32 v227, v134, v135
    v_exp_f32 v138, v138
    v_exp_f32 v139, v139
    v_cvt_pk_bf16_f32 v228, v136, v137
    v_exp_f32 v140, v140
    v_mfma_f32_32x32x16_bf16 v[160:175], v[216:219], v[224:227], v[160:175]
    v_exp_f32 v141, v141
    v_cvt_pk_bf16_f32 v229, v138, v139
    v_exp_f32 v142, v142
    v_exp_f32 v143, v143
    v_cvt_pk_bf16_f32 v230, v140, v141
    v_cvt_pk_bf16_f32 v231, v142, v143
    v_exp_f32 v144, v144
    v_exp_f32 v145, v145
    v_mfma_f32_32x32x16_bf16 v[160:175], v[220:223], v[228:231], v[160:175]
    v_exp_f32 v146, v146
    v_exp_f32 v147, v147
    v_cvt_pk_bf16_f32 v224, v144, v145
    v_exp_f32 v148, v148
    v_exp_f32 v149, v149
    s_waitcnt lgkmcnt(0)
    v_cvt_pk_bf16_f32 v225, v146, v147
    v_mfma_f32_32x32x16_bf16 v[128:143], v[24:27], v[16:19], v[240:255]
    s_waitcnt vmcnt(0)
    v_cmp_ne_u32 vcc, s26, v15
    s_and_b32 vcc_lo, vcc_lo, 0x1f1f
    s_and_b32 vcc_hi, vcc_hi, 0x0
    s_or_b32 s60, vcc_lo, vcc_hi
    s_cbranch_scc0 FOK_32
    s_mov_b32 s60, 0xf70000
    s_mov_b32 s61, 0x80000
    s_mov_b32 exec_lo, 0x1f1f
    s_mov_b32 exec_hi, 0x0
POLL_33:
    buffer_load_dword v15, v14, s[28:31], s60 offen sc1
    s_waitcnt vmcnt(0)
    v_cmp_ne_u32 vcc, s26, v15
    s_cbranch_vccz POLLD_34
    s_mov_b64 exec, vcc
    s_sub_u32 s61, s61, 1
    s_cbranch_scc0 POLL_33
POLLD_34:
    s_mov_b64 exec, -1
FOK_32:
    buffer_load_dwordx4 v[32:35], v7, s[28:31], s6 offen offset:0 sc1
    buffer_load_dwordx4 v[36:39], v13, s[28:31], s6 offen offset:0 sc1
    buffer_load_dwordx4 v[40:43], v7, s[28:31], s6 offen offset:1024 sc1
    buffer_load_dwordx4 v[44:47], v13, s[28:31], s6 offen offset:1024 sc1
    buffer_load_dwordx4 v[48:51], v7, s[28:31], s6 offen offset:2048 sc1
    buffer_load_dwordx4 v[52:55], v13, s[28:31], s6 offen offset:2048 sc1
    buffer_load_dwordx4 v[56:59], v7, s[28:31], s6 offen offset:3072 sc1
    buffer_load_dwordx4 v[60:63], v13, s[28:31], s6 offen offset:3072 sc1
    v_exp_f32 v150, v150
    v_exp_f32 v151, v151
    v_cvt_pk_bf16_f32 v226, v148, v149
    v_exp_f32 v152, v152
    v_exp_f32 v153, v153
    v_cvt_pk_bf16_f32 v227, v150, v151
    v_exp_f32 v154, v154
    v_exp_f32 v155, v155
    v_cvt_pk_bf16_f32 v228, v152, v153
    v_exp_f32 v156, v156
    v_mfma_f32_32x32x16_bf16 v[176:191], v[216:219], v[224:227], v[176:191]
    v_exp_f32 v157, v157
    v_cvt_pk_bf16_f32 v229, v154, v155
    v_exp_f32 v158, v158
    v_exp_f32 v159, v159
    v_cvt_pk_bf16_f32 v230, v156, v157
    v_cvt_pk_bf16_f32 v231, v158, v159
    s_setprio 2
    v_exp_f32 v128, v128
    v_exp_f32 v129, v129
    v_mfma_f32_32x32x16_bf16 v[176:191], v[220:223], v[228:231], v[176:191]
    v_exp_f32 v130, v130
    v_exp_f32 v131, v131
    v_cvt_pk_bf16_f32 v224, v128, v129
    v_exp_f32 v132, v132
    v_exp_f32 v133, v133
    v_cvt_pk_bf16_f32 v225, v130, v131
    v_mfma_f32_32x32x16_bf16 v[144:159], v[24:27], v[20:23], v[240:255]
    ds_read_b128 v[24:27], v2 offset:39520
    ds_read_b128 v[216:219], v3 offset:40544
    ds_read_b128 v[220:223], v4 offset:41056
    v_exp_f32 v134, v134
    v_exp_f32 v135, v135
    v_cvt_pk_bf16_f32 v226, v132, v133
    v_exp_f32 v136, v136
    v_exp_f32 v137, v137
    v_cvt_pk_bf16_f32 v227, v134, v135
    v_exp_f32 v138, v138
    v_exp_f32 v139, v139
    v_cvt_pk_bf16_f32 v228, v136, v137
    v_exp_f32 v140, v140
    v_mfma_f32_32x32x16_bf16 v[160:175], v[208:211], v[224:227], v[160:175]
    v_exp_f32 v141, v141
    v_cvt_pk_bf16_f32 v229, v138, v139
    v_exp_f32 v142, v142
    v_exp_f32 v143, v143
    v_cvt_pk_bf16_f32 v230, v140, v141
    v_cvt_pk_bf16_f32 v231, v142, v143
    v_exp_f32 v144, v144
    v_exp_f32 v145, v145
    v_mfma_f32_32x32x16_bf16 v[160:175], v[212:215], v[228:231], v[160:175]
    v_exp_f32 v146, v146
    v_exp_f32 v147, v147
    v_cvt_pk_bf16_f32 v224, v144, v145
    v_exp_f32 v148, v148
    v_exp_f32 v149, v149
    s_waitcnt lgkmcnt(0)
    v_cvt_pk_bf16_f32 v225, v146, v147
    v_mfma_f32_32x32x16_bf16 v[128:143], v[24:27], v[16:19], v[240:255]
    v_exp_f32 v150, v150
    v_exp_f32 v151, v151
    v_cvt_pk_bf16_f32 v226, v148, v149
    v_exp_f32 v152, v152
    v_exp_f32 v153, v153
    v_cvt_pk_bf16_f32 v227, v150, v151
    v_exp_f32 v154, v154
    v_exp_f32 v155, v155
    v_cvt_pk_bf16_f32 v228, v152, v153
    v_exp_f32 v156, v156
    v_mfma_f32_32x32x16_bf16 v[176:191], v[208:211], v[224:227], v[176:191]
    v_exp_f32 v157, v157
    v_cvt_pk_bf16_f32 v229, v154, v155
    v_exp_f32 v158, v158
    v_exp_f32 v159, v159
    v_cvt_pk_bf16_f32 v230, v156, v157
    v_cvt_pk_bf16_f32 v231, v158, v159
    v_exp_f32 v128, v128
    v_exp_f32 v129, v129
    v_mfma_f32_32x32x16_bf16 v[176:191], v[212:215], v[228:231], v[176:191]
    v_exp_f32 v130, v130
    v_exp_f32 v131, v131
    v_cvt_pk_bf16_f32 v224, v128, v129
    v_exp_f32 v132, v132
    v_exp_f32 v133, v133
    v_cvt_pk_bf16_f32 v225, v130, v131
    v_mfma_f32_32x32x16_bf16 v[144:159], v[24:27], v[20:23], v[240:255]
    ds_read_b128 v[24:27], v2 offset:41600
    ds_read_b128 v[208:211], v3 offset:42624
    ds_read_b128 v[212:215], v4 offset:43136
    s_waitcnt vmcnt(6)
    ds_read_b64_tr_b16 v[192:193], v5 offset:0
    ds_read_b64_tr_b16 v[194:195], v5 offset:1024
    ds_read_b64_tr_b16 v[196:197], v6 offset:0
    ds_read_b64_tr_b16 v[198:199], v6 offset:1024
    v_exp_f32 v134, v134
    v_exp_f32 v135, v135
    v_cvt_pk_bf16_f32 v226, v132, v133
    v_exp_f32 v136, v136
    v_exp_f32 v137, v137
    v_cvt_pk_bf16_f32 v227, v134, v135
    v_exp_f32 v138, v138
    v_exp_f32 v139, v139
    v_cvt_pk_bf16_f32 v228, v136, v137
    v_exp_f32 v140, v140
    v_mfma_f32_32x32x16_bf16 v[160:175], v[216:219], v[224:227], v[160:175]
    v_exp_f32 v141, v141
    v_cvt_pk_bf16_f32 v229, v138, v139
    v_exp_f32 v142, v142
    v_exp_f32 v143, v143
    v_cvt_pk_bf16_f32 v230, v140, v141
    v_cvt_pk_bf16_f32 v231, v142, v143
    v_exp_f32 v144, v144
    v_exp_f32 v145, v145
    v_mfma_f32_32x32x16_bf16 v[160:175], v[220:223], v[228:231], v[160:175]
    v_exp_f32 v146, v146
    v_exp_f32 v147, v147
    v_cvt_pk_bf16_f32 v224, v144, v145
    v_exp_f32 v148, v148
    v_exp_f32 v149, v149
    s_waitcnt lgkmcnt(0)
    v_cvt_pk_bf16_f32 v225, v146, v147
    v_mfma_f32_32x32x16_bf16 v[128:143], v[24:27], v[16:19], v[240:255]
    s_add_u32 m0, s11, 0
    s_add_u32 s7, s7, 16384
    buffer_load_dwordx4 v11, s[32:35], s7 offen lds
    buffer_load_dwordx4 v12, s[32:35], s7 offen offset:1024 lds
    v_exp_f32 v150, v150
    v_exp_f32 v151, v151
    v_cvt_pk_bf16_f32 v226, v148, v149
    v_exp_f32 v152, v152
    v_exp_f32 v153, v153
    v_cvt_pk_bf16_f32 v227, v150, v151
    v_mfma_f32_32x32x16_bf16 v[64:79], v[192:195], v[32:35], 0
    v_exp_f32 v154, v154
    v_exp_f32 v155, v155
    v_cvt_pk_bf16_f32 v228, v152, v153
    v_exp_f32 v156, v156
    v_mfma_f32_32x32x16_bf16 v[176:191], v[216:219], v[224:227], v[176:191]
    v_exp_f32 v157, v157
    v_cvt_pk_bf16_f32 v229, v154, v155
    v_exp_f32 v158, v158
    v_exp_f32 v159, v159
    v_cvt_pk_bf16_f32 v230, v156, v157
    v_mfma_f32_32x32x16_bf16 v[80:95], v[196:199], v[32:35], 0
    v_cvt_pk_bf16_f32 v231, v158, v159
    s_setprio 1
    v_exp_f32 v128, v128
    v_exp_f32 v129, v129
    v_mfma_f32_32x32x16_bf16 v[176:191], v[220:223], v[228:231], v[176:191]
    v_exp_f32 v130, v130
    v_exp_f32 v131, v131
    v_cvt_pk_bf16_f32 v224, v128, v129
    v_exp_f32 v132, v132
    v_exp_f32 v133, v133
    v_cvt_pk_bf16_f32 v225, v130, v131
    v_mfma_f32_32x32x16_bf16 v[144:159], v[24:27], v[20:23], v[240:255]
    ds_read_b128 v[24:27], v2 offset:43680
    ds_read_b128 v[216:219], v3 offset:44704
    ds_read_b128 v[220:223], v4 offset:45216
    s_waitcnt vmcnt(6)
    ds_read_b64_tr_b16 v[200:201], v5 offset:2048
    ds_read_b64_tr_b16 v[202:203], v5 offset:3072
    ds_read_b64_tr_b16 v[204:205], v6 offset:2048
    ds_read_b64_tr_b16 v[206:207], v6 offset:3072
    v_exp_f32 v134, v134
    v_exp_f32 v135, v135
    v_cvt_pk_bf16_f32 v226, v132, v133
    v_exp_f32 v136, v136
    v_exp_f32 v137, v137
    v_cvt_pk_bf16_f32 v227, v134, v135
    v_mfma_f32_32x32x16_bf16 v[96:111], v[192:195], v[36:39], 0
    v_exp_f32 v138, v138
    v_exp_f32 v139, v139
    v_cvt_pk_bf16_f32 v228, v136, v137
    v_exp_f32 v140, v140
    v_mfma_f32_32x32x16_bf16 v[160:175], v[208:211], v[224:227], v[160:175]
    v_exp_f32 v141, v141
    v_cvt_pk_bf16_f32 v229, v138, v139
    v_exp_f32 v142, v142
    v_exp_f32 v143, v143
    v_cvt_pk_bf16_f32 v230, v140, v141
    v_cvt_pk_bf16_f32 v231, v142, v143
    v_exp_f32 v144, v144
    v_exp_f32 v145, v145
    v_mfma_f32_32x32x16_bf16 v[160:175], v[212:215], v[228:231], v[160:175]
    v_exp_f32 v146, v146
    v_exp_f32 v147, v147
    v_cvt_pk_bf16_f32 v224, v144, v145
    v_exp_f32 v148, v148
    v_exp_f32 v149, v149
    s_waitcnt lgkmcnt(0)
    v_cvt_pk_bf16_f32 v225, v146, v147
    v_mfma_f32_32x32x16_bf16 v[128:143], v[24:27], v[16:19], v[240:255]
    s_add_u32 m0, s11, 2048
    s_add_u32 s7, s7, 16384
    buffer_load_dwordx4 v11, s[32:35], s7 offen lds
    buffer_load_dwordx4 v12, s[32:35], s7 offen offset:1024 lds
    v_exp_f32 v150, v150
    v_exp_f32 v151, v151
    v_cvt_pk_bf16_f32 v226, v148, v149
    v_exp_f32 v152, v152
    v_exp_f32 v153, v153
    v_cvt_pk_bf16_f32 v227, v150, v151
    v_mfma_f32_32x32x16_bf16 v[112:127], v[196:199], v[36:39], 0
    v_exp_f32 v154, v154
    v_exp_f32 v155, v155
    v_cvt_pk_bf16_f32 v228, v152, v153
    v_exp_f32 v156, v156
    v_mfma_f32_32x32x16_bf16 v[176:191], v[208:211], v[224:227], v[176:191]
    v_exp_f32 v157, v157
    v_cvt_pk_bf16_f32 v229, v154, v155
    v_exp_f32 v158, v158
    v_exp_f32 v159, v159
    v_cvt_pk_bf16_f32 v230, v156, v157
    v_mfma_f32_32x32x16_bf16 v[64:79], v[200:203], v[40:43], v[64:79]
    v_cvt_pk_bf16_f32 v231, v158, v159
    v_exp_f32 v128, v128
    v_exp_f32 v129, v129
    v_mfma_f32_32x32x16_bf16 v[176:191], v[212:215], v[228:231], v[176:191]
    v_exp_f32 v130, v130
    v_exp_f32 v131, v131
    v_cvt_pk_bf16_f32 v224, v128, v129
    v_exp_f32 v132, v132
    v_exp_f32 v133, v133
    v_cvt_pk_bf16_f32 v225, v130, v131
    v_mfma_f32_32x32x16_bf16 v[144:159], v[24:27], v[20:23], v[240:255]
    ds_read_b128 v[24:27], v2 offset:45760
    ds_read_b128 v[208:211], v3 offset:46784
    ds_read_b128 v[212:215], v4 offset:47296
    s_waitcnt vmcnt(6)
    ds_read_b64_tr_b16 v[192:193], v5 offset:4096
    ds_read_b64_tr_b16 v[194:195], v5 offset:5120
    ds_read_b64_tr_b16 v[196:197], v6 offset:4096
    ds_read_b64_tr_b16 v[198:199], v6 offset:5120
    v_exp_f32 v134, v134
    v_exp_f32 v135, v135
    v_cvt_pk_bf16_f32 v226, v132, v133
    v_exp_f32 v136, v136
    v_exp_f32 v137, v137
    v_cvt_pk_bf16_f32 v227, v134, v135
    v_mfma_f32_32x32x16_bf16 v[80:95], v[204:207], v[40:43], v[80:95]
    v_exp_f32 v138, v138
    v_exp_f32 v139, v139
    v_cvt_pk_bf16_f32 v228, v136, v137
    v_exp_f32 v140, v140
    v_mfma_f32_32x32x16_bf16 v[160:175], v[216:219], v[224:227], v[160:175]
    v_exp_f32 v141, v141
    v_cvt_pk_bf16_f32 v229, v138, v139
    v_exp_f32 v142, v142
    v_exp_f32 v143, v143
    v_cvt_pk_bf16_f32 v230, v140, v141
    v_cvt_pk_bf16_f32 v231, v142, v143
    v_exp_f32 v144, v144
    v_exp_f32 v145, v145
    v_mfma_f32_32x32x16_bf16 v[160:175], v[220:223], v[228:231], v[160:175]
    v_exp_f32 v146, v146
    v_exp_f32 v147, v147
    v_cvt_pk_bf16_f32 v224, v144, v145
    v_exp_f32 v148, v148
    v_exp_f32 v149, v149
    s_waitcnt lgkmcnt(0)
    v_cvt_pk_bf16_f32 v225, v146, v147
    v_mfma_f32_32x32x16_bf16 v[128:143], v[24:27], v[16:19], v[240:255]
    s_add_u32 m0, s11, 4096
    s_add_u32 s7, s7, 16384
    buffer_load_dwordx4 v11, s[32:35], s7 offen lds
    buffer_load_dwordx4 v12, s[32:35], s7 offen offset:1024 lds
    s_add_u32 s6, s6, 4096
    buffer_load_dwordx4 v[32:35], v7, s[28:31], s6 offen offset:0 sc1
    buffer_load_dwordx4 v[36:39], v13, s[28:31], s6 offen offset:0 sc1
    v_exp_f32 v150, v150
    v_exp_f32 v151, v151
    v_cvt_pk_bf16_f32 v226, v148, v149
    v_exp_f32 v152, v152
    v_exp_f32 v153, v153
    v_cvt_pk_bf16_f32 v227, v150, v151
    v_mfma_f32_32x32x16_bf16 v[96:111], v[200:203], v[44:47], v[96:111]
    v_exp_f32 v154, v154
    v_exp_f32 v155, v155
    v_cvt_pk_bf16_f32 v228, v152, v153
    v_exp_f32 v156, v156
    v_mfma_f32_32x32x16_bf16 v[176:191], v[216:219], v[224:227], v[176:191]
    v_exp_f32 v157, v157
    v_cvt_pk_bf16_f32 v229, v154, v155
    v_exp_f32 v158, v158
    v_exp_f32 v159, v159
    v_cvt_pk_bf16_f32 v230, v156, v157
    v_mfma_f32_32x32x16_bf16 v[112:127], v[204:207], v[44:47], v[112:127]
    v_cvt_pk_bf16_f32 v231, v158, v159
    s_setprio 0
    v_exp_f32 v128, v128
    v_exp_f32 v129, v129
    v_mfma_f32_32x32x16_bf16 v[176:191], v[220:223], v[228:231], v[176:191]
    v_exp_f32 v130, v130
    v_exp_f32 v131, v131
    v_cvt_pk_bf16_f32 v224, v128, v129
    v_exp_f32 v132, v132
    v_exp_f32 v133, v133
    v_cvt_pk_bf16_f32 v225, v130, v131
    v_mfma_f32_32x32x16_bf16 v[144:159], v[24:27], v[20:23], v[240:255]
    ds_read_b128 v[24:27], v2 offset:47840
    ds_read_b128 v[216:219], v3 offset:48864
    ds_read_b128 v[220:223], v4 offset:49376
    v_exp_f32 v134, v134
    v_exp_f32 v135, v135
    v_cvt_pk_bf16_f32 v226, v132, v133
    v_exp_f32 v136, v136
    v_exp_f32 v137, v137
    v_cvt_pk_bf16_f32 v227, v134, v135
    v_mfma_f32_32x32x16_bf16 v[64:79], v[192:195], v[48:51], v[64:79]
    v_exp_f32 v138, v138
    v_exp_f32 v139, v139
    v_cvt_pk_bf16_f32 v228, v136, v137
    v_exp_f32 v140, v140
    v_mfma_f32_32x32x16_bf16 v[160:175], v[208:211], v[224:227], v[160:175]
    v_exp_f32 v141, v141
    v_cvt_pk_bf16_f32 v229, v138, v139
    v_exp_f32 v142, v142
    v_exp_f32 v143, v143
    v_cvt_pk_bf16_f32 v230, v140, v141
    v_mfma_f32_32x32x16_bf16 v[80:95], v[196:199], v[48:51], v[80:95]
    v_cvt_pk_bf16_f32 v231, v142, v143
    v_exp_f32 v144, v144
    v_exp_f32 v145, v145
    v_mfma_f32_32x32x16_bf16 v[160:175], v[212:215], v[228:231], v[160:175]
    v_exp_f32 v146, v146
    v_exp_f32 v147, v147
    v_cvt_pk_bf16_f32 v224, v144, v145
    v_exp_f32 v148, v148
    v_exp_f32 v149, v149
    s_waitcnt lgkmcnt(0)
    v_cvt_pk_bf16_f32 v225, v146, v147
    v_mfma_f32_32x32x16_bf16 v[128:143], v[24:27], v[16:19], v[240:255]
    buffer_load_dwordx4 v[40:43], v7, s[28:31], s6 offen offset:1024 sc1
    buffer_load_dwordx4 v[44:47], v13, s[28:31], s6 offen offset:1024 sc1
    v_exp_f32 v150, v150
    v_exp_f32 v151, v151
    v_cvt_pk_bf16_f32 v226, v148, v149
    v_exp_f32 v152, v152
    v_exp_f32 v153, v153
    v_cvt_pk_bf16_f32 v227, v150, v151
    v_mfma_f32_32x32x16_bf16 v[96:111], v[192:195], v[52:55], v[96:111]
    v_exp_f32 v154, v154
    v_exp_f32 v155, v155
    v_cvt_pk_bf16_f32 v228, v152, v153
    v_exp_f32 v156, v156
    v_mfma_f32_32x32x16_bf16 v[176:191], v[208:211], v[224:227], v[176:191]
    v_exp_f32 v157, v157
    v_cvt_pk_bf16_f32 v229, v154, v155
    v_exp_f32 v158, v158
    v_exp_f32 v159, v159
    v_cvt_pk_bf16_f32 v230, v156, v157
    v_cvt_pk_bf16_f32 v231, v158, v159
    v_exp_f32 v128, v128
    v_exp_f32 v129, v129
    v_mfma_f32_32x32x16_bf16 v[176:191], v[212:215], v[228:231], v[176:191]
    v_exp_f32 v130, v130
    v_exp_f32 v131, v131
    v_cvt_pk_bf16_f32 v224, v128, v129
    v_exp_f32 v132, v132
    v_exp_f32 v133, v133
    v_cvt_pk_bf16_f32 v225, v130, v131
    v_mfma_f32_32x32x16_bf16 v[144:159], v[24:27], v[20:23], v[240:255]
    s_barrier
    s_cmp_lg_u32 s27, 0
    s_cbranch_scc1 PF_35
    s_lshl_b32 s60, s2, 7
    s_add_u32 s60, s60, 0xf30000
    v_mov_b32 v232, 0
    v_mov_b32 v233, s26
    s_mov_b64 exec, 1
    buffer_store_dword v233, v232, s[28:31], s60 offen sc1
    s_mov_b64 exec, -1
PF_35:
    s_add_u32 m0, s67, 33280
    s_nop 0
    buffer_load_dwordx4 v1, s[28:31], s66 offen offset:0 sc1 lds
    s_add_u32 m0, s67, 33280
    s_nop 0
    buffer_load_dwordx4 v1, s[28:31], s66 offen offset:1024 sc1 lds
    s_add_u32 s66, s66, 8192
    s_add_u32 m0, s67, 41600
    s_nop 0
    buffer_load_dwordx4 v1, s[28:31], s66 offen offset:0 sc1 lds
    s_add_u32 m0, s67, 41600
    s_nop 0
    buffer_load_dwordx4 v1, s[28:31], s66 offen offset:1024 sc1 lds
    s_add_u32 s66, s66, 8192
    ds_read_b128 v[24:27], v2 offset:0
    ds_read_b128 v[208:211], v3 offset:1024
    ds_read_b128 v[212:215], v4 offset:1536
    s_waitcnt vmcnt(14)
    ds_read_b64_tr_b16 v[200:201], v5 offset:6144
    ds_read_b64_tr_b16 v[202:203], v5 offset:7168
    ds_read_b64_tr_b16 v[204:205], v6 offset:6144
    ds_read_b64_tr_b16 v[206:207], v6 offset:7168
    v_exp_f32 v134, v134
    v_exp_f32 v135, v135
    v_cvt_pk_bf16_f32 v226, v132, v133
    v_exp_f32 v136, v136
    v_exp_f32 v137, v137
    v_cvt_pk_bf16_f32 v227, v134, v135
    v_mfma_f32_32x32x16_bf16 v[112:127], v[196:199], v[52:55], v[112:127]
    v_exp_f32 v138, v138
    v_exp_f32 v139, v139
    v_cvt_pk_bf16_f32 v228, v136, v137
    v_exp_f32 v140, v140
    v_mfma_f32_32x32x16_bf16 v[160:175], v[216:219], v[224:227], v[160:175]
    v_exp_f32 v141, v141
    v_cvt_pk_bf16_f32 v229, v138, v139
    v_exp_f32 v142, v142
    v_exp_f32 v143, v143
    v_cvt_pk_bf16_f32 v230, v140, v141
    v_cvt_pk_bf16_f32 v231, v142, v143
    v_exp_f32 v144, v144
    v_exp_f32 v145, v145
    v_mfma_f32_32x32x16_bf16 v[160:175], v[220:223], v[228:231], v[160:175]
    v_exp_f32 v146, v146
    v_exp_f32 v147, v147
    v_cvt_pk_bf16_f32 v224, v144, v145
    v_exp_f32 v148, v148
    v_exp_f32 v149, v149
    s_waitcnt lgkmcnt(0)
    v_cvt_pk_bf16_f32 v225, v146, v147
    v_mfma_f32_32x32x16_bf16 v[128:143], v[24:27], v[16:19], v[240:255]
    s_add_u32 m0, s11, 6144
    s_add_u32 s7, s7, 16384
    buffer_load_dwordx4 v11, s[32:35], s7 offen lds
    buffer_load_dwordx4 v12, s[32:35], s7 offen offset:1024 lds
    buffer_load_dwordx4 v[48:51], v7, s[28:31], s6 offen offset:2048 sc1
    buffer_load_dwordx4 v[52:55], v13, s[28:31], s6 offen offset:2048 sc1
    v_exp_f32 v150, v150
    v_exp_f32 v151, v151
    v_cvt_pk_bf16_f32 v226, v148, v149
    v_exp_f32 v152, v152
    v_exp_f32 v153, v153
    v_cvt_pk_bf16_f32 v227, v150, v151
    v_mfma_f32_32x32x16_bf16 v[64:79], v[200:203], v[56:59], v[64:79]
    v_exp_f32 v154, v154
    v_exp_f32 v155, v155
    v_cvt_pk_bf16_f32 v228, v152, v153
    v_exp_f32 v156, v156
    v_mfma_f32_32x32x16_bf16 v[176:191], v[216:219], v[224:227], v[176:191]
    v_exp_f32 v157, v157
    v_cvt_pk_bf16_f32 v229, v154, v155
    v_exp_f32 v158, v158
    v_exp_f32 v159, v159
    v_cvt_pk_bf16_f32 v230, v156, v157
    v_mfma_f32_32x32x16_bf16 v[80:95], v[204:207], v[56:59], v[80:95]
    v_cvt_pk_bf16_f32 v231, v158, v159
    s_setprio 3
    v_exp_f32 v128, v128
    v_exp_f32 v129, v129
    v_mfma_f32_32x32x16_bf16 v[176:191], v[220:223], v[228:231], v[176:191]
    v_exp_f32 v130, v130
    v_exp_f32 v131, v131
    v_cvt_pk_bf16_f32 v224, v128, v129
    v_exp_f32 v132, v132
    v_exp_f32 v133, v133
    v_cvt_pk_bf16_f32 v225, v130, v131
    v_mfma_f32_32x32x16_bf16 v[144:159], v[24:27], v[20:23], v[240:255]
    ds_read_b128 v[24:27], v2 offset:2080
    ds_read_b128 v[216:219], v3 offset:3104
    ds_read_b128 v[220:223], v4 offset:3616
    s_waitcnt vmcnt(10)
    ds_read_b64_tr_b16 v[192:193], v5 offset:0
    ds_read_b64_tr_b16 v[194:195], v5 offset:1024
    ds_read_b64_tr_b16 v[196:197], v6 offset:0
    ds_read_b64_tr_b16 v[198:199], v6 offset:1024
    v_exp_f32 v134, v134
    v_exp_f32 v135, v135
    v_cvt_pk_bf16_f32 v226, v132, v133
    v_exp_f32 v136, v136
    v_exp_f32 v137, v137
    v_cvt_pk_bf16_f32 v227, v134, v135
    v_mfma_f32_32x32x16_bf16 v[96:111], v[200:203], v[60:63], v[96:111]
    v_exp_f32 v138, v138
    v_exp_f32 v139, v139
    v_cvt_pk_bf16_f32 v228, v136, v137
    v_exp_f32 v140, v140
    v_mfma_f32_32x32x16_bf16 v[160:175], v[208:211], v[224:227], v[160:175]
    v_exp_f32 v141, v141
    v_cvt_pk_bf16_f32 v229, v138, v139
    v_exp_f32 v142, v142
    v_exp_f32 v143, v143
    v_cvt_pk_bf16_f32 v230, v140, v141
    v_cvt_pk_bf16_f32 v231, v142, v143
    v_exp_f32 v144, v144
    v_exp_f32 v145, v145
    v_mfma_f32_32x32x16_bf16 v[160:175], v[212:215], v[228:231], v[160:175]
    v_exp_f32 v146, v146
    v_exp_f32 v147, v147
    v_cvt_pk_bf16_f32 v224, v144, v145
    v_exp_f32 v148, v148
    v_exp_f32 v149, v149
    s_waitcnt lgkmcnt(0)
    v_cvt_pk_bf16_f32 v225, v146, v147
    v_mfma_f32_32x32x16_bf16 v[128:143], v[24:27], v[16:19], v[240:255]
    s_add_u32 m0, s11, 0
    s_add_u32 s7, s7, 16384
    buffer_load_dwordx4 v11, s[32:35], s7 offen lds
    buffer_load_dwordx4 v12, s[32:35], s7 offen offset:1024 lds
    v_exp_f32 v150, v150
    v_exp_f32 v151, v151
    v_cvt_pk_bf16_f32 v226, v148, v149
    v_exp_f32 v152, v152
    v_exp_f32 v153, v153
    v_cvt_pk_bf16_f32 v227, v150, v151
    v_mfma_f32_32x32x16_bf16 v[112:127], v[204:207], v[60:63], v[112:127]
    v_exp_f32 v154, v154
    v_exp_f32 v155, v155
    v_cvt_pk_bf16_f32 v228, v152, v153
    v_exp_f32 v156, v156
    v_mfma_f32_32x32x16_bf16 v[176:191], v[208:211], v[224:227], v[176:191]
    v_exp_f32 v157, v157
    v_cvt_pk_bf16_f32 v229, v154, v155
    v_exp_f32 v158, v158
    v_exp_f32 v159, v159
    v_cvt_pk_bf16_f32 v230, v156, v157
    v_mfma_f32_32x32x16_bf16 v[64:79], v[192:195], v[32:35], v[64:79]
    v_cvt_pk_bf16_f32 v231, v158, v159
    v_exp_f32 v128, v128
    v_exp_f32 v129, v129
    v_mfma_f32_32x32x16_bf16 v[176:191], v[212:215], v[228:231], v[176:191]
    v_exp_f32 v130, v130
    v_exp_f32 v131, v131
    v_cvt_pk_bf16_f32 v224, v128, v129
    v_exp_f32 v132, v132
    v_exp_f32 v133, v133
    v_cvt_pk_bf16_f32 v225, v130, v131
    v_mfma_f32_32x32x16_bf16 v[144:159], v[24:27], v[20:23], v[240:255]
    ds_read_b128 v[24:27], v2 offset:4160
    ds_read_b128 v[208:211], v3 offset:5184
    ds_read_b128 v[212:215], v4 offset:5696
    s_waitcnt vmcnt(10)
    ds_read_b64_tr_b16 v[200:201], v5 offset:2048
    ds_read_b64_tr_b16 v[202:203], v5 offset:3072
    ds_read_b64_tr_b16 v[204:205], v6 offset:2048
    ds_read_b64_tr_b16 v[206:207], v6 offset:3072
    v_exp_f32 v134, v134
    v_exp_f32 v135, v135
    v_cvt_pk_bf16_f32 v226, v132, v133
    v_exp_f32 v136, v136
    v_exp_f32 v137, v137
    v_cvt_pk_bf16_f32 v227, v134, v135
    v_mfma_f32_32x32x16_bf16 v[80:95], v[196:199], v[32:35], v[80:95]
    v_exp_f32 v138, v138
    v_exp_f32 v139, v139
    v_cvt_pk_bf16_f32 v228, v136, v137
    v_exp_f32 v140, v140
    v_mfma_f32_32x32x16_bf16 v[160:175], v[216:219], v[224:227], v[160:175]
    v_exp_f32 v141, v141
    v_cvt_pk_bf16_f32 v229, v138, v139
    v_exp_f32 v142, v142
    v_exp_f32 v143, v143
    v_cvt_pk_bf16_f32 v230, v140, v141
    v_cvt_pk_bf16_f32 v231, v142, v143
    v_exp_f32 v144, v144
    v_exp_f32 v145, v145
    v_mfma_f32_32x32x16_bf16 v[160:175], v[220:223], v[228:231], v[160:175]
    v_exp_f32 v146, v146
    v_exp_f32 v147, v147
    v_cvt_pk_bf16_f32 v224, v144, v145
    v_exp_f32 v148, v148
    v_exp_f32 v149, v149
    s_waitcnt lgkmcnt(0)
    v_cvt_pk_bf16_f32 v225, v146, v147
    v_mfma_f32_32x32x16_bf16 v[128:143], v[24:27], v[16:19], v[240:255]
    s_add_u32 m0, s11, 2048
    s_add_u32 s7, s7, 16384
    buffer_load_dwordx4 v11, s[32:35], s7 offen lds
    buffer_load_dwordx4 v12, s[32:35], s7 offen offset:1024 lds
    buffer_load_dwordx4 v[56:59], v7, s[28:31], s6 offen offset:3072 sc1
    buffer_load_dwordx4 v[60:63], v13, s[28:31], s6 offen offset:3072 sc1
    v_exp_f32 v150, v150
    v_exp_f32 v151, v151
    v_cvt_pk_bf16_f32 v226, v148, v149
    v_exp_f32 v152, v152
    v_exp_f32 v153, v153
    v_cvt_pk_bf16_f32 v227, v150, v151
    v_mfma_f32_32x32x16_bf16 v[96:111], v[192:195], v[36:39], v[96:111]
    v_exp_f32 v154, v154
    v_exp_f32 v155, v155
    v_cvt_pk_bf16_f32 v228, v152, v153
    v_exp_f32 v156, v156
    v_mfma_f32_32x32x16_bf16 v[176:191], v[216:219], v[224:227], v[176:191]
    v_exp_f32 v157, v157
    v_cvt_pk_bf16_f32 v229, v154, v155
    v_exp_f32 v158, v158
    v_exp_f32 v159, v159
    v_cvt_pk_bf16_f32 v230, v156, v157
    v_mfma_f32_32x32x16_bf16 v[112:127], v[196:199], v[36:39], v[112:127]
    v_cvt_pk_bf16_f32 v231, v158, v159
    s_setprio 2
    v_exp_f32 v128, v128
    v_exp_f32 v129, v129
    v_mfma_f32_32x32x16_bf16 v[176:191], v[220:223], v[228:231], v[176:191]
    v_exp_f32 v130, v130
    v_exp_f32 v131, v131
    v_cvt_pk_bf16_f32 v224, v128, v129
    v_exp_f32 v132, v132
    v_exp_f32 v133, v133
    v_cvt_pk_bf16_f32 v225, v130, v131
    v_mfma_f32_32x32x16_bf16 v[144:159], v[24:27], v[20:23], v[240:255]
    ds_read_b128 v[24:27], v2 offset:6240
    ds_read_b128 v[216:219], v3 offset:7264
    ds_read_b128 v[220:223], v4 offset:7776
    v_exp_f32 v134, v134
    v_exp_f32 v135, v135
    v_cvt_pk_bf16_f32 v226, v132, v133
    v_exp_f32 v136, v136
    v_exp_f32 v137, v137
    v_cvt_pk_bf16_f32 v227, v134, v135
    v_mfma_f32_32x32x16_bf16 v[64:79], v[200:203], v[40:43], v[64:79]
    v_exp_f32 v138, v138
    v_exp_f32 v139, v139
    v_cvt_pk_bf16_f32 v228, v136, v137
    v_exp_f32 v140, v140
    v_mfma_f32_32x32x16_bf16 v[160:175], v[208:211], v[224:227], v[160:175]
    v_exp_f32 v141, v141
    v_cvt_pk_bf16_f32 v229, v138, v139
    v_exp_f32 v142, v142
    v_exp_f32 v143, v143
    v_cvt_pk_bf16_f32 v230, v140, v141
    v_mfma_f32_32x32x16_bf16 v[80:95], v[204:207], v[40:43], v[80:95]
    v_cvt_pk_bf16_f32 v231, v142, v143
    v_exp_f32 v144, v144
    v_exp_f32 v145, v145
    v_mfma_f32_32x32x16_bf16 v[160:175], v[212:215], v[228:231], v[160:175]
    v_exp_f32 v146, v146
    v_exp_f32 v147, v147
    v_cvt_pk_bf16_f32 v224, v144, v145
    v_exp_f32 v148, v148
    v_exp_f32 v149, v149
    s_waitcnt lgkmcnt(0)
    v_cvt_pk_bf16_f32 v225, v146, v147
    v_mfma_f32_32x32x16_bf16 v[128:143], v[24:27], v[16:19], v[240:255]
    s_add_u32 s6, s6, 4096
    buffer_load_dwordx4 v[32:35], v7, s[28:31], s6 offen offset:0 sc1
    buffer_load_dwordx4 v[36:39], v13, s[28:31], s6 offen offset:0 sc1
    v_exp_f32 v150, v150
    v_exp_f32 v151, v151
    v_cvt_pk_bf16_f32 v226, v148, v149
    v_exp_f32 v152, v152
    v_exp_f32 v153, v153
    v_cvt_pk_bf16_f32 v227, v150, v151
    v_mfma_f32_32x32x16_bf16 v[96:111], v[200:203], v[44:47], v[96:111]
    v_exp_f32 v154, v154
    v_exp_f32 v155, v155
    v_cvt_pk_bf16_f32 v228, v152, v153
    v_exp_f32 v156, v156
    v_mfma_f32_32x32x16_bf16 v[176:191], v[208:211], v[224:227], v[176:191]
    v_exp_f32 v157, v157
    v_cvt_pk_bf16_f32 v229, v154, v155
    v_exp_f32 v158, v158
    v_exp_f32 v159, v159
    v_cvt_pk_bf16_f32 v230, v156, v157
    v_cvt_pk_bf16_f32 v231, v158, v159
    v_exp_f32 v128, v128
    v_exp_f32 v129, v129
    v_mfma_f32_32x32x16_bf16 v[176:191], v[212:215], v[228:231], v[176:191]
    v_exp_f32 v130, v130
    v_exp_f32 v131, v131
    v_cvt_pk_bf16_f32 v224, v128, v129
    v_exp_f32 v132, v132
    v_exp_f32 v133, v133
    v_cvt_pk_bf16_f32 v225, v130, v131
    v_mfma_f32_32x32x16_bf16 v[144:159], v[24:27], v[20:23], v[240:255]
    ds_read_b128 v[24:27], v2 offset:8320
    ds_read_b128 v[208:211], v3 offset:9344
    ds_read_b128 v[212:215], v4 offset:9856
    s_waitcnt vmcnt(8)
    ds_read_b64_tr_b16 v[192:193], v5 offset:4096
    ds_read_b64_tr_b16 v[194:195], v5 offset:5120
    ds_read_b64_tr_b16 v[196:197], v6 offset:4096
    ds_read_b64_tr_b16 v[198:199], v6 offset:5120
    v_exp_f32 v134, v134
    v_exp_f32 v135, v135
    v_cvt_pk_bf16_f32 v226, v132, v133
    v_exp_f32 v136, v136
    v_exp_f32 v137, v137
    v_cvt_pk_bf16_f32 v227, v134, v135
    v_mfma_f32_32x32x16_bf16 v[112:127], v[204:207], v[44:47], v[112:127]
    v_exp_f32 v138, v138
    v_exp_f32 v139, v139
    v_cvt_pk_bf16_f32 v228, v136, v137
    v_exp_f32 v140, v140
    v_mfma_f32_32x32x16_bf16 v[160:175], v[216:219], v[224:227], v[160:175]
    v_exp_f32 v141, v141
    v_cvt_pk_bf16_f32 v229, v138, v139
    v_exp_f32 v142, v142
    v_exp_f32 v143, v143
    v_cvt_pk_bf16_f32 v230, v140, v141
    v_cvt_pk_bf16_f32 v231, v142, v143
    v_exp_f32 v144, v144
    v_exp_f32 v145, v145
    v_mfma_f32_32x32x16_bf16 v[160:175], v[220:223], v[228:231], v[160:175]
    v_exp_f32 v146, v146
    v_exp_f32 v147, v147
    v_cvt_pk_bf16_f32 v224, v144, v145
    v_exp_f32 v148, v148
    v_exp_f32 v149, v149
    s_waitcnt lgkmcnt(0)
    v_cvt_pk_bf16_f32 v225, v146, v147
    v_mfma_f32_32x32x16_bf16 v[128:143], v[24:27], v[16:19], v[240:255]
    s_add_u32 m0, s11, 4096
    s_add_u32 s7, s7, 16384
    buffer_load_dwordx4 v11, s[32:35], s7 offen lds
    buffer_load_dwordx4 v12, s[32:35], s7 offen offset:1024 lds
    buffer_load_dwordx4 v[40:43], v7, s[28:31], s6 offen offset:1024 sc1
    buffer_load_dwordx4 v[44:47], v13, s[28:31], s6 offen offset:1024 sc1
    v_exp_f32 v150, v150
    v_exp_f32 v151, v151
    v_cvt_pk_bf16_f32 v226, v148, v149
    v_exp_f32 v152, v152
    v_exp_f32 v153, v153
    v_cvt_pk_bf16_f32 v227, v150, v151
    v_mfma_f32_32x32x16_bf16 v[64:79], v[192:195], v[48:51], v[64:79]
    v_exp_f32 v154, v154
    v_exp_f32 v155, v155
    v_cvt_pk_bf16_f32 v228, v152, v153
    v_exp_f32 v156, v156
    v_mfma_f32_32x32x16_bf16 v[176:191], v[216:219], v[224:227], v[176:191]
    v_exp_f32 v157, v157
    v_cvt_pk_bf16_f32 v229, v154, v155
    v_exp_f32 v158, v158
    v_exp_f32 v159, v159
    v_cvt_pk_bf16_f32 v230, v156, v157
    v_mfma_f32_32x32x16_bf16 v[80:95], v[196:199], v[48:51], v[80:95]
    v_cvt_pk_bf16_f32 v231, v158, v159
    s_setprio 1
    v_exp_f32 v128, v128
    v_exp_f32 v129, v129
    v_mfma_f32_32x32x16_bf16 v[176:191], v[220:223], v[228:231], v[176:191]
    v_exp_f32 v130, v130
    v_exp_f32 v131, v131
    v_cvt_pk_bf16_f32 v224, v128, v129
    v_exp_f32 v132, v132
    v_exp_f32 v133, v133
    v_cvt_pk_bf16_f32 v225, v130, v131
    v_mfma_f32_32x32x16_bf16 v[144:159], v[24:27], v[20:23], v[240:255]
    ds_read_b128 v[24:27], v2 offset:10400
    ds_read_b128 v[216:219], v3 offset:11424
    ds_read_b128 v[220:223], v4 offset:11936
    s_waitcnt vmcnt(6)
    ds_read_b64_tr_b16 v[200:201], v5 offset:6144
    ds_read_b64_tr_b16 v[202:203], v5 offset:7168
    ds_read_b64_tr_b16 v[204:205], v6 offset:6144
    ds_read_b64_tr_b16 v[206:207], v6 offset:7168
    v_exp_f32 v134, v134
    v_exp_f32 v135, v135
    v_cvt_pk_bf16_f32 v226, v132, v133
    v_exp_f32 v136, v136
    v_exp_f32 v137, v137
    v_cvt_pk_bf16_f32 v227, v134, v135
    v_mfma_f32_32x32x16_bf16 v[96:111], v[192:195], v[52:55], v[96:111]
    v_exp_f32 v138, v138
    v_exp_f32 v139, v139
    v_cvt_pk_bf16_f32 v228, v136, v137
    v_exp_f32 v140, v140
    v_mfma_f32_32x32x16_bf16 v[160:175], v[208:211], v[224:227], v[160:175]
    v_exp_f32 v141, v141
    v_cvt_pk_bf16_f32 v229, v138, v139
    v_exp_f32 v142, v142
    v_exp_f32 v143, v143
    v_cvt_pk_bf16_f32 v230, v140, v141
    v_cvt_pk_bf16_f32 v231, v142, v143
    v_exp_f32 v144, v144
    v_exp_f32 v145, v145
    v_mfma_f32_32x32x16_bf16 v[160:175], v[212:215], v[228:231], v[160:175]
    v_exp_f32 v146, v146
    v_exp_f32 v147, v147
    v_cvt_pk_bf16_f32 v224, v144, v145
    v_exp_f32 v148, v148
    v_exp_f32 v149, v149
    s_waitcnt lgkmcnt(0)
    v_cvt_pk_bf16_f32 v225, v146, v147
    v_mfma_f32_32x32x16_bf16 v[128:143], v[24:27], v[16:19], v[240:255]
    s_add_u32 m0, s11, 6144
    s_add_u32 s7, s7, 16384
    buffer_load_dwordx4 v11, s[32:35], s7 offen lds
    buffer_load_dwordx4 v12, s[32:35], s7 offen offset:1024 lds
    v_and_b32 v232, 31, v0
    v_lshlrev_b32 v232, 3, v232
    buffer_load_dwordx2 v[28:29], v232, s[28:31], s58 offen sc1
    buffer_load_dwordx2 v[30:31], v232, s[28:31], s59 offen sc1
    v_exp_f32 v150, v150
    v_exp_f32 v151, v151
    v_cvt_pk_bf16_f32 v226, v148, v149
    v_exp_f32 v152, v152
    v_exp_f32 v153, v153
    v_cvt_pk_bf16_f32 v227, v150, v151
    v_mfma_f32_32x32x16_bf16 v[112:127], v[196:199], v[52:55], v[112:127]
    v_exp_f32 v154, v154
    v_exp_f32 v155, v155
    v_cvt_pk_bf16_f32 v228, v152, v153
    v_exp_f32 v156, v156
    v_mfma_f32_32x32x16_bf16 v[176:191], v[208:211], v[224:227], v[176:191]
    v_exp_f32 v157, v157
    v_cvt_pk_bf16_f32 v229, v154, v155
    v_exp_f32 v158, v158
    v_exp_f32 v159, v159
    v_cvt_pk_bf16_f32 v230, v156, v157
    v_mfma_f32_32x32x16_bf16 v[64:79], v[200:203], v[56:59], v[64:79]
    v_cvt_pk_bf16_f32 v231, v158, v159
    v_exp_f32 v128, v128
    v_exp_f32 v129, v129
    v_mfma_f32_32x32x16_bf16 v[176:191], v[212:215], v[228:231], v[176:191]
    v_exp_f32 v130, v130
    v_exp_f32 v131, v131
    v_cvt_pk_bf16_f32 v224, v128, v129
    v_exp_f32 v132, v132
    v_exp_f32 v133, v133
    v_cvt_pk_bf16_f32 v225, v130, v131
    v_mfma_f32_32x32x16_bf16 v[144:159], v[24:27], v[20:23], v[240:255]
    ds_read_b128 v[24:27], v2 offset:12480
    ds_read_b128 v[208:211], v3 offset:13504
    ds_read_b128 v[212:215], v4 offset:14016
    v_exp_f32 v134, v134
    v_exp_f32 v135, v135
    v_cvt_pk_bf16_f32 v226, v132, v133
    v_exp_f32 v136, v136
    v_exp_f32 v137, v137
    v_cvt_pk_bf16_f32 v227, v134, v135
    v_mfma_f32_32x32x16_bf16 v[80:95], v[204:207], v[56:59], v[80:95]
    v_exp_f32 v138, v138
    v_exp_f32 v139, v139
    v_cvt_pk_bf16_f32 v228, v136, v137
    v_exp_f32 v140, v140
    v_mfma_f32_32x32x16_bf16 v[160:175], v[216:219], v[224:227], v[160:175]
    v_exp_f32 v141, v141
    v_cvt_pk_bf16_f32 v229, v138, v139
    v_exp_f32 v142, v142
    v_exp_f32 v143, v143
    v_cvt_pk_bf16_f32 v230, v140, v141
    v_cvt_pk_bf16_f32 v231, v142, v143
    v_exp_f32 v144, v144
    v_exp_f32 v145, v145
    v_mfma_f32_32x32x16_bf16 v[160:175], v[220:223], v[228:231], v[160:175]
    v_exp_f32 v146, v146
    v_exp_f32 v147, v147
    v_cvt_pk_bf16_f32 v224, v144, v145
    v_exp_f32 v148, v148
    v_exp_f32 v149, v149
    s_waitcnt lgkmcnt(0)
    v_cvt_pk_bf16_f32 v225, v146, v147
    v_mfma_f32_32x32x16_bf16 v[128:143], v[24:27], v[16:19], v[240:255]
    buffer_load_dwordx4 v[48:51], v7, s[28:31], s6 offen offset:2048 sc1
    buffer_load_dwordx4 v[52:55], v13, s[28:31], s6 offen offset:2048 sc1
    v_exp_f32 v150, v150
    v_exp_f32 v151, v151
    v_cvt_pk_bf16_f32 v226, v148, v149
    v_exp_f32 v152, v152
    v_exp_f32 v153, v153
    v_cvt_pk_bf16_f32 v227, v150, v151
    v_mfma_f32_32x32x16_bf16 v[96:111], v[200:203], v[60:63], v[96:111]
    v_exp_f32 v154, v154
    v_exp_f32 v155, v155
    v_cvt_pk_bf16_f32 v228, v152, v153
    v_exp_f32 v156, v156
    v_mfma_f32_32x32x16_bf16 v[176:191], v[216:219], v[224:227], v[176:191]
    v_exp_f32 v157, v157
    v_cvt_pk_bf16_f32 v229, v154, v155
    v_exp_f32 v158, v158
    v_exp_f32 v159, v159
    v_cvt_pk_bf16_f32 v230, v156, v157
    v_cvt_pk_bf16_f32 v231, v158, v159
    s_setprio 0
    v_exp_f32 v128, v128
    v_exp_f32 v129, v129
    v_mfma_f32_32x32x16_bf16 v[176:191], v[220:223], v[228:231], v[176:191]
    v_exp_f32 v130, v130
    v_exp_f32 v131, v131
    v_cvt_pk_bf16_f32 v224, v128, v129
    v_exp_f32 v132, v132
    v_exp_f32 v133, v133
    v_cvt_pk_bf16_f32 v225, v130, v131
    v_mfma_f32_32x32x16_bf16 v[144:159], v[24:27], v[20:23], v[240:255]
    ds_read_b128 v[24:27], v2 offset:14560
    ds_read_b128 v[216:219], v3 offset:15584
    ds_read_b128 v[220:223], v4 offset:16096
    s_waitcnt vmcnt(10)
    ds_read_b64_tr_b16 v[192:193], v5 offset:0
    ds_read_b64_tr_b16 v[194:195], v5 offset:1024
    ds_read_b64_tr_b16 v[196:197], v6 offset:0
    ds_read_b64_tr_b16 v[198:199], v6 offset:1024
    v_exp_f32 v134, v134
    v_exp_f32 v135, v135
    v_cvt_pk_bf16_f32 v226, v132, v133
    v_exp_f32 v136, v136
    v_exp_f32 v137, v137
    v_cvt_pk_bf16_f32 v227, v134, v135
    v_mfma_f32_32x32x16_bf16 v[112:127], v[204:207], v[60:63], v[112:127]
    v_exp_f32 v138, v138
    v_exp_f32 v139, v139
    v_cvt_pk_bf16_f32 v228, v136, v137
    v_exp_f32 v140, v140
    v_mfma_f32_32x32x16_bf16 v[160:175], v[208:211], v[224:227], v[160:175]
    v_exp_f32 v141, v141
    v_cvt_pk_bf16_f32 v229, v138, v139
    v_exp_f32 v142, v142
    v_exp_f32 v143, v143
    v_cvt_pk_bf16_f32 v230, v140, v141
    v_cvt_pk_bf16_f32 v231, v142, v143
    v_exp_f32 v144, v144
    v_exp_f32 v145, v145
    v_mfma_f32_32x32x16_bf16 v[160:175], v[212:215], v[228:231], v[160:175]
    v_exp_f32 v146, v146
    v_exp_f32 v147, v147
    v_cvt_pk_bf16_f32 v224, v144, v145
    v_exp_f32 v148, v148
    v_exp_f32 v149, v149
    s_waitcnt lgkmcnt(0)
    v_cvt_pk_bf16_f32 v225, v146, v147
    v_mfma_f32_32x32x16_bf16 v[128:143], v[24:27], v[16:19], v[240:255]
    s_add_u32 m0, s11, 0
    s_add_u32 s7, s7, 16384
    buffer_load_dwordx4 v11, s[32:35], s7 offen lds
    buffer_load_dwordx4 v12, s[32:35], s7 offen offset:1024 lds
    buffer_load_dwordx4 v[56:59], v7, s[28:31], s6 offen offset:3072 sc1
    buffer_load_dwordx4 v[60:63], v13, s[28:31], s6 offen offset:3072 sc1
    s_mov_b32 s60, 0xf30000
    s_mov_b32 exec_lo, 0xff
    s_mov_b32 exec_hi, 0x0
    buffer_load_dword v15, v10, s[28:31], s60 offen sc1
    s_mov_b64 exec, -1
    v_exp_f32 v150, v150
    v_exp_f32 v151, v151
    v_cvt_pk_bf16_f32 v226, v148, v149
    v_exp_f32 v152, v152
    v_exp_f32 v153, v153
    v_cvt_pk_bf16_f32 v227, v150, v151
    v_mfma_f32_32x32x16_bf16 v[64:79], v[192:195], v[32:35], v[64:79]
    v_exp_f32 v154, v154
    v_exp_f32 v155, v155
    v_cvt_pk_bf16_f32 v228, v152, v153
    v_exp_f32 v156, v156
    v_mfma_f32_32x32x16_bf16 v[176:191], v[208:211], v[224:227], v[176:191]
    v_exp_f32 v157, v157
    v_cvt_pk_bf16_f32 v229, v154, v155
    v_exp_f32 v158, v158
    v_exp_f32 v159, v159
    v_cvt_pk_bf16_f32 v230, v156, v157
    v_mfma_f32_32x32x16_bf16 v[80:95], v[196:199], v[32:35], v[80:95]
    v_cvt_pk_bf16_f32 v231, v158, v159
    v_exp_f32 v128, v128
    v_exp_f32 v129, v129
    v_mfma_f32_32x32x16_bf16 v[176:191], v[212:215], v[228:231], v[176:191]
    v_exp_f32 v130, v130
    v_exp_f32 v131, v131
    v_cvt_pk_bf16_f32 v224, v128, v129
    v_exp_f32 v132, v132
    v_exp_f32 v133, v133
    v_cvt_pk_bf16_f32 v225, v130, v131
    v_mfma_f32_32x32x16_bf16 v[144:159], v[24:27], v[20:23], v[240:255]
    s_barrier
    ds_read_b128 v[24:27], v2 offset:33280
    ds_read_b128 v[208:211], v3 offset:34304
    ds_read_b128 v[212:215], v4 offset:34816
    s_waitcnt vmcnt(11)
    ds_read_b64_tr_b16 v[200:201], v5 offset:2048
    ds_read_b64_tr_b16 v[202:203], v5 offset:3072
    ds_read_b64_tr_b16 v[204:205], v6 offset:2048
    ds_read_b64_tr_b16 v[206:207], v6 offset:3072
    v_exp_f32 v134, v134
    v_exp_f32 v135, v135
    v_cvt_pk_bf16_f32 v226, v132, v133
    v_exp_f32 v136, v136
    v_exp_f32 v137, v137
    v_cvt_pk_bf16_f32 v227, v134, v135
    v_mfma_f32_32x32x16_bf16 v[96:111], v[192:195], v[36:39], v[96:111]
    v_exp_f32 v138, v138
    v_exp_f32 v139, v139
    v_cvt_pk_bf16_f32 v228, v136, v137
    v_exp_f32 v140, v140
    v_mfma_f32_32x32x16_bf16 v[160:175], v[216:219], v[224:227], v[160:175]
    v_exp_f32 v141, v141
    v_cvt_pk_bf16_f32 v229, v138, v139
    v_exp_f32 v142, v142
    v_exp_f32 v143, v143
    v_cvt_pk_bf16_f32 v230, v140, v141
    v_cvt_pk_bf16_f32 v231, v142, v143
    v_exp_f32 v144, v144
    v_exp_f32 v145, v145
    v_mfma_f32_32x32x16_bf16 v[160:175], v[220:223], v[228:231], v[160:175]
    v_exp_f32 v146, v146
    v_exp_f32 v147, v147
    v_cvt_pk_bf16_f32 v224, v144, v145
    v_exp_f32 v148, v148
    v_exp_f32 v149, v149
    s_waitcnt lgkmcnt(0)
    v_cvt_pk_bf16_f32 v225, v146, v147
    v_mfma_f32_32x32x16_bf16 v[128:143], v[24:27], v[16:19], v[240:255]
    s_add_u32 m0, s11, 2048
    s_add_u32 s7, s7, 16384
    buffer_load_dwordx4 v11, s[32:35], s7 offen lds
    buffer_load_dwordx4 v12, s[32:35], s7 offen offset:1024 lds
    v_exp_f32 v150, v150
    v_exp_f32 v151, v151
    v_cvt_pk_bf16_f32 v226, v148, v149
    v_exp_f32 v152, v152
    v_exp_f32 v153, v153
    v_cvt_pk_bf16_f32 v227, v150, v151
    v_mfma_f32_32x32x16_bf16 v[112:127], v[196:199], v[36:39], v[112:127]
    v_exp_f32 v154, v154
    v_exp_f32 v155, v155
    v_cvt_pk_bf16_f32 v228, v152, v153
    v_exp_f32 v156, v156
    v_mfma_f32_32x32x16_bf16 v[176:191], v[216:219], v[224:227], v[176:191]
    v_exp_f32 v157, v157
    v_cvt_pk_bf16_f32 v229, v154, v155
    v_exp_f32 v158, v158
    v_exp_f32 v159, v159
    v_cvt_pk_bf16_f32 v230, v156, v157
    v_mfma_f32_32x32x16_bf16 v[64:79], v[200:203], v[40:43], v[64:79]
    v_cvt_pk_bf16_f32 v231, v158, v159
    s_setprio 3
    v_exp_f32 v128, v128
    v_exp_f32 v129, v129
    v_mfma_f32_32x32x16_bf16 v[176:191], v[220:223], v[228:231], v[176:191]
    v_exp_f32 v130, v130
    v_exp_f32 v131, v131
    v_cvt_pk_bf16_f32 v224, v128, v129
    v_exp_f32 v132, v132
    v_exp_f32 v133, v133
    v_cvt_pk_bf16_f32 v225, v130, v131
    v_mfma_f32_32x32x16_bf16 v[144:159], v[24:27], v[20:23], v[240:255]
    ds_read_b128 v[24:27], v2 offset:35360
    ds_read_b128 v[216:219], v3 offset:36384
    ds_read_b128 v[220:223], v4 offset:36896
    s_waitcnt vmcnt(7)
    ds_read_b64_tr_b16 v[192:193], v5 offset:4096
    ds_read_b64_tr_b16 v[194:195], v5 offset:5120
    ds_read_b64_tr_b16 v[196:197], v6 offset:4096
    ds_read_b64_tr_b16 v[198:199], v6 offset:5120
    v_exp_f32 v134, v134
    v_exp_f32 v135, v135
    v_cvt_pk_bf16_f32 v226, v132, v133
    v_exp_f32 v136, v136
    v_exp_f32 v137, v137
    v_cvt_pk_bf16_f32 v227, v134, v135
    v_mfma_f32_32x32x16_bf16 v[80:95], v[204:207], v[40:43], v[80:95]
    v_exp_f32 v138, v138
    v_exp_f32 v139, v139
    v_cvt_pk_bf16_f32 v228, v136, v137
    v_exp_f32 v140, v140
    v_mfma_f32_32x32x16_bf16 v[160:175], v[208:211], v[224:227], v[160:175]
    v_exp_f32 v141, v141
    v_cvt_pk_bf16_f32 v229, v138, v139
    v_exp_f32 v142, v142
    v_exp_f32 v143, v143
    v_cvt_pk_bf16_f32 v230, v140, v141
    v_cvt_pk_bf16_f32 v231, v142, v143
    v_exp_f32 v144, v144
    v_exp_f32 v145, v145
    v_mfma_f32_32x32x16_bf16 v[160:175], v[212:215], v[228:231], v[160:175]
    v_exp_f32 v146, v146
    v_exp_f32 v147, v147
    v_cvt_pk_bf16_f32 v224, v144, v145
    v_exp_f32 v148, v148
    v_exp_f32 v149, v149
    s_waitcnt lgkmcnt(0)
    v_cvt_pk_bf16_f32 v225, v146, v147
    v_mfma_f32_32x32x16_bf16 v[128:143], v[24:27], v[16:19], v[240:255]
    s_add_u32 m0, s11, 4096
    s_nop 0
    buffer_load_dwordx4 v11, s[36:39], s10 offen lds
    buffer_load_dwordx4 v12, s[36:39], s10 offen offset:1024 lds
    s_add_u32 s6, s6, 4096
    buffer_load_dwordx4 v[32:35], v7, s[28:31], s6 offen offset:0 sc1
    buffer_load_dwordx4 v[36:39], v13, s[28:31], s6 offen offset:0 sc1
    s_waitcnt vmcnt(6)
    v_cmp_ne_u32 vcc, s26, v15
    s_and_b32 vcc_lo, vcc_lo, 0xff
    s_and_b32 vcc_hi, vcc_hi, 0x0
    s_or_b32 s60, vcc_lo, vcc_hi
    s_cbranch_scc0 FOK_36
    s_mov_b32 s60, 0xf30000
    s_mov_b32 s61, 0x80000
    s_mov_b32 exec_lo, 0xff
    s_mov_b32 exec_hi, 0x0
POLL_37:
    buffer_load_dword v15, v10, s[28:31], s60 offen sc1
    s_waitcnt vmcnt(0)
    v_cmp_ne_u32 vcc, s26, v15
    s_cbranch_vccz POLLD_38
    s_mov_b64 exec, vcc
    s_sub_u32 s61, s61, 1
    s_cbranch_scc0 POLL_37
POLLD_38:
    s_mov_b64 exec, -1
FOK_36:
    s_mov_b32 s62, 0x80000
GRE_40:
    v_cmp_ne_u32 vcc, s26, v29
    v_cmp_ne_u32 s[60:61], s26, v31
    s_or_b64 vcc, vcc, s[60:61]
    s_cbranch_scc0 GOK_39
    v_and_b32 v232, 31, v0
    v_lshlrev_b32 v232, 3, v232
    s_sub_u32 s60, s18, 0x600000
    s_lshr_b32 s60, s60, 15
    s_lshl_b32 s60, s60, 8
    s_add_u32 s60, s60, 0xf00000
    s_lshl_b32 s61, s4, 1
    s_add_u32 s61, s61, s13
    s_lshl_b32 s61, s61, 8
    s_add_u32 s61, s61, 0xf00000
    buffer_load_dwordx2 v[28:29], v232, s[28:31], s60 offen sc1
    buffer_load_dwordx2 v[30:31], v232, s[28:31], s61 offen sc1
    s_waitcnt vmcnt(0)
    s_sub_u32 s62, s62, 1
    s_cbranch_scc0 GRE_40
GOK_39:
    v_sub_f32 v30, 1.0, v30
    v_cvt_pk_bf16_f32 v30, v30, v30
    v_lshlrev_b32 v30, 16, v30
    v_exp_f32 v150, v150
    v_exp_f32 v151, v151
    v_cvt_pk_bf16_f32 v226, v148, v149
    v_exp_f32 v152, v152
    v_exp_f32 v153, v153
    v_cvt_pk_bf16_f32 v227, v150, v151
    v_mfma_f32_32x32x16_bf16 v[96:111], v[200:203], v[44:47], v[96:111]
    v_exp_f32 v154, v154
    v_exp_f32 v155, v155
    v_cvt_pk_bf16_f32 v228, v152, v153
    v_exp_f32 v156, v156
    v_mfma_f32_32x32x16_bf16 v[176:191], v[208:211], v[224:227], v[176:191]
    v_exp_f32 v157, v157
    v_cvt_pk_bf16_f32 v229, v154, v155
    v_exp_f32 v158, v158
    v_exp_f32 v159, v159
    v_cvt_pk_bf16_f32 v230, v156, v157
    v_mfma_f32_32x32x16_bf16 v[112:127], v[204:207], v[44:47], v[112:127]
    v_cvt_pk_bf16_f32 v231, v158, v159
    v_exp_f32 v128, v128
    v_exp_f32 v129, v129
    v_mfma_f32_32x32x16_bf16 v[176:191], v[212:215], v[228:231], v[176:191]
    v_exp_f32 v130, v130
    v_exp_f32 v131, v131
    v_cvt_pk_bf16_f32 v224, v128, v129
    v_exp_f32 v132, v132
    v_exp_f32 v133, v133
    v_cvt_pk_bf16_f32 v225, v130, v131
    v_mfma_f32_32x32x16_bf16 v[144:159], v[24:27], v[20:23], v[240:255]
    ds_read_b128 v[24:27], v2 offset:37440
    ds_read_b128 v[208:211], v3 offset:38464
    ds_read_b128 v[212:215], v4 offset:38976
    v_exp_f32 v134, v134
    v_exp_f32 v135, v135
    v_cvt_pk_bf16_f32 v226, v132, v133
    v_exp_f32 v136, v136
    v_exp_f32 v137, v137
    v_cvt_pk_bf16_f32 v227, v134, v135
    v_mfma_f32_32x32x16_bf16 v[64:79], v[192:195], v[48:51], v[64:79]
    v_exp_f32 v138, v138
    v_exp_f32 v139, v139
    v_cvt_pk_bf16_f32 v228, v136, v137
    v_exp_f32 v140, v140
    v_mfma_f32_32x32x16_bf16 v[160:175], v[216:219], v[224:227], v[160:175]
    v_exp_f32 v141, v141
    v_cvt_pk_bf16_f32 v229, v138, v139
    v_exp_f32 v142, v142
    v_exp_f32 v143, v143
    v_cvt_pk_bf16_f32 v230, v140, v141
    v_mfma_f32_32x32x16_bf16 v[80:95], v[196:199], v[48:51], v[80:95]
    v_cvt_pk_bf16_f32 v231, v142, v143
    v_exp_f32 v144, v144
    v_exp_f32 v145, v145
    v_mfma_f32_32x32x16_bf16 v[160:175], v[220:223], v[228:231], v[160:175]
    v_exp_f32 v146, v146
    v_exp_f32 v147, v147
    v_cvt_pk_bf16_f32 v224, v144, v145
    v_exp_f32 v148, v148
    v_exp_f32 v149, v149
    s_waitcnt lgkmcnt(0)
    v_cvt_pk_bf16_f32 v225, v146, v147
    v_mfma_f32_32x32x16_bf16 v[128:143], v[24:27], v[16:19], v[240:255]
    buffer_load_dwordx4 v[40:43], v7, s[28:31], s6 offen offset:1024 sc1
    buffer_load_dwordx4 v[44:47], v13, s[28:31], s6 offen offset:1024 sc1
    v_exp_f32 v150, v150
    v_exp_f32 v151, v151
    v_cvt_pk_bf16_f32 v226, v148, v149
    v_exp_f32 v152, v152
    v_exp_f32 v153, v153
    v_cvt_pk_bf16_f32 v227, v150, v151
    v_mfma_f32_32x32x16_bf16 v[96:111], v[192:195], v[52:55], v[96:111]
    v_exp_f32 v154, v154
    v_exp_f32 v155, v155
    v_cvt_pk_bf16_f32 v228, v152, v153
    v_exp_f32 v156, v156
    v_mfma_f32_32x32x16_bf16 v[176:191], v[216:219], v[224:227], v[176:191]
    v_exp_f32 v157, v157
    v_cvt_pk_bf16_f32 v229, v154, v155
    v_exp_f32 v158, v158
    v_exp_f32 v159, v159
    v_cvt_pk_bf16_f32 v230, v156, v157
    v_cvt_pk_bf16_f32 v231, v158, v159
    s_setprio 2
    v_exp_f32 v128, v128
    v_exp_f32 v129, v129
    v_mfma_f32_32x32x16_bf16 v[176:191], v[220:223], v[228:231], v[176:191]
    v_exp_f32 v130, v130
    v_exp_f32 v131, v131
    v_cvt_pk_bf16_f32 v224, v128, v129
    v_exp_f32 v132, v132
    v_exp_f32 v133, v133
    v_cvt_pk_bf16_f32 v225, v130, v131
    v_mfma_f32_32x32x16_bf16 v[144:159], v[24:27], v[20:23], v[240:255]
    ds_read_b128 v[24:27], v2 offset:39520
    ds_read_b128 v[216:219], v3 offset:40544
    ds_read_b128 v[220:223], v4 offset:41056
    ds_read_b64_tr_b16 v[200:201], v5 offset:6144
    ds_read_b64_tr_b16 v[202:203], v5 offset:7168
    ds_read_b64_tr_b16 v[204:205], v6 offset:6144
    ds_read_b64_tr_b16 v[206:207], v6 offset:7168
    v_exp_f32 v134, v134
    v_exp_f32 v135, v135
    v_cvt_pk_bf16_f32 v226, v132, v133
    v_exp_f32 v136, v136
    v_exp_f32 v137, v137
    v_cvt_pk_bf16_f32 v227, v134, v135
    v_mfma_f32_32x32x16_bf16 v[112:127], v[196:199], v[52:55], v[112:127]
    v_exp_f32 v138, v138
    v_exp_f32 v139, v139
    v_cvt_pk_bf16_f32 v228, v136, v137
    v_exp_f32 v140, v140
    v_mfma_f32_32x32x16_bf16 v[160:175], v[208:211], v[224:227], v[160:175]
    v_exp_f32 v141, v141
    v_cvt_pk_bf16_f32 v229, v138, v139
    v_exp_f32 v142, v142
    v_exp_f32 v143, v143
    v_cvt_pk_bf16_f32 v230, v140, v141
    v_cvt_pk_bf16_f32 v231, v142, v143
    v_exp_f32 v144, v144
    v_exp_f32 v145, v145
    v_mfma_f32_32x32x16_bf16 v[160:175], v[212:215], v[228:231], v[160:175]
    v_exp_f32 v146, v146
    v_exp_f32 v147, v147
    v_cvt_pk_bf16_f32 v224, v144, v145
    v_exp_f32 v148, v148
    v_exp_f32 v149, v149
    s_waitcnt lgkmcnt(0)
    v_cvt_pk_bf16_f32 v225, v146, v147
    v_mfma_f32_32x32x16_bf16 v[128:143], v[24:27], v[16:19], v[240:255]
    s_add_u32 m0, s11, 6144
    s_add_u32 s10, s10, 16384
    buffer_load_dwordx4 v11, s[36:39], s10 offen lds
    buffer_load_dwordx4 v12, s[36:39], s10 offen offset:1024 lds
    v_exp_f32 v150, v150
    v_exp_f32 v151, v151
    v_cvt_pk_bf16_f32 v226, v148, v149
    v_exp_f32 v152, v152
    v_exp_f32 v153, v153
    v_cvt_pk_bf16_f32 v227, v150, v151
    v_mfma_f32_32x32x16_bf16 v[64:79], v[200:203], v[56:59], v[64:79]
    v_exp_f32 v154, v154
    v_exp_f32 v155, v155
    v_cvt_pk_bf16_f32 v228, v152, v153
    v_exp_f32 v156, v156
    v_mfma_f32_32x32x16_bf16 v[176:191], v[208:211], v[224:227], v[176:191]
    v_exp_f32 v157, v157
    v_cvt_pk_bf16_f32 v229, v154, v155
    v_exp_f32 v158, v158
    v_exp_f32 v159, v159
    v_cvt_pk_bf16_f32 v230, v156, v157
    v_mfma_f32_32x32x16_bf16 v[80:95], v[204:207], v[56:59], v[80:95]
    v_cvt_pk_bf16_f32 v231, v158, v159
    v_exp_f32 v128, v128
    v_exp_f32 v129, v129
    v_mfma_f32_32x32x16_bf16 v[176:191], v[212:215], v[228:231], v[176:191]
    v_exp_f32 v130, v130
    v_exp_f32 v131, v131
    v_cvt_pk_bf16_f32 v224, v128, v129
    v_exp_f32 v132, v132
    v_exp_f32 v133, v133
    v_cvt_pk_bf16_f32 v225, v130, v131
    v_mfma_f32_32x32x16_bf16 v[144:159], v[24:27], v[20:23], v[240:255]
    ds_read_b128 v[24:27], v2 offset:41600
    ds_read_b128 v[208:211], v3 offset:42624
    ds_read_b128 v[212:215], v4 offset:43136
    s_waitcnt vmcnt(4)
    ds_read_b64_tr_b16 v[192:193], v5 offset:0
    ds_read_b64_tr_b16 v[194:195], v5 offset:1024
    ds_read_b64_tr_b16 v[196:197], v6 offset:0
    ds_read_b64_tr_b16 v[198:199], v6 offset:1024
    v_exp_f32 v134, v134
    v_exp_f32 v135, v135
    v_cvt_pk_bf16_f32 v226, v132, v133
    v_exp_f32 v136, v136
    v_exp_f32 v137, v137
    v_cvt_pk_bf16_f32 v227, v134, v135
    v_mfma_f32_32x32x16_bf16 v[96:111], v[200:203], v[60:63], v[96:111]
    v_exp_f32 v138, v138
    v_exp_f32 v139, v139
    v_cvt_pk_bf16_f32 v228, v136, v137
    v_exp_f32 v140, v140
    v_mfma_f32_32x32x16_bf16 v[160:175], v[216:219], v[224:227], v[160:175]
    v_exp_f32 v141, v141
    v_cvt_pk_bf16_f32 v229, v138, v139
    v_exp_f32 v142, v142
    v_exp_f32 v143, v143
    v_cvt_pk_bf16_f32 v230, v140, v141
    v_cvt_pk_bf16_f32 v231, v142, v143
    v_exp_f32 v144, v144
    v_exp_f32 v145, v145
    v_mfma_f32_32x32x16_bf16 v[160:175], v[220:223], v[228:231], v[160:175]
    v_exp_f32 v146, v146
    v_exp_f32 v147, v147
    v_cvt_pk_bf16_f32 v224, v144, v145
    v_exp_f32 v148, v148
    v_exp_f32 v149, v149
    s_waitcnt lgkmcnt(0)
    v_cvt_pk_bf16_f32 v225, v146, v147
    v_mfma_f32_32x32x16_bf16 v[128:143], v[24:27], v[16:19], v[240:255]
    s_add_u32 m0, s11, 0
    s_add_u32 s10, s10, 16384
    buffer_load_dwordx4 v11, s[36:39], s10 offen lds
    buffer_load_dwordx4 v12, s[36:39], s10 offen offset:1024 lds
    v_exp_f32 v150, v150
    v_exp_f32 v151, v151
    v_cvt_pk_bf16_f32 v226, v148, v149
    v_exp_f32 v152, v152
    v_exp_f32 v153, v153
    v_cvt_pk_bf16_f32 v227, v150, v151
    v_mfma_f32_32x32x16_bf16 v[112:127], v[204:207], v[60:63], v[112:127]
    v_exp_f32 v154, v154
    v_exp_f32 v155, v155
    v_cvt_pk_bf16_f32 v228, v152, v153
    v_exp_f32 v156, v156
    v_mfma_f32_32x32x16_bf16 v[176:191], v[216:219], v[224:227], v[176:191]
    v_exp_f32 v157, v157
    v_cvt_pk_bf16_f32 v229, v154, v155
    v_exp_f32 v158, v158
    v_exp_f32 v159, v159
    v_cvt_pk_bf16_f32 v230, v156, v157
    v_mfma_f32_32x32x16_bf16 v[64:79], v[192:195], v[32:35], v[64:79]
    v_cvt_pk_bf16_f32 v231, v158, v159
    s_setprio 1
    v_exp_f32 v128, v128
    v_exp_f32 v129, v129
    v_mfma_f32_32x32x16_bf16 v[176:191], v[220:223], v[228:231], v[176:191]
    v_exp_f32 v130, v130
    v_exp_f32 v131, v131
    v_cvt_pk_bf16_f32 v224, v128, v129
    v_exp_f32 v132, v132
    v_exp_f32 v133, v133
    v_cvt_pk_bf16_f32 v225, v130, v131
    v_mfma_f32_32x32x16_bf16 v[144:159], v[24:27], v[20:23], v[240:255]
    ds_read_b128 v[24:27], v2 offset:43680
    ds_read_b128 v[216:219], v3 offset:44704
    ds_read_b128 v[220:223], v4 offset:45216
    v_exp_f32 v134, v134
    v_exp_f32 v135, v135
    v_cvt_pk_bf16_f32 v226, v132, v133
    v_exp_f32 v136, v136
    v_exp_f32 v137, v137
    v_cvt_pk_bf16_f32 v227, v134, v135
    v_mfma_f32_32x32x16_bf16 v[80:95], v[196:199], v[32:35], v[80:95]
    v_exp_f32 v138, v138
    v_exp_f32 v139, v139
    v_cvt_pk_bf16_f32 v228, v136, v137
    v_exp_f32 v140, v140
    v_mfma_f32_32x32x16_bf16 v[160:175], v[208:211], v[224:227], v[160:175]
    v_exp_f32 v141, v141
    v_cvt_pk_bf16_f32 v229, v138, v139
    v_exp_f32 v142, v142
    v_exp_f32 v143, v143
    v_cvt_pk_bf16_f32 v230, v140, v141
    v_cvt_pk_bf16_f32 v231, v142, v143
    v_exp_f32 v144, v144
    v_exp_f32 v145, v145
    v_mfma_f32_32x32x16_bf16 v[160:175], v[212:215], v[228:231], v[160:175]
    v_exp_f32 v146, v146
    v_exp_f32 v147, v147
    v_cvt_pk_bf16_f32 v224, v144, v145
    v_exp_f32 v148, v148
    v_exp_f32 v149, v149
    s_waitcnt lgkmcnt(0)
    v_cvt_pk_bf16_f32 v225, v146, v147
    v_mfma_f32_32x32x16_bf16 v[128:143], v[24:27], v[16:19], v[240:255]
    v_exp_f32 v150, v150
    v_exp_f32 v151, v151
    v_cvt_pk_bf16_f32 v226, v148, v149
    v_exp_f32 v152, v152
    v_exp_f32 v153, v153
    v_cvt_pk_bf16_f32 v227, v150, v151
    v_mfma_f32_32x32x16_bf16 v[96:111], v[192:195], v[36:39], v[96:111]
    v_exp_f32 v154, v154
    v_exp_f32 v155, v155
    v_cvt_pk_bf16_f32 v228, v152, v153
    v_exp_f32 v156, v156
    v_mfma_f32_32x32x16_bf16 v[176:191], v[208:211], v[224:227], v[176:191]
    v_exp_f32 v157, v157
    v_cvt_pk_bf16_f32 v229, v154, v155
    v_exp_f32 v158, v158
    v_exp_f32 v159, v159
    v_cvt_pk_bf16_f32 v230, v156, v157
    v_cvt_pk_bf16_f32 v231, v158, v159
    v_exp_f32 v128, v128
    v_exp_f32 v129, v129
    v_mfma_f32_32x32x16_bf16 v[176:191], v[212:215], v[228:231], v[176:191]
    v_exp_f32 v130, v130
    v_exp_f32 v131, v131
    v_cvt_pk_bf16_f32 v224, v128, v129
    v_exp_f32 v132, v132
    v_exp_f32 v133, v133
    v_cvt_pk_bf16_f32 v225, v130, v131
    v_mfma_f32_32x32x16_bf16 v[144:159], v[24:27], v[20:23], v[240:255]
    ds_read_b128 v[24:27], v2 offset:45760
    ds_read_b128 v[208:211], v3 offset:46784
    ds_read_b128 v[212:215], v4 offset:47296
    s_waitcnt vmcnt(4)
    ds_read_b64_tr_b16 v[200:201], v5 offset:2048
    ds_read_b64_tr_b16 v[202:203], v5 offset:3072
    ds_read_b64_tr_b16 v[204:205], v6 offset:2048
    ds_read_b64_tr_b16 v[206:207], v6 offset:3072
    v_exp_f32 v134, v134
    v_exp_f32 v135, v135
    v_cvt_pk_bf16_f32 v226, v132, v133
    v_exp_f32 v136, v136
    v_exp_f32 v137, v137
    v_cvt_pk_bf16_f32 v227, v134, v135
    v_mfma_f32_32x32x16_bf16 v[112:127], v[196:199], v[36:39], v[112:127]
    v_exp_f32 v138, v138
    v_exp_f32 v139, v139
    v_cvt_pk_bf16_f32 v228, v136, v137
    v_exp_f32 v140, v140
    v_mfma_f32_32x32x16_bf16 v[160:175], v[216:219], v[224:227], v[160:175]
    v_exp_f32 v141, v141
    v_cvt_pk_bf16_f32 v229, v138, v139
    v_exp_f32 v142, v142
    v_exp_f32 v143, v143
    v_cvt_pk_bf16_f32 v230, v140, v141
    v_cvt_pk_bf16_f32 v231, v142, v143
    v_exp_f32 v144, v144
    v_exp_f32 v145, v145
    v_mfma_f32_32x32x16_bf16 v[160:175], v[220:223], v[228:231], v[160:175]
    v_exp_f32 v146, v146
    v_exp_f32 v147, v147
    v_cvt_pk_bf16_f32 v224, v144, v145
    v_exp_f32 v148, v148
    v_exp_f32 v149, v149
    s_waitcnt lgkmcnt(0)
    v_cvt_pk_bf16_f32 v225, v146, v147
    v_mfma_f32_32x32x16_bf16 v[128:143], v[24:27], v[16:19], v[240:255]
    s_add_u32 m0, s11, 2048
    s_add_u32 s10, s10, 16384
    buffer_load_dwordx4 v11, s[36:39], s10 offen lds
    buffer_load_dwordx4 v12, s[36:39], s10 offen offset:1024 lds
    v_exp_f32 v150, v150
    v_exp_f32 v151, v151
    v_cvt_pk_bf16_f32 v226, v148, v149
    v_exp_f32 v152, v152
    v_exp_f32 v153, v153
    v_cvt_pk_bf16_f32 v227, v150, v151
    v_mfma_f32_32x32x16_bf16 v[64:79], v[200:203], v[40:43], v[64:79]
    v_exp_f32 v154, v154
    v_exp_f32 v155, v155
    v_cvt_pk_bf16_f32 v228, v152, v153
    v_exp_f32 v156, v156
    v_mfma_f32_32x32x16_bf16 v[176:191], v[216:219], v[224:227], v[176:191]
    v_exp_f32 v157, v157
    v_cvt_pk_bf16_f32 v229, v154, v155
    v_exp_f32 v158, v158
    v_exp_f32 v159, v159
    v_cvt_pk_bf16_f32 v230, v156, v157
    v_mfma_f32_32x32x16_bf16 v[80:95], v[204:207], v[40:43], v[80:95]
    v_cvt_pk_bf16_f32 v231, v158, v159
    s_setprio 0
    v_exp_f32 v128, v128
    v_exp_f32 v129, v129
    v_mfma_f32_32x32x16_bf16 v[176:191], v[220:223], v[228:231], v[176:191]
    v_exp_f32 v130, v130
    v_exp_f32 v131, v131
    v_cvt_pk_bf16_f32 v224, v128, v129
    v_exp_f32 v132, v132
    v_exp_f32 v133, v133
    v_cvt_pk_bf16_f32 v225, v130, v131
    v_mfma_f32_32x32x16_bf16 v[144:159], v[24:27], v[20:23], v[240:255]
    ds_read_b128 v[24:27], v2 offset:47840
    ds_read_b128 v[216:219], v3 offset:48864
    ds_read_b128 v[220:223], v4 offset:49376
    v_exp_f32 v134, v134
    v_exp_f32 v135, v135
    v_cvt_pk_bf16_f32 v226, v132, v133
    v_exp_f32 v136, v136
    v_exp_f32 v137, v137
    v_cvt_pk_bf16_f32 v227, v134, v135
    v_mfma_f32_32x32x16_bf16 v[96:111], v[200:203], v[44:47], v[96:111]
    v_exp_f32 v138, v138
    v_exp_f32 v139, v139
    v_cvt_pk_bf16_f32 v228, v136, v137
    v_exp_f32 v140, v140
    v_mfma_f32_32x32x16_bf16 v[160:175], v[208:211], v[224:227], v[160:175]
    v_exp_f32 v141, v141
    v_cvt_pk_bf16_f32 v229, v138, v139
    v_exp_f32 v142, v142
    v_exp_f32 v143, v143
    v_cvt_pk_bf16_f32 v230, v140, v141
    v_cvt_pk_bf16_f32 v231, v142, v143
    v_exp_f32 v144, v144
    v_exp_f32 v145, v145
    v_mfma_f32_32x32x16_bf16 v[160:175], v[212:215], v[228:231], v[160:175]
    v_exp_f32 v146, v146
    v_exp_f32 v147, v147
    v_cvt_pk_bf16_f32 v224, v144, v145
    v_exp_f32 v148, v148
    v_exp_f32 v149, v149
    s_waitcnt lgkmcnt(0)
    v_cvt_pk_bf16_f32 v225, v146, v147
    v_mfma_f32_32x32x16_bf16 v[128:143], v[24:27], v[16:19], v[240:255]
    s_lshl_b32 s60, s13, 13
    v_subrev_u32 v5, s60, v5
    v_xor_b32 v6, 64, v5
    v_exp_f32 v150, v150
    v_exp_f32 v151, v151
    v_cvt_pk_bf16_f32 v226, v148, v149
    v_exp_f32 v152, v152
    v_exp_f32 v153, v153
    v_cvt_pk_bf16_f32 v227, v150, v151
    v_mfma_f32_32x32x16_bf16 v[112:127], v[204:207], v[44:47], v[112:127]
    v_exp_f32 v154, v154
    v_exp_f32 v155, v155
    v_cvt_pk_bf16_f32 v228, v152, v153
    v_exp_f32 v156, v156
    v_mfma_f32_32x32x16_bf16 v[176:191], v[208:211], v[224:227], v[176:191]
    v_exp_f32 v157, v157
    v_cvt_pk_bf16_f32 v229, v154, v155
    v_exp_f32 v158, v158
    v_exp_f32 v159, v159
    v_cvt_pk_bf16_f32 v230, v156, v157
    v_cvt_pk_bf16_f32 v231, v158, v159
    v_exp_f32 v128, v128
    v_exp_f32 v129, v129
    v_mfma_f32_32x32x16_bf16 v[176:191], v[212:215], v[228:231], v[176:191]
    v_exp_f32 v130, v130
    v_exp_f32 v131, v131
    v_cvt_pk_bf16_f32 v224, v128, v129
    v_exp_f32 v132, v132
    v_exp_f32 v133, v133
    v_cvt_pk_bf16_f32 v225, v130, v131
    v_mfma_f32_32x32x16_bf16 v[144:159], v[24:27], v[20:23], v[240:255]
    v_exp_f32 v134, v134
    v_exp_f32 v135, v135
    v_cvt_pk_bf16_f32 v226, v132, v133
    v_exp_f32 v136, v136
    v_exp_f32 v137, v137
    v_cvt_pk_bf16_f32 v227, v134, v135
    v_exp_f32 v138, v138
    v_exp_f32 v139, v139
    v_cvt_pk_bf16_f32 v228, v136, v137
    v_exp_f32 v140, v140
    v_mfma_f32_32x32x16_bf16 v[160:175], v[216:219], v[224:227], v[160:175]
    v_exp_f32 v141, v141
    v_cvt_pk_bf16_f32 v229, v138, v139
    v_exp_f32 v142, v142
    v_exp_f32 v143, v143
    v_cvt_pk_bf16_f32 v230, v140, v141
    v_cvt_pk_bf16_f32 v231, v142, v143
    v_exp_f32 v144, v144
    v_exp_f32 v145, v145
    v_mfma_f32_32x32x16_bf16 v[160:175], v[220:223], v[228:231], v[160:175]
    v_exp_f32 v146, v146
    v_exp_f32 v147, v147
    v_cvt_pk_bf16_f32 v224, v144, v145
    v_exp_f32 v148, v148
    v_exp_f32 v149, v149
    s_waitcnt lgkmcnt(0)
    v_cvt_pk_bf16_f32 v225, v146, v147
    v_exp_f32 v150, v150
    v_exp_f32 v151, v151
    v_cvt_pk_bf16_f32 v226, v148, v149
    v_exp_f32 v152, v152
    v_exp_f32 v153, v153
    v_cvt_pk_bf16_f32 v227, v150, v151
    v_exp_f32 v154, v154
    v_exp_f32 v155, v155
    v_cvt_pk_bf16_f32 v228, v152, v153
    ds_write_b128 v8, v[160:163]
    ds_write_b128 v8, v[164:167] offset:1024
    v_lshrrev_b32 v232, 2, v1
    v_sub_u32 v233, v8, v1
    v_add_u32 v233, v233, v232
    ds_write_b32 v233, v168 offset:2048
    v_sub_u32 v234, v9, v1
    v_add_u32 v234, v234, v232
    v_exp_f32 v156, v156
    v_mfma_f32_32x32x16_bf16 v[176:191], v[216:219], v[224:227], v[176:191]
    v_exp_f32 v157, v157
    v_cvt_pk_bf16_f32 v229, v154, v155
    v_exp_f32 v158, v158
    v_exp_f32 v159, v159
    v_cvt_pk_bf16_f32 v230, v156, v157
    v_cvt_pk_bf16_f32 v231, v158, v159
    s_nop 1
    v_mfma_f32_32x32x16_bf16 v[176:191], v[220:223], v[228:231], v[176:191]
    s_lshl_b32 s60, s27, 13
    s_add_u32 s60, s60, 32768
    v_add_u32 v2, s60, v1
    v_xor_b32 v4, 0x2000, v2
    s_cmp_lg_u32 s52, 0
    s_cbranch_scc1 XW_41
    ds_write_b128 v2, v[64:67] offset:0
    ds_write_b128 v2, v[68:71] offset:1024
    ds_write_b128 v2, v[72:75] offset:2048
    ds_write_b128 v2, v[76:79] offset:3072
    ds_write_b128 v2, v[80:83] offset:4096
    ds_write_b128 v2, v[84:87] offset:5120
    ds_write_b128 v2, v[88:91] offset:6144
    ds_write_b128 v2, v[92:95] offset:7168
XW_41:
    s_waitcnt vmcnt(0) lgkmcnt(0)
    s_barrier
    ds_read_b128 v[128:131], v9
    ds_read_b128 v[132:135], v9 offset:1024
    ds_read_b32 v136, v234 offset:2048
    s_mov_b32 s62, 0x5d800000
    s_mov_b32 s63, 0x7e800000
    s_nop 1
    s_waitcnt lgkmcnt(0)
    v_add_f32 v176, v176, v128
    v_add_f32 v177, v177, v129
    v_add_f32 v178, v178, v130
    v_add_f32 v179, v179, v131
    v_add_f32 v180, v180, v132
    v_add_f32 v181, v181, v133
    v_add_f32 v182, v182, v134
    v_add_f32 v183, v183, v135
    v_add_f32 v184, v184, v136
    v_add_f32 v232, |v176|, |v177|
    v_add_f32 v233, |v178|, |v179|
    v_add_f32 v234, |v180|, |v181|
    v_add_f32 v235, |v182|, |v183|
    v_add_f32 v232, v232, v233
    v_add_f32 v234, v234, v235
    v_cmp_nlt_f32 vcc, v184, s62
    v_add_f32 v232, v232, v234
    v_cmp_nlt_f32 s[60:61], v232, s63
    s_or_b64 vcc, vcc, s[60:61]
    s_cbranch_scc1 ATT_fallback_42
ATT_fin_43:
    v_rcp_f32 v232, v184
    s_nop 0
    v_mul_f32 v232, v232, v28
    v_mul_f32 v176, v176, v232
    v_mul_f32 v177, v177, v232
    v_mul_f32 v178, v178, v232
    v_mul_f32 v179, v179, v232
    v_mul_f32 v180, v180, v232
    v_mul_f32 v181, v181, v232
    v_mul_f32 v182, v182, v232
    v_mul_f32 v183, v183, v232
    v_cvt_pk_bf16_f32 v224, v176, v177
    v_cvt_pk_bf16_f32 v225, v178, v179
    v_cvt_pk_bf16_f32 v226, v180, v181
    v_cvt_pk_bf16_f32 v227, v182, v183
    v_min_u32 v224, -2, v224
    v_min_u32 v225, -2, v225
    v_min_u32 v226, -2, v226
    v_min_u32 v227, -2, v227
    buffer_store_dwordx4 v[224:227], v1, s[28:31], s18 offen sc1
    s_cmp_eq_u32 s52, 0
    s_cbranch_scc1 K1_44
    ds_write_b128 v2, v[64:67] offset:0
    ds_write_b128 v2, v[68:71] offset:1024
    ds_write_b128 v2, v[72:75] offset:2048
    ds_write_b128 v2, v[76:79] offset:3072
    ds_write_b128 v2, v[80:83] offset:4096
    ds_write_b128 v2, v[84:87] offset:5120
    ds_write_b128 v2, v[88:91] offset:6144
    ds_write_b128 v2, v[92:95] offset:7168
    s_branch K2_45
K1_44:
    ds_read_b128 v[64:67], v4 offset:0
    ds_read_b128 v[68:71], v4 offset:1024
    ds_read_b128 v[72:75], v4 offset:2048
    ds_read_b128 v[76:79], v4 offset:3072
    ds_read_b128 v[80:83], v4 offset:4096
    ds_read_b128 v[84:87], v4 offset:5120
    ds_read_b128 v[88:91], v4 offset:6144
    ds_read_b128 v[92:95], v4 offset:7168
K2_45:
    v_mul_f32 v96, v96, v30
    v_mul_f32 v97, v97, v30
    v_mul_f32 v98, v98, v30
    v_mul_f32 v99, v99, v30
    v_mul_f32 v100, v100, v30
    v_mul_f32 v101, v101, v30
    v_mul_f32 v102, v102, v30
    v_mul_f32 v103, v103, v30
    v_mul_f32 v104, v104, v30
    v_mul_f32 v105, v105, v30
    v_mul_f32 v106, v106, v30
    v_mul_f32 v107, v107, v30
    v_mul_f32 v108, v108, v30
    v_mul_f32 v109, v109, v30
    v_mul_f32 v110, v110, v30
    v_mul_f32 v111, v111, v30
    v_mul_f32 v112, v112, v30
    v_mul_f32 v113, v113, v30
    v_mul_f32 v114, v114, v30
    v_mul_f32 v115, v115, v30
    v_mul_f32 v116, v116, v30
    v_mul_f32 v117, v117, v30
    v_mul_f32 v118, v118, v30
    v_mul_f32 v119, v119, v30
    v_mul_f32 v120, v120, v30
    v_mul_f32 v121, v121, v30
    v_mul_f32 v122, v122, v30
    v_mul_f32 v123, v123, v30
    v_mul_f32 v124, v124, v30
    v_mul_f32 v125, v125, v30
    v_mul_f32 v126, v126, v30
    v_mul_f32 v127, v127, v30
    s_mov_b32 s62, 0x80000
    s_waitcnt lgkmcnt(0)
    s_barrier
    s_cmp_eq_u32 s52, 0
    s_cbranch_scc1 K3_46
    ds_read_b128 v[64:67], v4 offset:0
    ds_read_b128 v[68:71], v4 offset:1024
    ds_read_b128 v[72:75], v4 offset:2048
    ds_read_b128 v[76:79], v4 offset:3072
    ds_read_b128 v[80:83], v4 offset:4096
    ds_read_b128 v[84:87], v4 offset:5120
    ds_read_b128 v[88:91], v4 offset:6144
    ds_read_b128 v[92:95], v4 offset:7168
K3_46:
    buffer_load_dwordx4 v[32:35], v1, s[28:31], s54 offen offset:0 sc1
    buffer_load_dwordx4 v[36:39], v1, s[28:31], s54 offen offset:1024 sc1
    s_waitcnt lgkmcnt(7)
    v_fma_f32 v96, v64, v30, v96
    v_fma_f32 v97, v65, v30, v97
    v_fma_f32 v98, v66, v30, v98
    v_fma_f32 v99, v67, v30, v99
    s_waitcnt lgkmcnt(6)
    v_fma_f32 v100, v68, v30, v100
    v_fma_f32 v101, v69, v30, v101
    v_fma_f32 v102, v70, v30, v102
    v_fma_f32 v103, v71, v30, v103
    s_waitcnt lgkmcnt(5)
    v_fma_f32 v104, v72, v30, v104
    v_fma_f32 v105, v73, v30, v105
    v_fma_f32 v106, v74, v30, v106
    v_fma_f32 v107, v75, v30, v107
    s_waitcnt lgkmcnt(4)
    v_fma_f32 v108, v76, v30, v108
    v_fma_f32 v109, v77, v30, v109
    v_fma_f32 v110, v78, v30, v110
    v_fma_f32 v111, v79, v30, v111
    s_waitcnt lgkmcnt(3)
    v_fma_f32 v112, v80, v30, v112
    v_fma_f32 v113, v81, v30, v113
    v_fma_f32 v114, v82, v30, v114
    v_fma_f32 v115, v83, v30, v115
    s_waitcnt lgkmcnt(2)
    v_fma_f32 v116, v84, v30, v116
    v_fma_f32 v117, v85, v30, v117
    v_fma_f32 v118, v86, v30, v118
    v_fma_f32 v119, v87, v30, v119
    s_waitcnt lgkmcnt(1)
    v_fma_f32 v120, v88, v30, v120
    v_fma_f32 v121, v89, v30, v121
    v_fma_f32 v122, v90, v30, v122
    v_fma_f32 v123, v91, v30, v123
    s_waitcnt lgkmcnt(0)
    v_fma_f32 v124, v92, v30, v124
    v_fma_f32 v125, v93, v30, v125
    v_fma_f32 v126, v94, v30, v126
    v_fma_f32 v127, v95, v30, v127
    ds_read_b64_tr_b16 v[128:129], v5 offset:4096
    ds_read_b64_tr_b16 v[130:131], v5 offset:5120
    ds_read_b64_tr_b16 v[132:133], v6 offset:4096
    ds_read_b64_tr_b16 v[134:135], v6 offset:5120
    buffer_load_dwordx4 v[40:43], v1, s[28:31], s54 offen offset:2048 sc1
    ds_read_b64_tr_b16 v[136:137], v5 offset:6144
    ds_read_b64_tr_b16 v[138:139], v5 offset:7168
    ds_read_b64_tr_b16 v[140:141], v6 offset:6144
    ds_read_b64_tr_b16 v[142:143], v6 offset:7168
    buffer_load_dwordx4 v[44:47], v1, s[28:31], s54 offen offset:3072 sc1
    s_waitcnt lgkmcnt(6)
    ds_read_b64_tr_b16 v[144:145], v5 offset:0
    ds_read_b64_tr_b16 v[146:147], v5 offset:1024
    ds_read_b64_tr_b16 v[148:149], v6 offset:0
    ds_read_b64_tr_b16 v[150:151], v6 offset:1024
    buffer_load_dwordx4 v[48:51], v1, s[28:31], s55 offen offset:0 sc1
    ds_read_b64_tr_b16 v[152:153], v5 offset:2048
    ds_read_b64_tr_b16 v[154:155], v5 offset:3072
    ds_read_b64_tr_b16 v[156:157], v6 offset:2048
    ds_read_b64_tr_b16 v[158:159], v6 offset:3072
    buffer_load_dwordx4 v[52:55], v1, s[28:31], s55 offen offset:1024 sc1
    s_waitcnt lgkmcnt(6)
    ds_read_b64_tr_b16 v[160:161], v5 offset:12288
    ds_read_b64_tr_b16 v[162:163], v5 offset:13312
    ds_read_b64_tr_b16 v[164:165], v6 offset:12288
    ds_read_b64_tr_b16 v[166:167], v6 offset:13312
    buffer_load_dwordx4 v[56:59], v1, s[28:31], s55 offen offset:2048 sc1
    ds_read_b64_tr_b16 v[168:169], v5 offset:14336
    ds_read_b64_tr_b16 v[170:171], v5 offset:15360
    ds_read_b64_tr_b16 v[172:173], v6 offset:14336
    ds_read_b64_tr_b16 v[174:175], v6 offset:15360
    buffer_load_dwordx4 v[60:63], v1, s[28:31], s55 offen offset:3072 sc1
    s_waitcnt lgkmcnt(6)
    ds_read_b64_tr_b16 v[176:177], v5 offset:8192
    ds_read_b64_tr_b16 v[178:179], v5 offset:9216
    ds_read_b64_tr_b16 v[180:181], v6 offset:8192
    ds_read_b64_tr_b16 v[182:183], v6 offset:9216
    ds_read_b64_tr_b16 v[184:185], v5 offset:10240
    ds_read_b64_tr_b16 v[186:187], v5 offset:11264
    ds_read_b64_tr_b16 v[188:189], v6 offset:10240
    ds_read_b64_tr_b16 v[190:191], v6 offset:11264
    v_and_b32 v232, 31, v0
    v_lshlrev_b32 v232, 10, v232
    v_lshrrev_b32 v233, 5, v0
    v_lshl_add_u32 v3, v233, 4, v232
    s_lshl_b32 s60, s13, 16
    s_add_u32 s60, s60, 0x8000
    s_xor_b32 s61, s14, 0
    s_mul_i32 s61, s61, 6144
    s_add_u32 s61, s61, s60
    v_add_u32 v236, s61, v1
    s_xor_b32 s61, s14, 1
    s_mul_i32 s61, s61, 6144
    s_add_u32 s61, s61, s60
    v_add_u32 v237, s61, v1
    s_xor_b32 s61, s14, 2
    s_mul_i32 s61, s61, 6144
    s_add_u32 s61, s61, s60
    v_add_u32 v238, s61, v1
    s_xor_b32 s61, s14, 3
    s_mul_i32 s61, s61, 6144
    s_add_u32 s61, s61, s60
    v_add_u32 v239, s61, v1
    s_waitcnt lgkmcnt(0)
    s_waitcnt vmcnt(7)
XR_47:
    v_max3_u32 v232, v32, v33, v34
    v_max_u32 v232, v232, v35
    v_cmp_eq_u32 vcc, -1, v232
    s_cbranch_vccnz XT_49
XO_48:
    v_mfma_f32_32x32x16_bf16 v[96:111], v[128:131], v[32:35], v[96:111]
    v_mfma_f32_32x32x16_bf16 v[112:127], v[132:135], v[32:35], v[112:127]
    s_waitcnt vmcnt(6)
XR_50:
    v_max3_u32 v232, v36, v37, v38
    v_max_u32 v232, v232, v39
    v_cmp_eq_u32 vcc, -1, v232
    s_cbranch_vccnz XT_52
XO_51:
    v_mfma_f32_32x32x16_bf16 v[96:111], v[136:139], v[36:39], v[96:111]
    v_mfma_f32_32x32x16_bf16 v[112:127], v[140:143], v[36:39], v[112:127]
    s_waitcnt vmcnt(5)
XR_53:
    v_max3_u32 v232, v40, v41, v42
    v_max_u32 v232, v232, v43
    v_cmp_eq_u32 vcc, -1, v232
    s_cbranch_vccnz XT_55
XO_54:
    v_mfma_f32_32x32x16_bf16 v[96:111], v[144:147], v[40:43], v[96:111]
    v_mfma_f32_32x32x16_bf16 v[112:127], v[148:151], v[40:43], v[112:127]
    s_waitcnt vmcnt(4)
XR_56:
    v_max3_u32 v232, v44, v45, v46
    v_max_u32 v232, v232, v47
    v_cmp_eq_u32 vcc, -1, v232
    s_cbranch_vccnz XT_58
XO_57:
    v_mfma_f32_32x32x16_bf16 v[96:111], v[152:155], v[44:47], v[96:111]
    v_mfma_f32_32x32x16_bf16 v[112:127], v[156:159], v[44:47], v[112:127]
    s_waitcnt vmcnt(3)
XR_59:
    v_max3_u32 v232, v48, v49, v50
    v_max_u32 v232, v232, v51
    v_cmp_eq_u32 vcc, -1, v232
    s_cbranch_vccnz XT_61
XO_60:
    v_mfma_f32_32x32x16_bf16 v[96:111], v[160:163], v[48:51], v[96:111]
    v_mfma_f32_32x32x16_bf16 v[112:127], v[164:167], v[48:51], v[112:127]
    s_waitcnt vmcnt(2)
XR_62:
    v_max3_u32 v232, v52, v53, v54
    v_max_u32 v232, v232, v55
    v_cmp_eq_u32 vcc, -1, v232
    s_cbranch_vccnz XT_64
XO_63:
    v_mfma_f32_32x32x16_bf16 v[96:111], v[168:171], v[52:55], v[96:111]
    v_mfma_f32_32x32x16_bf16 v[112:127], v[172:175], v[52:55], v[112:127]
    s_waitcnt vmcnt(1)
XR_65:
    v_max3_u32 v232, v56, v57, v58
    v_max_u32 v232, v232, v59
    v_cmp_eq_u32 vcc, -1, v232
    s_cbranch_vccnz XT_67
XO_66:
    v_mfma_f32_32x32x16_bf16 v[96:111], v[176:179], v[56:59], v[96:111]
    v_mfma_f32_32x32x16_bf16 v[112:127], v[180:183], v[56:59], v[112:127]
    s_waitcnt vmcnt(0)
XR_68:
    v_max3_u32 v232, v60, v61, v62
    v_max_u32 v232, v232, v63
    v_cmp_eq_u32 vcc, -1, v232
    s_cbranch_vccnz XT_70
XO_69:
    v_mfma_f32_32x32x16_bf16 v[96:111], v[184:187], v[60:63], v[96:111]
    v_mfma_f32_32x32x16_bf16 v[112:127], v[188:191], v[60:63], v[112:127]
    s_nop 7
    s_nop 1
    ds_write_b128 v237, v[104:107] offset:0
    ds_write_b128 v237, v[108:111] offset:1024
    ds_write_b128 v238, v[112:115] offset:2048
    ds_write_b128 v238, v[116:119] offset:3072
    ds_write_b128 v239, v[120:123] offset:4096
    ds_write_b128 v239, v[124:127] offset:5120
    s_waitcnt lgkmcnt(0)
    s_barrier
    ds_read_b128 v[32:35], v236 offset:0
    ds_read_b128 v[36:39], v236 offset:1024
    ds_read_b128 v[40:43], v236 offset:2048
    ds_read_b128 v[44:47], v236 offset:3072
    ds_read_b128 v[48:51], v236 offset:4096
    ds_read_b128 v[52:55], v236 offset:5120
    s_waitcnt lgkmcnt(4)
    v_add_f32 v96, v96, v32
    v_add_f32 v97, v97, v33
    v_add_f32 v98, v98, v34
    v_add_f32 v99, v99, v35
    v_add_f32 v100, v100, v36
    v_add_f32 v101, v101, v37
    v_add_f32 v102, v102, v38
    v_add_f32 v103, v103, v39
    s_waitcnt lgkmcnt(2)
    v_add_f32 v96, v96, v40
    v_add_f32 v97, v97, v41
    v_add_f32 v98, v98, v42
    v_add_f32 v99, v99, v43
    v_add_f32 v100, v100, v44
    v_add_f32 v101, v101, v45
    v_add_f32 v102, v102, v46
    v_add_f32 v103, v103, v47
    s_waitcnt lgkmcnt(0)
    v_add_f32 v96, v96, v48
    v_add_f32 v97, v97, v49
    v_add_f32 v98, v98, v50
    v_add_f32 v99, v99, v51
    v_add_f32 v100, v100, v52
    v_add_f32 v101, v101, v53
    v_add_f32 v102, v102, v54
    v_add_f32 v103, v103, v55
    v_cvt_pk_bf16_f32 v24, v96, v97
    v_cvt_pk_bf16_f32 v25, v98, v99
    v_cvt_pk_bf16_f32 v26, v100, v101
    v_cvt_pk_bf16_f32 v27, v102, v103
    s_nop 1
    v_permlane32_swap_b32 v24, v26
    v_permlane32_swap_b32 v25, v27
    buffer_store_dwordx4 v[24:27], v3, s[40:43], s56 offen
    s_endpgm
XT_49:
    buffer_load_dwordx4 v[32:35], v1, s[28:31], s54 offen offset:0 sc1
    buffer_load_dwordx4 v[36:39], v1, s[28:31], s54 offen offset:1024 sc1
    buffer_load_dwordx4 v[40:43], v1, s[28:31], s54 offen offset:2048 sc1
    buffer_load_dwordx4 v[44:47], v1, s[28:31], s54 offen offset:3072 sc1
    s_waitcnt vmcnt(0)
    s_sub_u32 s62, s62, 1
    s_cbranch_scc0 XR_47
    s_branch XO_48
XT_52:
    buffer_load_dwordx4 v[36:39], v1, s[28:31], s54 offen offset:1024 sc1
    buffer_load_dwordx4 v[40:43], v1, s[28:31], s54 offen offset:2048 sc1
    buffer_load_dwordx4 v[44:47], v1, s[28:31], s54 offen offset:3072 sc1
    buffer_load_dwordx4 v[48:51], v1, s[28:31], s55 offen offset:0 sc1
    s_waitcnt vmcnt(0)
    s_sub_u32 s62, s62, 1
    s_cbranch_scc0 XR_50
    s_branch XO_51
XT_55:
    buffer_load_dwordx4 v[40:43], v1, s[28:31], s54 offen offset:2048 sc1
    buffer_load_dwordx4 v[44:47], v1, s[28:31], s54 offen offset:3072 sc1
    buffer_load_dwordx4 v[48:51], v1, s[28:31], s55 offen offset:0 sc1
    buffer_load_dwordx4 v[52:55], v1, s[28:31], s55 offen offset:1024 sc1
    s_waitcnt vmcnt(0)
    s_sub_u32 s62, s62, 1
    s_cbranch_scc0 XR_53
    s_branch XO_54
XT_58:
    buffer_load_dwordx4 v[44:47], v1, s[28:31], s54 offen offset:3072 sc1
    buffer_load_dwordx4 v[48:51], v1, s[28:31], s55 offen offset:0 sc1
    buffer_load_dwordx4 v[52:55], v1, s[28:31], s55 offen offset:1024 sc1
    buffer_load_dwordx4 v[56:59], v1, s[28:31], s55 offen offset:2048 sc1
    s_waitcnt vmcnt(0)
    s_sub_u32 s62, s62, 1
    s_cbranch_scc0 XR_56
    s_branch XO_57
XT_61:
    buffer_load_dwordx4 v[48:51], v1, s[28:31], s55 offen offset:0 sc1
    buffer_load_dwordx4 v[52:55], v1, s[28:31], s55 offen offset:1024 sc1
    buffer_load_dwordx4 v[56:59], v1, s[28:31], s55 offen offset:2048 sc1
    buffer_load_dwordx4 v[60:63], v1, s[28:31], s55 offen offset:3072 sc1
    s_waitcnt vmcnt(0)
    s_sub_u32 s62, s62, 1
    s_cbranch_scc0 XR_59
    s_branch XO_60
XT_64:
    buffer_load_dwordx4 v[52:55], v1, s[28:31], s55 offen offset:1024 sc1
    buffer_load_dwordx4 v[56:59], v1, s[28:31], s55 offen offset:2048 sc1
    buffer_load_dwordx4 v[60:63], v1, s[28:31], s55 offen offset:3072 sc1
    s_waitcnt vmcnt(0)
    s_sub_u32 s62, s62, 1
    s_cbranch_scc0 XR_62
    s_branch XO_63
XT_67:
    buffer_load_dwordx4 v[56:59], v1, s[28:31], s55 offen offset:2048 sc1
    buffer_load_dwordx4 v[60:63], v1, s[28:31], s55 offen offset:3072 sc1
    s_waitcnt vmcnt(0)
    s_sub_u32 s62, s62, 1
    s_cbranch_scc0 XR_65
    s_branch XO_66
XT_70:
    buffer_load_dwordx4 v[60:63], v1, s[28:31], s55 offen offset:3072 sc1
    s_waitcnt vmcnt(0)
    s_sub_u32 s62, s62, 1
    s_cbranch_scc0 XR_68
    s_branch XO_69
ATT_fallback_42:
    s_lshl_b32 s63, s64, 17
    s_add_u32 s63, s63, 0x200000
    v_mov_b32 v232, 0xff800000
    s_mov_b32 s60, s63
    s_mov_b32 s61, 0
ATT_fb1_71:
    buffer_load_dwordx4 v[24:27], v1, s[28:31], s60 offen sc1
    s_waitcnt vmcnt(0)
    v_mfma_f32_32x32x16_bf16 v[128:143], v[24:27], v[20:23], 0
    s_nop 7
    s_nop 7
    v_max3_f32 v232, v232, v128, v129
    v_max3_f32 v232, v232, v130, v131
    v_max3_f32 v232, v232, v132, v133
    v_max3_f32 v232, v232, v134, v135
    v_max3_f32 v232, v232, v136, v137
    v_max3_f32 v232, v232, v138, v139
    v_max3_f32 v232, v232, v140, v141
    v_max3_f32 v232, v232, v142, v143
    s_add_u32 s60, s60, 2048
    s_add_u32 s61, s61, 1
    s_cmp_lt_u32 s61, 64
    s_cbranch_scc1 ATT_fb1_71
    v_mov_b32 v234, v232
    s_nop 1
    v_permlane32_swap_b32 v232, v234
    s_nop 1
    v_max_f32 v232, v232, v234
    v_sub_f32 v240, 0, v232
    v_mov_b32 v176, 0
    v_sub_f32 v241, 0, v232
    v_mov_b32 v177, 0
    v_sub_f32 v242, 0, v232
    v_mov_b32 v178, 0
    v_sub_f32 v243, 0, v232
    v_mov_b32 v179, 0
    v_sub_f32 v244, 0, v232
    v_mov_b32 v180, 0
    v_sub_f32 v245, 0, v232
    v_mov_b32 v181, 0
    v_sub_f32 v246, 0, v232
    v_mov_b32 v182, 0
    v_sub_f32 v247, 0, v232
    v_mov_b32 v183, 0
    v_sub_f32 v248, 0, v232
    v_mov_b32 v184, 0
    v_sub_f32 v249, 0, v232
    v_mov_b32 v185, 0
    v_sub_f32 v250, 0, v232
    v_mov_b32 v186, 0
    v_sub_f32 v251, 0, v232
    v_mov_b32 v187, 0
    v_sub_f32 v252, 0, v232
    v_mov_b32 v188, 0
    v_sub_f32 v253, 0, v232
    v_mov_b32 v189, 0
    v_sub_f32 v254, 0, v232
    v_mov_b32 v190, 0
    v_sub_f32 v255, 0, v232
    v_mov_b32 v191, 0
    v_lshrrev_b32 v232, 5, v0
    v_lshlrev_b32 v232, 8, v232
    v_and_b32 v233, 15, v0
    v_lshl_add_u32 v3, v233, 4, v232
    s_mov_b32 s60, s63
    s_mov_b32 s61, 0
ATT_fb2_72:
    buffer_load_dwordx4 v[24:27], v1, s[28:31], s60 offen sc1
    s_mov_b64 exec, s[0:1]
    buffer_load_dwordx4 v[208:211], v3, s[28:31], s60 offen offset:1024 sc1
    buffer_load_dwordx4 v[212:215], v3, s[28:31], s60 offen offset:1536 sc1
    s_mov_b64 exec, -1
    s_waitcnt vmcnt(0)
    v_mfma_f32_32x32x16_bf16 v[128:143], v[24:27], v[20:23], v[240:255]
    s_nop 7
    s_nop 7
    v_exp_f32 v128, v128
    v_exp_f32 v129, v129
    v_exp_f32 v130, v130
    v_exp_f32 v131, v131
    v_exp_f32 v132, v132
    v_exp_f32 v133, v133
    v_exp_f32 v134, v134
    v_exp_f32 v135, v135
    v_exp_f32 v136, v136
    v_exp_f32 v137, v137
    v_exp_f32 v138, v138
    v_exp_f32 v139, v139
    v_exp_f32 v140, v140
    v_exp_f32 v141, v141
    v_exp_f32 v142, v142
    v_exp_f32 v143, v143
    s_nop 0
    v_cvt_pk_bf16_f32 v224, v128, v129
    v_cvt_pk_bf16_f32 v225, v130, v131
    v_cvt_pk_bf16_f32 v226, v132, v133
    v_cvt_pk_bf16_f32 v227, v134, v135
    v_cvt_pk_bf16_f32 v228, v136, v137
    v_cvt_pk_bf16_f32 v229, v138, v139
    v_cvt_pk_bf16_f32 v230, v140, v141
    v_cvt_pk_bf16_f32 v231, v142, v143
    s_nop 1
    v_mfma_f32_32x32x16_bf16 v[176:191], v[208:211], v[224:227], v[176:191]
    v_mfma_f32_32x32x16_bf16 v[176:191], v[212:215], v[228:231], v[176:191]
    s_nop 7
    s_nop 7
    s_add_u32 s60, s60, 2048
    s_add_u32 s61, s61, 1
    s_cmp_lt_u32 s61, 64
    s_cbranch_scc1 ATT_fb2_72
    s_branch ATT_fin_43
K_end:
K_end_x:
    s_endpgm
.section .rodata,"a"
.p2align 6
.amdhsa_kernel gated_mix__softmax_full_mha__glu_gated_bilinear__prompt_kernel
  .amdhsa_next_free_vgpr 256
  .amdhsa_next_free_sgpr 102
  .amdhsa_accum_offset 256
  .amdhsa_group_segment_fixed_size 0
  .amdhsa_kernarg_size 88
  .amdhsa_user_sgpr_count 2
  .amdhsa_user_sgpr_kernarg_segment_ptr 1
  .amdhsa_system_sgpr_workgroup_id_x 1
.end_amdhsa_kernel
```
